```python
import torch

def _softmax(x, axis=-1):
    return torch.softmax(x, dim=axis)

def _gelu(x):
    return torch.nn.functional.gelu(x, approximate='tanh')

def _silu(x):
    return torch.nn.functional.silu(x)

def _sigmoid(x):
    return torch.sigmoid(x)

def _layernorm(x, axis=-1, eps=1e-05):
    m = x.mean(dim=axis, keepdim=True)
    v = x.var(dim=axis, keepdim=True, unbiased=False)
    return (x - m) / torch.sqrt(v + eps)

def _scatter_add(tgt, idx, src, axis=0):
    return tgt.clone().index_add_(axis, idx, src)

def _segment_sum(src, seg, n):
    out = torch.zeros((n,) + src.shape[1:], dtype=src.dtype)
    return out.index_add_(0, seg, src)

def _pad(x, pw):
    flat = tuple((v for pair in reversed(pw) for v in pair))
    return torch.nn.functional.pad(x, flat)
kernel_name = 'adaLN_cond__mha_block_cached__glu_gated_reglu__prompt'

def setup_inputs():

    _w = lambda a: (lambda t: t.to(torch.bfloat16) if t.is_floating_point() else t)(torch.as_tensor(a))

    def _A_setup():
        B, Sq, D = (1, 2048, 640)
        H, Sk, Dh = (32, 2048, 128)
        return {'x': _w((lambda *s: torch.randn(*s, dtype=torch.bfloat16) * 0.05)(B, Sq, D)), 'k_cache': _w((lambda *s: torch.randn(*s, dtype=torch.bfloat16) * 1.6)(B, H, Sk, Dh)), 'v_cache': _w((lambda *s: torch.randn(*s, dtype=torch.bfloat16) * 0.8)(B, H, Sk, Dh)), 'wq': _w((lambda *s: torch.randn(*s, dtype=torch.bfloat16) * 1.6)(D, H * Dh) * D ** (-0.5)), 'wo': _w((lambda *s: torch.randn(*s, dtype=torch.bfloat16) * 0.8)(H * Dh, D) * (H * Dh) ** (-0.5))}
    _A_in = _A_setup()

    def _B_setup():
        B, S, D, F = (1, 2048, 640, 1728)
        return {'x': _w((lambda *s: torch.randn(*s, dtype=torch.bfloat16) * 0.05)(B, S, D)), 'W_gate': _w((lambda *s: torch.randn(*s, dtype=torch.bfloat16) * 0.4)(D, F) * (2.0 / D) ** 0.5), 'W_up': _w((lambda *s: torch.randn(*s, dtype=torch.bfloat16) * 0.4)(D, F) * (2.0 / D) ** 0.5), 'W_down': _w((lambda *s: torch.randn(*s, dtype=torch.bfloat16) * 0.4)(F, D) * (1.0 / F) ** 0.5)}
    _B_in = _B_setup()
    return {'A_x': _A_in['x'], 'A_k_cache': _A_in['k_cache'], 'A_v_cache': _A_in['v_cache'], 'A_wq': _A_in['wq'], 'A_wo': _A_in['wo'], 'B_x': _B_in['x'], 'B_W_gate': _B_in['W_gate'], 'B_W_up': _B_in['W_up'], 'B_W_down': _B_in['W_down'], 'c': _w((lambda *s: torch.randn(*s, dtype=torch.bfloat16) * 0.2)(1, 640) * 8.0), 'w_mod': _w((lambda *s: torch.randn(*s, dtype=torch.bfloat16) * 0.2)(640, 6 * 640) * 640 ** (-0.5) * 8.0)}

def reference(A_x, A_k_cache, A_v_cache, A_wq, A_wo, B_x, B_W_gate, B_W_up, B_W_down, c, w_mod):

    def _A_ref(x, k_cache, v_cache, wq, wo):
        B, Sq, D = x.shape
        H, Dh = (32, 128)
        q = (lambda x, *d: x.permute(*d))((x @ wq).reshape(B, Sq, H, Dh), 0, 2, 1, 3)
        scores = torch.einsum('bhqd,bhkd->bhqk', q, k_cache) * Dh ** (-0.5)
        p = _softmax(scores, axis=-1)
        o = torch.einsum('bhqk,bhkd->bhqd', p, v_cache)
        return (lambda x, *d: x.permute(*d))(o, 0, 2, 1, 3).reshape(B, Sq, H * Dh) @ wo

    def _B_ref(x, W_gate, W_up, W_down):
        gate = torch.einsum('bsd,df->bsf', x, W_gate)
        up = torch.einsum('bsd,df->bsf', x, W_up)
        gate = gate * (lambda x, dt: x.to(dt))(gate > 0, gate.dtype)
        h = gate * up
        return torch.einsum('bsf,fd->bsd', h, W_down)
    x = A_x
    mod = (_silu(c) @ w_mod).reshape(c.shape[0], 6, 1, -1)
    sa, ca, ga, sb, cb, gb = (mod[:, 0].clone(), mod[:, 1].clone(), mod[:, 2].clone(), mod[:, 3].clone(), mod[:, 4].clone(), mod[:, 5].clone())
    h = _layernorm(x, axis=-1) * (1 + ca) + sa
    x = x + ga * _A_ref(h, A_k_cache, A_v_cache, A_wq, A_wo)
    h = _layernorm(x, axis=-1) * (1 + cb) + sb
    x = x + gb * _B_ref(h, B_W_gate, B_W_up, B_W_down)
    return x
```

```asm
; @launch grid=(256,1,1) block=(256,1,1) lds=163840
.amdgcn_target "amdgcn-amd-amdhsa--gfx950"
.text
.globl adaLN_cond__mha_block_cached__glu_gated_reglu__prompt_kernel
.p2align 8
.type adaLN_cond__mha_block_cached__glu_gated_reglu__prompt_kernel,@function
adaLN_cond__mha_block_cached__glu_gated_reglu__prompt_kernel:
s_cmp_ge_u32 s2, 256
s_cbranch_scc1 L_m_end
s_load_dwordx16 s[44:59], s[0:1], 0
s_load_dwordx8 s[60:67], s[0:1], 64
s_load_dwordx4 s[68:71], s[0:1], 96
s_getpc_b64 s[92:93]
L_m_pc:
s_mov_b32 s94, L_m_end-L_m_pc
s_mov_b32 s95, 0x20000
s_lshr_b32 s3, s2, 3
s_lshl_b32 s3, s3, 12
v_lshrrev_b32 v1, 6, v0
v_and_b32 v8, 7, v0
v_lshl_add_u32 v8, v1, 3, v8
v_lshl_add_u32 v8, v8, 7, s3
s_mov_b64 exec, 0xff
buffer_load_dword a135, v8, s[92:95], 0 offen
s_mov_b64 exec, -1
s_sub_u32 s32, s2, 136
s_cmp_ge_u32 s32, 40
s_cselect_b32 s35, 640, 0
s_cselect_b32 s36, 2455040, 0
s_lshl_b32 s33, s32, 6
s_add_u32 s33, s33, s36
s_sub_u32 s36, s2, 8
s_mul_i32 s37, s36, 20480
s_cmp_lt_u32 s36, 128
s_cselect_b32 s22, 2621440, 0
v_lshrrev_b32 v8, 2, v0
v_lshlrev_b32 v9, 1, v8
v_mul_u32_u24 v8, 7680, v8
v_and_b32 v2, 3, v0
v_lshl_add_u32 v8, v2, 4, v8
v_and_b32 v2, 15, v0
v_mul_u32_u24 v2, 1280, v2
v_and_b32 v3, 48, v0
v_mul_u32_u24 v4, 320, v1
v_add3_u32 v2, v2, v3, v4
s_cmp_lt_u32 s32, 80
s_cselect_b64 vcc, -1, 0
s_cselect_b32 s22, 4915200, s22
s_cselect_b32 s33, s33, s37
s_cselect_b32 s34, 491520, 64
s_cselect_b32 s6, 1280, 0
s_mov_b32 s23, 0x20000
s_mov_b32 s7, 0x20000
v_cndmask_b32 v8, v2, v8, vcc
s_waitcnt lgkmcnt(0)
s_cselect_b32 s20, s64, s44
s_cselect_b32 s21, s65, s45
s_mov_b32 s4, s62
s_mov_b32 s5, s63
s_mov_b32 s16, s70
s_mov_b32 s17, s71
s_mov_b32 s18, 50331648
s_mov_b32 s19, 0x20000
s_cmp_lg_u32 s2, 0
s_cbranch_scc1 L_m_nz
v_lshlrev_b32 v24, 4, v0
s_mov_b32 s3, 40894464
v_mov_b32 v20, 0
v_mov_b32 v21, 0
v_mov_b32 v22, 0
v_mov_b32 v23, 0
buffer_store_dwordx4 v[20:23], v24, s[16:19], s3 offen sc1
s_add_u32 s3, s3, 4096
buffer_store_dwordx4 v[20:23], v24, s[16:19], s3 offen sc1
s_add_u32 s3, s3, 4096
buffer_store_dwordx4 v[20:23], v24, s[16:19], s3 offen sc1
s_add_u32 s3, s3, 4096
buffer_store_dwordx4 v[20:23], v24, s[16:19], s3 offen sc1
s_add_u32 s3, s3, 4096
buffer_store_dwordx4 v[20:23], v24, s[16:19], s3 offen sc1
s_add_u32 s3, s3, 4096
buffer_store_dwordx4 v[20:23], v24, s[16:19], s3 offen sc1
s_add_u32 s3, s3, 4096
buffer_store_dwordx4 v[20:23], v24, s[16:19], s3 offen sc1
s_add_u32 s3, s3, 4096
L_m_nz:
buffer_load_ushort v12, v9, s[4:7], s35 offen offset:0
buffer_load_ushort v13, v9, s[4:7], s35 offen offset:128
buffer_load_ushort v14, v9, s[4:7], s35 offen offset:256
buffer_load_ushort v15, v9, s[4:7], s35 offen offset:384
buffer_load_ushort v16, v9, s[4:7], s35 offen offset:512
buffer_load_dwordx4 v[96:99], v8, s[20:23], s33 offen
s_add_u32 s33, s33, s34
buffer_load_dwordx4 v[100:103], v8, s[20:23], s33 offen
s_add_u32 s33, s33, s34
buffer_load_dwordx4 v[104:107], v8, s[20:23], s33 offen
s_add_u32 s33, s33, s34
buffer_load_dwordx4 v[108:111], v8, s[20:23], s33 offen
s_add_u32 s33, s33, s34
buffer_load_dwordx4 v[112:115], v8, s[20:23], s33 offen
s_add_u32 s33, s33, s34
v_mov_b32 v7, v0
v_and_b32 v0, 63, v0
v_readfirstlane_b32 s28, v1
s_and_b32 s83, s2, 7
s_bfe_u32 s84, s2, 0x20003
s_lshr_b32 s85, s2, 5
s_lshl_b32 s29, s83, 2
s_add_u32 s29, s29, s84
s_lshl_b32 s3, s85, 2
s_add_u32 s30, s3, s28
s_lshr_b32 s72, s83, 1
s_add_u32 s72, s72, s3
s_and_b32 s73, s83, 1
s_lshl_b32 s73, s73, 2
s_add_u32 s73, s73, s84
s_lshl_b32 s74, s84, 3
s_add_u32 s74, s74, s83
s_mov_b32 s84, s85
s_lshr_b32 s3, s2, 3
s_mul_i32 s74, s83, 27
s_add_u32 s74, s74, s3
s_and_b32 s84, s74, 7
s_lshr_b32 s74, s74, 3
s_mul_i32 s32, s83, 27
s_add_u32 s33, s32, 34
s_lshr_b32 s33, s33, 3
s_add_u32 s32, s32, 7
s_lshr_b32 s32, s32, 3
s_add_u32 s32, s32, s3
s_sub_u32 s32, s32, 27
s_cmp_lt_u32 s32, s33
s_cselect_b32 s32, s32, 27
s_cmp_lt_u32 s3, 27
s_cselect_b32 s74, s74, s32
s_lshl_b32 s31, s28, 12
v_lshlrev_b32 v250, 4, v0
v_lshrrev_b32 v1, 5, v0
v_bfe_u32 v2, v0, 2, 3
v_and_b32 v3, 3, v0
v_lshlrev_b32 v4, 4, v3
v_lshl_add_u32 v4, v1, 6, v4
v_lshl_add_u32 v254, v2, 13, v4
s_lshl_b32 s3, s28, 17
v_add_u32 v254, s3, v254
v_lshrrev_b32 v5, 2, v2
v_lshlrev_b32 v5, 5, v5
v_xor_b32 v4, v5, v4
v_lshl_add_u32 v248, v2, 8, v4
v_add_u32 v248, s31, v248
v_lshrrev_b32 v4, 4, v0
v_and_b32 v2, 15, v0
s_mov_b32 s86, 0
s_mov_b32 s89, s85
s_mov_b32 s90, 0
s_mov_b32 s91, 9
s_lshl_b32 s3, s29, 8
s_add_u32 s12, s50, s3
s_addc_u32 s13, s51, 0
s_sub_u32 s12, s12, 4096
s_subb_u32 s13, s13, 0
s_sub_u32 s14, 5246976, s3
s_mov_b32 s15, 0x20000
s_mov_b32 s24, s68
s_mov_b32 s25, s69
s_mov_b32 s26, 256
s_mov_b32 s27, 0x20000
s_mov_b32 s0, 0
v_bfe_u32 v5, v0, 3, 1
v_and_b32 v6, 7, v0
v_bfe_u32 v11, v0, 2, 1
v_lshlrev_b32 v11, 1, v11
v_xor_b32 v11, v11, v4
v_lshlrev_b32 v11, 4, v11
v_lshl_add_u32 v11, v6, 6, v11
v_lshl_add_u32 v245, v5, 11, v11
v_bfe_u32 v5, v0, 2, 3
v_lshlrev_b32 v5, 6, v5
v_lshl_add_u32 v5, v3, 3, v5
v_and_b32 v6, 16, v0
v_lshl_add_u32 v5, v6, 1, v5
v_lshl_add_u32 v5, v1, 11, v5
v_add_u32 v247, 0x10000, v5
v_lshlrev_b32 v5, 4, v2
v_lshl_add_u32 v252, v4, 11, v5
v_add_u32 v251, 0, v252
v_mov_b32 v5, 0
v_mov_b32 v6, 163584
ds_write_b32 v6, v5
s_lshl_b32 s3, s30, 9
s_add_u32 s3, s3, 12288
v_lshl_add_u32 v5, v3, 7, s3
s_mov_b32 s3, 10240
v_writelane_b32 v5, s3, 4
s_mov_b32 s3, 1120
v_add_u32 v6, 0, v0
v_mul_u32_u24 v6, 6554, v6
v_lshrrev_b32 v6, 16, v6
v_mad_u32_u24 v6, v6, s3, v250
v_accvgpr_write_b32 a128, v6
v_add_u32 v6, 64, v0
v_mul_u32_u24 v6, 6554, v6
v_lshrrev_b32 v6, 16, v6
v_mad_u32_u24 v6, v6, s3, v250
v_accvgpr_write_b32 a129, v6
v_add_u32 v6, 128, v0
v_mul_u32_u24 v6, 6554, v6
v_lshrrev_b32 v6, 16, v6
v_mad_u32_u24 v6, v6, s3, v250
v_accvgpr_write_b32 a130, v6
v_add_u32 v6, 192, v0
v_mul_u32_u24 v6, 6554, v6
v_lshrrev_b32 v6, 16, v6
v_mad_u32_u24 v6, v6, s3, v250
v_accvgpr_write_b32 a131, v6
v_add_u32 v6, 256, v0
v_mul_u32_u24 v6, 6554, v6
v_lshrrev_b32 v6, 16, v6
v_mad_u32_u24 v6, v6, s3, v250
v_accvgpr_write_b32 a132, v6
v_lshrrev_b32 v6, 2, v0
v_mul_u32_u24 v6, 160, v6
v_mad_u32_u24 v6, v3, 40, v6
v_accvgpr_write_b32 a133, v6
v_lshrrev_b32 v6, 1, v0
v_mul_u32_u24 v6, 7680, v6
v_and_b32 v11, 16, v250
v_add_u32 v6, v6, v11
v_accvgpr_write_b32 a134, v6
s_lshr_b32 s75, s2, 1
s_and_b32 s76, s2, 1
s_lshl_b32 s76, s76, 2
s_add_u32 s76, s76, s28
s_mul_i32 s78, s75, 40960
s_mul_i32 s3, s76, 160
s_add_u32 s78, s78, s3
s_lshl_b32 s79, s76, 7
s_add_u32 s79, s79, s75
s_cmp_eq_u32 s28, 0
s_cselect_b32 s80, 4, 256
s_mul_i32 s79, s79, 5120
s_add_u32 s79, s79, 19922944
s_mul_i32 s77, s28, 8064
s_add_u32 s77, s77, 131072
s_mul_i32 s87, s28, 14
s_cmp_eq_u32 s28, 3
s_cselect_b32 s87, 41, s87
s_lshl_b32 s76, s72, 3
s_add_u32 s76, s76, s73
s_lshl_b32 s76, s76, 2
s_add_u32 s76, s76, s28
s_mul_i32 s76, s76, 5120
s_add_u32 s76, s76, 42991616
s_and_b32 s3, s72, 1
s_lshl_b32 s3, s3, 2
s_add_u32 s75, s3, s28
s_lshl_b32 s81, s73, 3
s_add_u32 s81, s81, s75
s_lshl_b32 s81, s81, 4
s_mul_i32 s81, s81, 5120
s_add_u32 s81, s81, 19922944
s_cmp_ge_u32 s2, 216
s_cbranch_scc1 L_m_free
s_cmp_ge_u32 s2, 136
s_cbranch_scc1 L_m_gemv
s_cmp_ge_u32 s2, 8
s_cbranch_scc1 L_m_ln
s_cmp_lg_u32 s2, 0
s_cbranch_scc1 L_m_idle
L_m_zero:
v_mov_b32 v9, 1
s_waitcnt vmcnt(0)
s_barrier
s_cmp_lg_u32 s28, 0
s_cbranch_scc1 L_m_p1done
s_mov_b64 exec, 1
buffer_store_dword v9, off, s[24:27], 0 offset:128 sc1
s_mov_b64 exec, -1
s_branch L_m_p1done
L_m_idle:
v_lshlrev_b32 v9, 7, v7
v_mov_b32 v20, 0
s_lshl_b32 s32, s2, 16
s_add_u32 s32, s32, 40894464
buffer_store_dword v20, v9, s[16:19], s32 offen sc1
s_add_u32 s32, s32, 32768
buffer_store_dword v20, v9, s[16:19], s32 offen sc1
L_m_free:
s_lshl_b32 s3, s28, 8
s_add_u32 s3, s3, s2
s_cmp_lg_u32 s3, 216
s_cbranch_scc1 L_m_nosil
s_mov_b32 s4, s62
s_mov_b32 s5, s63
s_mov_b32 s6, 1280
s_mov_b32 s7, 0x20000
v_mul_u32_u24 v9, 20, v0
buffer_load_dwordx4 v[12:15], v9, s[4:7], 0 offen
buffer_load_dword v16, v9, s[4:7], 0 offen offset:16
s_mov_b32 s34, 2629632
s_mov_b32 s86, 40904704
s_waitcnt vmcnt(0)
v_lshlrev_b32 v20, 16, v12
v_and_b32 v21, 0xffff0000, v12
v_lshlrev_b32 v22, 16, v13
v_and_b32 v23, 0xffff0000, v13
v_lshlrev_b32 v24, 16, v14
v_and_b32 v25, 0xffff0000, v14
v_lshlrev_b32 v26, 16, v15
v_and_b32 v27, 0xffff0000, v15
v_lshlrev_b32 v28, 16, v16
v_and_b32 v29, 0xffff0000, v16
v_mul_f32 v30, 0xbfb8aa3b, v20
v_mul_f32 v31, 0xbfb8aa3b, v21
v_mul_f32 v32, 0xbfb8aa3b, v22
v_mul_f32 v33, 0xbfb8aa3b, v23
v_mul_f32 v34, 0xbfb8aa3b, v24
v_mul_f32 v35, 0xbfb8aa3b, v25
v_mul_f32 v36, 0xbfb8aa3b, v26
v_mul_f32 v37, 0xbfb8aa3b, v27
v_mul_f32 v38, 0xbfb8aa3b, v28
v_mul_f32 v39, 0xbfb8aa3b, v29
v_exp_f32 v30, v30
v_exp_f32 v31, v31
v_exp_f32 v32, v32
v_exp_f32 v33, v33
v_exp_f32 v34, v34
v_exp_f32 v35, v35
v_exp_f32 v36, v36
v_exp_f32 v37, v37
v_exp_f32 v38, v38
v_exp_f32 v39, v39
v_add_f32 v30, 1.0, v30
v_add_f32 v31, 1.0, v31
v_add_f32 v32, 1.0, v32
v_add_f32 v33, 1.0, v33
v_add_f32 v34, 1.0, v34
v_add_f32 v35, 1.0, v35
v_add_f32 v36, 1.0, v36
v_add_f32 v37, 1.0, v37
v_add_f32 v38, 1.0, v38
v_add_f32 v39, 1.0, v39
v_rcp_f32 v30, v30
v_rcp_f32 v31, v31
v_rcp_f32 v32, v32
v_rcp_f32 v33, v33
v_rcp_f32 v34, v34
v_rcp_f32 v35, v35
v_rcp_f32 v36, v36
v_rcp_f32 v37, v37
v_rcp_f32 v38, v38
v_rcp_f32 v39, v39
v_mul_f32 v20, v20, v30
v_mul_f32 v21, v21, v31
v_mul_f32 v22, v22, v32
v_mul_f32 v23, v23, v33
v_mul_f32 v24, v24, v34
v_mul_f32 v25, v25, v35
v_mul_f32 v26, v26, v36
v_mul_f32 v27, v27, v37
v_mul_f32 v28, v28, v38
v_mul_f32 v29, v29, v39
v_cvt_pk_bf16_f32 v12, v20, v21
v_cvt_pk_bf16_f32 v13, v22, v23
v_cvt_pk_bf16_f32 v14, v24, v25
v_cvt_pk_bf16_f32 v15, v26, v27
v_cvt_pk_bf16_f32 v16, v28, v29
buffer_store_dwordx4 v[12:15], v9, s[16:19], s34 offen sc1
buffer_store_dword v16, v9, s[16:19], s34 offen offset:16 sc1
s_branch L_m_p1done
L_m_nosil:
s_cmp_ge_u32 s90, 9
s_cbranch_scc1 L_m_wq1d
L_m_wq1:
s_lshl_b32 s3, s89, 14
s_add_u32 m0, s3, s31
s_lshl_b32 s3, s89, 19
s_add_u32 s43, s3, 4096
buffer_load_dwordx4 v254, s[12:15], s43 offen offset:0 lds
s_add_u32 s43, s3, 3200
buffer_load_dwordx4 v254, s[12:15], s43 offen offset:1024 lds
s_add_u32 s43, s3, 67584
buffer_load_dwordx4 v254, s[12:15], s43 offen offset:2048 lds
s_add_u32 s43, s3, 66688
buffer_load_dwordx4 v254, s[12:15], s43 offen offset:3072 lds
s_add_u32 s89, s89, 1
s_cmp_eq_u32 s89, s91
s_cselect_b32 s89, 0, s89
s_add_u32 s90, s90, 1
s_cmp_lt_u32 s90, 9
s_cbranch_scc1 L_m_wq1
L_m_wq1d:
s_branch L_m_p1done
L_m_gemv:
s_sub_u32 s32, s2, 136
s_waitcnt vmcnt(5)
v_lshlrev_b32 v20, 16, v12
v_lshlrev_b32 v21, 16, v13
v_lshlrev_b32 v22, 16, v14
v_lshlrev_b32 v23, 16, v15
v_lshlrev_b32 v24, 16, v16
v_mul_f32 v30, 0xbfb8aa3b, v20
v_mul_f32 v31, 0xbfb8aa3b, v21
v_mul_f32 v32, 0xbfb8aa3b, v22
v_mul_f32 v33, 0xbfb8aa3b, v23
v_mul_f32 v34, 0xbfb8aa3b, v24
v_exp_f32 v30, v30
v_exp_f32 v31, v31
v_exp_f32 v32, v32
v_exp_f32 v33, v33
v_exp_f32 v34, v34
v_add_f32 v30, 1.0, v30
v_add_f32 v31, 1.0, v31
v_add_f32 v32, 1.0, v32
v_add_f32 v33, 1.0, v33
v_add_f32 v34, 1.0, v34
v_rcp_f32 v30, v30
v_rcp_f32 v31, v31
v_rcp_f32 v32, v32
v_rcp_f32 v33, v33
v_rcp_f32 v34, v34
v_mul_f32 v20, v20, v30
v_mul_f32 v21, v21, v31
v_mul_f32 v22, v22, v32
v_mul_f32 v23, v23, v33
v_mul_f32 v24, v24, v34
v_cvt_pk_bf16_f32 v12, v20, v20
v_cvt_pk_bf16_f32 v13, v21, v21
v_cvt_pk_bf16_f32 v14, v22, v22
v_cvt_pk_bf16_f32 v15, v23, v23
v_cvt_pk_bf16_f32 v16, v24, v24
v_lshlrev_b32 v20, 16, v12
v_lshlrev_b32 v21, 16, v13
v_lshlrev_b32 v22, 16, v14
v_lshlrev_b32 v23, 16, v15
v_lshlrev_b32 v24, 16, v16
s_mov_b32 s34, 0xffff0000
s_waitcnt vmcnt(4)
v_lshlrev_b32 v30, 16, v96
v_and_b32 v31, s34, v96
v_lshlrev_b32 v32, 16, v97
v_and_b32 v33, s34, v97
v_lshlrev_b32 v34, 16, v98
v_and_b32 v35, s34, v98
v_lshlrev_b32 v36, 16, v99
v_and_b32 v37, s34, v99
v_pk_mul_f32 v[80:81], v[30:31], v[20:21] op_sel:[0,0] op_sel_hi:[1,0]
v_pk_mul_f32 v[82:83], v[32:33], v[20:21] op_sel:[0,0] op_sel_hi:[1,0]
v_pk_mul_f32 v[84:85], v[34:35], v[20:21] op_sel:[0,0] op_sel_hi:[1,0]
v_pk_mul_f32 v[86:87], v[36:37], v[20:21] op_sel:[0,0] op_sel_hi:[1,0]
s_waitcnt vmcnt(3)
v_lshlrev_b32 v30, 16, v100
v_and_b32 v31, s34, v100
v_lshlrev_b32 v32, 16, v101
v_and_b32 v33, s34, v101
v_lshlrev_b32 v34, 16, v102
v_and_b32 v35, s34, v102
v_lshlrev_b32 v36, 16, v103
v_and_b32 v37, s34, v103
v_pk_fma_f32 v[80:81], v[30:31], v[20:21], v[80:81] op_sel:[0,1,0] op_sel_hi:[1,1,1]
v_pk_fma_f32 v[82:83], v[32:33], v[20:21], v[82:83] op_sel:[0,1,0] op_sel_hi:[1,1,1]
v_pk_fma_f32 v[84:85], v[34:35], v[20:21], v[84:85] op_sel:[0,1,0] op_sel_hi:[1,1,1]
v_pk_fma_f32 v[86:87], v[36:37], v[20:21], v[86:87] op_sel:[0,1,0] op_sel_hi:[1,1,1]
s_waitcnt vmcnt(2)
v_lshlrev_b32 v30, 16, v104
v_and_b32 v31, s34, v104
v_lshlrev_b32 v32, 16, v105
v_and_b32 v33, s34, v105
v_lshlrev_b32 v34, 16, v106
v_and_b32 v35, s34, v106
v_lshlrev_b32 v36, 16, v107
v_and_b32 v37, s34, v107
v_pk_fma_f32 v[80:81], v[30:31], v[22:23], v[80:81] op_sel:[0,0,0] op_sel_hi:[1,0,1]
v_pk_fma_f32 v[82:83], v[32:33], v[22:23], v[82:83] op_sel:[0,0,0] op_sel_hi:[1,0,1]
v_pk_fma_f32 v[84:85], v[34:35], v[22:23], v[84:85] op_sel:[0,0,0] op_sel_hi:[1,0,1]
v_pk_fma_f32 v[86:87], v[36:37], v[22:23], v[86:87] op_sel:[0,0,0] op_sel_hi:[1,0,1]
s_waitcnt vmcnt(1)
v_lshlrev_b32 v30, 16, v108
v_and_b32 v31, s34, v108
v_lshlrev_b32 v32, 16, v109
v_and_b32 v33, s34, v109
v_lshlrev_b32 v34, 16, v110
v_and_b32 v35, s34, v110
v_lshlrev_b32 v36, 16, v111
v_and_b32 v37, s34, v111
v_pk_fma_f32 v[80:81], v[30:31], v[22:23], v[80:81] op_sel:[0,1,0] op_sel_hi:[1,1,1]
v_pk_fma_f32 v[82:83], v[32:33], v[22:23], v[82:83] op_sel:[0,1,0] op_sel_hi:[1,1,1]
v_pk_fma_f32 v[84:85], v[34:35], v[22:23], v[84:85] op_sel:[0,1,0] op_sel_hi:[1,1,1]
v_pk_fma_f32 v[86:87], v[36:37], v[22:23], v[86:87] op_sel:[0,1,0] op_sel_hi:[1,1,1]
s_waitcnt vmcnt(0)
buffer_load_dword v11, off, s[24:27], 0 offset:128 sc1
v_lshlrev_b32 v30, 16, v112
v_and_b32 v31, s34, v112
v_lshlrev_b32 v32, 16, v113
v_and_b32 v33, s34, v113
v_lshlrev_b32 v34, 16, v114
v_and_b32 v35, s34, v114
v_lshlrev_b32 v36, 16, v115
v_and_b32 v37, s34, v115
v_pk_fma_f32 v[80:81], v[30:31], v[24:25], v[80:81] op_sel:[0,0,0] op_sel_hi:[1,0,1]
v_pk_fma_f32 v[82:83], v[32:33], v[24:25], v[82:83] op_sel:[0,0,0] op_sel_hi:[1,0,1]
v_pk_fma_f32 v[84:85], v[34:35], v[24:25], v[84:85] op_sel:[0,0,0] op_sel_hi:[1,0,1]
v_pk_fma_f32 v[86:87], v[36:37], v[24:25], v[86:87] op_sel:[0,0,0] op_sel_hi:[1,0,1]
v_lshrrev_b32 v8, 4, v7
v_lshlrev_b32 v8, 7, v8
v_lshl_add_u32 v8, v3, 5, v8
v_add_u32 v8, 155648, v8
v_add_f32 v80, v80, v80 row_ror:4
v_add_f32 v81, v81, v81 row_ror:4
v_add_f32 v82, v82, v82 row_ror:4
v_add_f32 v83, v83, v83 row_ror:4
v_add_f32 v84, v84, v84 row_ror:4
v_add_f32 v85, v85, v85 row_ror:4
v_add_f32 v86, v86, v86 row_ror:4
v_add_f32 v87, v87, v87 row_ror:4
v_add_f32 v80, v80, v80 row_ror:8
v_add_f32 v81, v81, v81 row_ror:8
v_add_f32 v82, v82, v82 row_ror:8
v_add_f32 v83, v83, v83 row_ror:8
v_add_f32 v84, v84, v84 row_ror:8
v_add_f32 v85, v85, v85 row_ror:8
v_add_f32 v86, v86, v86 row_ror:8
v_add_f32 v87, v87, v87 row_ror:8
ds_write_b128 v8, v[80:83]
ds_write_b128 v8, v[84:87] offset:16
v_and_b32 v10, 31, v0
v_lshlrev_b32 v10, 2, v10
v_lshl_add_u32 v8, v1, 10, v10
v_add_u32 v8, 155648, v8
s_waitcnt vmcnt(0)
v_cmp_eq_u32 vcc, 0, v11
s_cmp_eq_u64 vcc, 0
s_cbranch_scc1 L_m_gemvgo
s_mov_b32 s82, 0
L_m_poll2:
buffer_load_dword v11, off, s[24:27], 0 offset:128 sc1
s_waitcnt vmcnt(0)
v_cmp_gt_u32 vcc, 1, v11
s_cmp_eq_u64 vcc, 0
s_cbranch_scc1 L_m_poll2d
s_sleep 1
s_add_u32 s82, s82, 1
s_cmp_lt_u32 s82, 0x40000
s_cbranch_scc1 L_m_poll2
L_m_poll2d:
L_m_gemvgo:
s_waitcnt vmcnt(0) lgkmcnt(0)
s_barrier
s_cmp_lg_u32 s28, 0
s_cbranch_scc1 L_m_noflag
ds_read2_b32 v[12:13], v8 offset0:0 offset1:32
ds_read2_b32 v[14:15], v8 offset0:64 offset1:96
ds_read2_b32 v[16:17], v8 offset0:128 offset1:160
ds_read2_b32 v[18:19], v8 offset0:192 offset1:224
s_lshl_b32 s37, s32, 7
s_add_u32 s37, s37, 40894464
s_waitcnt lgkmcnt(0)
v_pk_add_f32 v[12:13], v[12:13], v[14:15]
v_pk_add_f32 v[16:17], v[16:17], v[18:19]
v_pk_add_f32 v[12:13], v[12:13], v[16:17]
v_add_f32 v12, v12, v13
v_mov_b32 v13, v12
s_nop 1
v_permlane32_swap_b32 v12, v13
s_nop 1
v_add_f32 v12, v12, v13
v_or_b32 v12, 1, v12
s_mov_b32 exec_hi, 0
buffer_store_dword v12, v10, s[16:19], s37 offen sc1
s_mov_b64 exec, -1
s_branch L_m_noflag
L_m_ln:
s_sub_u32 s32, s2, 8
s_mov_b32 s91, 9
s_min_u32 s89, s89, 8
v_lshlrev_b32 v9, 5, v2
v_add_u32 v9, 155648, v9
s_lshl_b32 s34, s28, 3
v_add_u32 v10, s34, v9
s_lshr_b32 s35, s32, 2
s_and_b32 s36, s32, 3
s_mul_i32 s37, s35, 20
s_mul_i32 s38, s28, 5
s_add_u32 s37, s37, s38
s_lshl_b32 s37, s37, 2
s_add_u32 s37, s37, s36
s_lshl_b32 s37, s37, 10
s_lshl_b32 s86, s32, 7
s_add_u32 s86, s86, 40906752
s_cmp_eq_u32 s28, 0
s_cselect_b32 s86, s86, 0
s_mov_b32 s34, 0xffff0000
s_mov_b32 s38, 0x3bcccccd
s_mov_b32 s39, 0x3acccccd
v_and_b32 v90, 31, v0
v_mul_u32_u24 v90, 20, v90
v_mul_u32_u24 v91, 2560, v1
v_add_u32 v90, v90, v91
s_mul_i32 s40, s28, 640
s_add_u32 s40, s40, 40894464
s_add_u32 s41, s40, 5120
s_mul_i32 s3, s28, 1280
s_add_u32 s3, s3, 147456
v_mad_u32_u24 v91, v0, 20, s3
v_lshl_add_u32 v92, v4, 5, s3
v_cvt_f32_u32 v93, v1
s_waitcnt vmcnt(4)
v_lshlrev_b32 v32, 16, v96
v_and_b32 v33, s34, v96
v_lshlrev_b32 v34, 16, v97
v_and_b32 v35, s34, v97
v_lshlrev_b32 v36, 16, v98
v_and_b32 v37, s34, v98
v_lshlrev_b32 v38, 16, v99
v_and_b32 v39, s34, v99
v_pk_add_f32 v[72:73], v[32:33], v[34:35]
v_pk_add_f32 v[72:73], v[72:73], v[36:37]
v_pk_add_f32 v[72:73], v[72:73], v[38:39]
s_waitcnt vmcnt(3)
v_lshlrev_b32 v40, 16, v100
v_and_b32 v41, s34, v100
v_lshlrev_b32 v42, 16, v101
v_and_b32 v43, s34, v101
v_lshlrev_b32 v44, 16, v102
v_and_b32 v45, s34, v102
v_lshlrev_b32 v46, 16, v103
v_and_b32 v47, s34, v103
v_pk_add_f32 v[72:73], v[72:73], v[40:41]
v_pk_add_f32 v[72:73], v[72:73], v[42:43]
v_pk_add_f32 v[72:73], v[72:73], v[44:45]
v_pk_add_f32 v[72:73], v[72:73], v[46:47]
s_waitcnt vmcnt(2)
v_lshlrev_b32 v48, 16, v104
v_and_b32 v49, s34, v104
v_lshlrev_b32 v50, 16, v105
v_and_b32 v51, s34, v105
v_lshlrev_b32 v52, 16, v106
v_and_b32 v53, s34, v106
v_lshlrev_b32 v54, 16, v107
v_and_b32 v55, s34, v107
v_pk_add_f32 v[72:73], v[72:73], v[48:49]
v_pk_add_f32 v[72:73], v[72:73], v[50:51]
v_pk_add_f32 v[72:73], v[72:73], v[52:53]
v_pk_add_f32 v[72:73], v[72:73], v[54:55]
s_waitcnt vmcnt(1)
v_lshlrev_b32 v56, 16, v108
v_and_b32 v57, s34, v108
v_lshlrev_b32 v58, 16, v109
v_and_b32 v59, s34, v109
v_lshlrev_b32 v60, 16, v110
v_and_b32 v61, s34, v110
v_lshlrev_b32 v62, 16, v111
v_and_b32 v63, s34, v111
v_pk_add_f32 v[72:73], v[72:73], v[56:57]
v_pk_add_f32 v[72:73], v[72:73], v[58:59]
v_pk_add_f32 v[72:73], v[72:73], v[60:61]
v_pk_add_f32 v[72:73], v[72:73], v[62:63]
s_waitcnt vmcnt(0)
buffer_load_dword v94, off, s[24:27], 0 offset:128 sc1
s_lshl_b32 s3, s89, 14
s_add_u32 m0, s3, s31
s_lshl_b32 s3, s89, 19
s_add_u32 s43, s3, 4096
buffer_load_dwordx4 v254, s[12:15], s43 offen offset:0 lds
s_add_u32 s43, s3, 3200
buffer_load_dwordx4 v254, s[12:15], s43 offen offset:1024 lds
s_add_u32 s43, s3, 67584
buffer_load_dwordx4 v254, s[12:15], s43 offen offset:2048 lds
s_add_u32 s43, s3, 66688
buffer_load_dwordx4 v254, s[12:15], s43 offen offset:3072 lds
s_add_u32 s89, s89, 1
s_cmp_eq_u32 s89, s91
s_cselect_b32 s89, 0, s89
s_add_u32 s90, s90, 1
v_lshlrev_b32 v64, 16, v112
v_and_b32 v65, s34, v112
v_lshlrev_b32 v66, 16, v113
v_and_b32 v67, s34, v113
v_lshlrev_b32 v68, 16, v114
v_and_b32 v69, s34, v114
v_lshlrev_b32 v70, 16, v115
v_and_b32 v71, s34, v115
v_pk_add_f32 v[72:73], v[72:73], v[64:65]
v_pk_add_f32 v[72:73], v[72:73], v[66:67]
v_pk_add_f32 v[72:73], v[72:73], v[68:69]
v_pk_add_f32 v[72:73], v[72:73], v[70:71]
v_add_f32 v72, v72, v73
v_mov_b32 v73, v72
s_nop 1
v_permlane16_swap_b32 v72, v73
s_nop 1
v_add_f32 v72, v72, v73
v_mov_b32 v73, v72
s_nop 1
v_permlane32_swap_b32 v72, v73
s_nop 1
v_add_f32 v72, v72, v73
v_mul_f32 v74, 0xbbcccccd, v72
v_pk_add_f32 v[32:33], v[32:33], v[74:75] op_sel_hi:[1,0]
v_pk_add_f32 v[34:35], v[34:35], v[74:75] op_sel_hi:[1,0]
v_pk_add_f32 v[36:37], v[36:37], v[74:75] op_sel_hi:[1,0]
v_pk_add_f32 v[38:39], v[38:39], v[74:75] op_sel_hi:[1,0]
v_pk_add_f32 v[40:41], v[40:41], v[74:75] op_sel_hi:[1,0]
v_pk_add_f32 v[42:43], v[42:43], v[74:75] op_sel_hi:[1,0]
v_pk_add_f32 v[44:45], v[44:45], v[74:75] op_sel_hi:[1,0]
v_pk_add_f32 v[46:47], v[46:47], v[74:75] op_sel_hi:[1,0]
v_pk_add_f32 v[48:49], v[48:49], v[74:75] op_sel_hi:[1,0]
v_pk_add_f32 v[50:51], v[50:51], v[74:75] op_sel_hi:[1,0]
v_pk_add_f32 v[52:53], v[52:53], v[74:75] op_sel_hi:[1,0]
v_pk_add_f32 v[54:55], v[54:55], v[74:75] op_sel_hi:[1,0]
v_pk_add_f32 v[56:57], v[56:57], v[74:75] op_sel_hi:[1,0]
v_pk_add_f32 v[58:59], v[58:59], v[74:75] op_sel_hi:[1,0]
v_pk_add_f32 v[60:61], v[60:61], v[74:75] op_sel_hi:[1,0]
v_pk_add_f32 v[62:63], v[62:63], v[74:75] op_sel_hi:[1,0]
v_pk_add_f32 v[64:65], v[64:65], v[74:75] op_sel_hi:[1,0]
v_pk_add_f32 v[66:67], v[66:67], v[74:75] op_sel_hi:[1,0]
v_pk_add_f32 v[68:69], v[68:69], v[74:75] op_sel_hi:[1,0]
v_pk_add_f32 v[70:71], v[70:71], v[74:75] op_sel_hi:[1,0]
v_pk_mul_f32 v[76:77], v[32:33], v[32:33]
v_pk_mul_f32 v[78:79], v[34:35], v[34:35]
v_pk_fma_f32 v[76:77], v[36:37], v[36:37], v[76:77]
v_pk_fma_f32 v[78:79], v[38:39], v[38:39], v[78:79]
v_pk_fma_f32 v[76:77], v[40:41], v[40:41], v[76:77]
v_pk_fma_f32 v[78:79], v[42:43], v[42:43], v[78:79]
v_pk_fma_f32 v[76:77], v[44:45], v[44:45], v[76:77]
v_pk_fma_f32 v[78:79], v[46:47], v[46:47], v[78:79]
v_pk_fma_f32 v[76:77], v[48:49], v[48:49], v[76:77]
v_pk_fma_f32 v[78:79], v[50:51], v[50:51], v[78:79]
v_pk_fma_f32 v[76:77], v[52:53], v[52:53], v[76:77]
v_pk_fma_f32 v[78:79], v[54:55], v[54:55], v[78:79]
v_pk_fma_f32 v[76:77], v[56:57], v[56:57], v[76:77]
v_pk_fma_f32 v[78:79], v[58:59], v[58:59], v[78:79]
v_pk_fma_f32 v[76:77], v[60:61], v[60:61], v[76:77]
v_pk_fma_f32 v[78:79], v[62:63], v[62:63], v[78:79]
v_pk_fma_f32 v[76:77], v[64:65], v[64:65], v[76:77]
v_pk_fma_f32 v[78:79], v[66:67], v[66:67], v[78:79]
v_pk_fma_f32 v[76:77], v[68:69], v[68:69], v[76:77]
v_pk_fma_f32 v[78:79], v[70:71], v[70:71], v[78:79]
v_pk_add_f32 v[76:77], v[76:77], v[78:79]
v_add_f32 v73, v76, v77
v_mov_b32 v76, v73
s_nop 1
v_permlane16_swap_b32 v73, v76
s_nop 1
v_add_f32 v73, v73, v76
v_mov_b32 v76, v73
s_nop 1
v_permlane32_swap_b32 v73, v76
s_nop 1
v_add_f32 v73, v73, v76
ds_write_b64 v10, v[72:73]
s_waitcnt lgkmcnt(0)
s_barrier
ds_read_b128 v[80:83], v9
ds_read_b128 v[84:87], v9 offset:16
v_mov_b32 v79, 0x3727c5ac
s_waitcnt lgkmcnt(0)
v_pk_add_f32 v[76:77], v[80:81], v[82:83]
v_pk_add_f32 v[88:89], v[84:85], v[86:87]
v_pk_add_f32 v[76:77], v[76:77], v[88:89]
v_mul_f32 v76, 0xbacccccd, v76
v_fma_f32 v80, v80, s38, v76
v_fma_f32 v82, v82, s38, v76
v_fma_f32 v84, v84, s38, v76
v_fma_f32 v86, v86, s38, v76
v_mul_f32 v80, v80, v80
v_fmac_f32 v80, v82, v82
v_fmac_f32 v80, v84, v84
v_fmac_f32 v80, v86, v86
v_fmac_f32 v77, 0x43200000, v80
v_fma_f32 v77, v77, s39, v79
v_rsq_f32 v78, v77
v_sub_f32 v76, v76, v74
v_mul_f32 v79, v76, v78
v_pk_fma_f32 v[32:33], v[32:33], v[78:79], v[78:79] op_sel:[0,0,1] op_sel_hi:[1,0,1]
v_pk_fma_f32 v[34:35], v[34:35], v[78:79], v[78:79] op_sel:[0,0,1] op_sel_hi:[1,0,1]
v_pk_fma_f32 v[36:37], v[36:37], v[78:79], v[78:79] op_sel:[0,0,1] op_sel_hi:[1,0,1]
v_pk_fma_f32 v[38:39], v[38:39], v[78:79], v[78:79] op_sel:[0,0,1] op_sel_hi:[1,0,1]
v_pk_fma_f32 v[40:41], v[40:41], v[78:79], v[78:79] op_sel:[0,0,1] op_sel_hi:[1,0,1]
v_pk_fma_f32 v[42:43], v[42:43], v[78:79], v[78:79] op_sel:[0,0,1] op_sel_hi:[1,0,1]
v_pk_fma_f32 v[44:45], v[44:45], v[78:79], v[78:79] op_sel:[0,0,1] op_sel_hi:[1,0,1]
v_pk_fma_f32 v[46:47], v[46:47], v[78:79], v[78:79] op_sel:[0,0,1] op_sel_hi:[1,0,1]
v_pk_fma_f32 v[48:49], v[48:49], v[78:79], v[78:79] op_sel:[0,0,1] op_sel_hi:[1,0,1]
v_pk_fma_f32 v[50:51], v[50:51], v[78:79], v[78:79] op_sel:[0,0,1] op_sel_hi:[1,0,1]
v_pk_fma_f32 v[52:53], v[52:53], v[78:79], v[78:79] op_sel:[0,0,1] op_sel_hi:[1,0,1]
v_pk_fma_f32 v[54:55], v[54:55], v[78:79], v[78:79] op_sel:[0,0,1] op_sel_hi:[1,0,1]
v_pk_fma_f32 v[56:57], v[56:57], v[78:79], v[78:79] op_sel:[0,0,1] op_sel_hi:[1,0,1]
v_pk_fma_f32 v[58:59], v[58:59], v[78:79], v[78:79] op_sel:[0,0,1] op_sel_hi:[1,0,1]
v_pk_fma_f32 v[60:61], v[60:61], v[78:79], v[78:79] op_sel:[0,0,1] op_sel_hi:[1,0,1]
v_pk_fma_f32 v[62:63], v[62:63], v[78:79], v[78:79] op_sel:[0,0,1] op_sel_hi:[1,0,1]
v_pk_fma_f32 v[64:65], v[64:65], v[78:79], v[78:79] op_sel:[0,0,1] op_sel_hi:[1,0,1]
v_pk_fma_f32 v[66:67], v[66:67], v[78:79], v[78:79] op_sel:[0,0,1] op_sel_hi:[1,0,1]
v_pk_fma_f32 v[68:69], v[68:69], v[78:79], v[78:79] op_sel:[0,0,1] op_sel_hi:[1,0,1]
v_pk_fma_f32 v[70:71], v[70:71], v[78:79], v[78:79] op_sel:[0,0,1] op_sel_hi:[1,0,1]
s_waitcnt vmcnt(4)
v_cmp_eq_u32 vcc, 0, v94
s_cmp_eq_u64 vcc, 0
s_cbranch_scc1 L_m_lngo
s_mov_b32 s82, 0
L_m_poll3:
buffer_load_dword v94, off, s[24:27], 0 offset:128 sc1
s_waitcnt vmcnt(0)
v_cmp_gt_u32 vcc, 1, v94
s_cmp_eq_u64 vcc, 0
s_cbranch_scc1 L_m_poll3d
s_sleep 1
s_add_u32 s82, s82, 1
s_cmp_lt_u32 s82, 0x40000
s_cbranch_scc1 L_m_poll3
L_m_poll3d:
L_m_lngo:
s_cmp_ge_u32 s90, 3
s_cbranch_scc1 L_m_wq4d
L_m_wq4:
s_lshl_b32 s3, s89, 14
s_add_u32 m0, s3, s31
s_lshl_b32 s3, s89, 19
s_add_u32 s43, s3, 4096
buffer_load_dwordx4 v254, s[12:15], s43 offen offset:0 lds
s_add_u32 s43, s3, 3200
buffer_load_dwordx4 v254, s[12:15], s43 offen offset:1024 lds
s_add_u32 s43, s3, 67584
buffer_load_dwordx4 v254, s[12:15], s43 offen offset:2048 lds
s_add_u32 s43, s3, 66688
buffer_load_dwordx4 v254, s[12:15], s43 offen offset:3072 lds
s_add_u32 s89, s89, 1
s_cmp_eq_u32 s89, s91
s_cselect_b32 s89, 0, s89
s_add_u32 s90, s90, 1
s_cmp_lt_u32 s90, 3
s_cbranch_scc1 L_m_wq4
L_m_wq4d:
s_mov_b32 s0, 1
s_branch L_m_chs
L_m_lnback:
s_mov_b32 s0, 2
s_mov_b32 s82, 0
L_m_poll5:
buffer_load_dwordx4 v[12:15], v90, s[16:19], s40 offen sc1
buffer_load_dword v16, v90, s[16:19], s40 offen offset:16 sc1
buffer_load_dwordx4 v[20:23], v90, s[16:19], s41 offen sc1
buffer_load_dword v24, v90, s[16:19], s41 offen offset:16 sc1
s_waitcnt vmcnt(0)
v_and_b32 v11, v12, v13
v_and_b32 v17, v14, v15
v_and_b32 v18, v16, v20
v_and_b32 v19, v21, v22
v_and_b32 v25, v23, v24
v_and_b32 v11, v11, v17
v_and_b32 v18, v18, v19
v_and_b32 v11, v11, v25
v_and_b32 v11, v11, v18
v_and_b32 v11, 1, v11
v_cmp_gt_u32 vcc, 1, v11
s_cmp_eq_u64 vcc, 0
s_cbranch_scc1 L_m_poll5d
s_sleep 1
s_add_u32 s82, s82, 1
s_cmp_lt_u32 s82, 0x40000
s_cbranch_scc1 L_m_poll5
L_m_poll5d:
v_add_f32 v12, v12, v20
v_add_f32 v13, v13, v21
v_add_f32 v14, v14, v22
v_add_f32 v15, v15, v23
v_add_f32 v16, v16, v24
v_cvt_pk_bf16_f32 v12, v12, v12
v_cvt_pk_bf16_f32 v13, v13, v13
v_cvt_pk_bf16_f32 v14, v14, v14
v_cvt_pk_bf16_f32 v15, v15, v15
v_cvt_pk_bf16_f32 v16, v16, v16
v_lshlrev_b32 v12, 16, v12
v_lshlrev_b32 v13, 16, v13
v_lshlrev_b32 v14, 16, v14
v_lshlrev_b32 v15, 16, v15
v_lshlrev_b32 v16, 16, v16
v_add_f32 v12, v93, v12
v_add_f32 v13, v93, v13
v_add_f32 v14, v93, v14
v_add_f32 v15, v93, v15
v_add_f32 v16, v93, v16
v_cvt_pk_bf16_f32 v12, v12, v12
v_cvt_pk_bf16_f32 v13, v13, v13
v_cvt_pk_bf16_f32 v14, v14, v14
v_cvt_pk_bf16_f32 v15, v15, v15
v_cvt_pk_bf16_f32 v16, v16, v16
v_lshlrev_b32 v12, 16, v12
v_lshlrev_b32 v13, 16, v13
v_lshlrev_b32 v14, 16, v14
v_lshlrev_b32 v15, 16, v15
v_lshlrev_b32 v16, 16, v16
v_mul_f32 v12, 0x3e0293ee, v12
v_mul_f32 v13, 0x3e0293ee, v13
v_mul_f32 v14, 0x3e0293ee, v14
v_mul_f32 v15, 0x3e0293ee, v15
v_mul_f32 v16, 0x3e0293ee, v16
ds_write2_b32 v91, v12, v13 offset1:1
ds_write2_b32 v91, v14, v15 offset0:2 offset1:3
ds_write_b32 v91, v16 offset:16
ds_read_b128 v[128:131], v92 offset:0
ds_read_b128 v[132:135], v92 offset:16
ds_read_b128 v[136:139], v92 offset:640
ds_read_b128 v[140:143], v92 offset:656
ds_read_b128 v[144:147], v92 offset:128
ds_read_b128 v[148:151], v92 offset:144
ds_read_b128 v[152:155], v92 offset:768
ds_read_b128 v[156:159], v92 offset:784
ds_read_b128 v[160:163], v92 offset:256
ds_read_b128 v[164:167], v92 offset:272
ds_read_b128 v[168:171], v92 offset:896
ds_read_b128 v[172:175], v92 offset:912
s_waitcnt lgkmcnt(8)
ds_read_b128 v[176:179], v92 offset:384
ds_read_b128 v[180:183], v92 offset:400
ds_read_b128 v[184:187], v92 offset:1024
ds_read_b128 v[188:191], v92 offset:1040
v_pk_fma_f32 v[32:33], v[32:33], v[136:137], v[128:129]
v_pk_fma_f32 v[34:35], v[34:35], v[138:139], v[130:131]
v_pk_fma_f32 v[36:37], v[36:37], v[140:141], v[132:133]
v_pk_fma_f32 v[38:39], v[38:39], v[142:143], v[134:135]
v_cvt_pk_bf16_f32 v96, v32, v33
v_cvt_pk_bf16_f32 v97, v34, v35
v_cvt_pk_bf16_f32 v98, v36, v37
v_cvt_pk_bf16_f32 v99, v38, v39
buffer_store_dwordx4 v[96:99], v250, s[16:19], s37 offen sc1
s_add_u32 s37, s37, 4096
s_waitcnt lgkmcnt(8)
ds_read_b128 v[192:195], v92 offset:512
ds_read_b128 v[196:199], v92 offset:528
ds_read_b128 v[200:203], v92 offset:1152
ds_read_b128 v[204:207], v92 offset:1168
v_pk_fma_f32 v[40:41], v[40:41], v[152:153], v[144:145]
v_pk_fma_f32 v[42:43], v[42:43], v[154:155], v[146:147]
v_pk_fma_f32 v[44:45], v[44:45], v[156:157], v[148:149]
v_pk_fma_f32 v[46:47], v[46:47], v[158:159], v[150:151]
v_cvt_pk_bf16_f32 v100, v40, v41
v_cvt_pk_bf16_f32 v101, v42, v43
v_cvt_pk_bf16_f32 v102, v44, v45
v_cvt_pk_bf16_f32 v103, v46, v47
buffer_store_dwordx4 v[100:103], v250, s[16:19], s37 offen sc1
s_add_u32 s37, s37, 4096
s_waitcnt lgkmcnt(8)
v_pk_fma_f32 v[48:49], v[48:49], v[168:169], v[160:161]
v_pk_fma_f32 v[50:51], v[50:51], v[170:171], v[162:163]
v_pk_fma_f32 v[52:53], v[52:53], v[172:173], v[164:165]
v_pk_fma_f32 v[54:55], v[54:55], v[174:175], v[166:167]
v_cvt_pk_bf16_f32 v104, v48, v49
v_cvt_pk_bf16_f32 v105, v50, v51
v_cvt_pk_bf16_f32 v106, v52, v53
v_cvt_pk_bf16_f32 v107, v54, v55
buffer_store_dwordx4 v[104:107], v250, s[16:19], s37 offen sc1
s_add_u32 s37, s37, 4096
s_waitcnt lgkmcnt(4)
v_pk_fma_f32 v[56:57], v[56:57], v[184:185], v[176:177]
v_pk_fma_f32 v[58:59], v[58:59], v[186:187], v[178:179]
v_pk_fma_f32 v[60:61], v[60:61], v[188:189], v[180:181]
v_pk_fma_f32 v[62:63], v[62:63], v[190:191], v[182:183]
v_cvt_pk_bf16_f32 v108, v56, v57
v_cvt_pk_bf16_f32 v109, v58, v59
v_cvt_pk_bf16_f32 v110, v60, v61
v_cvt_pk_bf16_f32 v111, v62, v63
buffer_store_dwordx4 v[108:111], v250, s[16:19], s37 offen sc1
s_add_u32 s37, s37, 4096
s_waitcnt lgkmcnt(0)
v_pk_fma_f32 v[64:65], v[64:65], v[200:201], v[192:193]
v_pk_fma_f32 v[66:67], v[66:67], v[202:203], v[194:195]
v_pk_fma_f32 v[68:69], v[68:69], v[204:205], v[196:197]
v_pk_fma_f32 v[70:71], v[70:71], v[206:207], v[198:199]
v_cvt_pk_bf16_f32 v112, v64, v65
v_cvt_pk_bf16_f32 v113, v66, v67
v_cvt_pk_bf16_f32 v114, v68, v69
v_cvt_pk_bf16_f32 v115, v70, v71
buffer_store_dwordx4 v[112:115], v250, s[16:19], s37 offen sc1
s_add_u32 s37, s37, 4096
s_waitcnt vmcnt(0)
s_barrier
s_branch L_m_havego
.p2align 12
L_m_p1done:
s_mov_b32 s82, 0
L_m_poll6:
buffer_load_dword v9, off, s[24:27], 0 offset:128 sc1
s_waitcnt vmcnt(0)
v_cmp_gt_u32 vcc, 1, v9
s_cmp_eq_u64 vcc, 0
s_cbranch_scc1 L_m_poll6d
s_sleep 8
s_add_u32 s82, s82, 1
s_cmp_lt_u32 s82, 0x40000
s_cbranch_scc1 L_m_poll6
L_m_poll6d:
L_m_havego:
s_cmp_eq_u32 s86, 0
s_cbranch_scc1 L_m_noflag
v_mov_b32 v9, 1
s_mov_b64 exec, 1
buffer_store_dword v9, off, s[16:19], s86 sc1
s_mov_b64 exec, -1
L_m_noflag:
s_lshl_b32 s3, s29, 19
s_add_u32 s46, s46, s3
s_addc_u32 s47, s47, 0
s_sub_u32 s46, s46, 896
s_subb_u32 s47, s47, 0
s_add_u32 s48, s48, s3
s_addc_u32 s49, s49, 0
s_sub_u32 s48, s48, 896
s_subb_u32 s49, s49, 0
s_cmp_ge_u32 s90, s91
s_cbranch_scc1 L_m_wq7d
L_m_wq7:
s_lshl_b32 s3, s89, 14
s_add_u32 m0, s3, s31
s_lshl_b32 s3, s89, 19
s_add_u32 s43, s3, 4096
buffer_load_dwordx4 v254, s[12:15], s43 offen offset:0 lds
s_add_u32 s43, s3, 3200
buffer_load_dwordx4 v254, s[12:15], s43 offen offset:1024 lds
s_add_u32 s43, s3, 67584
buffer_load_dwordx4 v254, s[12:15], s43 offen offset:2048 lds
s_add_u32 s43, s3, 66688
buffer_load_dwordx4 v254, s[12:15], s43 offen offset:3072 lds
s_add_u32 s89, s89, 1
s_cmp_eq_u32 s89, s91
s_cselect_b32 s89, 0, s89
s_add_u32 s90, s90, 1
s_cmp_lt_u32 s90, s91
s_cbranch_scc1 L_m_wq7
L_m_wq7d:
s_mov_b32 s20, s52
s_mov_b32 s21, s53
s_mov_b32 s22, 5242880
s_mov_b32 s23, 0x20000
s_mov_b32 s38, 0
s_mov_b32 s41, 40894464
s_mul_i32 s40, s30, 81920
s_mov_b32 s88, s64
s_mov_b32 s89, s65
s_cmp_lt_u32 s2, 160
s_cselect_b32 s90, 4915200, 0
s_mov_b32 s91, 0x20000
s_mul_i32 s86, s83, 20
s_lshr_b32 s3, s2, 3
s_add_u32 s86, s86, s3
s_cmp_lt_u32 s30, 16
s_cselect_b32 s8, s46, s48
s_cselect_b32 s9, s47, s49
s_mov_b32 s10, 525184
s_mov_b32 s11, 0x20000
s_and_b32 s36, s30, 15
s_mul_i32 s36, s36, 3072
s_add_u32 s36, s36, 896
v_min_u32 v253, 368, v250
v_lshlrev_b32 v253, 3, v253
s_cmp_eq_u32 s0, 2
s_cbranch_scc1 L_m_chd
L_m_chs:
s_mov_b64 exec, 0
s_cmp_eq_u32 s28, 1
s_cbranch_scc1 L_m_c0_1
s_cmp_eq_u32 s28, 2
s_cbranch_scc1 L_m_c0_2
s_cmp_eq_u32 s28, 3
s_cbranch_scc1 L_m_c0_3
s_branch L_m_c0_0
L_m_c0_ret:
s_mov_b64 exec, -1
s_cmp_eq_u32 s0, 1
s_cbranch_scc1 L_m_lnback
L_m_chd:
s_mov_b64 exec, 31
s_mov_b32 s82, 0
L_m_poll8:
buffer_load_dword v11, v5, s[16:19], s41 offen sc1
s_waitcnt vmcnt(0)
v_cmp_gt_u32 vcc, 1, v11
s_cmp_eq_u64 vcc, 0
s_cbranch_scc1 L_m_poll8d
s_sleep 2
s_add_u32 s82, s82, 1
s_cmp_lt_u32 s82, 0x40000
s_cbranch_scc1 L_m_poll8
L_m_poll8d:
s_mov_b64 exec, -1
s_add_u32 s42, s40, 0
buffer_load_dwordx4 a[136:139], v250, s[16:19], s42 offen offset:0 sc1
buffer_load_dwordx4 a[140:143], v250, s[16:19], s42 offen offset:1024 sc1
buffer_load_dwordx4 a[144:147], v250, s[16:19], s42 offen offset:2048 sc1
buffer_load_dwordx4 a[148:151], v250, s[16:19], s42 offen offset:3072 sc1
s_add_u32 s42, s40, 4096
buffer_load_dwordx4 a[152:155], v250, s[16:19], s42 offen offset:0 sc1
buffer_load_dwordx4 a[156:159], v250, s[16:19], s42 offen offset:1024 sc1
buffer_load_dwordx4 a[160:163], v250, s[16:19], s42 offen offset:2048 sc1
buffer_load_dwordx4 a[164:167], v250, s[16:19], s42 offen offset:3072 sc1
s_add_u32 s42, s40, 8192
buffer_load_dwordx4 a[168:171], v250, s[16:19], s42 offen offset:0 sc1
buffer_load_dwordx4 a[172:175], v250, s[16:19], s42 offen offset:1024 sc1
buffer_load_dwordx4 a[176:179], v250, s[16:19], s42 offen offset:2048 sc1
buffer_load_dwordx4 a[180:183], v250, s[16:19], s42 offen offset:3072 sc1
s_waitcnt lgkmcnt(0)
s_barrier
ds_read_b64_tr_b16 a[64:65], v251 offset:0
ds_read_b64_tr_b16 a[66:67], v251 offset:256
ds_read_b64_tr_b16 a[68:69], v251 offset:8192
ds_read_b64_tr_b16 a[70:71], v251 offset:8448
ds_read_b64_tr_b16 a[72:73], v251 offset:8
ds_read_b64_tr_b16 a[74:75], v251 offset:264
ds_read_b64_tr_b16 a[76:77], v251 offset:8200
ds_read_b64_tr_b16 a[78:79], v251 offset:8456
v_mov_b32 v244, v245
v_mov_b32 v246, v247
v_xor_b32 v249, 32, v247
s_waitcnt vmcnt(4)
s_waitcnt lgkmcnt(4)
v_mfma_f32_16x16x32_bf16 v[0:3], a[64:67], a[136:139], 0
ds_read_b64_tr_b16 a[80:81], v251 offset:512
ds_read_b64_tr_b16 a[82:83], v251 offset:768
v_mfma_f32_16x16x32_bf16 v[0:3], a[68:71], a[152:155], v[0:3]
ds_read_b64_tr_b16 a[84:85], v251 offset:8704
ds_read_b64_tr_b16 a[86:87], v251 offset:8960
v_mfma_f32_16x16x32_bf16 v[32:35], a[68:71], a[156:159], 0
s_add_u32 s42, s40, 12288
buffer_load_dwordx4 a[184:187], v250, s[16:19], s42 offen offset:0 sc1
v_mfma_f32_16x16x32_bf16 v[32:35], a[64:67], a[140:143], v[32:35]
v_mfma_f32_16x16x32_bf16 v[64:67], a[64:67], a[144:147], 0
v_mfma_f32_16x16x32_bf16 v[64:67], a[68:71], a[160:163], v[64:67]
buffer_load_dwordx4 a[188:191], v250, s[16:19], s42 offen offset:1024 sc1
v_mfma_f32_16x16x32_bf16 v[96:99], a[68:71], a[164:167], 0
v_mfma_f32_16x16x32_bf16 v[96:99], a[64:67], a[148:151], v[96:99]
s_waitcnt lgkmcnt(4)
v_mfma_f32_16x16x32_bf16 v[100:103], a[72:75], a[148:151], 0
ds_read_b64_tr_b16 a[88:89], v251 offset:520
ds_read_b64_tr_b16 a[90:91], v251 offset:776
v_mfma_f32_16x16x32_bf16 v[100:103], a[76:79], a[164:167], v[100:103]
ds_read_b64_tr_b16 a[92:93], v251 offset:8712
ds_read_b64_tr_b16 a[94:95], v251 offset:8968
v_mfma_f32_16x16x32_bf16 v[68:71], a[76:79], a[160:163], 0
buffer_load_dwordx4 a[192:195], v250, s[16:19], s42 offen offset:2048 sc1
v_mfma_f32_16x16x32_bf16 v[68:71], a[72:75], a[144:147], v[68:71]
v_mfma_f32_16x16x32_bf16 v[36:39], a[72:75], a[140:143], 0
v_mfma_f32_16x16x32_bf16 v[36:39], a[76:79], a[156:159], v[36:39]
buffer_load_dwordx4 a[196:199], v250, s[16:19], s42 offen offset:3072 sc1
v_mfma_f32_16x16x32_bf16 v[4:7], a[76:79], a[152:155], 0
v_mfma_f32_16x16x32_bf16 v[4:7], a[72:75], a[136:139], v[4:7]
s_waitcnt lgkmcnt(4)
v_mfma_f32_16x16x32_bf16 v[8:11], a[80:83], a[136:139], 0
ds_read_b64_tr_b16 a[96:97], v251 offset:1024
ds_read_b64_tr_b16 a[98:99], v251 offset:1280
v_mfma_f32_16x16x32_bf16 v[8:11], a[84:87], a[152:155], v[8:11]
ds_read_b64_tr_b16 a[100:101], v251 offset:9216
ds_read_b64_tr_b16 a[102:103], v251 offset:9472
v_mfma_f32_16x16x32_bf16 v[40:43], a[84:87], a[156:159], 0
s_add_u32 s42, s40, 16384
buffer_load_dwordx4 a[200:203], v250, s[16:19], s42 offen offset:0 sc1
v_mfma_f32_16x16x32_bf16 v[40:43], a[80:83], a[140:143], v[40:43]
v_mfma_f32_16x16x32_bf16 v[72:75], a[80:83], a[144:147], 0
v_mfma_f32_16x16x32_bf16 v[72:75], a[84:87], a[160:163], v[72:75]
buffer_load_dwordx4 a[204:207], v250, s[16:19], s42 offen offset:1024 sc1
v_mfma_f32_16x16x32_bf16 v[104:107], a[84:87], a[164:167], 0
v_mfma_f32_16x16x32_bf16 v[104:107], a[80:83], a[148:151], v[104:107]
s_waitcnt lgkmcnt(4)
v_mfma_f32_16x16x32_bf16 v[108:111], a[88:91], a[148:151], 0
ds_read_b64_tr_b16 a[104:105], v251 offset:1032
ds_read_b64_tr_b16 a[106:107], v251 offset:1288
v_mfma_f32_16x16x32_bf16 v[108:111], a[92:95], a[164:167], v[108:111]
ds_read_b64_tr_b16 a[108:109], v251 offset:9224
ds_read_b64_tr_b16 a[110:111], v251 offset:9480
v_mfma_f32_16x16x32_bf16 v[76:79], a[92:95], a[160:163], 0
buffer_load_dwordx4 a[208:211], v250, s[16:19], s42 offen offset:2048 sc1
v_mfma_f32_16x16x32_bf16 v[76:79], a[88:91], a[144:147], v[76:79]
v_mfma_f32_16x16x32_bf16 v[44:47], a[88:91], a[140:143], 0
v_mfma_f32_16x16x32_bf16 v[44:47], a[92:95], a[156:159], v[44:47]
buffer_load_dwordx4 a[212:215], v250, s[16:19], s42 offen offset:3072 sc1
v_mfma_f32_16x16x32_bf16 v[12:15], a[92:95], a[152:155], 0
v_mfma_f32_16x16x32_bf16 v[12:15], a[88:91], a[136:139], v[12:15]
s_waitcnt lgkmcnt(4)
v_mfma_f32_16x16x32_bf16 v[16:19], a[96:99], a[136:139], 0
ds_read_b64_tr_b16 a[112:113], v251 offset:1536
ds_read_b64_tr_b16 a[114:115], v251 offset:1792
v_mfma_f32_16x16x32_bf16 v[16:19], a[100:103], a[152:155], v[16:19]
ds_read_b64_tr_b16 a[116:117], v251 offset:9728
ds_read_b64_tr_b16 a[118:119], v251 offset:9984
v_mfma_f32_16x16x32_bf16 v[48:51], a[100:103], a[156:159], 0
s_add_u32 s42, s40, 20480
buffer_load_dwordx4 a[216:219], v250, s[16:19], s42 offen offset:0 sc1
v_mfma_f32_16x16x32_bf16 v[48:51], a[96:99], a[140:143], v[48:51]
v_mfma_f32_16x16x32_bf16 v[80:83], a[96:99], a[144:147], 0
v_mfma_f32_16x16x32_bf16 v[80:83], a[100:103], a[160:163], v[80:83]
buffer_load_dwordx4 a[220:223], v250, s[16:19], s42 offen offset:1024 sc1
v_mfma_f32_16x16x32_bf16 v[112:115], a[100:103], a[164:167], 0
v_mfma_f32_16x16x32_bf16 v[112:115], a[96:99], a[148:151], v[112:115]
s_waitcnt lgkmcnt(4)
v_mfma_f32_16x16x32_bf16 v[116:119], a[104:107], a[148:151], 0
ds_read_b64_tr_b16 a[120:121], v251 offset:1544
ds_read_b64_tr_b16 a[122:123], v251 offset:1800
v_mfma_f32_16x16x32_bf16 v[116:119], a[108:111], a[164:167], v[116:119]
ds_read_b64_tr_b16 a[124:125], v251 offset:9736
ds_read_b64_tr_b16 a[126:127], v251 offset:9992
v_mfma_f32_16x16x32_bf16 v[84:87], a[108:111], a[160:163], 0
buffer_load_dwordx4 a[224:227], v250, s[16:19], s42 offen offset:2048 sc1
v_mfma_f32_16x16x32_bf16 v[84:87], a[104:107], a[144:147], v[84:87]
v_mfma_f32_16x16x32_bf16 v[52:55], a[104:107], a[140:143], 0
v_mfma_f32_16x16x32_bf16 v[52:55], a[108:111], a[156:159], v[52:55]
v_mfma_f32_16x16x32_bf16 v[20:23], a[108:111], a[152:155], 0
v_add_u32 v251, 16384, v252
v_mfma_f32_16x16x32_bf16 v[20:23], a[104:107], a[136:139], v[20:23]
s_waitcnt lgkmcnt(4)
v_mfma_f32_16x16x32_bf16 v[24:27], a[112:115], a[136:139], 0
ds_read_b64_tr_b16 a[64:65], v251 offset:0
ds_read_b64_tr_b16 a[66:67], v251 offset:256
v_mfma_f32_16x16x32_bf16 v[24:27], a[116:119], a[152:155], v[24:27]
ds_read_b64_tr_b16 a[68:69], v251 offset:8192
ds_read_b64_tr_b16 a[70:71], v251 offset:8448
v_mfma_f32_16x16x32_bf16 v[56:59], a[116:119], a[156:159], 0
buffer_load_dwordx4 a[228:231], v250, s[16:19], s42 offen offset:3072 sc1
v_mfma_f32_16x16x32_bf16 v[56:59], a[112:115], a[140:143], v[56:59]
v_mfma_f32_16x16x32_bf16 v[88:91], a[112:115], a[144:147], 0
v_mfma_f32_16x16x32_bf16 v[88:91], a[116:119], a[160:163], v[88:91]
v_mfma_f32_16x16x32_bf16 v[120:123], a[116:119], a[164:167], 0
v_mfma_f32_16x16x32_bf16 v[120:123], a[112:115], a[148:151], v[120:123]
s_waitcnt lgkmcnt(4)
v_mfma_f32_16x16x32_bf16 v[124:127], a[120:123], a[148:151], 0
ds_read_b64_tr_b16 a[72:73], v251 offset:8
ds_read_b64_tr_b16 a[74:75], v251 offset:264
v_mfma_f32_16x16x32_bf16 v[124:127], a[124:127], a[164:167], v[124:127]
ds_read_b64_tr_b16 a[76:77], v251 offset:8200
ds_read_b64_tr_b16 a[78:79], v251 offset:8456
v_mfma_f32_16x16x32_bf16 v[92:95], a[124:127], a[160:163], 0
buffer_load_dword a135, v253, s[8:11], s36 offen
v_mfma_f32_16x16x32_bf16 v[92:95], a[120:123], a[144:147], v[92:95]
v_mfma_f32_16x16x32_bf16 v[60:63], a[120:123], a[140:143], 0
v_mfma_f32_16x16x32_bf16 v[60:63], a[124:127], a[156:159], v[60:63]
v_mfma_f32_16x16x32_bf16 v[28:31], a[124:127], a[152:155], 0
v_mfma_f32_16x16x32_bf16 v[28:31], a[120:123], a[136:139], v[28:31]
s_waitcnt lgkmcnt(4)
s_waitcnt vmcnt(9)
v_mfma_f32_16x16x32_bf16 v[0:3], a[64:67], a[168:171], v[0:3]
ds_read_b64_tr_b16 a[80:81], v251 offset:512
ds_read_b64_tr_b16 a[82:83], v251 offset:768
v_mfma_f32_16x16x32_bf16 v[0:3], a[68:71], a[184:187], v[0:3]
ds_read_b64_tr_b16 a[84:85], v251 offset:8704
ds_read_b64_tr_b16 a[86:87], v251 offset:8960
v_mfma_f32_16x16x32_bf16 v[32:35], a[68:71], a[188:191], v[32:35]
s_add_u32 s42, s40, 24576
buffer_load_dwordx4 a[136:139], v250, s[16:19], s42 offen offset:0 sc1
v_mfma_f32_16x16x32_bf16 v[32:35], a[64:67], a[172:175], v[32:35]
v_mfma_f32_16x16x32_bf16 v[64:67], a[64:67], a[176:179], v[64:67]
v_mfma_f32_16x16x32_bf16 v[64:67], a[68:71], a[192:195], v[64:67]
v_mfma_f32_16x16x32_bf16 v[96:99], a[68:71], a[196:199], v[96:99]
v_mfma_f32_16x16x32_bf16 v[96:99], a[64:67], a[180:183], v[96:99]
s_waitcnt lgkmcnt(4)
v_mfma_f32_16x16x32_bf16 v[100:103], a[72:75], a[180:183], v[100:103]
ds_read_b64_tr_b16 a[88:89], v251 offset:520
ds_read_b64_tr_b16 a[90:91], v251 offset:776
v_mfma_f32_16x16x32_bf16 v[100:103], a[76:79], a[196:199], v[100:103]
ds_read_b64_tr_b16 a[92:93], v251 offset:8712
ds_read_b64_tr_b16 a[94:95], v251 offset:8968
v_mfma_f32_16x16x32_bf16 v[68:71], a[76:79], a[192:195], v[68:71]
buffer_load_dwordx4 a[140:143], v250, s[16:19], s42 offen offset:1024 sc1
v_mfma_f32_16x16x32_bf16 v[68:71], a[72:75], a[176:179], v[68:71]
v_mfma_f32_16x16x32_bf16 v[36:39], a[72:75], a[172:175], v[36:39]
v_mfma_f32_16x16x32_bf16 v[36:39], a[76:79], a[188:191], v[36:39]
v_mfma_f32_16x16x32_bf16 v[4:7], a[76:79], a[184:187], v[4:7]
v_mfma_f32_16x16x32_bf16 v[4:7], a[72:75], a[168:171], v[4:7]
s_waitcnt lgkmcnt(4)
v_mfma_f32_16x16x32_bf16 v[8:11], a[80:83], a[168:171], v[8:11]
ds_read_b64_tr_b16 a[96:97], v251 offset:1024
ds_read_b64_tr_b16 a[98:99], v251 offset:1280
v_mfma_f32_16x16x32_bf16 v[8:11], a[84:87], a[184:187], v[8:11]
ds_read_b64_tr_b16 a[100:101], v251 offset:9216
ds_read_b64_tr_b16 a[102:103], v251 offset:9472
v_mfma_f32_16x16x32_bf16 v[40:43], a[84:87], a[188:191], v[40:43]
buffer_load_dwordx4 a[144:147], v250, s[16:19], s42 offen offset:2048 sc1
v_mfma_f32_16x16x32_bf16 v[40:43], a[80:83], a[172:175], v[40:43]
v_mfma_f32_16x16x32_bf16 v[72:75], a[80:83], a[176:179], v[72:75]
v_mfma_f32_16x16x32_bf16 v[72:75], a[84:87], a[192:195], v[72:75]
v_mfma_f32_16x16x32_bf16 v[104:107], a[84:87], a[196:199], v[104:107]
v_mfma_f32_16x16x32_bf16 v[104:107], a[80:83], a[180:183], v[104:107]
s_waitcnt lgkmcnt(4)
v_mfma_f32_16x16x32_bf16 v[108:111], a[88:91], a[180:183], v[108:111]
ds_read_b64_tr_b16 a[104:105], v251 offset:1032
ds_read_b64_tr_b16 a[106:107], v251 offset:1288
v_mfma_f32_16x16x32_bf16 v[108:111], a[92:95], a[196:199], v[108:111]
ds_read_b64_tr_b16 a[108:109], v251 offset:9224
ds_read_b64_tr_b16 a[110:111], v251 offset:9480
v_mfma_f32_16x16x32_bf16 v[76:79], a[92:95], a[192:195], v[76:79]
buffer_load_dwordx4 a[148:151], v250, s[16:19], s42 offen offset:3072 sc1
v_mfma_f32_16x16x32_bf16 v[76:79], a[88:91], a[176:179], v[76:79]
v_mfma_f32_16x16x32_bf16 v[44:47], a[88:91], a[172:175], v[44:47]
v_mfma_f32_16x16x32_bf16 v[44:47], a[92:95], a[188:191], v[44:47]
v_mfma_f32_16x16x32_bf16 v[12:15], a[92:95], a[184:187], v[12:15]
v_mfma_f32_16x16x32_bf16 v[12:15], a[88:91], a[168:171], v[12:15]
s_waitcnt lgkmcnt(4)
v_mfma_f32_16x16x32_bf16 v[16:19], a[96:99], a[168:171], v[16:19]
ds_read_b64_tr_b16 a[112:113], v251 offset:1536
ds_read_b64_tr_b16 a[114:115], v251 offset:1792
v_mfma_f32_16x16x32_bf16 v[16:19], a[100:103], a[184:187], v[16:19]
ds_read_b64_tr_b16 a[116:117], v251 offset:9728
ds_read_b64_tr_b16 a[118:119], v251 offset:9984
v_mfma_f32_16x16x32_bf16 v[48:51], a[100:103], a[188:191], v[48:51]
s_add_u32 s42, s40, 28672
buffer_load_dwordx4 a[152:155], v250, s[16:19], s42 offen offset:0 sc1
v_mfma_f32_16x16x32_bf16 v[48:51], a[96:99], a[172:175], v[48:51]
v_mfma_f32_16x16x32_bf16 v[80:83], a[96:99], a[176:179], v[80:83]
v_mfma_f32_16x16x32_bf16 v[80:83], a[100:103], a[192:195], v[80:83]
v_mfma_f32_16x16x32_bf16 v[112:115], a[100:103], a[196:199], v[112:115]
v_mfma_f32_16x16x32_bf16 v[112:115], a[96:99], a[180:183], v[112:115]
s_waitcnt lgkmcnt(4)
v_mfma_f32_16x16x32_bf16 v[116:119], a[104:107], a[180:183], v[116:119]
ds_read_b64_tr_b16 a[120:121], v251 offset:1544
ds_read_b64_tr_b16 a[122:123], v251 offset:1800
v_mfma_f32_16x16x32_bf16 v[116:119], a[108:111], a[196:199], v[116:119]
ds_read_b64_tr_b16 a[124:125], v251 offset:9736
ds_read_b64_tr_b16 a[126:127], v251 offset:9992
v_mfma_f32_16x16x32_bf16 v[84:87], a[108:111], a[192:195], v[84:87]
buffer_load_dwordx4 a[156:159], v250, s[16:19], s42 offen offset:1024 sc1
v_mfma_f32_16x16x32_bf16 v[84:87], a[104:107], a[176:179], v[84:87]
v_mfma_f32_16x16x32_bf16 v[52:55], a[104:107], a[172:175], v[52:55]
v_mfma_f32_16x16x32_bf16 v[52:55], a[108:111], a[188:191], v[52:55]
v_mfma_f32_16x16x32_bf16 v[20:23], a[108:111], a[184:187], v[20:23]
v_add_u32 v251, 32768, v252
v_mfma_f32_16x16x32_bf16 v[20:23], a[104:107], a[168:171], v[20:23]
s_waitcnt lgkmcnt(4)
v_mfma_f32_16x16x32_bf16 v[24:27], a[112:115], a[168:171], v[24:27]
ds_read_b64_tr_b16 a[64:65], v251 offset:0
ds_read_b64_tr_b16 a[66:67], v251 offset:256
v_mfma_f32_16x16x32_bf16 v[24:27], a[116:119], a[184:187], v[24:27]
ds_read_b64_tr_b16 a[68:69], v251 offset:8192
ds_read_b64_tr_b16 a[70:71], v251 offset:8448
v_mfma_f32_16x16x32_bf16 v[56:59], a[116:119], a[188:191], v[56:59]
buffer_load_dwordx4 a[160:163], v250, s[16:19], s42 offen offset:2048 sc1
v_mfma_f32_16x16x32_bf16 v[56:59], a[112:115], a[172:175], v[56:59]
v_mfma_f32_16x16x32_bf16 v[88:91], a[112:115], a[176:179], v[88:91]
v_mfma_f32_16x16x32_bf16 v[88:91], a[116:119], a[192:195], v[88:91]
v_mfma_f32_16x16x32_bf16 v[120:123], a[116:119], a[196:199], v[120:123]
v_mfma_f32_16x16x32_bf16 v[120:123], a[112:115], a[180:183], v[120:123]
s_waitcnt lgkmcnt(4)
v_mfma_f32_16x16x32_bf16 v[124:127], a[120:123], a[180:183], v[124:127]
ds_read_b64_tr_b16 a[72:73], v251 offset:8
ds_read_b64_tr_b16 a[74:75], v251 offset:264
v_mfma_f32_16x16x32_bf16 v[124:127], a[124:127], a[196:199], v[124:127]
ds_read_b64_tr_b16 a[76:77], v251 offset:8200
ds_read_b64_tr_b16 a[78:79], v251 offset:8456
v_mfma_f32_16x16x32_bf16 v[92:95], a[124:127], a[192:195], v[92:95]
buffer_load_dwordx4 a[164:167], v250, s[16:19], s42 offen offset:3072 sc1
v_mfma_f32_16x16x32_bf16 v[92:95], a[120:123], a[176:179], v[92:95]
v_mfma_f32_16x16x32_bf16 v[60:63], a[120:123], a[172:175], v[60:63]
v_mfma_f32_16x16x32_bf16 v[60:63], a[124:127], a[188:191], v[60:63]
v_mfma_f32_16x16x32_bf16 v[28:31], a[124:127], a[184:187], v[28:31]
v_mfma_f32_16x16x32_bf16 v[28:31], a[120:123], a[168:171], v[28:31]
s_waitcnt lgkmcnt(4)
s_waitcnt vmcnt(9)
v_mfma_f32_16x16x32_bf16 v[0:3], a[64:67], a[200:203], v[0:3]
ds_read_b64_tr_b16 a[80:81], v251 offset:512
ds_read_b64_tr_b16 a[82:83], v251 offset:768
v_mfma_f32_16x16x32_bf16 v[0:3], a[68:71], a[216:219], v[0:3]
ds_read_b64_tr_b16 a[84:85], v251 offset:8704
ds_read_b64_tr_b16 a[86:87], v251 offset:8960
v_mfma_f32_16x16x32_bf16 v[32:35], a[68:71], a[220:223], v[32:35]
s_add_u32 s42, s40, 32768
buffer_load_dwordx4 a[168:171], v250, s[16:19], s42 offen offset:0 sc1
v_mfma_f32_16x16x32_bf16 v[32:35], a[64:67], a[204:207], v[32:35]
v_mfma_f32_16x16x32_bf16 v[64:67], a[64:67], a[208:211], v[64:67]
v_mfma_f32_16x16x32_bf16 v[64:67], a[68:71], a[224:227], v[64:67]
v_mfma_f32_16x16x32_bf16 v[96:99], a[68:71], a[228:231], v[96:99]
v_mfma_f32_16x16x32_bf16 v[96:99], a[64:67], a[212:215], v[96:99]
s_waitcnt lgkmcnt(4)
v_mfma_f32_16x16x32_bf16 v[100:103], a[72:75], a[212:215], v[100:103]
ds_read_b64_tr_b16 a[88:89], v251 offset:520
ds_read_b64_tr_b16 a[90:91], v251 offset:776
v_mfma_f32_16x16x32_bf16 v[100:103], a[76:79], a[228:231], v[100:103]
ds_read_b64_tr_b16 a[92:93], v251 offset:8712
ds_read_b64_tr_b16 a[94:95], v251 offset:8968
v_mfma_f32_16x16x32_bf16 v[68:71], a[76:79], a[224:227], v[68:71]
buffer_load_dwordx4 a[172:175], v250, s[16:19], s42 offen offset:1024 sc1
v_mfma_f32_16x16x32_bf16 v[68:71], a[72:75], a[208:211], v[68:71]
v_mfma_f32_16x16x32_bf16 v[36:39], a[72:75], a[204:207], v[36:39]
v_mfma_f32_16x16x32_bf16 v[36:39], a[76:79], a[220:223], v[36:39]
v_mfma_f32_16x16x32_bf16 v[4:7], a[76:79], a[216:219], v[4:7]
v_mfma_f32_16x16x32_bf16 v[4:7], a[72:75], a[200:203], v[4:7]
s_waitcnt lgkmcnt(4)
v_mfma_f32_16x16x32_bf16 v[8:11], a[80:83], a[200:203], v[8:11]
ds_read_b64_tr_b16 a[96:97], v251 offset:1024
ds_read_b64_tr_b16 a[98:99], v251 offset:1280
v_mfma_f32_16x16x32_bf16 v[8:11], a[84:87], a[216:219], v[8:11]
ds_read_b64_tr_b16 a[100:101], v251 offset:9216
ds_read_b64_tr_b16 a[102:103], v251 offset:9472
v_mfma_f32_16x16x32_bf16 v[40:43], a[84:87], a[220:223], v[40:43]
buffer_load_dwordx4 a[176:179], v250, s[16:19], s42 offen offset:2048 sc1
v_mfma_f32_16x16x32_bf16 v[40:43], a[80:83], a[204:207], v[40:43]
v_mfma_f32_16x16x32_bf16 v[72:75], a[80:83], a[208:211], v[72:75]
v_mfma_f32_16x16x32_bf16 v[72:75], a[84:87], a[224:227], v[72:75]
v_mfma_f32_16x16x32_bf16 v[104:107], a[84:87], a[228:231], v[104:107]
v_mfma_f32_16x16x32_bf16 v[104:107], a[80:83], a[212:215], v[104:107]
s_waitcnt lgkmcnt(4)
v_mfma_f32_16x16x32_bf16 v[108:111], a[88:91], a[212:215], v[108:111]
ds_read_b64_tr_b16 a[104:105], v251 offset:1032
ds_read_b64_tr_b16 a[106:107], v251 offset:1288
v_mfma_f32_16x16x32_bf16 v[108:111], a[92:95], a[228:231], v[108:111]
ds_read_b64_tr_b16 a[108:109], v251 offset:9224
ds_read_b64_tr_b16 a[110:111], v251 offset:9480
v_mfma_f32_16x16x32_bf16 v[76:79], a[92:95], a[224:227], v[76:79]
buffer_load_dwordx4 a[180:183], v250, s[16:19], s42 offen offset:3072 sc1
v_mfma_f32_16x16x32_bf16 v[76:79], a[88:91], a[208:211], v[76:79]
v_mfma_f32_16x16x32_bf16 v[44:47], a[88:91], a[204:207], v[44:47]
v_mfma_f32_16x16x32_bf16 v[44:47], a[92:95], a[220:223], v[44:47]
v_mfma_f32_16x16x32_bf16 v[12:15], a[92:95], a[216:219], v[12:15]
v_mfma_f32_16x16x32_bf16 v[12:15], a[88:91], a[200:203], v[12:15]
s_waitcnt lgkmcnt(4)
v_mfma_f32_16x16x32_bf16 v[16:19], a[96:99], a[200:203], v[16:19]
ds_read_b64_tr_b16 a[112:113], v251 offset:1536
ds_read_b64_tr_b16 a[114:115], v251 offset:1792
v_mfma_f32_16x16x32_bf16 v[16:19], a[100:103], a[216:219], v[16:19]
ds_read_b64_tr_b16 a[116:117], v251 offset:9728
ds_read_b64_tr_b16 a[118:119], v251 offset:9984
v_mfma_f32_16x16x32_bf16 v[48:51], a[100:103], a[220:223], v[48:51]
s_add_u32 s42, s40, 36864
buffer_load_dwordx4 a[184:187], v250, s[16:19], s42 offen offset:0 sc1
v_mfma_f32_16x16x32_bf16 v[48:51], a[96:99], a[204:207], v[48:51]
v_mfma_f32_16x16x32_bf16 v[80:83], a[96:99], a[208:211], v[80:83]
v_mfma_f32_16x16x32_bf16 v[80:83], a[100:103], a[224:227], v[80:83]
v_mfma_f32_16x16x32_bf16 v[112:115], a[100:103], a[228:231], v[112:115]
v_mfma_f32_16x16x32_bf16 v[112:115], a[96:99], a[212:215], v[112:115]
s_waitcnt lgkmcnt(4)
v_mfma_f32_16x16x32_bf16 v[116:119], a[104:107], a[212:215], v[116:119]
ds_read_b64_tr_b16 a[120:121], v251 offset:1544
ds_read_b64_tr_b16 a[122:123], v251 offset:1800
v_mfma_f32_16x16x32_bf16 v[116:119], a[108:111], a[228:231], v[116:119]
ds_read_b64_tr_b16 a[124:125], v251 offset:9736
ds_read_b64_tr_b16 a[126:127], v251 offset:9992
v_mfma_f32_16x16x32_bf16 v[84:87], a[108:111], a[224:227], v[84:87]
buffer_load_dwordx4 a[188:191], v250, s[16:19], s42 offen offset:1024 sc1
v_mfma_f32_16x16x32_bf16 v[84:87], a[104:107], a[208:211], v[84:87]
v_mfma_f32_16x16x32_bf16 v[52:55], a[104:107], a[204:207], v[52:55]
v_mfma_f32_16x16x32_bf16 v[52:55], a[108:111], a[220:223], v[52:55]
v_mfma_f32_16x16x32_bf16 v[20:23], a[108:111], a[216:219], v[20:23]
v_add_u32 v251, 49152, v252
v_mfma_f32_16x16x32_bf16 v[20:23], a[104:107], a[200:203], v[20:23]
s_waitcnt lgkmcnt(4)
v_mfma_f32_16x16x32_bf16 v[24:27], a[112:115], a[200:203], v[24:27]
s_barrier
ds_read_b64_tr_b16 a[64:65], v251 offset:0
ds_read_b64_tr_b16 a[66:67], v251 offset:256
v_mfma_f32_16x16x32_bf16 v[24:27], a[116:119], a[216:219], v[24:27]
ds_read_b64_tr_b16 a[68:69], v251 offset:8192
ds_read_b64_tr_b16 a[70:71], v251 offset:8448
v_mfma_f32_16x16x32_bf16 v[56:59], a[116:119], a[220:223], v[56:59]
buffer_load_dwordx4 a[192:195], v250, s[16:19], s42 offen offset:2048 sc1
v_mfma_f32_16x16x32_bf16 v[56:59], a[112:115], a[204:207], v[56:59]
v_mfma_f32_16x16x32_bf16 v[88:91], a[112:115], a[208:211], v[88:91]
v_mfma_f32_16x16x32_bf16 v[88:91], a[116:119], a[224:227], v[88:91]
v_mfma_f32_16x16x32_bf16 v[120:123], a[116:119], a[228:231], v[120:123]
v_mfma_f32_16x16x32_bf16 v[120:123], a[112:115], a[212:215], v[120:123]
s_waitcnt lgkmcnt(4)
v_mfma_f32_16x16x32_bf16 v[124:127], a[120:123], a[212:215], v[124:127]
ds_read_b64_tr_b16 a[72:73], v251 offset:8
ds_read_b64_tr_b16 a[74:75], v251 offset:264
v_mfma_f32_16x16x32_bf16 v[124:127], a[124:127], a[228:231], v[124:127]
ds_read_b64_tr_b16 a[76:77], v251 offset:8200
ds_read_b64_tr_b16 a[78:79], v251 offset:8456
v_mfma_f32_16x16x32_bf16 v[92:95], a[124:127], a[224:227], v[92:95]
buffer_load_dwordx4 a[196:199], v250, s[16:19], s42 offen offset:3072 sc1
v_mfma_f32_16x16x32_bf16 v[92:95], a[120:123], a[208:211], v[92:95]
s_add_u32 s4, s46, 896
s_addc_u32 s5, s47, 0
s_add_u32 s6, s46, 0
s_addc_u32 s7, s47, 0
s_add_u32 m0, s31, 0
v_mfma_f32_16x16x32_bf16 v[60:63], a[120:123], a[204:207], v[60:63]
global_load_lds_dwordx4 v248, s[4:5] offset:0
v_mfma_f32_16x16x32_bf16 v[60:63], a[124:127], a[220:223], v[60:63]
v_mfma_f32_16x16x32_bf16 v[28:31], a[124:127], a[216:219], v[28:31]
v_mfma_f32_16x16x32_bf16 v[28:31], a[120:123], a[200:203], v[28:31]
s_waitcnt lgkmcnt(4)
s_waitcnt vmcnt(9)
v_mfma_f32_16x16x32_bf16 v[0:3], a[64:67], a[136:139], v[0:3]
ds_read_b64_tr_b16 a[80:81], v251 offset:512
ds_read_b64_tr_b16 a[82:83], v251 offset:768
v_mfma_f32_16x16x32_bf16 v[0:3], a[68:71], a[152:155], v[0:3]
ds_read_b64_tr_b16 a[84:85], v251 offset:8704
ds_read_b64_tr_b16 a[86:87], v251 offset:8960
v_mfma_f32_16x16x32_bf16 v[32:35], a[68:71], a[156:159], v[32:35]
s_add_u32 s42, s40, 40960
buffer_load_dwordx4 a[200:203], v250, s[16:19], s42 offen offset:0 sc1
v_mfma_f32_16x16x32_bf16 v[32:35], a[64:67], a[140:143], v[32:35]
v_mfma_f32_16x16x32_bf16 v[64:67], a[64:67], a[144:147], v[64:67]
v_mfma_f32_16x16x32_bf16 v[64:67], a[68:71], a[160:163], v[64:67]
v_mfma_f32_16x16x32_bf16 v[96:99], a[68:71], a[164:167], v[96:99]
v_mfma_f32_16x16x32_bf16 v[96:99], a[64:67], a[148:151], v[96:99]
s_waitcnt lgkmcnt(4)
v_mfma_f32_16x16x32_bf16 v[100:103], a[72:75], a[148:151], v[100:103]
ds_read_b64_tr_b16 a[88:89], v251 offset:520
ds_read_b64_tr_b16 a[90:91], v251 offset:776
v_mfma_f32_16x16x32_bf16 v[100:103], a[76:79], a[164:167], v[100:103]
ds_read_b64_tr_b16 a[92:93], v251 offset:8712
ds_read_b64_tr_b16 a[94:95], v251 offset:8968
v_mfma_f32_16x16x32_bf16 v[68:71], a[76:79], a[160:163], v[68:71]
buffer_load_dwordx4 a[204:207], v250, s[16:19], s42 offen offset:1024 sc1
v_mfma_f32_16x16x32_bf16 v[68:71], a[72:75], a[144:147], v[68:71]
v_mfma_f32_16x16x32_bf16 v[36:39], a[72:75], a[140:143], v[36:39]
global_load_lds_dwordx4 v248, s[6:7] offset:1024
v_mfma_f32_16x16x32_bf16 v[36:39], a[76:79], a[156:159], v[36:39]
v_mfma_f32_16x16x32_bf16 v[4:7], a[76:79], a[152:155], v[4:7]
v_mfma_f32_16x16x32_bf16 v[4:7], a[72:75], a[136:139], v[4:7]
s_waitcnt lgkmcnt(4)
v_mfma_f32_16x16x32_bf16 v[8:11], a[80:83], a[136:139], v[8:11]
ds_read_b64_tr_b16 a[96:97], v251 offset:1024
ds_read_b64_tr_b16 a[98:99], v251 offset:1280
v_mfma_f32_16x16x32_bf16 v[8:11], a[84:87], a[152:155], v[8:11]
ds_read_b64_tr_b16 a[100:101], v251 offset:9216
ds_read_b64_tr_b16 a[102:103], v251 offset:9472
v_mfma_f32_16x16x32_bf16 v[40:43], a[84:87], a[156:159], v[40:43]
buffer_load_dwordx4 a[208:211], v250, s[16:19], s42 offen offset:2048 sc1
v_mfma_f32_16x16x32_bf16 v[40:43], a[80:83], a[140:143], v[40:43]
v_mfma_f32_16x16x32_bf16 v[72:75], a[80:83], a[144:147], v[72:75]
v_mfma_f32_16x16x32_bf16 v[72:75], a[84:87], a[160:163], v[72:75]
v_mfma_f32_16x16x32_bf16 v[104:107], a[84:87], a[164:167], v[104:107]
v_mfma_f32_16x16x32_bf16 v[104:107], a[80:83], a[148:151], v[104:107]
s_waitcnt lgkmcnt(4)
v_mfma_f32_16x16x32_bf16 v[108:111], a[88:91], a[148:151], v[108:111]
ds_read_b64_tr_b16 a[104:105], v251 offset:1032
ds_read_b64_tr_b16 a[106:107], v251 offset:1288
v_mfma_f32_16x16x32_bf16 v[108:111], a[92:95], a[164:167], v[108:111]
ds_read_b64_tr_b16 a[108:109], v251 offset:9224
ds_read_b64_tr_b16 a[110:111], v251 offset:9480
v_mfma_f32_16x16x32_bf16 v[76:79], a[92:95], a[160:163], v[76:79]
buffer_load_dwordx4 a[212:215], v250, s[16:19], s42 offen offset:3072 sc1
v_mfma_f32_16x16x32_bf16 v[76:79], a[88:91], a[144:147], v[76:79]
v_mfma_f32_16x16x32_bf16 v[44:47], a[88:91], a[140:143], v[44:47]
global_load_lds_dwordx4 v248, s[4:5] offset:2048
v_mfma_f32_16x16x32_bf16 v[44:47], a[92:95], a[156:159], v[44:47]
v_mfma_f32_16x16x32_bf16 v[12:15], a[92:95], a[152:155], v[12:15]
v_mfma_f32_16x16x32_bf16 v[12:15], a[88:91], a[136:139], v[12:15]
s_waitcnt lgkmcnt(4)
v_mfma_f32_16x16x32_bf16 v[16:19], a[96:99], a[136:139], v[16:19]
ds_read_b64_tr_b16 a[112:113], v251 offset:1536
ds_read_b64_tr_b16 a[114:115], v251 offset:1792
v_mfma_f32_16x16x32_bf16 v[16:19], a[100:103], a[152:155], v[16:19]
ds_read_b64_tr_b16 a[116:117], v251 offset:9728
ds_read_b64_tr_b16 a[118:119], v251 offset:9984
v_mfma_f32_16x16x32_bf16 v[48:51], a[100:103], a[156:159], v[48:51]
s_add_u32 s42, s40, 45056
buffer_load_dwordx4 a[216:219], v250, s[16:19], s42 offen offset:0 sc1
v_mfma_f32_16x16x32_bf16 v[48:51], a[96:99], a[140:143], v[48:51]
v_mfma_f32_16x16x32_bf16 v[80:83], a[96:99], a[144:147], v[80:83]
v_mfma_f32_16x16x32_bf16 v[80:83], a[100:103], a[160:163], v[80:83]
v_mfma_f32_16x16x32_bf16 v[112:115], a[100:103], a[164:167], v[112:115]
v_mfma_f32_16x16x32_bf16 v[112:115], a[96:99], a[148:151], v[112:115]
s_waitcnt lgkmcnt(4)
v_mfma_f32_16x16x32_bf16 v[116:119], a[104:107], a[148:151], v[116:119]
ds_read_b64_tr_b16 a[120:121], v251 offset:1544
ds_read_b64_tr_b16 a[122:123], v251 offset:1800
v_mfma_f32_16x16x32_bf16 v[116:119], a[108:111], a[164:167], v[116:119]
ds_read_b64_tr_b16 a[124:125], v251 offset:9736
ds_read_b64_tr_b16 a[126:127], v251 offset:9992
v_mfma_f32_16x16x32_bf16 v[84:87], a[108:111], a[160:163], v[84:87]
buffer_load_dwordx4 a[220:223], v250, s[16:19], s42 offen offset:1024 sc1
v_mfma_f32_16x16x32_bf16 v[84:87], a[104:107], a[144:147], v[84:87]
L_m_c0_0:
s_cbranch_execz L_m_c0_4
v_mfma_f32_16x16x32_bf16 v[52:55], a[104:107], a[140:143], v[52:55]
global_load_lds_dwordx4 v248, s[6:7] offset:3072
v_mfma_f32_16x16x32_bf16 v[52:55], a[108:111], a[156:159], v[52:55]
v_mfma_f32_16x16x32_bf16 v[20:23], a[108:111], a[152:155], v[20:23]
v_add_u32 v251, 65536, v252
v_mfma_f32_16x16x32_bf16 v[20:23], a[104:107], a[136:139], v[20:23]
s_waitcnt lgkmcnt(4)
v_mfma_f32_16x16x32_bf16 v[24:27], a[112:115], a[136:139], v[24:27]
ds_read_b64_tr_b16 a[64:65], v251 offset:0
ds_read_b64_tr_b16 a[66:67], v251 offset:256
v_mfma_f32_16x16x32_bf16 v[24:27], a[116:119], a[152:155], v[24:27]
ds_read_b64_tr_b16 a[68:69], v251 offset:8192
ds_read_b64_tr_b16 a[70:71], v251 offset:8448
v_mfma_f32_16x16x32_bf16 v[56:59], a[116:119], a[156:159], v[56:59]
buffer_load_dwordx4 a[224:227], v250, s[16:19], s42 offen offset:2048 sc1
v_mfma_f32_16x16x32_bf16 v[56:59], a[112:115], a[140:143], v[56:59]
v_mfma_f32_16x16x32_bf16 v[88:91], a[112:115], a[144:147], v[88:91]
v_mfma_f32_16x16x32_bf16 v[88:91], a[116:119], a[160:163], v[88:91]
v_mfma_f32_16x16x32_bf16 v[120:123], a[116:119], a[164:167], v[120:123]
v_mfma_f32_16x16x32_bf16 v[120:123], a[112:115], a[148:151], v[120:123]
s_waitcnt lgkmcnt(4)
v_mfma_f32_16x16x32_bf16 v[124:127], a[120:123], a[148:151], v[124:127]
ds_read_b64_tr_b16 a[72:73], v251 offset:8
ds_read_b64_tr_b16 a[74:75], v251 offset:264
v_mfma_f32_16x16x32_bf16 v[124:127], a[124:127], a[164:167], v[124:127]
ds_read_b64_tr_b16 a[76:77], v251 offset:8200
ds_read_b64_tr_b16 a[78:79], v251 offset:8456
v_mfma_f32_16x16x32_bf16 v[92:95], a[124:127], a[160:163], v[92:95]
buffer_load_dwordx4 a[228:231], v250, s[16:19], s42 offen offset:3072 sc1
v_mfma_f32_16x16x32_bf16 v[92:95], a[120:123], a[144:147], v[92:95]
s_add_u32 s4, s46, 17280
s_addc_u32 s5, s47, 0
s_add_u32 s6, s46, 16384
s_addc_u32 s7, s47, 0
s_add_u32 m0, s31, 16384
v_mfma_f32_16x16x32_bf16 v[60:63], a[120:123], a[140:143], v[60:63]
global_load_lds_dwordx4 v248, s[4:5] offset:0
v_mfma_f32_16x16x32_bf16 v[60:63], a[124:127], a[156:159], v[60:63]
v_mfma_f32_16x16x32_bf16 v[28:31], a[124:127], a[152:155], v[28:31]
v_mfma_f32_16x16x32_bf16 v[28:31], a[120:123], a[136:139], v[28:31]
s_waitcnt lgkmcnt(4)
s_waitcnt vmcnt(13)
v_mfma_f32_16x16x32_bf16 v[0:3], a[64:67], a[168:171], v[0:3]
ds_read_b64_tr_b16 a[80:81], v251 offset:512
ds_read_b64_tr_b16 a[82:83], v251 offset:768
v_mfma_f32_16x16x32_bf16 v[0:3], a[68:71], a[184:187], v[0:3]
ds_read_b64_tr_b16 a[84:85], v251 offset:8704
ds_read_b64_tr_b16 a[86:87], v251 offset:8960
v_mfma_f32_16x16x32_bf16 v[32:35], a[68:71], a[188:191], v[32:35]
s_add_u32 s42, s40, 49152
buffer_load_dwordx4 a[136:139], v250, s[16:19], s42 offen offset:0 sc1
v_mfma_f32_16x16x32_bf16 v[32:35], a[64:67], a[172:175], v[32:35]
v_mfma_f32_16x16x32_bf16 v[64:67], a[64:67], a[176:179], v[64:67]
v_mfma_f32_16x16x32_bf16 v[64:67], a[68:71], a[192:195], v[64:67]
v_mfma_f32_16x16x32_bf16 v[96:99], a[68:71], a[196:199], v[96:99]
v_mfma_f32_16x16x32_bf16 v[96:99], a[64:67], a[180:183], v[96:99]
s_waitcnt lgkmcnt(4)
v_mfma_f32_16x16x32_bf16 v[100:103], a[72:75], a[180:183], v[100:103]
ds_read_b64_tr_b16 a[88:89], v251 offset:520
ds_read_b64_tr_b16 a[90:91], v251 offset:776
v_mfma_f32_16x16x32_bf16 v[100:103], a[76:79], a[196:199], v[100:103]
ds_read_b64_tr_b16 a[92:93], v251 offset:8712
ds_read_b64_tr_b16 a[94:95], v251 offset:8968
v_mfma_f32_16x16x32_bf16 v[68:71], a[76:79], a[192:195], v[68:71]
buffer_load_dwordx4 a[140:143], v250, s[16:19], s42 offen offset:1024 sc1
v_mfma_f32_16x16x32_bf16 v[68:71], a[72:75], a[176:179], v[68:71]
v_mfma_f32_16x16x32_bf16 v[36:39], a[72:75], a[172:175], v[36:39]
global_load_lds_dwordx4 v248, s[6:7] offset:1024
v_mfma_f32_16x16x32_bf16 v[36:39], a[76:79], a[188:191], v[36:39]
v_mfma_f32_16x16x32_bf16 v[4:7], a[76:79], a[184:187], v[4:7]
v_mfma_f32_16x16x32_bf16 v[4:7], a[72:75], a[168:171], v[4:7]
s_waitcnt lgkmcnt(4)
v_mfma_f32_16x16x32_bf16 v[8:11], a[80:83], a[168:171], v[8:11]
ds_read_b64_tr_b16 a[96:97], v251 offset:1024
ds_read_b64_tr_b16 a[98:99], v251 offset:1280
v_mfma_f32_16x16x32_bf16 v[8:11], a[84:87], a[184:187], v[8:11]
ds_read_b64_tr_b16 a[100:101], v251 offset:9216
ds_read_b64_tr_b16 a[102:103], v251 offset:9472
v_mfma_f32_16x16x32_bf16 v[40:43], a[84:87], a[188:191], v[40:43]
buffer_load_dwordx4 a[144:147], v250, s[16:19], s42 offen offset:2048 sc1
v_mfma_f32_16x16x32_bf16 v[40:43], a[80:83], a[172:175], v[40:43]
v_mfma_f32_16x16x32_bf16 v[72:75], a[80:83], a[176:179], v[72:75]
v_mfma_f32_16x16x32_bf16 v[72:75], a[84:87], a[192:195], v[72:75]
v_mfma_f32_16x16x32_bf16 v[104:107], a[84:87], a[196:199], v[104:107]
v_mfma_f32_16x16x32_bf16 v[104:107], a[80:83], a[180:183], v[104:107]
s_waitcnt lgkmcnt(4)
v_mfma_f32_16x16x32_bf16 v[108:111], a[88:91], a[180:183], v[108:111]
ds_read_b64_tr_b16 a[104:105], v251 offset:1032
ds_read_b64_tr_b16 a[106:107], v251 offset:1288
v_mfma_f32_16x16x32_bf16 v[108:111], a[92:95], a[196:199], v[108:111]
ds_read_b64_tr_b16 a[108:109], v251 offset:9224
ds_read_b64_tr_b16 a[110:111], v251 offset:9480
v_mfma_f32_16x16x32_bf16 v[76:79], a[92:95], a[192:195], v[76:79]
buffer_load_dwordx4 a[148:151], v250, s[16:19], s42 offen offset:3072 sc1
v_mfma_f32_16x16x32_bf16 v[76:79], a[88:91], a[176:179], v[76:79]
v_mfma_f32_16x16x32_bf16 v[44:47], a[88:91], a[172:175], v[44:47]
global_load_lds_dwordx4 v248, s[4:5] offset:2048
v_mfma_f32_16x16x32_bf16 v[44:47], a[92:95], a[188:191], v[44:47]
v_mfma_f32_16x16x32_bf16 v[12:15], a[92:95], a[184:187], v[12:15]
v_mfma_f32_16x16x32_bf16 v[12:15], a[88:91], a[168:171], v[12:15]
s_waitcnt lgkmcnt(4)
v_mfma_f32_16x16x32_bf16 v[16:19], a[96:99], a[168:171], v[16:19]
ds_read_b64_tr_b16 a[112:113], v251 offset:1536
ds_read_b64_tr_b16 a[114:115], v251 offset:1792
v_mfma_f32_16x16x32_bf16 v[16:19], a[100:103], a[184:187], v[16:19]
ds_read_b64_tr_b16 a[116:117], v251 offset:9728
ds_read_b64_tr_b16 a[118:119], v251 offset:9984
v_mfma_f32_16x16x32_bf16 v[48:51], a[100:103], a[188:191], v[48:51]
s_add_u32 s42, s40, 53248
buffer_load_dwordx4 a[152:155], v250, s[16:19], s42 offen offset:0 sc1
v_mfma_f32_16x16x32_bf16 v[48:51], a[96:99], a[172:175], v[48:51]
v_mfma_f32_16x16x32_bf16 v[80:83], a[96:99], a[176:179], v[80:83]
v_mfma_f32_16x16x32_bf16 v[80:83], a[100:103], a[192:195], v[80:83]
v_mfma_f32_16x16x32_bf16 v[112:115], a[100:103], a[196:199], v[112:115]
v_mfma_f32_16x16x32_bf16 v[112:115], a[96:99], a[180:183], v[112:115]
s_waitcnt lgkmcnt(4)
v_mfma_f32_16x16x32_bf16 v[116:119], a[104:107], a[180:183], v[116:119]
ds_read_b64_tr_b16 a[120:121], v251 offset:1544
ds_read_b64_tr_b16 a[122:123], v251 offset:1800
v_mfma_f32_16x16x32_bf16 v[116:119], a[108:111], a[196:199], v[116:119]
ds_read_b64_tr_b16 a[124:125], v251 offset:9736
ds_read_b64_tr_b16 a[126:127], v251 offset:9992
v_mfma_f32_16x16x32_bf16 v[84:87], a[108:111], a[192:195], v[84:87]
buffer_load_dwordx4 a[156:159], v250, s[16:19], s42 offen offset:1024 sc1
v_mfma_f32_16x16x32_bf16 v[84:87], a[104:107], a[176:179], v[84:87]
v_mfma_f32_16x16x32_bf16 v[52:55], a[104:107], a[172:175], v[52:55]
global_load_lds_dwordx4 v248, s[6:7] offset:3072
v_mfma_f32_16x16x32_bf16 v[52:55], a[108:111], a[188:191], v[52:55]
v_mfma_f32_16x16x32_bf16 v[20:23], a[108:111], a[184:187], v[20:23]
v_add_u32 v251, 81920, v252
v_mfma_f32_16x16x32_bf16 v[20:23], a[104:107], a[168:171], v[20:23]
s_waitcnt lgkmcnt(4)
v_mfma_f32_16x16x32_bf16 v[24:27], a[112:115], a[168:171], v[24:27]
s_barrier
ds_read_b64_tr_b16 a[64:65], v251 offset:0
ds_read_b64_tr_b16 a[66:67], v251 offset:256
v_mfma_f32_16x16x32_bf16 v[24:27], a[116:119], a[184:187], v[24:27]
ds_read_b64_tr_b16 a[68:69], v251 offset:8192
ds_read_b64_tr_b16 a[70:71], v251 offset:8448
v_mfma_f32_16x16x32_bf16 v[56:59], a[116:119], a[188:191], v[56:59]
buffer_load_dwordx4 a[160:163], v250, s[16:19], s42 offen offset:2048 sc1
v_mfma_f32_16x16x32_bf16 v[56:59], a[112:115], a[172:175], v[56:59]
v_mfma_f32_16x16x32_bf16 v[88:91], a[112:115], a[176:179], v[88:91]
v_mfma_f32_16x16x32_bf16 v[88:91], a[116:119], a[192:195], v[88:91]
v_mfma_f32_16x16x32_bf16 v[120:123], a[116:119], a[196:199], v[120:123]
v_mfma_f32_16x16x32_bf16 v[120:123], a[112:115], a[180:183], v[120:123]
s_waitcnt lgkmcnt(4)
v_mfma_f32_16x16x32_bf16 v[124:127], a[120:123], a[180:183], v[124:127]
ds_read_b64_tr_b16 a[72:73], v251 offset:8
ds_read_b64_tr_b16 a[74:75], v251 offset:264
v_mfma_f32_16x16x32_bf16 v[124:127], a[124:127], a[196:199], v[124:127]
ds_read_b64_tr_b16 a[76:77], v251 offset:8200
ds_read_b64_tr_b16 a[78:79], v251 offset:8456
v_mfma_f32_16x16x32_bf16 v[92:95], a[124:127], a[192:195], v[92:95]
buffer_load_dwordx4 a[164:167], v250, s[16:19], s42 offen offset:3072 sc1
v_mfma_f32_16x16x32_bf16 v[92:95], a[120:123], a[176:179], v[92:95]
s_add_u32 m0, s31, 49152
s_mov_b32 s43, 4722688
v_mfma_f32_16x16x32_bf16 v[60:63], a[120:123], a[172:175], v[60:63]
buffer_load_dwordx4 v254, s[12:15], s43 offen offset:0 lds
v_mfma_f32_16x16x32_bf16 v[60:63], a[124:127], a[188:191], v[60:63]
v_mfma_f32_16x16x32_bf16 v[28:31], a[124:127], a[184:187], v[28:31]
v_mfma_f32_16x16x32_bf16 v[28:31], a[120:123], a[168:171], v[28:31]
s_waitcnt lgkmcnt(4)
s_waitcnt vmcnt(13)
v_mfma_f32_16x16x32_bf16 v[0:3], a[64:67], a[200:203], v[0:3]
ds_read_b64_tr_b16 a[80:81], v251 offset:512
ds_read_b64_tr_b16 a[82:83], v251 offset:768
v_mfma_f32_16x16x32_bf16 v[0:3], a[68:71], a[216:219], v[0:3]
ds_read_b64_tr_b16 a[84:85], v251 offset:8704
ds_read_b64_tr_b16 a[86:87], v251 offset:8960
v_mfma_f32_16x16x32_bf16 v[32:35], a[68:71], a[220:223], v[32:35]
s_add_u32 s42, s40, 57344
buffer_load_dwordx4 a[168:171], v250, s[16:19], s42 offen offset:0 sc1
v_mfma_f32_16x16x32_bf16 v[32:35], a[64:67], a[204:207], v[32:35]
v_mfma_f32_16x16x32_bf16 v[64:67], a[64:67], a[208:211], v[64:67]
v_mfma_f32_16x16x32_bf16 v[64:67], a[68:71], a[224:227], v[64:67]
v_mfma_f32_16x16x32_bf16 v[96:99], a[68:71], a[228:231], v[96:99]
v_mfma_f32_16x16x32_bf16 v[96:99], a[64:67], a[212:215], v[96:99]
s_waitcnt lgkmcnt(4)
v_mfma_f32_16x16x32_bf16 v[100:103], a[72:75], a[212:215], v[100:103]
ds_read_b64_tr_b16 a[88:89], v251 offset:520
ds_read_b64_tr_b16 a[90:91], v251 offset:776
v_mfma_f32_16x16x32_bf16 v[100:103], a[76:79], a[228:231], v[100:103]
ds_read_b64_tr_b16 a[92:93], v251 offset:8712
ds_read_b64_tr_b16 a[94:95], v251 offset:8968
v_mfma_f32_16x16x32_bf16 v[68:71], a[76:79], a[224:227], v[68:71]
buffer_load_dwordx4 a[172:175], v250, s[16:19], s42 offen offset:1024 sc1
v_mfma_f32_16x16x32_bf16 v[68:71], a[72:75], a[208:211], v[68:71]
s_mov_b32 s43, 4721792
v_mfma_f32_16x16x32_bf16 v[36:39], a[72:75], a[204:207], v[36:39]
buffer_load_dwordx4 v254, s[12:15], s43 offen offset:1024 lds
v_mfma_f32_16x16x32_bf16 v[36:39], a[76:79], a[220:223], v[36:39]
v_mfma_f32_16x16x32_bf16 v[4:7], a[76:79], a[216:219], v[4:7]
v_mfma_f32_16x16x32_bf16 v[4:7], a[72:75], a[200:203], v[4:7]
s_waitcnt lgkmcnt(4)
v_mfma_f32_16x16x32_bf16 v[8:11], a[80:83], a[200:203], v[8:11]
ds_read_b64_tr_b16 a[96:97], v251 offset:1024
ds_read_b64_tr_b16 a[98:99], v251 offset:1280
v_mfma_f32_16x16x32_bf16 v[8:11], a[84:87], a[216:219], v[8:11]
ds_read_b64_tr_b16 a[100:101], v251 offset:9216
ds_read_b64_tr_b16 a[102:103], v251 offset:9472
v_mfma_f32_16x16x32_bf16 v[40:43], a[84:87], a[220:223], v[40:43]
buffer_load_dwordx4 a[176:179], v250, s[16:19], s42 offen offset:2048 sc1
v_mfma_f32_16x16x32_bf16 v[40:43], a[80:83], a[204:207], v[40:43]
v_mfma_f32_16x16x32_bf16 v[72:75], a[80:83], a[208:211], v[72:75]
v_mfma_f32_16x16x32_bf16 v[72:75], a[84:87], a[224:227], v[72:75]
v_mfma_f32_16x16x32_bf16 v[104:107], a[84:87], a[228:231], v[104:107]
v_mfma_f32_16x16x32_bf16 v[104:107], a[80:83], a[212:215], v[104:107]
s_waitcnt lgkmcnt(4)
v_mfma_f32_16x16x32_bf16 v[108:111], a[88:91], a[212:215], v[108:111]
ds_read_b64_tr_b16 a[104:105], v251 offset:1032
ds_read_b64_tr_b16 a[106:107], v251 offset:1288
v_mfma_f32_16x16x32_bf16 v[108:111], a[92:95], a[228:231], v[108:111]
ds_read_b64_tr_b16 a[108:109], v251 offset:9224
ds_read_b64_tr_b16 a[110:111], v251 offset:9480
v_mfma_f32_16x16x32_bf16 v[76:79], a[92:95], a[224:227], v[76:79]
buffer_load_dwordx4 a[180:183], v250, s[16:19], s42 offen offset:3072 sc1
v_mfma_f32_16x16x32_bf16 v[76:79], a[88:91], a[208:211], v[76:79]
s_mov_b32 s43, 4786176
v_mfma_f32_16x16x32_bf16 v[44:47], a[88:91], a[204:207], v[44:47]
buffer_load_dwordx4 v254, s[12:15], s43 offen offset:2048 lds
v_mfma_f32_16x16x32_bf16 v[44:47], a[92:95], a[220:223], v[44:47]
v_mfma_f32_16x16x32_bf16 v[12:15], a[92:95], a[216:219], v[12:15]
v_mfma_f32_16x16x32_bf16 v[12:15], a[88:91], a[200:203], v[12:15]
s_waitcnt lgkmcnt(4)
v_mfma_f32_16x16x32_bf16 v[16:19], a[96:99], a[200:203], v[16:19]
ds_read_b64_tr_b16 a[112:113], v251 offset:1536
ds_read_b64_tr_b16 a[114:115], v251 offset:1792
v_mfma_f32_16x16x32_bf16 v[16:19], a[100:103], a[216:219], v[16:19]
ds_read_b64_tr_b16 a[116:117], v251 offset:9728
ds_read_b64_tr_b16 a[118:119], v251 offset:9984
v_mfma_f32_16x16x32_bf16 v[48:51], a[100:103], a[220:223], v[48:51]
s_add_u32 s42, s40, 61440
buffer_load_dwordx4 a[184:187], v250, s[16:19], s42 offen offset:0 sc1
v_mfma_f32_16x16x32_bf16 v[48:51], a[96:99], a[204:207], v[48:51]
v_mfma_f32_16x16x32_bf16 v[80:83], a[96:99], a[208:211], v[80:83]
v_mfma_f32_16x16x32_bf16 v[80:83], a[100:103], a[224:227], v[80:83]
v_mfma_f32_16x16x32_bf16 v[112:115], a[100:103], a[228:231], v[112:115]
v_mfma_f32_16x16x32_bf16 v[112:115], a[96:99], a[212:215], v[112:115]
s_waitcnt lgkmcnt(4)
v_mfma_f32_16x16x32_bf16 v[116:119], a[104:107], a[212:215], v[116:119]
ds_read_b64_tr_b16 a[120:121], v251 offset:1544
ds_read_b64_tr_b16 a[122:123], v251 offset:1800
v_mfma_f32_16x16x32_bf16 v[116:119], a[108:111], a[228:231], v[116:119]
ds_read_b64_tr_b16 a[124:125], v251 offset:9736
ds_read_b64_tr_b16 a[126:127], v251 offset:9992
v_mfma_f32_16x16x32_bf16 v[84:87], a[108:111], a[224:227], v[84:87]
buffer_load_dwordx4 a[188:191], v250, s[16:19], s42 offen offset:1024 sc1
v_mfma_f32_16x16x32_bf16 v[84:87], a[104:107], a[208:211], v[84:87]
s_mov_b32 s43, 4785280
v_mfma_f32_16x16x32_bf16 v[52:55], a[104:107], a[204:207], v[52:55]
buffer_load_dwordx4 v254, s[12:15], s43 offen offset:3072 lds
v_mfma_f32_16x16x32_bf16 v[52:55], a[108:111], a[220:223], v[52:55]
v_mfma_f32_16x16x32_bf16 v[20:23], a[108:111], a[216:219], v[20:23]
v_add_u32 v251, 98304, v252
v_mfma_f32_16x16x32_bf16 v[20:23], a[104:107], a[200:203], v[20:23]
s_waitcnt lgkmcnt(4)
v_mfma_f32_16x16x32_bf16 v[24:27], a[112:115], a[200:203], v[24:27]
ds_read_b64_tr_b16 a[64:65], v251 offset:0
ds_read_b64_tr_b16 a[66:67], v251 offset:256
v_mfma_f32_16x16x32_bf16 v[24:27], a[116:119], a[216:219], v[24:27]
ds_read_b64_tr_b16 a[68:69], v251 offset:8192
ds_read_b64_tr_b16 a[70:71], v251 offset:8448
v_mfma_f32_16x16x32_bf16 v[56:59], a[116:119], a[220:223], v[56:59]
buffer_load_dwordx4 a[192:195], v250, s[16:19], s42 offen offset:2048 sc1
v_mfma_f32_16x16x32_bf16 v[56:59], a[112:115], a[204:207], v[56:59]
v_mfma_f32_16x16x32_bf16 v[88:91], a[112:115], a[208:211], v[88:91]
v_mfma_f32_16x16x32_bf16 v[88:91], a[116:119], a[224:227], v[88:91]
v_mfma_f32_16x16x32_bf16 v[120:123], a[116:119], a[228:231], v[120:123]
v_mfma_f32_16x16x32_bf16 v[120:123], a[112:115], a[212:215], v[120:123]
s_waitcnt lgkmcnt(4)
v_mfma_f32_16x16x32_bf16 v[124:127], a[120:123], a[212:215], v[124:127]
ds_read_b64_tr_b16 a[72:73], v251 offset:8
ds_read_b64_tr_b16 a[74:75], v251 offset:264
v_mfma_f32_16x16x32_bf16 v[124:127], a[124:127], a[228:231], v[124:127]
ds_read_b64_tr_b16 a[76:77], v251 offset:8200
ds_read_b64_tr_b16 a[78:79], v251 offset:8456
v_mfma_f32_16x16x32_bf16 v[92:95], a[124:127], a[224:227], v[92:95]
buffer_load_dwordx4 a[196:199], v250, s[16:19], s42 offen offset:3072 sc1
v_mfma_f32_16x16x32_bf16 v[92:95], a[120:123], a[208:211], v[92:95]
s_add_u32 s4, s46, 33664
s_addc_u32 s5, s47, 0
s_add_u32 s6, s46, 32768
s_addc_u32 s7, s47, 0
s_add_u32 m0, s31, 32768
v_mfma_f32_16x16x32_bf16 v[60:63], a[120:123], a[204:207], v[60:63]
global_load_lds_dwordx4 v248, s[4:5] offset:0
v_mfma_f32_16x16x32_bf16 v[60:63], a[124:127], a[220:223], v[60:63]
v_mfma_f32_16x16x32_bf16 v[28:31], a[124:127], a[216:219], v[28:31]
v_mfma_f32_16x16x32_bf16 v[28:31], a[120:123], a[200:203], v[28:31]
s_waitcnt lgkmcnt(4)
s_waitcnt vmcnt(13)
v_mfma_f32_16x16x32_bf16 v[0:3], a[64:67], a[136:139], v[0:3]
ds_read_b64_tr_b16 a[80:81], v251 offset:512
ds_read_b64_tr_b16 a[82:83], v251 offset:768
v_mfma_f32_16x16x32_bf16 v[0:3], a[68:71], a[152:155], v[0:3]
ds_read_b64_tr_b16 a[84:85], v251 offset:8704
ds_read_b64_tr_b16 a[86:87], v251 offset:8960
v_mfma_f32_16x16x32_bf16 v[32:35], a[68:71], a[156:159], v[32:35]
s_add_u32 s42, s40, 65536
buffer_load_dwordx4 a[200:203], v250, s[16:19], s42 offen offset:0 sc1
v_mfma_f32_16x16x32_bf16 v[32:35], a[64:67], a[140:143], v[32:35]
v_mfma_f32_16x16x32_bf16 v[64:67], a[64:67], a[144:147], v[64:67]
v_mfma_f32_16x16x32_bf16 v[64:67], a[68:71], a[160:163], v[64:67]
v_mfma_f32_16x16x32_bf16 v[96:99], a[68:71], a[164:167], v[96:99]
v_mfma_f32_16x16x32_bf16 v[96:99], a[64:67], a[148:151], v[96:99]
s_waitcnt lgkmcnt(4)
v_mfma_f32_16x16x32_bf16 v[100:103], a[72:75], a[148:151], v[100:103]
ds_read_b64_tr_b16 a[88:89], v251 offset:520
ds_read_b64_tr_b16 a[90:91], v251 offset:776
v_mfma_f32_16x16x32_bf16 v[100:103], a[76:79], a[164:167], v[100:103]
ds_read_b64_tr_b16 a[92:93], v251 offset:8712
ds_read_b64_tr_b16 a[94:95], v251 offset:8968
v_mfma_f32_16x16x32_bf16 v[68:71], a[76:79], a[160:163], v[68:71]
buffer_load_dwordx4 a[204:207], v250, s[16:19], s42 offen offset:1024 sc1
v_mfma_f32_16x16x32_bf16 v[68:71], a[72:75], a[144:147], v[68:71]
v_mfma_f32_16x16x32_bf16 v[36:39], a[72:75], a[140:143], v[36:39]
global_load_lds_dwordx4 v248, s[6:7] offset:1024
v_mfma_f32_16x16x32_bf16 v[36:39], a[76:79], a[156:159], v[36:39]
v_mfma_f32_16x16x32_bf16 v[4:7], a[76:79], a[152:155], v[4:7]
v_mfma_f32_16x16x32_bf16 v[4:7], a[72:75], a[136:139], v[4:7]
s_waitcnt lgkmcnt(4)
v_mfma_f32_16x16x32_bf16 v[8:11], a[80:83], a[136:139], v[8:11]
ds_read_b64_tr_b16 a[96:97], v251 offset:1024
ds_read_b64_tr_b16 a[98:99], v251 offset:1280
v_mfma_f32_16x16x32_bf16 v[8:11], a[84:87], a[152:155], v[8:11]
ds_read_b64_tr_b16 a[100:101], v251 offset:9216
ds_read_b64_tr_b16 a[102:103], v251 offset:9472
v_mfma_f32_16x16x32_bf16 v[40:43], a[84:87], a[156:159], v[40:43]
buffer_load_dwordx4 a[208:211], v250, s[16:19], s42 offen offset:2048 sc1
v_mfma_f32_16x16x32_bf16 v[40:43], a[80:83], a[140:143], v[40:43]
v_mfma_f32_16x16x32_bf16 v[72:75], a[80:83], a[144:147], v[72:75]
v_mfma_f32_16x16x32_bf16 v[72:75], a[84:87], a[160:163], v[72:75]
v_mfma_f32_16x16x32_bf16 v[104:107], a[84:87], a[164:167], v[104:107]
v_mfma_f32_16x16x32_bf16 v[104:107], a[80:83], a[148:151], v[104:107]
s_waitcnt lgkmcnt(4)
v_mfma_f32_16x16x32_bf16 v[108:111], a[88:91], a[148:151], v[108:111]
ds_read_b64_tr_b16 a[104:105], v251 offset:1032
ds_read_b64_tr_b16 a[106:107], v251 offset:1288
v_mfma_f32_16x16x32_bf16 v[108:111], a[92:95], a[164:167], v[108:111]
ds_read_b64_tr_b16 a[108:109], v251 offset:9224
ds_read_b64_tr_b16 a[110:111], v251 offset:9480
v_mfma_f32_16x16x32_bf16 v[76:79], a[92:95], a[160:163], v[76:79]
buffer_load_dwordx4 a[212:215], v250, s[16:19], s42 offen offset:3072 sc1
v_mfma_f32_16x16x32_bf16 v[76:79], a[88:91], a[144:147], v[76:79]
v_mfma_f32_16x16x32_bf16 v[44:47], a[88:91], a[140:143], v[44:47]
global_load_lds_dwordx4 v248, s[4:5] offset:2048
v_mfma_f32_16x16x32_bf16 v[44:47], a[92:95], a[156:159], v[44:47]
v_mfma_f32_16x16x32_bf16 v[12:15], a[92:95], a[152:155], v[12:15]
v_mfma_f32_16x16x32_bf16 v[12:15], a[88:91], a[136:139], v[12:15]
s_waitcnt lgkmcnt(4)
v_mfma_f32_16x16x32_bf16 v[16:19], a[96:99], a[136:139], v[16:19]
ds_read_b64_tr_b16 a[112:113], v251 offset:1536
ds_read_b64_tr_b16 a[114:115], v251 offset:1792
v_mfma_f32_16x16x32_bf16 v[16:19], a[100:103], a[152:155], v[16:19]
ds_read_b64_tr_b16 a[116:117], v251 offset:9728
ds_read_b64_tr_b16 a[118:119], v251 offset:9984
v_mfma_f32_16x16x32_bf16 v[48:51], a[100:103], a[156:159], v[48:51]
s_add_u32 s42, s40, 69632
buffer_load_dwordx4 a[216:219], v250, s[16:19], s42 offen offset:0 sc1
v_mfma_f32_16x16x32_bf16 v[48:51], a[96:99], a[140:143], v[48:51]
v_mfma_f32_16x16x32_bf16 v[80:83], a[96:99], a[144:147], v[80:83]
v_mfma_f32_16x16x32_bf16 v[80:83], a[100:103], a[160:163], v[80:83]
v_mfma_f32_16x16x32_bf16 v[112:115], a[100:103], a[164:167], v[112:115]
v_mfma_f32_16x16x32_bf16 v[112:115], a[96:99], a[148:151], v[112:115]
s_waitcnt lgkmcnt(4)
v_mfma_f32_16x16x32_bf16 v[116:119], a[104:107], a[148:151], v[116:119]
ds_read_b64_tr_b16 a[120:121], v251 offset:1544
ds_read_b64_tr_b16 a[122:123], v251 offset:1800
v_mfma_f32_16x16x32_bf16 v[116:119], a[108:111], a[164:167], v[116:119]
ds_read_b64_tr_b16 a[124:125], v251 offset:9736
ds_read_b64_tr_b16 a[126:127], v251 offset:9992
v_mfma_f32_16x16x32_bf16 v[84:87], a[108:111], a[160:163], v[84:87]
buffer_load_dwordx4 a[220:223], v250, s[16:19], s42 offen offset:1024 sc1
v_mfma_f32_16x16x32_bf16 v[84:87], a[104:107], a[144:147], v[84:87]
v_mfma_f32_16x16x32_bf16 v[52:55], a[104:107], a[140:143], v[52:55]
global_load_lds_dwordx4 v248, s[6:7] offset:3072
v_mfma_f32_16x16x32_bf16 v[52:55], a[108:111], a[156:159], v[52:55]
v_mfma_f32_16x16x32_bf16 v[20:23], a[108:111], a[152:155], v[20:23]
v_add_u32 v251, 114688, v252
v_mfma_f32_16x16x32_bf16 v[20:23], a[104:107], a[136:139], v[20:23]
s_waitcnt lgkmcnt(4)
v_mfma_f32_16x16x32_bf16 v[24:27], a[112:115], a[136:139], v[24:27]
s_barrier
ds_read_b64_tr_b16 a[64:65], v251 offset:0
ds_read_b64_tr_b16 a[66:67], v251 offset:256
v_mfma_f32_16x16x32_bf16 v[24:27], a[116:119], a[152:155], v[24:27]
ds_read_b64_tr_b16 a[68:69], v251 offset:8192
ds_read_b64_tr_b16 a[70:71], v251 offset:8448
v_mfma_f32_16x16x32_bf16 v[56:59], a[116:119], a[156:159], v[56:59]
buffer_load_dwordx4 a[224:227], v250, s[16:19], s42 offen offset:2048 sc1
v_mfma_f32_16x16x32_bf16 v[56:59], a[112:115], a[140:143], v[56:59]
v_mfma_f32_16x16x32_bf16 v[88:91], a[112:115], a[144:147], v[88:91]
v_mfma_f32_16x16x32_bf16 v[88:91], a[116:119], a[160:163], v[88:91]
v_mfma_f32_16x16x32_bf16 v[120:123], a[116:119], a[164:167], v[120:123]
v_mfma_f32_16x16x32_bf16 v[120:123], a[112:115], a[148:151], v[120:123]
s_waitcnt lgkmcnt(4)
v_mfma_f32_16x16x32_bf16 v[124:127], a[120:123], a[148:151], v[124:127]
ds_read_b64_tr_b16 a[72:73], v251 offset:8
ds_read_b64_tr_b16 a[74:75], v251 offset:264
v_mfma_f32_16x16x32_bf16 v[124:127], a[124:127], a[164:167], v[124:127]
ds_read_b64_tr_b16 a[76:77], v251 offset:8200
ds_read_b64_tr_b16 a[78:79], v251 offset:8456
v_mfma_f32_16x16x32_bf16 v[92:95], a[124:127], a[160:163], v[92:95]
buffer_load_dwordx4 a[228:231], v250, s[16:19], s42 offen offset:3072 sc1
v_mfma_f32_16x16x32_bf16 v[92:95], a[120:123], a[144:147], v[92:95]
s_add_u32 s8, s48, 896
s_addc_u32 s9, s49, 0
s_add_u32 s10, s48, 0
s_addc_u32 s11, s49, 0
s_add_u32 m0, s31, 65536
v_mfma_f32_16x16x32_bf16 v[60:63], a[120:123], a[140:143], v[60:63]
global_load_lds_dwordx4 v248, s[8:9] offset:0
v_mfma_f32_16x16x32_bf16 v[60:63], a[124:127], a[156:159], v[60:63]
v_mfma_f32_16x16x32_bf16 v[28:31], a[124:127], a[152:155], v[28:31]
v_mfma_f32_16x16x32_bf16 v[28:31], a[120:123], a[136:139], v[28:31]
s_waitcnt lgkmcnt(4)
s_waitcnt vmcnt(13)
v_mfma_f32_16x16x32_bf16 v[0:3], a[64:67], a[168:171], v[0:3]
ds_read_b64_tr_b16 a[80:81], v251 offset:512
ds_read_b64_tr_b16 a[82:83], v251 offset:768
v_mfma_f32_16x16x32_bf16 v[0:3], a[68:71], a[184:187], v[0:3]
ds_read_b64_tr_b16 a[84:85], v251 offset:8704
ds_read_b64_tr_b16 a[86:87], v251 offset:8960
v_mfma_f32_16x16x32_bf16 v[32:35], a[68:71], a[188:191], v[32:35]
s_add_u32 s42, s40, 73728
buffer_load_dwordx4 a[136:139], v250, s[16:19], s42 offen offset:0 sc1
v_mfma_f32_16x16x32_bf16 v[32:35], a[64:67], a[172:175], v[32:35]
v_mfma_f32_16x16x32_bf16 v[64:67], a[64:67], a[176:179], v[64:67]
v_mfma_f32_16x16x32_bf16 v[64:67], a[68:71], a[192:195], v[64:67]
v_mfma_f32_16x16x32_bf16 v[96:99], a[68:71], a[196:199], v[96:99]
v_mfma_f32_16x16x32_bf16 v[96:99], a[64:67], a[180:183], v[96:99]
s_waitcnt lgkmcnt(4)
v_mfma_f32_16x16x32_bf16 v[100:103], a[72:75], a[180:183], v[100:103]
ds_read_b64_tr_b16 a[88:89], v251 offset:520
ds_read_b64_tr_b16 a[90:91], v251 offset:776
v_mfma_f32_16x16x32_bf16 v[100:103], a[76:79], a[196:199], v[100:103]
ds_read_b64_tr_b16 a[92:93], v251 offset:8712
ds_read_b64_tr_b16 a[94:95], v251 offset:8968
v_mfma_f32_16x16x32_bf16 v[68:71], a[76:79], a[192:195], v[68:71]
buffer_load_dwordx4 a[140:143], v250, s[16:19], s42 offen offset:1024 sc1
v_mfma_f32_16x16x32_bf16 v[68:71], a[72:75], a[176:179], v[68:71]
v_mfma_f32_16x16x32_bf16 v[36:39], a[72:75], a[172:175], v[36:39]
global_load_lds_dwordx4 v248, s[10:11] offset:1024
v_mfma_f32_16x16x32_bf16 v[36:39], a[76:79], a[188:191], v[36:39]
v_mfma_f32_16x16x32_bf16 v[4:7], a[76:79], a[184:187], v[4:7]
v_mfma_f32_16x16x32_bf16 v[4:7], a[72:75], a[168:171], v[4:7]
s_waitcnt lgkmcnt(4)
v_mfma_f32_16x16x32_bf16 v[8:11], a[80:83], a[168:171], v[8:11]
ds_read_b64_tr_b16 a[96:97], v251 offset:1024
ds_read_b64_tr_b16 a[98:99], v251 offset:1280
v_mfma_f32_16x16x32_bf16 v[8:11], a[84:87], a[184:187], v[8:11]
ds_read_b64_tr_b16 a[100:101], v251 offset:9216
ds_read_b64_tr_b16 a[102:103], v251 offset:9472
v_mfma_f32_16x16x32_bf16 v[40:43], a[84:87], a[188:191], v[40:43]
buffer_load_dwordx4 a[144:147], v250, s[16:19], s42 offen offset:2048 sc1
v_mfma_f32_16x16x32_bf16 v[40:43], a[80:83], a[172:175], v[40:43]
v_mfma_f32_16x16x32_bf16 v[72:75], a[80:83], a[176:179], v[72:75]
v_mfma_f32_16x16x32_bf16 v[72:75], a[84:87], a[192:195], v[72:75]
v_mfma_f32_16x16x32_bf16 v[104:107], a[84:87], a[196:199], v[104:107]
v_mfma_f32_16x16x32_bf16 v[104:107], a[80:83], a[180:183], v[104:107]
s_waitcnt lgkmcnt(4)
v_mfma_f32_16x16x32_bf16 v[108:111], a[88:91], a[180:183], v[108:111]
ds_read_b64_tr_b16 a[104:105], v251 offset:1032
ds_read_b64_tr_b16 a[106:107], v251 offset:1288
v_mfma_f32_16x16x32_bf16 v[108:111], a[92:95], a[196:199], v[108:111]
ds_read_b64_tr_b16 a[108:109], v251 offset:9224
ds_read_b64_tr_b16 a[110:111], v251 offset:9480
v_mfma_f32_16x16x32_bf16 v[76:79], a[92:95], a[192:195], v[76:79]
buffer_load_dwordx4 a[148:151], v250, s[16:19], s42 offen offset:3072 sc1
v_mfma_f32_16x16x32_bf16 v[76:79], a[88:91], a[176:179], v[76:79]
v_mfma_f32_16x16x32_bf16 v[44:47], a[88:91], a[172:175], v[44:47]
global_load_lds_dwordx4 v248, s[8:9] offset:2048
v_mfma_f32_16x16x32_bf16 v[44:47], a[92:95], a[188:191], v[44:47]
v_mfma_f32_16x16x32_bf16 v[12:15], a[92:95], a[184:187], v[12:15]
v_mfma_f32_16x16x32_bf16 v[12:15], a[88:91], a[168:171], v[12:15]
s_waitcnt lgkmcnt(4)
v_mfma_f32_16x16x32_bf16 v[16:19], a[96:99], a[168:171], v[16:19]
ds_read_b64_tr_b16 a[112:113], v251 offset:1536
ds_read_b64_tr_b16 a[114:115], v251 offset:1792
v_mfma_f32_16x16x32_bf16 v[16:19], a[100:103], a[184:187], v[16:19]
ds_read_b64_tr_b16 a[116:117], v251 offset:9728
ds_read_b64_tr_b16 a[118:119], v251 offset:9984
v_mfma_f32_16x16x32_bf16 v[48:51], a[100:103], a[188:191], v[48:51]
s_add_u32 s42, s40, 77824
buffer_load_dwordx4 a[152:155], v250, s[16:19], s42 offen offset:0 sc1
v_mfma_f32_16x16x32_bf16 v[48:51], a[96:99], a[172:175], v[48:51]
v_mfma_f32_16x16x32_bf16 v[80:83], a[96:99], a[176:179], v[80:83]
v_mfma_f32_16x16x32_bf16 v[80:83], a[100:103], a[192:195], v[80:83]
v_mfma_f32_16x16x32_bf16 v[112:115], a[100:103], a[196:199], v[112:115]
v_mfma_f32_16x16x32_bf16 v[112:115], a[96:99], a[180:183], v[112:115]
s_waitcnt lgkmcnt(4)
v_mfma_f32_16x16x32_bf16 v[116:119], a[104:107], a[180:183], v[116:119]
ds_read_b64_tr_b16 a[120:121], v251 offset:1544
ds_read_b64_tr_b16 a[122:123], v251 offset:1800
v_mfma_f32_16x16x32_bf16 v[116:119], a[108:111], a[196:199], v[116:119]
ds_read_b64_tr_b16 a[124:125], v251 offset:9736
ds_read_b64_tr_b16 a[126:127], v251 offset:9992
v_mfma_f32_16x16x32_bf16 v[84:87], a[108:111], a[192:195], v[84:87]
buffer_load_dwordx4 a[156:159], v250, s[16:19], s42 offen offset:1024 sc1
v_mfma_f32_16x16x32_bf16 v[84:87], a[104:107], a[176:179], v[84:87]
v_mfma_f32_16x16x32_bf16 v[52:55], a[104:107], a[172:175], v[52:55]
global_load_lds_dwordx4 v248, s[10:11] offset:3072
v_mfma_f32_16x16x32_bf16 v[52:55], a[108:111], a[188:191], v[52:55]
v_mfma_f32_16x16x32_bf16 v[20:23], a[108:111], a[184:187], v[20:23]
v_add_u32 v251, 131072, v252
v_mfma_f32_16x16x32_bf16 v[20:23], a[104:107], a[168:171], v[20:23]
s_waitcnt lgkmcnt(4)
v_mfma_f32_16x16x32_bf16 v[24:27], a[112:115], a[168:171], v[24:27]
ds_read_b64_tr_b16 a[64:65], v251 offset:0
ds_read_b64_tr_b16 a[66:67], v251 offset:256
v_mfma_f32_16x16x32_bf16 v[24:27], a[116:119], a[184:187], v[24:27]
ds_read_b64_tr_b16 a[68:69], v251 offset:8192
ds_read_b64_tr_b16 a[70:71], v251 offset:8448
v_mfma_f32_16x16x32_bf16 v[56:59], a[116:119], a[188:191], v[56:59]
buffer_load_dwordx4 a[160:163], v250, s[16:19], s42 offen offset:2048 sc1
v_mfma_f32_16x16x32_bf16 v[56:59], a[112:115], a[172:175], v[56:59]
v_mfma_f32_16x16x32_bf16 v[88:91], a[112:115], a[176:179], v[88:91]
v_mfma_f32_16x16x32_bf16 v[88:91], a[116:119], a[192:195], v[88:91]
v_mfma_f32_16x16x32_bf16 v[120:123], a[116:119], a[196:199], v[120:123]
v_mfma_f32_16x16x32_bf16 v[120:123], a[112:115], a[180:183], v[120:123]
s_waitcnt lgkmcnt(4)
v_mfma_f32_16x16x32_bf16 v[124:127], a[120:123], a[180:183], v[124:127]
ds_read_b64_tr_b16 a[72:73], v251 offset:8
ds_read_b64_tr_b16 a[74:75], v251 offset:264
v_mfma_f32_16x16x32_bf16 v[124:127], a[124:127], a[196:199], v[124:127]
ds_read_b64_tr_b16 a[76:77], v251 offset:8200
ds_read_b64_tr_b16 a[78:79], v251 offset:8456
v_mfma_f32_16x16x32_bf16 v[92:95], a[124:127], a[192:195], v[92:95]
buffer_load_dwordx4 a[164:167], v250, s[16:19], s42 offen offset:3072 sc1
v_mfma_f32_16x16x32_bf16 v[92:95], a[120:123], a[176:179], v[92:95]
s_add_u32 s8, s48, 17280
s_addc_u32 s9, s49, 0
s_add_u32 s10, s48, 16384
s_addc_u32 s11, s49, 0
s_add_u32 m0, s31, 81920
v_mfma_f32_16x16x32_bf16 v[60:63], a[120:123], a[172:175], v[60:63]
L_m_c0_1:
s_cbranch_execz L_m_c0_5
global_load_lds_dwordx4 v248, s[8:9] offset:0
v_mfma_f32_16x16x32_bf16 v[60:63], a[124:127], a[188:191], v[60:63]
v_mfma_f32_16x16x32_bf16 v[28:31], a[124:127], a[184:187], v[28:31]
v_mfma_f32_16x16x32_bf16 v[28:31], a[120:123], a[168:171], v[28:31]
s_waitcnt lgkmcnt(4)
s_waitcnt vmcnt(13)
v_mfma_f32_16x16x32_bf16 v[0:3], a[64:67], a[200:203], v[0:3]
ds_read_b64_tr_b16 a[80:81], v251 offset:512
ds_read_b64_tr_b16 a[82:83], v251 offset:768
v_mfma_f32_16x16x32_bf16 v[0:3], a[68:71], a[216:219], v[0:3]
ds_read_b64_tr_b16 a[84:85], v251 offset:8704
ds_read_b64_tr_b16 a[86:87], v251 offset:8960
v_mfma_f32_16x16x32_bf16 v[32:35], a[68:71], a[220:223], v[32:35]
v_mfma_f32_16x16x32_bf16 v[32:35], a[64:67], a[204:207], v[32:35]
v_mfma_f32_16x16x32_bf16 v[64:67], a[64:67], a[208:211], v[64:67]
v_mfma_f32_16x16x32_bf16 v[64:67], a[68:71], a[224:227], v[64:67]
v_mfma_f32_16x16x32_bf16 v[96:99], a[68:71], a[228:231], v[96:99]
v_mfma_f32_16x16x32_bf16 v[96:99], a[64:67], a[212:215], v[96:99]
s_waitcnt lgkmcnt(4)
v_mfma_f32_16x16x32_bf16 v[100:103], a[72:75], a[212:215], v[100:103]
ds_read_b64_tr_b16 a[88:89], v251 offset:520
ds_read_b64_tr_b16 a[90:91], v251 offset:776
v_mfma_f32_16x16x32_bf16 v[100:103], a[76:79], a[228:231], v[100:103]
ds_read_b64_tr_b16 a[92:93], v251 offset:8712
ds_read_b64_tr_b16 a[94:95], v251 offset:8968
v_mfma_f32_16x16x32_bf16 v[68:71], a[76:79], a[224:227], v[68:71]
v_mfma_f32_16x16x32_bf16 v[68:71], a[72:75], a[208:211], v[68:71]
v_mfma_f32_16x16x32_bf16 v[36:39], a[72:75], a[204:207], v[36:39]
global_load_lds_dwordx4 v248, s[10:11] offset:1024
v_mfma_f32_16x16x32_bf16 v[36:39], a[76:79], a[220:223], v[36:39]
v_mfma_f32_16x16x32_bf16 v[4:7], a[76:79], a[216:219], v[4:7]
v_mfma_f32_16x16x32_bf16 v[4:7], a[72:75], a[200:203], v[4:7]
s_waitcnt lgkmcnt(4)
v_mfma_f32_16x16x32_bf16 v[8:11], a[80:83], a[200:203], v[8:11]
ds_read_b64_tr_b16 a[96:97], v251 offset:1024
ds_read_b64_tr_b16 a[98:99], v251 offset:1280
v_mfma_f32_16x16x32_bf16 v[8:11], a[84:87], a[216:219], v[8:11]
ds_read_b64_tr_b16 a[100:101], v251 offset:9216
ds_read_b64_tr_b16 a[102:103], v251 offset:9472
v_mfma_f32_16x16x32_bf16 v[40:43], a[84:87], a[220:223], v[40:43]
v_mfma_f32_16x16x32_bf16 v[40:43], a[80:83], a[204:207], v[40:43]
v_mfma_f32_16x16x32_bf16 v[72:75], a[80:83], a[208:211], v[72:75]
v_mfma_f32_16x16x32_bf16 v[72:75], a[84:87], a[224:227], v[72:75]
v_mfma_f32_16x16x32_bf16 v[104:107], a[84:87], a[228:231], v[104:107]
v_mfma_f32_16x16x32_bf16 v[104:107], a[80:83], a[212:215], v[104:107]
s_waitcnt lgkmcnt(4)
v_mfma_f32_16x16x32_bf16 v[108:111], a[88:91], a[212:215], v[108:111]
ds_read_b64_tr_b16 a[104:105], v251 offset:1032
ds_read_b64_tr_b16 a[106:107], v251 offset:1288
v_mfma_f32_16x16x32_bf16 v[108:111], a[92:95], a[228:231], v[108:111]
ds_read_b64_tr_b16 a[108:109], v251 offset:9224
ds_read_b64_tr_b16 a[110:111], v251 offset:9480
v_mfma_f32_16x16x32_bf16 v[76:79], a[92:95], a[224:227], v[76:79]
v_mfma_f32_16x16x32_bf16 v[76:79], a[88:91], a[208:211], v[76:79]
v_mfma_f32_16x16x32_bf16 v[44:47], a[88:91], a[204:207], v[44:47]
global_load_lds_dwordx4 v248, s[8:9] offset:2048
v_mfma_f32_16x16x32_bf16 v[44:47], a[92:95], a[220:223], v[44:47]
v_mfma_f32_16x16x32_bf16 v[12:15], a[92:95], a[216:219], v[12:15]
v_mfma_f32_16x16x32_bf16 v[12:15], a[88:91], a[200:203], v[12:15]
s_waitcnt lgkmcnt(4)
v_mfma_f32_16x16x32_bf16 v[16:19], a[96:99], a[200:203], v[16:19]
ds_read_b64_tr_b16 a[112:113], v251 offset:1536
ds_read_b64_tr_b16 a[114:115], v251 offset:1792
v_mfma_f32_16x16x32_bf16 v[16:19], a[100:103], a[216:219], v[16:19]
ds_read_b64_tr_b16 a[116:117], v251 offset:9728
ds_read_b64_tr_b16 a[118:119], v251 offset:9984
v_mfma_f32_16x16x32_bf16 v[48:51], a[100:103], a[220:223], v[48:51]
v_mfma_f32_16x16x32_bf16 v[48:51], a[96:99], a[204:207], v[48:51]
v_mfma_f32_16x16x32_bf16 v[80:83], a[96:99], a[208:211], v[80:83]
v_mfma_f32_16x16x32_bf16 v[80:83], a[100:103], a[224:227], v[80:83]
v_mfma_f32_16x16x32_bf16 v[112:115], a[100:103], a[228:231], v[112:115]
v_mfma_f32_16x16x32_bf16 v[112:115], a[96:99], a[212:215], v[112:115]
s_waitcnt lgkmcnt(4)
v_mfma_f32_16x16x32_bf16 v[116:119], a[104:107], a[212:215], v[116:119]
ds_read_b64_tr_b16 a[120:121], v251 offset:1544
ds_read_b64_tr_b16 a[122:123], v251 offset:1800
v_mfma_f32_16x16x32_bf16 v[116:119], a[108:111], a[228:231], v[116:119]
ds_read_b64_tr_b16 a[124:125], v251 offset:9736
ds_read_b64_tr_b16 a[126:127], v251 offset:9992
v_mfma_f32_16x16x32_bf16 v[84:87], a[108:111], a[224:227], v[84:87]
v_mfma_f32_16x16x32_bf16 v[84:87], a[104:107], a[208:211], v[84:87]
v_mfma_f32_16x16x32_bf16 v[52:55], a[104:107], a[204:207], v[52:55]
global_load_lds_dwordx4 v248, s[10:11] offset:3072
v_mfma_f32_16x16x32_bf16 v[52:55], a[108:111], a[220:223], v[52:55]
v_mfma_f32_16x16x32_bf16 v[20:23], a[108:111], a[216:219], v[20:23]
v_add_u32 v251, 49152, v252
v_mfma_f32_16x16x32_bf16 v[20:23], a[104:107], a[200:203], v[20:23]
s_waitcnt lgkmcnt(4)
v_mfma_f32_16x16x32_bf16 v[24:27], a[112:115], a[200:203], v[24:27]
s_barrier
ds_read_b64_tr_b16 a[64:65], v251 offset:0
ds_read_b64_tr_b16 a[66:67], v251 offset:256
v_mfma_f32_16x16x32_bf16 v[24:27], a[116:119], a[216:219], v[24:27]
ds_read_b64_tr_b16 a[68:69], v251 offset:8192
ds_read_b64_tr_b16 a[70:71], v251 offset:8448
v_mfma_f32_16x16x32_bf16 v[56:59], a[116:119], a[220:223], v[56:59]
v_mfma_f32_16x16x32_bf16 v[56:59], a[112:115], a[204:207], v[56:59]
v_mfma_f32_16x16x32_bf16 v[88:91], a[112:115], a[208:211], v[88:91]
v_mfma_f32_16x16x32_bf16 v[88:91], a[116:119], a[224:227], v[88:91]
v_mfma_f32_16x16x32_bf16 v[120:123], a[116:119], a[228:231], v[120:123]
v_mfma_f32_16x16x32_bf16 v[120:123], a[112:115], a[212:215], v[120:123]
s_waitcnt lgkmcnt(4)
v_mfma_f32_16x16x32_bf16 v[124:127], a[120:123], a[212:215], v[124:127]
ds_read_b64_tr_b16 a[72:73], v251 offset:8
ds_read_b64_tr_b16 a[74:75], v251 offset:264
v_mfma_f32_16x16x32_bf16 v[124:127], a[124:127], a[228:231], v[124:127]
ds_read_b64_tr_b16 a[76:77], v251 offset:8200
ds_read_b64_tr_b16 a[78:79], v251 offset:8456
v_mfma_f32_16x16x32_bf16 v[92:95], a[124:127], a[224:227], v[92:95]
v_mfma_f32_16x16x32_bf16 v[92:95], a[120:123], a[208:211], v[92:95]
v_mfma_f32_16x16x32_bf16 v[60:63], a[120:123], a[204:207], v[60:63]
v_mfma_f32_16x16x32_bf16 v[60:63], a[124:127], a[220:223], v[60:63]
v_mfma_f32_16x16x32_bf16 v[28:31], a[124:127], a[216:219], v[28:31]
v_mfma_f32_16x16x32_bf16 v[28:31], a[120:123], a[200:203], v[28:31]
s_waitcnt lgkmcnt(4)
s_waitcnt vmcnt(4)
v_mfma_f32_16x16x32_bf16 v[0:3], a[64:67], a[136:139], v[0:3]
ds_read_b64_tr_b16 a[80:81], v251 offset:512
ds_read_b64_tr_b16 a[82:83], v251 offset:768
v_mfma_f32_16x16x32_bf16 v[0:3], a[68:71], a[152:155], v[0:3]
ds_read_b64_tr_b16 a[84:85], v251 offset:8704
ds_read_b64_tr_b16 a[86:87], v251 offset:8960
v_mfma_f32_16x16x32_bf16 v[32:35], a[68:71], a[156:159], v[32:35]
v_mfma_f32_16x16x32_bf16 v[32:35], a[64:67], a[140:143], v[32:35]
v_mfma_f32_16x16x32_bf16 v[64:67], a[64:67], a[144:147], v[64:67]
v_mfma_f32_16x16x32_bf16 v[64:67], a[68:71], a[160:163], v[64:67]
v_mfma_f32_16x16x32_bf16 v[96:99], a[68:71], a[164:167], v[96:99]
v_mfma_f32_16x16x32_bf16 v[96:99], a[64:67], a[148:151], v[96:99]
s_waitcnt lgkmcnt(4)
v_mfma_f32_16x16x32_bf16 v[100:103], a[72:75], a[148:151], v[100:103]
ds_read_b64_tr_b16 a[88:89], v251 offset:520
ds_read_b64_tr_b16 a[90:91], v251 offset:776
v_mfma_f32_16x16x32_bf16 v[100:103], a[76:79], a[164:167], v[100:103]
ds_read_b64_tr_b16 a[92:93], v251 offset:8712
ds_read_b64_tr_b16 a[94:95], v251 offset:8968
v_mfma_f32_16x16x32_bf16 v[68:71], a[76:79], a[160:163], v[68:71]
v_mfma_f32_16x16x32_bf16 v[68:71], a[72:75], a[144:147], v[68:71]
v_mfma_f32_16x16x32_bf16 v[36:39], a[72:75], a[140:143], v[36:39]
v_mfma_f32_16x16x32_bf16 v[36:39], a[76:79], a[156:159], v[36:39]
v_mfma_f32_16x16x32_bf16 v[4:7], a[76:79], a[152:155], v[4:7]
v_mfma_f32_16x16x32_bf16 v[4:7], a[72:75], a[136:139], v[4:7]
s_waitcnt lgkmcnt(4)
v_mfma_f32_16x16x32_bf16 v[8:11], a[80:83], a[136:139], v[8:11]
ds_read_b64_tr_b16 a[96:97], v251 offset:1024
ds_read_b64_tr_b16 a[98:99], v251 offset:1280
v_mfma_f32_16x16x32_bf16 v[8:11], a[84:87], a[152:155], v[8:11]
ds_read_b64_tr_b16 a[100:101], v251 offset:9216
ds_read_b64_tr_b16 a[102:103], v251 offset:9472
v_mfma_f32_16x16x32_bf16 v[40:43], a[84:87], a[156:159], v[40:43]
v_mfma_f32_16x16x32_bf16 v[40:43], a[80:83], a[140:143], v[40:43]
v_cvt_pk_bf16_f32 v240, v0, v1
v_cvt_pk_bf16_f32 v241, v2, v3
v_mfma_f32_16x16x32_bf16 v[72:75], a[80:83], a[144:147], v[72:75]
v_cvt_pk_bf16_f32 v242, v4, v5
v_cvt_pk_bf16_f32 v243, v6, v7
v_mfma_f32_16x16x32_bf16 v[72:75], a[84:87], a[160:163], v[72:75]
v_accvgpr_write_b32 a0, v240
v_accvgpr_write_b32 a1, v241
v_mfma_f32_16x16x32_bf16 v[104:107], a[84:87], a[164:167], v[104:107]
v_accvgpr_write_b32 a2, v242
v_accvgpr_write_b32 a3, v243
v_mfma_f32_16x16x32_bf16 v[104:107], a[80:83], a[148:151], v[104:107]
s_waitcnt lgkmcnt(4)
v_cvt_pk_bf16_f32 v240, v32, v33
v_cvt_pk_bf16_f32 v241, v34, v35
v_mfma_f32_16x16x32_bf16 v[108:111], a[88:91], a[148:151], v[108:111]
ds_read_b64_tr_b16 a[104:105], v251 offset:1032
ds_read_b64_tr_b16 a[106:107], v251 offset:1288
v_mfma_f32_16x16x32_bf16 v[108:111], a[92:95], a[164:167], v[108:111]
ds_read_b64_tr_b16 a[108:109], v251 offset:9224
ds_read_b64_tr_b16 a[110:111], v251 offset:9480
v_mfma_f32_16x16x32_bf16 v[76:79], a[92:95], a[160:163], v[76:79]
v_cvt_pk_bf16_f32 v242, v36, v37
v_cvt_pk_bf16_f32 v243, v38, v39
v_mfma_f32_16x16x32_bf16 v[76:79], a[88:91], a[144:147], v[76:79]
v_accvgpr_write_b32 a16, v240
v_accvgpr_write_b32 a17, v241
v_mfma_f32_16x16x32_bf16 v[44:47], a[88:91], a[140:143], v[44:47]
v_accvgpr_write_b32 a18, v242
v_accvgpr_write_b32 a19, v243
v_mfma_f32_16x16x32_bf16 v[44:47], a[92:95], a[156:159], v[44:47]
v_cvt_pk_bf16_f32 v240, v64, v65
v_cvt_pk_bf16_f32 v241, v66, v67
v_mfma_f32_16x16x32_bf16 v[12:15], a[92:95], a[152:155], v[12:15]
v_cvt_pk_bf16_f32 v242, v68, v69
v_cvt_pk_bf16_f32 v243, v70, v71
v_mfma_f32_16x16x32_bf16 v[12:15], a[88:91], a[136:139], v[12:15]
s_waitcnt lgkmcnt(4)
v_accvgpr_write_b32 a32, v240
v_accvgpr_write_b32 a33, v241
v_mfma_f32_16x16x32_bf16 v[16:19], a[96:99], a[136:139], v[16:19]
ds_read_b64_tr_b16 a[112:113], v251 offset:1536
ds_read_b64_tr_b16 a[114:115], v251 offset:1792
v_mfma_f32_16x16x32_bf16 v[16:19], a[100:103], a[152:155], v[16:19]
ds_read_b64_tr_b16 a[116:117], v251 offset:9728
ds_read_b64_tr_b16 a[118:119], v251 offset:9984
v_mfma_f32_16x16x32_bf16 v[48:51], a[100:103], a[156:159], v[48:51]
ds_read_b128 a[64:67], v244 offset:0
ds_read_b128 a[80:83], v244 offset:4096
v_mfma_f32_16x16x32_bf16 v[48:51], a[96:99], a[140:143], v[48:51]
v_accvgpr_write_b32 a34, v242
v_accvgpr_write_b32 a35, v243
v_mfma_f32_16x16x32_bf16 v[80:83], a[96:99], a[144:147], v[80:83]
v_cvt_pk_bf16_f32 v240, v96, v97
v_cvt_pk_bf16_f32 v241, v98, v99
v_mfma_f32_16x16x32_bf16 v[80:83], a[100:103], a[160:163], v[80:83]
v_cvt_pk_bf16_f32 v242, v100, v101
v_cvt_pk_bf16_f32 v243, v102, v103
v_mfma_f32_16x16x32_bf16 v[112:115], a[100:103], a[164:167], v[112:115]
v_accvgpr_write_b32 a48, v240
v_accvgpr_write_b32 a49, v241
v_mfma_f32_16x16x32_bf16 v[112:115], a[96:99], a[148:151], v[112:115]
s_waitcnt lgkmcnt(6)
v_accvgpr_write_b32 a50, v242
v_accvgpr_write_b32 a51, v243
v_mfma_f32_16x16x32_bf16 v[116:119], a[104:107], a[148:151], v[116:119]
ds_read_b64_tr_b16 a[120:121], v251 offset:1544
ds_read_b64_tr_b16 a[122:123], v251 offset:1800
v_mfma_f32_16x16x32_bf16 v[116:119], a[108:111], a[164:167], v[116:119]
ds_read_b64_tr_b16 a[124:125], v251 offset:9736
ds_read_b64_tr_b16 a[126:127], v251 offset:9992
v_mfma_f32_16x16x32_bf16 v[84:87], a[108:111], a[160:163], v[84:87]
ds_read_b128 a[68:71], v244 offset:512
ds_read_b128 a[84:87], v244 offset:4608
v_mfma_f32_16x16x32_bf16 v[84:87], a[104:107], a[144:147], v[84:87]
v_cvt_pk_bf16_f32 v240, v8, v9
v_cvt_pk_bf16_f32 v241, v10, v11
v_mfma_f32_16x16x32_bf16 v[52:55], a[104:107], a[140:143], v[52:55]
v_cvt_pk_bf16_f32 v242, v12, v13
v_cvt_pk_bf16_f32 v243, v14, v15
v_mfma_f32_16x16x32_bf16 v[52:55], a[108:111], a[156:159], v[52:55]
v_accvgpr_write_b32 a4, v240
v_accvgpr_write_b32 a5, v241
v_mfma_f32_16x16x32_bf16 v[20:23], a[108:111], a[152:155], v[20:23]
v_accvgpr_write_b32 a6, v242
v_accvgpr_write_b32 a7, v243
v_mfma_f32_16x16x32_bf16 v[20:23], a[104:107], a[136:139], v[20:23]
s_waitcnt lgkmcnt(8)
v_cvt_pk_bf16_f32 v240, v40, v41
v_cvt_pk_bf16_f32 v241, v42, v43
v_mfma_f32_16x16x32_bf16 v[24:27], a[112:115], a[136:139], v[24:27]
v_cvt_pk_bf16_f32 v242, v44, v45
v_cvt_pk_bf16_f32 v243, v46, v47
v_mfma_f32_16x16x32_bf16 v[24:27], a[116:119], a[152:155], v[24:27]
v_accvgpr_write_b32 a20, v240
v_accvgpr_write_b32 a21, v241
v_mfma_f32_16x16x32_bf16 v[56:59], a[116:119], a[156:159], v[56:59]
ds_read_b128 a[72:75], v244 offset:1024
ds_read_b128 a[88:91], v244 offset:5120
v_mfma_f32_16x16x32_bf16 v[56:59], a[112:115], a[140:143], v[56:59]
v_accvgpr_write_b32 a22, v242
v_accvgpr_write_b32 a23, v243
v_mfma_f32_16x16x32_bf16 v[88:91], a[112:115], a[144:147], v[88:91]
v_cvt_pk_bf16_f32 v240, v72, v73
v_cvt_pk_bf16_f32 v241, v74, v75
v_mfma_f32_16x16x32_bf16 v[88:91], a[116:119], a[160:163], v[88:91]
v_cvt_pk_bf16_f32 v242, v76, v77
v_cvt_pk_bf16_f32 v243, v78, v79
v_mfma_f32_16x16x32_bf16 v[120:123], a[116:119], a[164:167], v[120:123]
v_accvgpr_write_b32 a36, v240
v_accvgpr_write_b32 a37, v241
v_mfma_f32_16x16x32_bf16 v[120:123], a[112:115], a[148:151], v[120:123]
s_waitcnt lgkmcnt(4)
v_accvgpr_write_b32 a38, v242
v_accvgpr_write_b32 a39, v243
v_mfma_f32_16x16x32_bf16 v[124:127], a[120:123], a[148:151], v[124:127]
v_cvt_pk_bf16_f32 v240, v104, v105
v_cvt_pk_bf16_f32 v241, v106, v107
v_mfma_f32_16x16x32_bf16 v[124:127], a[124:127], a[164:167], v[124:127]
v_cvt_pk_bf16_f32 v242, v108, v109
v_cvt_pk_bf16_f32 v243, v110, v111
v_mfma_f32_16x16x32_bf16 v[92:95], a[124:127], a[160:163], v[92:95]
ds_read_b128 a[76:79], v244 offset:1536
ds_read_b128 a[92:95], v244 offset:5632
v_mfma_f32_16x16x32_bf16 v[92:95], a[120:123], a[144:147], v[92:95]
v_accvgpr_write_b32 a52, v240
v_accvgpr_write_b32 a53, v241
v_mfma_f32_16x16x32_bf16 v[60:63], a[120:123], a[140:143], v[60:63]
v_accvgpr_write_b32 a54, v242
v_accvgpr_write_b32 a55, v243
v_mfma_f32_16x16x32_bf16 v[60:63], a[124:127], a[156:159], v[60:63]
v_cvt_pk_bf16_f32 v240, v16, v17
v_cvt_pk_bf16_f32 v241, v18, v19
v_mfma_f32_16x16x32_bf16 v[28:31], a[124:127], a[152:155], v[28:31]
v_cvt_pk_bf16_f32 v242, v20, v21
v_cvt_pk_bf16_f32 v243, v22, v23
v_mfma_f32_16x16x32_bf16 v[28:31], a[120:123], a[136:139], v[28:31]
v_accvgpr_write_b32 a8, v240
v_accvgpr_write_b32 a9, v241
s_nop 1
v_mfma_f32_16x16x32_bf16 v[128:131], a[64:67], a[0:3], 0
s_mov_b32 s34, 12
v_accvgpr_write_b32 a10, v242
v_accvgpr_write_b32 a11, v243
v_mfma_f32_16x16x32_bf16 v[136:139], a[64:67], a[16:19], 0
s_mov_b32 s35, 0
v_cvt_pk_bf16_f32 v240, v48, v49
v_cvt_pk_bf16_f32 v241, v50, v51
v_mfma_f32_16x16x32_bf16 v[144:147], a[64:67], a[32:35], 0
s_mov_b32 s37, 49152
v_cvt_pk_bf16_f32 v242, v52, v53
v_cvt_pk_bf16_f32 v243, v54, v55
v_mfma_f32_16x16x32_bf16 v[152:155], a[64:67], a[48:51], 0
s_mov_b32 s39, 98304
ds_read_b128 a[64:67], v244 offset:8192
v_accvgpr_write_b32 a24, v240
v_accvgpr_write_b32 a25, v241
s_nop 1
v_mfma_f32_16x16x32_bf16 v[132:135], a[80:83], a[0:3], 0
s_add_u32 s4, s46, 50048
s_addc_u32 s5, s47, 0
v_accvgpr_write_b32 a26, v242
v_accvgpr_write_b32 a27, v243
v_mfma_f32_16x16x32_bf16 v[140:143], a[80:83], a[16:19], 0
s_add_u32 s6, s46, 49152
s_addc_u32 s7, s47, 0
v_cvt_pk_bf16_f32 v240, v80, v81
v_cvt_pk_bf16_f32 v241, v82, v83
v_mfma_f32_16x16x32_bf16 v[148:151], a[80:83], a[32:35], 0
s_add_u32 s8, s48, 33664
s_addc_u32 s9, s49, 0
v_cvt_pk_bf16_f32 v242, v84, v85
v_cvt_pk_bf16_f32 v243, v86, v87
v_mfma_f32_16x16x32_bf16 v[156:159], a[80:83], a[48:51], 0
s_add_u32 s10, s48, 32768
s_addc_u32 s11, s49, 0
ds_read_b128 a[80:83], v244 offset:12288
v_accvgpr_write_b32 a40, v240
v_accvgpr_write_b32 a41, v241
s_waitcnt lgkmcnt(7)
s_nop 1
v_mfma_f32_16x16x32_bf16 v[128:131], a[68:71], a[4:7], v[128:131]
v_accvgpr_write_b32 a42, v242
v_accvgpr_write_b32 a43, v243
v_mfma_f32_16x16x32_bf16 v[136:139], a[68:71], a[20:23], v[136:139]
v_cvt_pk_bf16_f32 v240, v112, v113
v_cvt_pk_bf16_f32 v241, v114, v115
v_mfma_f32_16x16x32_bf16 v[144:147], a[68:71], a[36:39], v[144:147]
v_cvt_pk_bf16_f32 v242, v116, v117
v_cvt_pk_bf16_f32 v243, v118, v119
v_mfma_f32_16x16x32_bf16 v[152:155], a[68:71], a[52:55], v[152:155]
ds_read_b128 a[68:71], v244 offset:8704
v_accvgpr_write_b32 a56, v240
v_accvgpr_write_b32 a57, v241
s_waitcnt lgkmcnt(7)
s_nop 1
v_mfma_f32_16x16x32_bf16 v[132:135], a[84:87], a[4:7], v[132:135]
v_accvgpr_write_b32 a58, v242
v_accvgpr_write_b32 a59, v243
v_mfma_f32_16x16x32_bf16 v[140:143], a[84:87], a[20:23], v[140:143]
v_cvt_pk_bf16_f32 v240, v24, v25
v_cvt_pk_bf16_f32 v241, v26, v27
v_mfma_f32_16x16x32_bf16 v[148:151], a[84:87], a[36:39], v[148:151]
v_cvt_pk_bf16_f32 v242, v28, v29
v_cvt_pk_bf16_f32 v243, v30, v31
v_mfma_f32_16x16x32_bf16 v[156:159], a[84:87], a[52:55], v[156:159]
ds_read_b128 a[84:87], v244 offset:12800
v_accvgpr_write_b32 a12, v240
v_accvgpr_write_b32 a13, v241
s_waitcnt lgkmcnt(7)
s_nop 1
v_mfma_f32_16x16x32_bf16 v[128:131], a[72:75], a[8:11], v[128:131]
v_accvgpr_write_b32 a14, v242
v_accvgpr_write_b32 a15, v243
v_mfma_f32_16x16x32_bf16 v[136:139], a[72:75], a[24:27], v[136:139]
v_cvt_pk_bf16_f32 v240, v56, v57
v_cvt_pk_bf16_f32 v241, v58, v59
v_mfma_f32_16x16x32_bf16 v[144:147], a[72:75], a[40:43], v[144:147]
v_cvt_pk_bf16_f32 v242, v60, v61
v_cvt_pk_bf16_f32 v243, v62, v63
v_mfma_f32_16x16x32_bf16 v[152:155], a[72:75], a[56:59], v[152:155]
ds_read_b128 a[72:75], v244 offset:9216
v_accvgpr_write_b32 a28, v240
v_accvgpr_write_b32 a29, v241
s_waitcnt lgkmcnt(7)
s_nop 1
v_mfma_f32_16x16x32_bf16 v[132:135], a[88:91], a[8:11], v[132:135]
v_accvgpr_write_b32 a30, v242
v_accvgpr_write_b32 a31, v243
v_mfma_f32_16x16x32_bf16 v[140:143], a[88:91], a[24:27], v[140:143]
v_cvt_pk_bf16_f32 v240, v88, v89
v_cvt_pk_bf16_f32 v241, v90, v91
v_mfma_f32_16x16x32_bf16 v[148:151], a[88:91], a[40:43], v[148:151]
v_cvt_pk_bf16_f32 v242, v92, v93
v_cvt_pk_bf16_f32 v243, v94, v95
v_mfma_f32_16x16x32_bf16 v[156:159], a[88:91], a[56:59], v[156:159]
v_accvgpr_write_b32 a44, v240
v_accvgpr_write_b32 a45, v241
v_accvgpr_write_b32 a46, v242
v_accvgpr_write_b32 a47, v243
v_cvt_pk_bf16_f32 v240, v120, v121
v_cvt_pk_bf16_f32 v241, v122, v123
v_cvt_pk_bf16_f32 v242, v124, v125
v_cvt_pk_bf16_f32 v243, v126, v127
v_accvgpr_write_b32 a60, v240
v_accvgpr_write_b32 a61, v241
v_accvgpr_write_b32 a62, v242
v_accvgpr_write_b32 a63, v243
s_waitcnt lgkmcnt(6)
s_nop 1
v_mfma_f32_16x16x32_bf16 v[128:131], a[76:79], a[12:15], v[128:131]
v_mfma_f32_16x16x32_bf16 v[136:139], a[76:79], a[28:31], v[136:139]
v_mfma_f32_16x16x32_bf16 v[144:147], a[76:79], a[44:47], v[144:147]
v_mfma_f32_16x16x32_bf16 v[152:155], a[76:79], a[60:63], v[152:155]
ds_read_b128 a[76:79], v244 offset:9728
s_waitcnt lgkmcnt(6)
s_nop 1
v_mfma_f32_16x16x32_bf16 v[132:135], a[92:95], a[12:15], v[132:135]
v_mov_b32 v240, 0
v_mfma_f32_16x16x32_bf16 v[140:143], a[92:95], a[28:31], v[140:143]
v_mov_b32 v241, 0
v_mfma_f32_16x16x32_bf16 v[148:151], a[92:95], a[44:47], v[148:151]
v_mov_b32 v242, 0
v_mfma_f32_16x16x32_bf16 v[156:159], a[92:95], a[60:63], v[156:159]
v_mov_b32 v243, 0
s_nop 1
v_max3_f32 v224, v128, v129, v130
v_max3_f32 v225, v131, v132, v133
v_max3_f32 v224, v224, v134, v135
v_max_f32 v224, v224, v225
v_max3_f32 v228, v136, v137, v138
v_max3_f32 v229, v139, v140, v141
v_max3_f32 v228, v228, v142, v143
v_max_f32 v228, v228, v229
v_max3_f32 v232, v144, v145, v146
v_max3_f32 v233, v147, v148, v149
v_max3_f32 v232, v232, v150, v151
v_max_f32 v232, v232, v233
v_max3_f32 v236, v152, v153, v154
v_max3_f32 v237, v155, v156, v157
v_max3_f32 v236, v236, v158, v159
v_max_f32 v236, v236, v237
v_mov_b32 v225, v224
v_mov_b32 v229, v228
v_mov_b32 v233, v232
v_mov_b32 v237, v236
v_permlane16_swap_b32 v224, v225
v_permlane16_swap_b32 v228, v229
v_permlane16_swap_b32 v232, v233
v_permlane16_swap_b32 v236, v237
v_max_f32 v224, v224, v225
v_max_f32 v228, v228, v229
v_max_f32 v232, v232, v233
v_max_f32 v236, v236, v237
v_mov_b32 v225, v224
v_mov_b32 v229, v228
v_mov_b32 v233, v232
v_mov_b32 v237, v236
v_permlane32_swap_b32 v224, v225
v_permlane32_swap_b32 v228, v229
v_permlane32_swap_b32 v232, v233
v_permlane32_swap_b32 v236, v237
v_max_f32 v224, v224, v225
v_max_f32 v228, v228, v229
v_max_f32 v232, v232, v233
v_max_f32 v236, v236, v237
v_sub_f32 v224, 0xc2000000, v224
v_sub_f32 v228, 0xc2000000, v228
v_sub_f32 v232, 0xc2000000, v232
v_sub_f32 v236, 0xc2000000, v236
v_mov_b32 v225, v224
v_mov_b32 v226, v224
v_mov_b32 v227, v224
v_mov_b32 v229, v228
v_mov_b32 v230, v228
v_mov_b32 v231, v228
v_mov_b32 v233, v232
v_mov_b32 v234, v232
v_mov_b32 v235, v232
v_mov_b32 v237, v236
v_mov_b32 v238, v236
v_mov_b32 v239, v236
L_m_havemax:
v_pk_add_f32 v[128:129], v[128:129], v[224:225]
v_pk_add_f32 v[130:131], v[130:131], v[224:225]
v_pk_add_f32 v[136:137], v[136:137], v[228:229]
v_pk_add_f32 v[138:139], v[138:139], v[228:229]
v_pk_add_f32 v[144:145], v[144:145], v[232:233]
v_pk_add_f32 v[146:147], v[146:147], v[232:233]
v_pk_add_f32 v[152:153], v[152:153], v[236:237]
v_pk_add_f32 v[154:155], v[154:155], v[236:237]
v_pk_add_f32 v[132:133], v[132:133], v[224:225]
v_pk_add_f32 v[134:135], v[134:135], v[224:225]
v_pk_add_f32 v[140:141], v[140:141], v[228:229]
v_pk_add_f32 v[142:143], v[142:143], v[228:229]
v_pk_add_f32 v[148:149], v[148:149], v[232:233]
v_pk_add_f32 v[150:151], v[150:151], v[232:233]
v_pk_add_f32 v[156:157], v[156:157], v[236:237]
v_pk_add_f32 v[158:159], v[158:159], v[236:237]
v_exp_f32 v128, v128
v_exp_f32 v129, v129
v_exp_f32 v130, v130
v_exp_f32 v131, v131
v_exp_f32 v136, v136
v_exp_f32 v137, v137
v_exp_f32 v138, v138
v_exp_f32 v139, v139
v_exp_f32 v144, v144
v_exp_f32 v145, v145
v_exp_f32 v146, v146
v_exp_f32 v147, v147
v_exp_f32 v152, v152
v_exp_f32 v153, v153
v_exp_f32 v154, v154
v_exp_f32 v155, v155
v_exp_f32 v132, v132
v_exp_f32 v133, v133
v_exp_f32 v134, v134
v_exp_f32 v135, v135
v_exp_f32 v140, v140
v_exp_f32 v141, v141
v_exp_f32 v142, v142
v_exp_f32 v143, v143
v_and_b32 v251, 0x30, v250
v_cmp_eq_u32 vcc, 0, v251
v_mov_b32 v251, 0x3f803f80
v_cvt_pk_bf16_f32 v160, v128, v129
v_cvt_pk_bf16_f32 v161, v130, v131
v_add_f32 v241, v241, v136
v_add_f32 v241, v241, v137
v_cvt_pk_bf16_f32 v164, v136, v137
v_add_f32 v241, v241, v138
v_add_f32 v241, v241, v139
v_cvt_pk_bf16_f32 v165, v138, v139
v_cvt_pk_bf16_f32 v168, v144, v145
v_cvt_pk_bf16_f32 v169, v146, v147
v_add_f32 v243, v243, v152
v_add_f32 v243, v243, v153
v_cvt_pk_bf16_f32 v172, v152, v153
v_add_f32 v243, v243, v154
v_add_f32 v243, v243, v155
v_cvt_pk_bf16_f32 v173, v154, v155
v_cvt_pk_bf16_f32 v162, v132, v133
v_cvt_pk_bf16_f32 v163, v134, v135
v_add_f32 v241, v241, v140
v_cvt_pk_bf16_f32 v166, v140, v141
v_cndmask_b32 v251, 0, v251, vcc
v_accvgpr_write_b32 a112, v251
v_accvgpr_write_b32 a113, v251
v_accvgpr_write_b32 a114, v251
v_accvgpr_write_b32 a115, v251
s_waitcnt lgkmcnt(0)
v_mfma_f32_16x16x32_bf16 v[128:131], a[64:67], a[0:3], v[224:227]
v_exp_f32 v148, v148
s_barrier
v_mfma_f32_16x16x32_bf16 v[128:131], a[68:71], a[4:7], v[128:131]
ds_read_b128 a[88:91], v244 offset:13312
v_mfma_f32_16x16x32_bf16 v[128:131], a[72:75], a[8:11], v[128:131]
s_add_u32 m0, s37, s31
v_exp_f32 v149, v149
v_mfma_f32_16x16x32_bf16 v[128:131], a[76:79], a[12:15], v[128:131]
v_add_f32 v241, v241, v141
v_cvt_pk_bf16_f32 v167, v142, v143
v_mfma_f32_16x16x32_bf16 v[136:139], a[76:79], a[28:31], v[228:231]
v_exp_f32 v150, v150
v_mfma_f32_16x16x32_bf16 v[136:139], a[72:75], a[24:27], v[136:139]
ds_read_b128 a[92:95], v244 offset:13824
global_load_lds_dwordx4 v248, s[4:5] offset:0
v_mfma_f32_16x16x32_bf16 v[136:139], a[68:71], a[20:23], v[136:139]
v_exp_f32 v151, v151
v_mfma_f32_16x16x32_bf16 v[136:139], a[64:67], a[16:19], v[136:139]
v_add_f32 v241, v241, v142
v_cvt_pk_bf16_f32 v170, v148, v149
v_mfma_f32_16x16x32_bf16 v[144:147], a[64:67], a[32:35], v[232:235]
s_mul_i32 s43, s28, 1228800
v_exp_f32 v156, v156
s_lshl_b32 s3, s86, 5
v_mfma_f32_16x16x32_bf16 v[144:147], a[68:71], a[36:39], v[144:147]
global_load_lds_dwordx4 v248, s[6:7] offset:1024
v_mfma_f32_16x16x32_bf16 v[144:147], a[72:75], a[40:43], v[144:147]
s_add_u32 s43, s43, s3
v_exp_f32 v157, v157
s_mul_i32 s36, s28, 320
v_mfma_f32_16x16x32_bf16 v[144:147], a[76:79], a[44:47], v[144:147]
v_add_f32 v241, v241, v143
v_cvt_pk_bf16_f32 v171, v150, v151
v_mfma_f32_16x16x32_bf16 v[152:155], a[76:79], a[60:63], v[236:239]
s_add_u32 s36, s36, 2629632
v_exp_f32 v158, v158
v_mfma_f32_16x16x32_bf16 v[152:155], a[72:75], a[56:59], v[152:155]
L_m_c0_2:
s_cbranch_execz L_m_c0_6
global_load_lds_dwordx4 v248, s[4:5] offset:2048
global_load_lds_dwordx4 v248, s[6:7] offset:3072
v_mfma_f32_16x16x32_bf16 v[152:155], a[68:71], a[52:55], v[152:155]
v_exp_f32 v159, v159
v_mfma_f32_16x16x32_bf16 v[152:155], a[64:67], a[48:51], v[152:155]
s_waitcnt lgkmcnt(0)
v_add_f32 v243, v243, v156
v_cvt_pk_bf16_f32 v174, v156, v157
v_mfma_f32_16x16x32_bf16 v[132:135], a[80:83], a[0:3], v[224:227]
v_exp_f32 v128, v128
v_mfma_f32_16x16x32_bf16 v[132:135], a[84:87], a[4:7], v[132:135]
v_accvgpr_read_b32 v252, a134
v_lshrrev_b32 v253, 4, v250
v_mfma_f32_16x16x32_bf16 v[132:135], a[88:91], a[8:11], v[132:135]
v_exp_f32 v129, v129
v_mfma_f32_16x16x32_bf16 v[132:135], a[92:95], a[12:15], v[132:135]
v_add_f32 v243, v243, v157
v_cvt_pk_bf16_f32 v175, v158, v159
v_mfma_f32_16x16x32_bf16 v[140:143], a[92:95], a[28:31], v[228:231]
v_exp_f32 v130, v130
v_mfma_f32_16x16x32_bf16 v[140:143], a[88:91], a[24:27], v[140:143]
v_and_b32 v253, 48, v253
v_bfe_u32 v251, v250, 1, 7
v_mfma_f32_16x16x32_bf16 v[140:143], a[84:87], a[20:23], v[140:143]
v_exp_f32 v131, v131
v_mfma_f32_16x16x32_bf16 v[140:143], a[80:83], a[16:19], v[140:143]
v_add_f32 v243, v243, v158
v_cvt_pk_bf16_f32 v176, v128, v129
v_mfma_f32_16x16x32_bf16 v[148:151], a[80:83], a[32:35], v[232:235]
s_mov_b32 s33, s35
v_exp_f32 v136, v136
s_add_u32 s35, s35, 16384
v_mfma_f32_16x16x32_bf16 v[148:151], a[84:87], a[36:39], v[148:151]
v_lshl_add_u32 v251, v253, 4, v251
v_add_u32 v251, s77, v251
v_mfma_f32_16x16x32_bf16 v[148:151], a[88:91], a[40:43], v[148:151]
s_and_b32 s35, s35, 0xffff
v_exp_f32 v137, v137
v_mfma_f32_16x16x32_bf16 v[148:151], a[92:95], a[44:47], v[148:151]
v_add_f32 v243, v243, v159
v_cvt_pk_bf16_f32 v177, v130, v131
v_mfma_f32_16x16x32_bf16 v[156:159], a[92:95], a[60:63], v[236:239]
s_add_u32 s42, s43, 2560
v_exp_f32 v138, v138
s_add_u32 m0, s77, 0
v_mfma_f32_16x16x32_bf16 v[156:159], a[88:91], a[56:59], v[156:159]
buffer_load_dwordx4 v252, s[88:91], s42 offen nt lds
v_mfma_f32_16x16x32_bf16 v[156:159], a[84:87], a[52:55], v[156:159]
v_exp_f32 v139, v139
v_mfma_f32_16x16x32_bf16 v[156:159], a[80:83], a[48:51], v[156:159]
v_add_f32 v241, v241, v136
v_cvt_pk_bf16_f32 v180, v136, v137
v_exp_f32 v144, v144
v_exp_f32 v145, v145
v_add_f32 v241, v241, v137
v_cvt_pk_bf16_f32 v181, v138, v139
v_exp_f32 v146, v146
v_exp_f32 v147, v147
v_add_f32 v241, v241, v138
v_cvt_pk_bf16_f32 v184, v144, v145
v_add_u32 v244, s35, v245
s_add_u32 s4, s4, 16384
v_exp_f32 v152, v152
s_addc_u32 s5, s5, 0
s_add_u32 s6, s6, 16384
v_exp_f32 v153, v153
s_addc_u32 s7, s7, 0
v_add_f32 v241, v241, v139
v_cvt_pk_bf16_f32 v185, v146, v147
v_exp_f32 v154, v154
v_exp_f32 v155, v155
v_add_f32 v243, v243, v152
v_cvt_pk_bf16_f32 v188, v152, v153
v_exp_f32 v132, v132
ds_read_b128 a[64:67], v244 offset:0
ds_read_b128 a[68:71], v244 offset:512
v_exp_f32 v133, v133
v_add_f32 v243, v243, v153
v_cvt_pk_bf16_f32 v189, v154, v155
v_exp_f32 v134, v134
ds_read_b128 a[72:75], v244 offset:1024
ds_read_b128 a[76:79], v244 offset:1536
v_exp_f32 v135, v135
v_add_f32 v243, v243, v154
v_cvt_pk_bf16_f32 v178, v132, v133
v_exp_f32 v140, v140
ds_read_b128 a[80:83], v244 offset:4096
v_add_u32 v246, s33, v247
v_exp_f32 v141, v141
v_add_f32 v243, v243, v155
v_cvt_pk_bf16_f32 v179, v134, v135
v_exp_f32 v142, v142
ds_read_b128 a[84:87], v244 offset:4608
v_xor_b32 v249, 32, v246
v_exp_f32 v143, v143
s_waitcnt lgkmcnt(2)
v_add_f32 v241, v241, v140
v_cvt_pk_bf16_f32 v182, v140, v141
v_mfma_f32_16x16x32_bf16 v[128:131], a[64:67], a[0:3], v[224:227]
v_exp_f32 v148, v148
v_mfma_f32_16x16x32_bf16 v[128:131], a[68:71], a[4:7], v[128:131]
ds_read_b128 a[88:91], v244 offset:5120
v_accvgpr_write_b32 a124, 0
v_mfma_f32_16x16x32_bf16 v[128:131], a[72:75], a[8:11], v[128:131]
s_add_u32 m0, s39, s31
v_exp_f32 v149, v149
v_mfma_f32_16x16x32_bf16 v[128:131], a[76:79], a[12:15], v[128:131]
v_add_f32 v241, v241, v141
v_cvt_pk_bf16_f32 v183, v142, v143
v_mfma_f32_16x16x32_bf16 v[136:139], a[76:79], a[28:31], v[228:231]
v_exp_f32 v150, v150
v_mfma_f32_16x16x32_bf16 v[136:139], a[72:75], a[24:27], v[136:139]
ds_read_b128 a[92:95], v244 offset:5632
global_load_lds_dwordx4 v248, s[8:9] offset:0
v_mfma_f32_16x16x32_bf16 v[136:139], a[68:71], a[20:23], v[136:139]
v_exp_f32 v151, v151
v_mfma_f32_16x16x32_bf16 v[136:139], a[64:67], a[16:19], v[136:139]
v_add_f32 v241, v241, v142
v_cvt_pk_bf16_f32 v186, v148, v149
v_mfma_f32_16x16x32_bf16 v[144:147], a[64:67], a[32:35], v[232:235]
v_exp_f32 v156, v156
v_mfma_f32_16x16x32_bf16 v[144:147], a[68:71], a[36:39], v[144:147]
global_load_lds_dwordx4 v248, s[10:11] offset:1024
v_accvgpr_write_b32 a125, 0
v_accvgpr_write_b32 a126, 0
v_mfma_f32_16x16x32_bf16 v[144:147], a[72:75], a[40:43], v[144:147]
v_exp_f32 v157, v157
v_mfma_f32_16x16x32_bf16 v[144:147], a[76:79], a[44:47], v[144:147]
v_add_f32 v241, v241, v143
v_cvt_pk_bf16_f32 v187, v150, v151
v_mfma_f32_16x16x32_bf16 v[152:155], a[76:79], a[60:63], v[236:239]
v_exp_f32 v158, v158
v_mfma_f32_16x16x32_bf16 v[152:155], a[72:75], a[56:59], v[152:155]
global_load_lds_dwordx4 v248, s[8:9] offset:2048
global_load_lds_dwordx4 v248, s[10:11] offset:3072
v_accvgpr_write_b32 a127, 0
v_mfma_f32_16x16x32_bf16 v[152:155], a[68:71], a[52:55], v[152:155]
v_exp_f32 v159, v159
v_mfma_f32_16x16x32_bf16 v[152:155], a[64:67], a[48:51], v[152:155]
s_waitcnt lgkmcnt(0)
v_add_f32 v243, v243, v156
v_cvt_pk_bf16_f32 v190, v156, v157
v_mfma_f32_16x16x32_bf16 v[132:135], a[80:83], a[0:3], v[224:227]
v_exp_f32 v128, v128
v_mfma_f32_16x16x32_bf16 v[132:135], a[84:87], a[4:7], v[132:135]
ds_read_b64_tr_b16 a[96:97], v246 offset:0
ds_read_b64_tr_b16 a[98:99], v246 offset:4096
v_mfma_f32_16x16x32_bf16 v[132:135], a[88:91], a[8:11], v[132:135]
v_exp_f32 v129, v129
v_mfma_f32_16x16x32_bf16 v[132:135], a[92:95], a[12:15], v[132:135]
v_add_f32 v243, v243, v157
v_cvt_pk_bf16_f32 v191, v158, v159
v_mfma_f32_16x16x32_bf16 v[140:143], a[92:95], a[28:31], v[228:231]
v_exp_f32 v130, v130
v_mfma_f32_16x16x32_bf16 v[140:143], a[88:91], a[24:27], v[140:143]
ds_read_b64_tr_b16 a[100:101], v246 offset:8192
ds_read_b64_tr_b16 a[102:103], v246 offset:12288
v_mfma_f32_16x16x32_bf16 v[140:143], a[84:87], a[20:23], v[140:143]
v_exp_f32 v131, v131
v_mfma_f32_16x16x32_bf16 v[140:143], a[80:83], a[16:19], v[140:143]
v_add_f32 v243, v243, v158
v_cvt_pk_bf16_f32 v192, v128, v129
v_mfma_f32_16x16x32_bf16 v[148:151], a[80:83], a[32:35], v[232:235]
v_exp_f32 v136, v136
v_mfma_f32_16x16x32_bf16 v[148:151], a[84:87], a[36:39], v[148:151]
ds_read_b64_tr_b16 a[104:105], v249 offset:0
ds_read_b64_tr_b16 a[106:107], v249 offset:4096
v_mfma_f32_16x16x32_bf16 v[148:151], a[88:91], a[40:43], v[148:151]
v_exp_f32 v137, v137
v_mfma_f32_16x16x32_bf16 v[148:151], a[92:95], a[44:47], v[148:151]
v_add_f32 v243, v243, v159
v_cvt_pk_bf16_f32 v193, v130, v131
v_mfma_f32_16x16x32_bf16 v[156:159], a[92:95], a[60:63], v[236:239]
v_exp_f32 v138, v138
v_mfma_f32_16x16x32_bf16 v[156:159], a[88:91], a[56:59], v[156:159]
ds_read_b64_tr_b16 a[108:109], v249 offset:8192
ds_read_b64_tr_b16 a[110:111], v249 offset:12288
v_mfma_f32_16x16x32_bf16 v[156:159], a[84:87], a[52:55], v[156:159]
v_exp_f32 v139, v139
v_mfma_f32_16x16x32_bf16 v[156:159], a[80:83], a[48:51], v[156:159]
s_waitcnt lgkmcnt(4)
v_add_f32 v241, v241, v136
v_cvt_pk_bf16_f32 v196, v136, v137
v_mfma_f32_16x16x32_bf16 v[0:3], a[96:99], v[160:163], 0
s_add_u32 s39, s37, 65536
v_exp_f32 v144, v144
s_add_u32 s37, s37, 16384
v_mfma_f32_16x16x32_bf16 v[0:3], a[100:103], v[176:179], v[0:3]
ds_read_b64_tr_b16 a[80:81], v246 offset:512
ds_read_b64_tr_b16 a[82:83], v246 offset:4608
v_mfma_f32_16x16x32_bf16 v[32:35], a[100:103], v[180:183], 0
s_and_b32 s37, s37, 0xffff
v_exp_f32 v145, v145
v_mfma_f32_16x16x32_bf16 v[32:35], a[96:99], v[164:167], v[32:35]
v_add_f32 v241, v241, v137
v_cvt_pk_bf16_f32 v197, v138, v139
v_mfma_f32_16x16x32_bf16 v[64:67], a[96:99], v[168:171], 0
s_add_u32 s42, s43, 248320
v_exp_f32 v146, v146
v_mfma_f32_16x16x32_bf16 v[64:67], a[100:103], v[184:187], v[64:67]
ds_read_b64_tr_b16 a[84:85], v246 offset:8704
ds_read_b64_tr_b16 a[86:87], v246 offset:12800
v_mfma_f32_16x16x32_bf16 v[96:99], a[100:103], v[188:191], 0
s_add_u32 m0, s77, 1024
v_exp_f32 v147, v147
v_mfma_f32_16x16x32_bf16 v[96:99], a[96:99], v[172:175], v[96:99]
s_waitcnt lgkmcnt(4)
v_add_f32 v241, v241, v138
v_cvt_pk_bf16_f32 v200, v144, v145
v_mfma_f32_16x16x32_bf16 a[116:119], a[112:115], v[160:163], 0
buffer_load_dwordx4 v252, s[88:91], s42 offen nt lds
v_mfma_f32_16x16x32_bf16 a[116:119], a[112:115], v[176:179], a[116:119]
v_mfma_f32_16x16x32_bf16 v[100:103], a[104:107], v[172:175], 0
s_add_u32 s8, s8, 16384
v_exp_f32 v152, v152
s_addc_u32 s9, s9, 0
v_mfma_f32_16x16x32_bf16 v[100:103], a[108:111], v[188:191], v[100:103]
ds_read_b64_tr_b16 a[88:89], v249 offset:512
ds_read_b64_tr_b16 a[90:91], v249 offset:4608
v_mfma_f32_16x16x32_bf16 v[68:71], a[108:111], v[184:187], 0
s_add_u32 s10, s10, 16384
v_exp_f32 v153, v153
s_addc_u32 s11, s11, 0
v_mfma_f32_16x16x32_bf16 v[68:71], a[104:107], v[168:171], v[68:71]
v_add_f32 v241, v241, v139
v_cvt_pk_bf16_f32 v201, v146, v147
v_mfma_f32_16x16x32_bf16 v[36:39], a[104:107], v[164:167], 0
v_exp_f32 v154, v154
v_mfma_f32_16x16x32_bf16 v[36:39], a[108:111], v[180:183], v[36:39]
ds_read_b64_tr_b16 a[92:93], v249 offset:8704
ds_read_b64_tr_b16 a[94:95], v249 offset:12800
v_mfma_f32_16x16x32_bf16 v[4:7], a[108:111], v[176:179], 0
v_exp_f32 v155, v155
v_mfma_f32_16x16x32_bf16 v[4:7], a[104:107], v[160:163], v[4:7]
s_waitcnt lgkmcnt(4)
v_add_f32 v243, v243, v152
v_cvt_pk_bf16_f32 v204, v152, v153
v_mfma_f32_16x16x32_bf16 v[8:11], a[80:83], v[160:163], 0
v_exp_f32 v132, v132
v_mfma_f32_16x16x32_bf16 v[8:11], a[84:87], v[176:179], v[8:11]
ds_read_b128 a[64:67], v244 offset:8192
ds_read_b128 a[68:71], v244 offset:8704
v_mfma_f32_16x16x32_bf16 v[40:43], a[84:87], v[180:183], 0
v_exp_f32 v133, v133
v_mfma_f32_16x16x32_bf16 v[40:43], a[80:83], v[164:167], v[40:43]
v_add_f32 v243, v243, v153
v_cvt_pk_bf16_f32 v205, v154, v155
v_mfma_f32_16x16x32_bf16 v[72:75], a[80:83], v[168:171], 0
v_exp_f32 v134, v134
v_mfma_f32_16x16x32_bf16 v[72:75], a[84:87], v[184:187], v[72:75]
ds_read_b128 a[72:75], v244 offset:9216
ds_read_b128 a[76:79], v244 offset:9728
v_mfma_f32_16x16x32_bf16 v[104:107], a[84:87], v[188:191], 0
v_exp_f32 v135, v135
v_mfma_f32_16x16x32_bf16 v[104:107], a[80:83], v[172:175], v[104:107]
s_waitcnt lgkmcnt(4)
v_add_f32 v243, v243, v154
v_cvt_pk_bf16_f32 v194, v132, v133
v_mfma_f32_16x16x32_bf16 v[108:111], a[88:91], v[172:175], 0
s_add_u32 s42, s43, 494080
v_exp_f32 v140, v140
s_add_u32 m0, s77, 2048
v_mfma_f32_16x16x32_bf16 v[108:111], a[92:95], v[188:191], v[108:111]
ds_read_b128 a[80:83], v244 offset:12288
buffer_load_dwordx4 v252, s[88:91], s42 offen nt lds
v_mfma_f32_16x16x32_bf16 v[76:79], a[92:95], v[184:187], 0
v_exp_f32 v141, v141
v_mfma_f32_16x16x32_bf16 v[76:79], a[88:91], v[168:171], v[76:79]
v_add_f32 v243, v243, v155
v_cvt_pk_bf16_f32 v195, v134, v135
v_mfma_f32_16x16x32_bf16 v[44:47], a[88:91], v[164:167], 0
v_exp_f32 v142, v142
v_mfma_f32_16x16x32_bf16 v[44:47], a[92:95], v[180:183], v[44:47]
ds_read_b128 a[84:87], v244 offset:12800
v_mfma_f32_16x16x32_bf16 v[12:15], a[92:95], v[176:179], 0
v_exp_f32 v143, v143
v_mfma_f32_16x16x32_bf16 v[12:15], a[88:91], v[160:163], v[12:15]
s_waitcnt lgkmcnt(2)
v_add_f32 v241, v241, v140
v_cvt_pk_bf16_f32 v198, v140, v141
v_mfma_f32_16x16x32_bf16 v[128:131], a[64:67], a[0:3], v[224:227]
s_waitcnt vmcnt(11)
v_exp_f32 v148, v148
s_barrier
v_mfma_f32_16x16x32_bf16 v[128:131], a[68:71], a[4:7], v[128:131]
ds_read_b128 a[88:91], v244 offset:13312
v_mfma_f32_16x16x32_bf16 v[128:131], a[72:75], a[8:11], v[128:131]
s_add_u32 m0, s37, s31
v_exp_f32 v149, v149
v_mfma_f32_16x16x32_bf16 v[128:131], a[76:79], a[12:15], v[128:131]
v_add_f32 v241, v241, v141
v_cvt_pk_bf16_f32 v199, v142, v143
v_mfma_f32_16x16x32_bf16 v[136:139], a[76:79], a[28:31], v[228:231]
v_exp_f32 v150, v150
v_mfma_f32_16x16x32_bf16 v[136:139], a[72:75], a[24:27], v[136:139]
ds_read_b128 a[92:95], v244 offset:13824
global_load_lds_dwordx4 v248, s[4:5] offset:0
v_mfma_f32_16x16x32_bf16 v[136:139], a[68:71], a[20:23], v[136:139]
v_exp_f32 v151, v151
v_mfma_f32_16x16x32_bf16 v[136:139], a[64:67], a[16:19], v[136:139]
v_add_f32 v241, v241, v142
v_cvt_pk_bf16_f32 v202, v148, v149
v_mfma_f32_16x16x32_bf16 v[144:147], a[64:67], a[32:35], v[232:235]
v_exp_f32 v156, v156
v_mfma_f32_16x16x32_bf16 v[144:147], a[68:71], a[36:39], v[144:147]
global_load_lds_dwordx4 v248, s[6:7] offset:1024
v_mfma_f32_16x16x32_bf16 v[144:147], a[72:75], a[40:43], v[144:147]
v_exp_f32 v157, v157
v_mfma_f32_16x16x32_bf16 v[144:147], a[76:79], a[44:47], v[144:147]
v_add_f32 v241, v241, v143
v_cvt_pk_bf16_f32 v203, v150, v151
v_mfma_f32_16x16x32_bf16 v[152:155], a[76:79], a[60:63], v[236:239]
v_exp_f32 v158, v158
v_mfma_f32_16x16x32_bf16 v[152:155], a[72:75], a[56:59], v[152:155]
global_load_lds_dwordx4 v248, s[4:5] offset:2048
global_load_lds_dwordx4 v248, s[6:7] offset:3072
v_mfma_f32_16x16x32_bf16 v[152:155], a[68:71], a[52:55], v[152:155]
v_exp_f32 v159, v159
v_mfma_f32_16x16x32_bf16 v[152:155], a[64:67], a[48:51], v[152:155]
s_waitcnt lgkmcnt(0)
v_add_f32 v243, v243, v156
v_cvt_pk_bf16_f32 v206, v156, v157
v_mfma_f32_16x16x32_bf16 v[132:135], a[80:83], a[0:3], v[224:227]
v_exp_f32 v128, v128
v_mfma_f32_16x16x32_bf16 v[132:135], a[84:87], a[4:7], v[132:135]
ds_read_b64_tr_b16 a[96:97], v246 offset:1024
ds_read_b64_tr_b16 a[98:99], v246 offset:5120
v_mfma_f32_16x16x32_bf16 v[132:135], a[88:91], a[8:11], v[132:135]
v_exp_f32 v129, v129
v_mfma_f32_16x16x32_bf16 v[132:135], a[92:95], a[12:15], v[132:135]
v_add_f32 v243, v243, v157
v_cvt_pk_bf16_f32 v207, v158, v159
v_mfma_f32_16x16x32_bf16 v[140:143], a[92:95], a[28:31], v[228:231]
v_exp_f32 v130, v130
v_mfma_f32_16x16x32_bf16 v[140:143], a[88:91], a[24:27], v[140:143]
ds_read_b64_tr_b16 a[100:101], v246 offset:9216
ds_read_b64_tr_b16 a[102:103], v246 offset:13312
v_mfma_f32_16x16x32_bf16 v[140:143], a[84:87], a[20:23], v[140:143]
v_exp_f32 v131, v131
v_mfma_f32_16x16x32_bf16 v[140:143], a[80:83], a[16:19], v[140:143]
v_add_f32 v243, v243, v158
v_cvt_pk_bf16_f32 v208, v128, v129
v_mfma_f32_16x16x32_bf16 v[148:151], a[80:83], a[32:35], v[232:235]
s_mov_b32 s33, s35
v_exp_f32 v136, v136
s_add_u32 s35, s35, 16384
v_mfma_f32_16x16x32_bf16 v[148:151], a[84:87], a[36:39], v[148:151]
ds_read_b64_tr_b16 a[104:105], v249 offset:1024
ds_read_b64_tr_b16 a[106:107], v249 offset:5120
v_mfma_f32_16x16x32_bf16 v[148:151], a[88:91], a[40:43], v[148:151]
s_and_b32 s35, s35, 0xffff
v_exp_f32 v137, v137
v_mfma_f32_16x16x32_bf16 v[148:151], a[92:95], a[44:47], v[148:151]
v_add_f32 v243, v243, v159
v_cvt_pk_bf16_f32 v209, v130, v131
v_mfma_f32_16x16x32_bf16 v[156:159], a[92:95], a[60:63], v[236:239]
v_exp_f32 v138, v138
v_mfma_f32_16x16x32_bf16 v[156:159], a[88:91], a[56:59], v[156:159]
ds_read_b64_tr_b16 a[108:109], v249 offset:9216
ds_read_b64_tr_b16 a[110:111], v249 offset:13312
v_mfma_f32_16x16x32_bf16 v[156:159], a[84:87], a[52:55], v[156:159]
v_exp_f32 v139, v139
v_mfma_f32_16x16x32_bf16 v[156:159], a[80:83], a[48:51], v[156:159]
s_waitcnt lgkmcnt(4)
v_add_f32 v241, v241, v136
v_cvt_pk_bf16_f32 v212, v136, v137
v_mfma_f32_16x16x32_bf16 v[16:19], a[96:99], v[160:163], 0
v_exp_f32 v144, v144
v_mfma_f32_16x16x32_bf16 v[16:19], a[100:103], v[176:179], v[16:19]
ds_read_b64_tr_b16 a[80:81], v246 offset:1536
ds_read_b64_tr_b16 a[82:83], v246 offset:5632
v_mfma_f32_16x16x32_bf16 v[48:51], a[100:103], v[180:183], 0
v_exp_f32 v145, v145
v_mfma_f32_16x16x32_bf16 v[48:51], a[96:99], v[164:167], v[48:51]
v_add_f32 v241, v241, v137
v_cvt_pk_bf16_f32 v213, v138, v139
v_mfma_f32_16x16x32_bf16 v[80:83], a[96:99], v[168:171], 0
s_add_u32 s42, s43, 739840
v_exp_f32 v146, v146
v_mfma_f32_16x16x32_bf16 v[80:83], a[100:103], v[184:187], v[80:83]
ds_read_b64_tr_b16 a[84:85], v246 offset:9728
ds_read_b64_tr_b16 a[86:87], v246 offset:13824
v_mfma_f32_16x16x32_bf16 v[112:115], a[100:103], v[188:191], 0
s_add_u32 m0, s77, 3072
v_exp_f32 v147, v147
v_mfma_f32_16x16x32_bf16 v[112:115], a[96:99], v[172:175], v[112:115]
s_waitcnt lgkmcnt(4)
v_add_f32 v241, v241, v138
v_cvt_pk_bf16_f32 v216, v144, v145
v_mfma_f32_16x16x32_bf16 a[120:123], a[112:115], v[168:171], 0
buffer_load_dwordx4 v252, s[88:91], s42 offen nt lds
v_add_u32 v244, s35, v245
v_mfma_f32_16x16x32_bf16 a[120:123], a[112:115], v[184:187], a[120:123]
v_mfma_f32_16x16x32_bf16 v[116:119], a[104:107], v[172:175], 0
s_add_u32 s4, s4, 16384
v_exp_f32 v152, v152
s_addc_u32 s5, s5, 0
v_mfma_f32_16x16x32_bf16 v[116:119], a[108:111], v[188:191], v[116:119]
ds_read_b64_tr_b16 a[88:89], v249 offset:1536
ds_read_b64_tr_b16 a[90:91], v249 offset:5632
v_mfma_f32_16x16x32_bf16 v[84:87], a[108:111], v[184:187], 0
s_add_u32 s6, s6, 16384
v_exp_f32 v153, v153
s_addc_u32 s7, s7, 0
v_mfma_f32_16x16x32_bf16 v[84:87], a[104:107], v[168:171], v[84:87]
v_add_f32 v241, v241, v139
v_cvt_pk_bf16_f32 v217, v146, v147
v_mfma_f32_16x16x32_bf16 v[52:55], a[104:107], v[164:167], 0
v_exp_f32 v154, v154
v_mfma_f32_16x16x32_bf16 v[52:55], a[108:111], v[180:183], v[52:55]
ds_read_b64_tr_b16 a[92:93], v249 offset:9728
ds_read_b64_tr_b16 a[94:95], v249 offset:13824
v_mfma_f32_16x16x32_bf16 v[20:23], a[108:111], v[176:179], 0
v_exp_f32 v155, v155
v_mfma_f32_16x16x32_bf16 v[20:23], a[104:107], v[160:163], v[20:23]
s_waitcnt lgkmcnt(4)
v_add_f32 v243, v243, v152
v_cvt_pk_bf16_f32 v220, v152, v153
v_mfma_f32_16x16x32_bf16 v[24:27], a[80:83], v[160:163], 0
v_exp_f32 v132, v132
v_mfma_f32_16x16x32_bf16 v[24:27], a[84:87], v[176:179], v[24:27]
ds_read_b128 a[64:67], v244 offset:0
ds_read_b128 a[68:71], v244 offset:512
v_mfma_f32_16x16x32_bf16 v[56:59], a[84:87], v[180:183], 0
v_exp_f32 v133, v133
v_mfma_f32_16x16x32_bf16 v[56:59], a[80:83], v[164:167], v[56:59]
v_add_f32 v243, v243, v153
v_cvt_pk_bf16_f32 v221, v154, v155
v_mfma_f32_16x16x32_bf16 v[88:91], a[80:83], v[168:171], 0
v_exp_f32 v134, v134
v_mfma_f32_16x16x32_bf16 v[88:91], a[84:87], v[184:187], v[88:91]
ds_read_b128 a[72:75], v244 offset:1024
ds_read_b128 a[76:79], v244 offset:1536
v_mfma_f32_16x16x32_bf16 v[120:123], a[84:87], v[188:191], 0
v_exp_f32 v135, v135
v_mfma_f32_16x16x32_bf16 v[120:123], a[80:83], v[172:175], v[120:123]
s_waitcnt lgkmcnt(4)
v_add_f32 v243, v243, v154
v_cvt_pk_bf16_f32 v210, v132, v133
v_mfma_f32_16x16x32_bf16 v[124:127], a[88:91], v[172:175], 0
v_exp_f32 v140, v140
v_mfma_f32_16x16x32_bf16 v[124:127], a[92:95], v[188:191], v[124:127]
ds_read_b128 a[80:83], v244 offset:4096
v_add_u32 v246, s33, v247
v_mfma_f32_16x16x32_bf16 v[92:95], a[92:95], v[184:187], 0
v_exp_f32 v141, v141
v_mfma_f32_16x16x32_bf16 v[92:95], a[88:91], v[168:171], v[92:95]
v_add_f32 v243, v243, v155
v_cvt_pk_bf16_f32 v211, v134, v135
v_mfma_f32_16x16x32_bf16 v[60:63], a[88:91], v[164:167], 0
v_exp_f32 v142, v142
v_mfma_f32_16x16x32_bf16 v[60:63], a[92:95], v[180:183], v[60:63]
ds_read_b128 a[84:87], v244 offset:4608
v_xor_b32 v249, 32, v246
v_mfma_f32_16x16x32_bf16 v[28:31], a[92:95], v[176:179], 0
v_exp_f32 v143, v143
v_mfma_f32_16x16x32_bf16 v[28:31], a[88:91], v[160:163], v[28:31]
s_waitcnt lgkmcnt(2)
v_add_f32 v241, v241, v140
v_cvt_pk_bf16_f32 v214, v140, v141
v_mfma_f32_16x16x32_bf16 v[128:131], a[64:67], a[0:3], v[224:227]
v_exp_f32 v148, v148
v_mfma_f32_16x16x32_bf16 v[128:131], a[68:71], a[4:7], v[128:131]
ds_read_b128 a[88:91], v244 offset:5120
v_mfma_f32_16x16x32_bf16 v[128:131], a[72:75], a[8:11], v[128:131]
s_add_u32 m0, s39, s31
v_exp_f32 v149, v149
v_mfma_f32_16x16x32_bf16 v[128:131], a[76:79], a[12:15], v[128:131]
v_add_f32 v241, v241, v141
v_cvt_pk_bf16_f32 v215, v142, v143
v_mfma_f32_16x16x32_bf16 v[136:139], a[76:79], a[28:31], v[228:231]
v_exp_f32 v150, v150
v_mfma_f32_16x16x32_bf16 v[136:139], a[72:75], a[24:27], v[136:139]
ds_read_b128 a[92:95], v244 offset:5632
global_load_lds_dwordx4 v248, s[8:9] offset:0
v_mfma_f32_16x16x32_bf16 v[136:139], a[68:71], a[20:23], v[136:139]
v_exp_f32 v151, v151
v_mfma_f32_16x16x32_bf16 v[136:139], a[64:67], a[16:19], v[136:139]
v_add_f32 v241, v241, v142
v_cvt_pk_bf16_f32 v218, v148, v149
v_mfma_f32_16x16x32_bf16 v[144:147], a[64:67], a[32:35], v[232:235]
v_exp_f32 v156, v156
v_mfma_f32_16x16x32_bf16 v[144:147], a[68:71], a[36:39], v[144:147]
global_load_lds_dwordx4 v248, s[10:11] offset:1024
v_mfma_f32_16x16x32_bf16 v[144:147], a[72:75], a[40:43], v[144:147]
v_exp_f32 v157, v157
v_mfma_f32_16x16x32_bf16 v[144:147], a[76:79], a[44:47], v[144:147]
v_add_f32 v241, v241, v143
v_cvt_pk_bf16_f32 v219, v150, v151
v_mfma_f32_16x16x32_bf16 v[152:155], a[76:79], a[60:63], v[236:239]
v_exp_f32 v158, v158
v_mfma_f32_16x16x32_bf16 v[152:155], a[72:75], a[56:59], v[152:155]
global_load_lds_dwordx4 v248, s[8:9] offset:2048
global_load_lds_dwordx4 v248, s[10:11] offset:3072
v_mfma_f32_16x16x32_bf16 v[152:155], a[68:71], a[52:55], v[152:155]
v_exp_f32 v159, v159
v_mfma_f32_16x16x32_bf16 v[152:155], a[64:67], a[48:51], v[152:155]
s_waitcnt lgkmcnt(0)
v_add_f32 v243, v243, v156
v_cvt_pk_bf16_f32 v222, v156, v157
v_mfma_f32_16x16x32_bf16 v[132:135], a[80:83], a[0:3], v[224:227]
v_exp_f32 v128, v128
v_mfma_f32_16x16x32_bf16 v[132:135], a[84:87], a[4:7], v[132:135]
ds_read_b64_tr_b16 a[96:97], v246 offset:0
ds_read_b64_tr_b16 a[98:99], v246 offset:4096
v_mfma_f32_16x16x32_bf16 v[132:135], a[88:91], a[8:11], v[132:135]
v_exp_f32 v129, v129
v_mfma_f32_16x16x32_bf16 v[132:135], a[92:95], a[12:15], v[132:135]
v_add_f32 v243, v243, v157
v_cvt_pk_bf16_f32 v223, v158, v159
v_mfma_f32_16x16x32_bf16 v[140:143], a[92:95], a[28:31], v[228:231]
v_exp_f32 v130, v130
v_mfma_f32_16x16x32_bf16 v[140:143], a[88:91], a[24:27], v[140:143]
ds_read_b64_tr_b16 a[100:101], v246 offset:8192
ds_read_b64_tr_b16 a[102:103], v246 offset:12288
v_mfma_f32_16x16x32_bf16 v[140:143], a[84:87], a[20:23], v[140:143]
v_exp_f32 v131, v131
v_mfma_f32_16x16x32_bf16 v[140:143], a[80:83], a[16:19], v[140:143]
v_add_f32 v243, v243, v158
v_cvt_pk_bf16_f32 v160, v128, v129
v_mfma_f32_16x16x32_bf16 v[148:151], a[80:83], a[32:35], v[232:235]
v_exp_f32 v136, v136
v_mfma_f32_16x16x32_bf16 v[148:151], a[84:87], a[36:39], v[148:151]
ds_read_b64_tr_b16 a[104:105], v249 offset:0
ds_read_b64_tr_b16 a[106:107], v249 offset:4096
v_mfma_f32_16x16x32_bf16 v[148:151], a[88:91], a[40:43], v[148:151]
v_exp_f32 v137, v137
v_mfma_f32_16x16x32_bf16 v[148:151], a[92:95], a[44:47], v[148:151]
v_add_f32 v243, v243, v159
v_cvt_pk_bf16_f32 v161, v130, v131
v_mfma_f32_16x16x32_bf16 v[156:159], a[92:95], a[60:63], v[236:239]
v_exp_f32 v138, v138
v_mfma_f32_16x16x32_bf16 v[156:159], a[88:91], a[56:59], v[156:159]
ds_read_b64_tr_b16 a[108:109], v249 offset:8192
ds_read_b64_tr_b16 a[110:111], v249 offset:12288
v_mfma_f32_16x16x32_bf16 v[156:159], a[84:87], a[52:55], v[156:159]
v_exp_f32 v139, v139
v_mfma_f32_16x16x32_bf16 v[156:159], a[80:83], a[48:51], v[156:159]
s_waitcnt lgkmcnt(4)
v_add_f32 v241, v241, v136
v_cvt_pk_bf16_f32 v164, v136, v137
v_mfma_f32_16x16x32_bf16 v[0:3], a[96:99], v[192:195], v[0:3]
s_add_u32 s39, s37, 65536
v_exp_f32 v144, v144
s_add_u32 s37, s37, 16384
v_mfma_f32_16x16x32_bf16 v[0:3], a[100:103], v[208:211], v[0:3]
ds_read_b64_tr_b16 a[80:81], v246 offset:512
ds_read_b64_tr_b16 a[82:83], v246 offset:4608
v_mfma_f32_16x16x32_bf16 v[32:35], a[100:103], v[212:215], v[32:35]
s_and_b32 s37, s37, 0xffff
v_exp_f32 v145, v145
v_mfma_f32_16x16x32_bf16 v[32:35], a[96:99], v[196:199], v[32:35]
v_add_f32 v241, v241, v137
v_cvt_pk_bf16_f32 v165, v138, v139
v_mfma_f32_16x16x32_bf16 v[64:67], a[96:99], v[200:203], v[64:67]
s_add_u32 s42, s43, 985600
v_exp_f32 v146, v146
v_mfma_f32_16x16x32_bf16 v[64:67], a[100:103], v[216:219], v[64:67]
ds_read_b64_tr_b16 a[84:85], v246 offset:8704
ds_read_b64_tr_b16 a[86:87], v246 offset:12800
v_mfma_f32_16x16x32_bf16 v[96:99], a[100:103], v[220:223], v[96:99]
s_add_u32 m0, s77, 4096
v_exp_f32 v147, v147
v_mfma_f32_16x16x32_bf16 v[96:99], a[96:99], v[204:207], v[96:99]
s_waitcnt lgkmcnt(4)
v_add_f32 v241, v241, v138
v_cvt_pk_bf16_f32 v168, v144, v145
v_mfma_f32_16x16x32_bf16 a[116:119], a[112:115], v[192:195], a[116:119]
buffer_load_dwordx4 v252, s[88:91], s42 offen nt lds
v_mfma_f32_16x16x32_bf16 a[116:119], a[112:115], v[208:211], a[116:119]
v_mfma_f32_16x16x32_bf16 v[100:103], a[104:107], v[204:207], v[100:103]
s_add_u32 s8, s8, 16384
v_exp_f32 v152, v152
s_addc_u32 s9, s9, 0
v_mfma_f32_16x16x32_bf16 v[100:103], a[108:111], v[220:223], v[100:103]
ds_read_b64_tr_b16 a[88:89], v249 offset:512
ds_read_b64_tr_b16 a[90:91], v249 offset:4608
v_mfma_f32_16x16x32_bf16 v[68:71], a[108:111], v[216:219], v[68:71]
s_add_u32 s10, s10, 16384
v_exp_f32 v153, v153
s_addc_u32 s11, s11, 0
v_mfma_f32_16x16x32_bf16 v[68:71], a[104:107], v[200:203], v[68:71]
v_add_f32 v241, v241, v139
v_cvt_pk_bf16_f32 v169, v146, v147
v_mfma_f32_16x16x32_bf16 v[36:39], a[104:107], v[196:199], v[36:39]
v_exp_f32 v154, v154
v_mfma_f32_16x16x32_bf16 v[36:39], a[108:111], v[212:215], v[36:39]
ds_read_b64_tr_b16 a[92:93], v249 offset:8704
ds_read_b64_tr_b16 a[94:95], v249 offset:12800
v_mfma_f32_16x16x32_bf16 v[4:7], a[108:111], v[208:211], v[4:7]
v_exp_f32 v155, v155
v_mfma_f32_16x16x32_bf16 v[4:7], a[104:107], v[192:195], v[4:7]
s_waitcnt lgkmcnt(4)
v_add_f32 v243, v243, v152
v_cvt_pk_bf16_f32 v172, v152, v153
v_mfma_f32_16x16x32_bf16 v[8:11], a[80:83], v[192:195], v[8:11]
v_exp_f32 v132, v132
v_mfma_f32_16x16x32_bf16 v[8:11], a[84:87], v[208:211], v[8:11]
ds_read_b128 a[64:67], v244 offset:8192
ds_read_b128 a[68:71], v244 offset:8704
v_mfma_f32_16x16x32_bf16 v[40:43], a[84:87], v[212:215], v[40:43]
v_exp_f32 v133, v133
v_mfma_f32_16x16x32_bf16 v[40:43], a[80:83], v[196:199], v[40:43]
v_add_f32 v243, v243, v153
v_cvt_pk_bf16_f32 v173, v154, v155
v_mfma_f32_16x16x32_bf16 v[72:75], a[80:83], v[200:203], v[72:75]
v_exp_f32 v134, v134
v_mfma_f32_16x16x32_bf16 v[72:75], a[84:87], v[216:219], v[72:75]
ds_read_b128 a[72:75], v244 offset:9216
ds_read_b128 a[76:79], v244 offset:9728
v_mfma_f32_16x16x32_bf16 v[104:107], a[84:87], v[220:223], v[104:107]
v_exp_f32 v135, v135
v_mfma_f32_16x16x32_bf16 v[104:107], a[80:83], v[204:207], v[104:107]
s_waitcnt lgkmcnt(4)
v_add_f32 v243, v243, v154
v_cvt_pk_bf16_f32 v162, v132, v133
v_mfma_f32_16x16x32_bf16 v[108:111], a[88:91], v[204:207], v[108:111]
v_exp_f32 v140, v140
v_mfma_f32_16x16x32_bf16 v[108:111], a[92:95], v[220:223], v[108:111]
ds_read_b128 a[80:83], v244 offset:12288
buffer_load_dwordx4 a[156:159], v253, s[16:19], s36 offen offset:0 sc1
v_mfma_f32_16x16x32_bf16 v[76:79], a[92:95], v[216:219], v[76:79]
L_m_c0_3:
s_cbranch_execz L_m_c0_7
v_exp_f32 v141, v141
v_mfma_f32_16x16x32_bf16 v[76:79], a[88:91], v[200:203], v[76:79]
v_add_f32 v243, v243, v155
v_cvt_pk_bf16_f32 v163, v134, v135
v_mfma_f32_16x16x32_bf16 v[44:47], a[88:91], v[196:199], v[44:47]
v_exp_f32 v142, v142
v_mfma_f32_16x16x32_bf16 v[44:47], a[92:95], v[212:215], v[44:47]
ds_read_b128 a[84:87], v244 offset:12800
buffer_load_dwordx4 a[160:163], v253, s[16:19], s36 offen offset:64 sc1
v_mfma_f32_16x16x32_bf16 v[12:15], a[92:95], v[208:211], v[12:15]
v_exp_f32 v143, v143
v_mfma_f32_16x16x32_bf16 v[12:15], a[88:91], v[192:195], v[12:15]
s_waitcnt lgkmcnt(2)
v_add_f32 v241, v241, v140
v_cvt_pk_bf16_f32 v166, v140, v141
v_mfma_f32_16x16x32_bf16 v[128:131], a[64:67], a[0:3], v[224:227]
s_waitcnt vmcnt(14)
v_exp_f32 v148, v148
s_barrier
v_mfma_f32_16x16x32_bf16 v[128:131], a[68:71], a[4:7], v[128:131]
ds_read_b128 a[88:91], v244 offset:13312
buffer_load_dwordx4 a[164:167], v253, s[16:19], s36 offen offset:128 sc1
v_mfma_f32_16x16x32_bf16 v[128:131], a[72:75], a[8:11], v[128:131]
s_add_u32 m0, s37, s31
v_exp_f32 v149, v149
v_mfma_f32_16x16x32_bf16 v[128:131], a[76:79], a[12:15], v[128:131]
v_add_f32 v241, v241, v141
v_cvt_pk_bf16_f32 v167, v142, v143
v_mfma_f32_16x16x32_bf16 v[136:139], a[76:79], a[28:31], v[228:231]
v_exp_f32 v150, v150
v_mfma_f32_16x16x32_bf16 v[136:139], a[72:75], a[24:27], v[136:139]
ds_read_b128 a[92:95], v244 offset:13824
global_load_lds_dwordx4 v248, s[4:5] offset:0
v_mfma_f32_16x16x32_bf16 v[136:139], a[68:71], a[20:23], v[136:139]
v_exp_f32 v151, v151
v_mfma_f32_16x16x32_bf16 v[136:139], a[64:67], a[16:19], v[136:139]
v_add_f32 v241, v241, v142
v_cvt_pk_bf16_f32 v170, v148, v149
v_mfma_f32_16x16x32_bf16 v[144:147], a[64:67], a[32:35], v[232:235]
v_exp_f32 v156, v156
v_mfma_f32_16x16x32_bf16 v[144:147], a[68:71], a[36:39], v[144:147]
global_load_lds_dwordx4 v248, s[6:7] offset:1024
buffer_load_dwordx4 a[168:171], v253, s[16:19], s36 offen offset:192 sc1
v_mfma_f32_16x16x32_bf16 v[144:147], a[72:75], a[40:43], v[144:147]
v_exp_f32 v157, v157
v_mfma_f32_16x16x32_bf16 v[144:147], a[76:79], a[44:47], v[144:147]
v_add_f32 v241, v241, v143
v_cvt_pk_bf16_f32 v171, v150, v151
v_mfma_f32_16x16x32_bf16 v[152:155], a[76:79], a[60:63], v[236:239]
v_exp_f32 v158, v158
v_mfma_f32_16x16x32_bf16 v[152:155], a[72:75], a[56:59], v[152:155]
global_load_lds_dwordx4 v248, s[4:5] offset:2048
global_load_lds_dwordx4 v248, s[6:7] offset:3072
v_mfma_f32_16x16x32_bf16 v[152:155], a[68:71], a[52:55], v[152:155]
v_exp_f32 v159, v159
v_mfma_f32_16x16x32_bf16 v[152:155], a[64:67], a[48:51], v[152:155]
s_waitcnt lgkmcnt(0)
v_add_f32 v243, v243, v156
v_cvt_pk_bf16_f32 v174, v156, v157
v_mfma_f32_16x16x32_bf16 v[132:135], a[80:83], a[0:3], v[224:227]
v_exp_f32 v128, v128
v_mfma_f32_16x16x32_bf16 v[132:135], a[84:87], a[4:7], v[132:135]
ds_read_b64_tr_b16 a[96:97], v246 offset:1024
ds_read_b64_tr_b16 a[98:99], v246 offset:5120
v_mfma_f32_16x16x32_bf16 v[132:135], a[88:91], a[8:11], v[132:135]
v_exp_f32 v129, v129
v_mfma_f32_16x16x32_bf16 v[132:135], a[92:95], a[12:15], v[132:135]
v_add_f32 v243, v243, v157
v_cvt_pk_bf16_f32 v175, v158, v159
v_mfma_f32_16x16x32_bf16 v[140:143], a[92:95], a[28:31], v[228:231]
v_exp_f32 v130, v130
v_mfma_f32_16x16x32_bf16 v[140:143], a[88:91], a[24:27], v[140:143]
ds_read_b64_tr_b16 a[100:101], v246 offset:9216
ds_read_b64_tr_b16 a[102:103], v246 offset:13312
v_mfma_f32_16x16x32_bf16 v[140:143], a[84:87], a[20:23], v[140:143]
v_exp_f32 v131, v131
v_mfma_f32_16x16x32_bf16 v[140:143], a[80:83], a[16:19], v[140:143]
v_add_f32 v243, v243, v158
v_cvt_pk_bf16_f32 v176, v128, v129
v_mfma_f32_16x16x32_bf16 v[148:151], a[80:83], a[32:35], v[232:235]
s_mov_b32 s33, s35
v_exp_f32 v136, v136
s_add_u32 s35, s35, 16384
v_mfma_f32_16x16x32_bf16 v[148:151], a[84:87], a[36:39], v[148:151]
ds_read_b64_tr_b16 a[104:105], v249 offset:1024
ds_read_b64_tr_b16 a[106:107], v249 offset:5120
v_mfma_f32_16x16x32_bf16 v[148:151], a[88:91], a[40:43], v[148:151]
s_and_b32 s35, s35, 0xffff
v_exp_f32 v137, v137
v_mfma_f32_16x16x32_bf16 v[148:151], a[92:95], a[44:47], v[148:151]
v_add_f32 v243, v243, v159
v_cvt_pk_bf16_f32 v177, v130, v131
v_mfma_f32_16x16x32_bf16 v[156:159], a[92:95], a[60:63], v[236:239]
v_exp_f32 v138, v138
v_mfma_f32_16x16x32_bf16 v[156:159], a[88:91], a[56:59], v[156:159]
ds_read_b64_tr_b16 a[108:109], v249 offset:9216
ds_read_b64_tr_b16 a[110:111], v249 offset:13312
v_mfma_f32_16x16x32_bf16 v[156:159], a[84:87], a[52:55], v[156:159]
v_exp_f32 v139, v139
v_mfma_f32_16x16x32_bf16 v[156:159], a[80:83], a[48:51], v[156:159]
s_waitcnt lgkmcnt(4)
v_add_f32 v241, v241, v136
v_cvt_pk_bf16_f32 v180, v136, v137
v_mfma_f32_16x16x32_bf16 v[16:19], a[96:99], v[192:195], v[16:19]
v_exp_f32 v144, v144
v_mfma_f32_16x16x32_bf16 v[16:19], a[100:103], v[208:211], v[16:19]
ds_read_b64_tr_b16 a[80:81], v246 offset:1536
ds_read_b64_tr_b16 a[82:83], v246 offset:5632
v_mfma_f32_16x16x32_bf16 v[48:51], a[100:103], v[212:215], v[48:51]
v_exp_f32 v145, v145
v_mfma_f32_16x16x32_bf16 v[48:51], a[96:99], v[196:199], v[48:51]
v_add_f32 v241, v241, v137
v_cvt_pk_bf16_f32 v181, v138, v139
v_mfma_f32_16x16x32_bf16 v[80:83], a[96:99], v[200:203], v[80:83]
v_exp_f32 v146, v146
v_mfma_f32_16x16x32_bf16 v[80:83], a[100:103], v[216:219], v[80:83]
ds_read_b64_tr_b16 a[84:85], v246 offset:9728
ds_read_b64_tr_b16 a[86:87], v246 offset:13824
v_mfma_f32_16x16x32_bf16 v[112:115], a[100:103], v[220:223], v[112:115]
v_exp_f32 v147, v147
v_mfma_f32_16x16x32_bf16 v[112:115], a[96:99], v[204:207], v[112:115]
s_waitcnt lgkmcnt(4)
v_add_f32 v241, v241, v138
v_cvt_pk_bf16_f32 v184, v144, v145
v_mfma_f32_16x16x32_bf16 a[120:123], a[112:115], v[200:203], a[120:123]
buffer_load_dwordx4 a[172:175], v253, s[16:19], s36 offen offset:256 sc1
v_add_u32 v244, s35, v245
v_mfma_f32_16x16x32_bf16 a[120:123], a[112:115], v[216:219], a[120:123]
v_mfma_f32_16x16x32_bf16 v[116:119], a[104:107], v[204:207], v[116:119]
s_add_u32 s4, s4, 16384
v_exp_f32 v152, v152
s_addc_u32 s5, s5, 0
v_mfma_f32_16x16x32_bf16 v[116:119], a[108:111], v[220:223], v[116:119]
ds_read_b64_tr_b16 a[88:89], v249 offset:1536
ds_read_b64_tr_b16 a[90:91], v249 offset:5632
v_mfma_f32_16x16x32_bf16 v[84:87], a[108:111], v[216:219], v[84:87]
s_add_u32 s6, s6, 16384
v_exp_f32 v153, v153
s_addc_u32 s7, s7, 0
v_mfma_f32_16x16x32_bf16 v[84:87], a[104:107], v[200:203], v[84:87]
v_add_f32 v241, v241, v139
v_cvt_pk_bf16_f32 v185, v146, v147
v_mfma_f32_16x16x32_bf16 v[52:55], a[104:107], v[196:199], v[52:55]
v_exp_f32 v154, v154
v_mfma_f32_16x16x32_bf16 v[52:55], a[108:111], v[212:215], v[52:55]
ds_read_b64_tr_b16 a[92:93], v249 offset:9728
ds_read_b64_tr_b16 a[94:95], v249 offset:13824
v_mfma_f32_16x16x32_bf16 v[20:23], a[108:111], v[208:211], v[20:23]
v_exp_f32 v155, v155
v_mfma_f32_16x16x32_bf16 v[20:23], a[104:107], v[192:195], v[20:23]
s_waitcnt lgkmcnt(4)
v_add_f32 v243, v243, v152
v_cvt_pk_bf16_f32 v188, v152, v153
v_mfma_f32_16x16x32_bf16 v[24:27], a[80:83], v[192:195], v[24:27]
v_exp_f32 v132, v132
v_mfma_f32_16x16x32_bf16 v[24:27], a[84:87], v[208:211], v[24:27]
ds_read_b128 a[64:67], v244 offset:0
ds_read_b128 a[68:71], v244 offset:512
v_mfma_f32_16x16x32_bf16 v[56:59], a[84:87], v[212:215], v[56:59]
v_exp_f32 v133, v133
v_mfma_f32_16x16x32_bf16 v[56:59], a[80:83], v[196:199], v[56:59]
v_add_f32 v243, v243, v153
v_cvt_pk_bf16_f32 v189, v154, v155
v_mfma_f32_16x16x32_bf16 v[88:91], a[80:83], v[200:203], v[88:91]
v_exp_f32 v134, v134
v_mfma_f32_16x16x32_bf16 v[88:91], a[84:87], v[216:219], v[88:91]
ds_read_b128 a[72:75], v244 offset:1024
ds_read_b128 a[76:79], v244 offset:1536
v_mfma_f32_16x16x32_bf16 v[120:123], a[84:87], v[220:223], v[120:123]
v_exp_f32 v135, v135
v_mfma_f32_16x16x32_bf16 v[120:123], a[80:83], v[204:207], v[120:123]
s_waitcnt lgkmcnt(4)
v_add_f32 v243, v243, v154
v_cvt_pk_bf16_f32 v178, v132, v133
v_mfma_f32_16x16x32_bf16 v[124:127], a[88:91], v[204:207], v[124:127]
v_exp_f32 v140, v140
v_mfma_f32_16x16x32_bf16 v[124:127], a[92:95], v[220:223], v[124:127]
ds_read_b128 a[80:83], v244 offset:4096
v_add_u32 v246, s33, v247
v_mfma_f32_16x16x32_bf16 v[92:95], a[92:95], v[216:219], v[92:95]
v_exp_f32 v141, v141
v_mfma_f32_16x16x32_bf16 v[92:95], a[88:91], v[200:203], v[92:95]
v_add_f32 v243, v243, v155
v_cvt_pk_bf16_f32 v179, v134, v135
v_mfma_f32_16x16x32_bf16 v[60:63], a[88:91], v[196:199], v[60:63]
v_exp_f32 v142, v142
v_mfma_f32_16x16x32_bf16 v[60:63], a[92:95], v[212:215], v[60:63]
ds_read_b128 a[84:87], v244 offset:4608
v_xor_b32 v249, 32, v246
v_mfma_f32_16x16x32_bf16 v[28:31], a[92:95], v[208:211], v[28:31]
v_exp_f32 v143, v143
v_mfma_f32_16x16x32_bf16 v[28:31], a[88:91], v[192:195], v[28:31]
s_waitcnt lgkmcnt(2)
v_add_f32 v241, v241, v140
v_cvt_pk_bf16_f32 v182, v140, v141
v_mfma_f32_16x16x32_bf16 v[128:131], a[64:67], a[0:3], v[224:227]
s_waitcnt vmcnt(14)
v_exp_f32 v148, v148
v_mfma_f32_16x16x32_bf16 v[128:131], a[68:71], a[4:7], v[128:131]
ds_read_b128 a[88:91], v244 offset:5120
ds_read_b64_tr_b16 a[136:137], v251 offset:0
v_mfma_f32_16x16x32_bf16 v[128:131], a[72:75], a[8:11], v[128:131]
s_add_u32 m0, s39, s31
v_exp_f32 v149, v149
v_mfma_f32_16x16x32_bf16 v[128:131], a[76:79], a[12:15], v[128:131]
v_add_f32 v241, v241, v141
v_cvt_pk_bf16_f32 v183, v142, v143
v_mfma_f32_16x16x32_bf16 v[136:139], a[76:79], a[28:31], v[228:231]
v_exp_f32 v150, v150
v_mfma_f32_16x16x32_bf16 v[136:139], a[72:75], a[24:27], v[136:139]
ds_read_b128 a[92:95], v244 offset:5632
global_load_lds_dwordx4 v248, s[8:9] offset:0
v_mfma_f32_16x16x32_bf16 v[136:139], a[68:71], a[20:23], v[136:139]
v_exp_f32 v151, v151
v_mfma_f32_16x16x32_bf16 v[136:139], a[64:67], a[16:19], v[136:139]
v_add_f32 v241, v241, v142
v_cvt_pk_bf16_f32 v186, v148, v149
v_mfma_f32_16x16x32_bf16 v[144:147], a[64:67], a[32:35], v[232:235]
v_exp_f32 v156, v156
v_mfma_f32_16x16x32_bf16 v[144:147], a[68:71], a[36:39], v[144:147]
global_load_lds_dwordx4 v248, s[10:11] offset:1024
ds_read_b64_tr_b16 a[138:139], v251 offset:128
v_mfma_f32_16x16x32_bf16 v[144:147], a[72:75], a[40:43], v[144:147]
v_exp_f32 v157, v157
v_mfma_f32_16x16x32_bf16 v[144:147], a[76:79], a[44:47], v[144:147]
v_add_f32 v241, v241, v143
v_cvt_pk_bf16_f32 v187, v150, v151
v_mfma_f32_16x16x32_bf16 v[152:155], a[76:79], a[60:63], v[236:239]
v_exp_f32 v158, v158
v_mfma_f32_16x16x32_bf16 v[152:155], a[72:75], a[56:59], v[152:155]
global_load_lds_dwordx4 v248, s[8:9] offset:2048
global_load_lds_dwordx4 v248, s[10:11] offset:3072
v_mfma_f32_16x16x32_bf16 v[152:155], a[68:71], a[52:55], v[152:155]
v_exp_f32 v159, v159
v_mfma_f32_16x16x32_bf16 v[152:155], a[64:67], a[48:51], v[152:155]
s_waitcnt lgkmcnt(1)
v_add_f32 v243, v243, v156
v_cvt_pk_bf16_f32 v190, v156, v157
v_mfma_f32_16x16x32_bf16 v[132:135], a[80:83], a[0:3], v[224:227]
v_exp_f32 v128, v128
v_mfma_f32_16x16x32_bf16 v[132:135], a[84:87], a[4:7], v[132:135]
ds_read_b64_tr_b16 a[96:97], v246 offset:0
ds_read_b64_tr_b16 a[98:99], v246 offset:4096
v_mfma_f32_16x16x32_bf16 v[132:135], a[88:91], a[8:11], v[132:135]
v_exp_f32 v129, v129
v_mfma_f32_16x16x32_bf16 v[132:135], a[92:95], a[12:15], v[132:135]
v_add_f32 v243, v243, v157
v_cvt_pk_bf16_f32 v191, v158, v159
v_mfma_f32_16x16x32_bf16 v[140:143], a[92:95], a[28:31], v[228:231]
v_exp_f32 v130, v130
v_mfma_f32_16x16x32_bf16 v[140:143], a[88:91], a[24:27], v[140:143]
ds_read_b64_tr_b16 a[100:101], v246 offset:8192
ds_read_b64_tr_b16 a[102:103], v246 offset:12288
v_mfma_f32_16x16x32_bf16 v[140:143], a[84:87], a[20:23], v[140:143]
v_exp_f32 v131, v131
v_mfma_f32_16x16x32_bf16 v[140:143], a[80:83], a[16:19], v[140:143]
v_add_f32 v243, v243, v158
v_cvt_pk_bf16_f32 v192, v128, v129
v_mfma_f32_16x16x32_bf16 v[148:151], a[80:83], a[32:35], v[232:235]
v_exp_f32 v136, v136
v_mfma_f32_16x16x32_bf16 v[148:151], a[84:87], a[36:39], v[148:151]
ds_read_b64_tr_b16 a[104:105], v249 offset:0
ds_read_b64_tr_b16 a[106:107], v249 offset:4096
v_mfma_f32_16x16x32_bf16 v[148:151], a[88:91], a[40:43], v[148:151]
v_exp_f32 v137, v137
v_mfma_f32_16x16x32_bf16 v[148:151], a[92:95], a[44:47], v[148:151]
v_add_f32 v243, v243, v159
v_cvt_pk_bf16_f32 v193, v130, v131
v_mfma_f32_16x16x32_bf16 v[156:159], a[92:95], a[60:63], v[236:239]
v_exp_f32 v138, v138
v_mfma_f32_16x16x32_bf16 v[156:159], a[88:91], a[56:59], v[156:159]
ds_read_b64_tr_b16 a[108:109], v249 offset:8192
ds_read_b64_tr_b16 a[110:111], v249 offset:12288
v_mfma_f32_16x16x32_bf16 v[156:159], a[84:87], a[52:55], v[156:159]
v_exp_f32 v139, v139
v_mfma_f32_16x16x32_bf16 v[156:159], a[80:83], a[48:51], v[156:159]
s_waitcnt lgkmcnt(4)
v_add_f32 v241, v241, v136
v_cvt_pk_bf16_f32 v196, v136, v137
v_mfma_f32_16x16x32_bf16 v[0:3], a[96:99], v[160:163], v[0:3]
s_add_u32 s39, s37, 65536
v_exp_f32 v144, v144
s_add_u32 s37, s37, 16384
v_mfma_f32_16x16x32_bf16 v[0:3], a[100:103], v[176:179], v[0:3]
ds_read_b64_tr_b16 a[80:81], v246 offset:512
ds_read_b64_tr_b16 a[82:83], v246 offset:4608
v_mfma_f32_16x16x32_bf16 v[32:35], a[100:103], v[180:183], v[32:35]
s_and_b32 s37, s37, 0xffff
v_exp_f32 v145, v145
v_mfma_f32_16x16x32_bf16 v[32:35], a[96:99], v[164:167], v[32:35]
v_add_f32 v241, v241, v137
v_cvt_pk_bf16_f32 v197, v138, v139
v_mfma_f32_16x16x32_bf16 v[64:67], a[96:99], v[168:171], v[64:67]
v_exp_f32 v146, v146
v_mfma_f32_16x16x32_bf16 v[64:67], a[100:103], v[184:187], v[64:67]
ds_read_b64_tr_b16 a[84:85], v246 offset:8704
ds_read_b64_tr_b16 a[86:87], v246 offset:12800
v_mfma_f32_16x16x32_bf16 v[96:99], a[100:103], v[188:191], v[96:99]
v_exp_f32 v147, v147
v_mfma_f32_16x16x32_bf16 v[96:99], a[96:99], v[172:175], v[96:99]
s_waitcnt lgkmcnt(4)
v_add_f32 v241, v241, v138
v_cvt_pk_bf16_f32 v200, v144, v145
v_mfma_f32_16x16x32_bf16 a[116:119], a[112:115], v[160:163], a[116:119]
ds_read_b64_tr_b16 a[140:141], v251 offset:1024
ds_read_b64_tr_b16 a[142:143], v251 offset:1152
v_mfma_f32_16x16x32_bf16 a[116:119], a[112:115], v[176:179], a[116:119]
ds_read_b64_tr_b16 a[144:145], v251 offset:2048
ds_read_b64_tr_b16 a[146:147], v251 offset:2176
v_mfma_f32_16x16x32_bf16 v[100:103], a[104:107], v[172:175], v[100:103]
s_add_u32 s8, s8, 16384
v_exp_f32 v152, v152
s_addc_u32 s9, s9, 0
v_mfma_f32_16x16x32_bf16 v[100:103], a[108:111], v[188:191], v[100:103]
ds_read_b64_tr_b16 a[88:89], v249 offset:512
ds_read_b64_tr_b16 a[90:91], v249 offset:4608
v_mfma_f32_16x16x32_bf16 v[68:71], a[108:111], v[184:187], v[68:71]
s_add_u32 s10, s10, 16384
v_exp_f32 v153, v153
s_addc_u32 s11, s11, 0
v_mfma_f32_16x16x32_bf16 v[68:71], a[104:107], v[168:171], v[68:71]
v_add_f32 v241, v241, v139
v_cvt_pk_bf16_f32 v201, v146, v147
v_mfma_f32_16x16x32_bf16 v[36:39], a[104:107], v[164:167], v[36:39]
v_exp_f32 v154, v154
v_mfma_f32_16x16x32_bf16 v[36:39], a[108:111], v[180:183], v[36:39]
ds_read_b64_tr_b16 a[92:93], v249 offset:8704
ds_read_b64_tr_b16 a[94:95], v249 offset:12800
v_mfma_f32_16x16x32_bf16 v[4:7], a[108:111], v[176:179], v[4:7]
v_exp_f32 v155, v155
v_mfma_f32_16x16x32_bf16 v[4:7], a[104:107], v[160:163], v[4:7]
s_waitcnt lgkmcnt(8)
v_add_f32 v243, v243, v152
v_cvt_pk_bf16_f32 v204, v152, v153
v_mfma_f32_16x16x32_bf16 v[8:11], a[80:83], v[160:163], v[8:11]
v_exp_f32 v132, v132
v_mfma_f32_16x16x32_bf16 v[8:11], a[84:87], v[176:179], v[8:11]
ds_read_b128 a[64:67], v244 offset:8192
ds_read_b128 a[68:71], v244 offset:8704
v_mfma_f32_16x16x32_bf16 v[40:43], a[84:87], v[180:183], v[40:43]
v_exp_f32 v133, v133
v_mfma_f32_16x16x32_bf16 v[40:43], a[80:83], v[164:167], v[40:43]
v_add_f32 v243, v243, v153
v_cvt_pk_bf16_f32 v205, v154, v155
v_mfma_f32_16x16x32_bf16 v[72:75], a[80:83], v[168:171], v[72:75]
v_exp_f32 v134, v134
v_mfma_f32_16x16x32_bf16 v[72:75], a[84:87], v[184:187], v[72:75]
ds_read_b128 a[72:75], v244 offset:9216
ds_read_b128 a[76:79], v244 offset:9728
v_mfma_f32_16x16x32_bf16 v[104:107], a[84:87], v[188:191], v[104:107]
v_exp_f32 v135, v135
v_mfma_f32_16x16x32_bf16 v[104:107], a[80:83], v[172:175], v[104:107]
s_waitcnt lgkmcnt(4)
v_add_f32 v243, v243, v154
v_cvt_pk_bf16_f32 v194, v132, v133
v_mfma_f32_16x16x32_bf16 v[108:111], a[88:91], v[172:175], v[108:111]
v_exp_f32 v140, v140
v_mfma_f32_16x16x32_bf16 v[108:111], a[92:95], v[188:191], v[108:111]
ds_read_b128 a[80:83], v244 offset:12288
ds_read_b64_tr_b16 a[148:149], v251 offset:3072
v_mfma_f32_16x16x32_bf16 v[76:79], a[92:95], v[184:187], v[76:79]
v_exp_f32 v141, v141
v_mfma_f32_16x16x32_bf16 v[76:79], a[88:91], v[168:171], v[76:79]
v_add_f32 v243, v243, v155
v_cvt_pk_bf16_f32 v195, v134, v135
v_mfma_f32_16x16x32_bf16 v[44:47], a[88:91], v[164:167], v[44:47]
s_waitcnt vmcnt(13)
v_exp_f32 v142, v142
v_mfma_f32_16x16x32_bf16 v[44:47], a[92:95], v[180:183], v[44:47]
ds_read_b128 a[84:87], v244 offset:12800
ds_read_b64_tr_b16 a[150:151], v251 offset:3200
v_mfma_f32_16x16x32_bf16 v[12:15], a[92:95], v[176:179], v[12:15]
v_exp_f32 v143, v143
v_mfma_f32_16x16x32_bf16 v[12:15], a[88:91], v[160:163], v[12:15]
s_waitcnt lgkmcnt(4)
v_add_f32 v241, v241, v140
v_cvt_pk_bf16_f32 v198, v140, v141
v_mfma_f32_16x16x32_bf16 v[128:131], a[64:67], a[0:3], v[224:227]
v_exp_f32 v148, v148
s_barrier
v_mfma_f32_16x16x32_bf16 v[128:131], a[68:71], a[4:7], v[128:131]
ds_read_b128 a[88:91], v244 offset:13312
ds_read_b64_tr_b16 a[152:153], v251 offset:4096
v_mfma_f32_16x16x32_bf16 v[128:131], a[72:75], a[8:11], v[128:131]
s_add_u32 m0, s37, s31
v_exp_f32 v149, v149
v_mfma_f32_16x16x32_bf16 v[128:131], a[76:79], a[12:15], v[128:131]
v_add_f32 v241, v241, v141
v_cvt_pk_bf16_f32 v199, v142, v143
v_mfma_f32_16x16x32_bf16 v[136:139], a[76:79], a[28:31], v[228:231]
v_exp_f32 v150, v150
v_mfma_f32_16x16x32_bf16 v[136:139], a[72:75], a[24:27], v[136:139]
ds_read_b128 a[92:95], v244 offset:13824
global_load_lds_dwordx4 v248, s[4:5] offset:0
v_mfma_f32_16x16x32_bf16 v[136:139], a[68:71], a[20:23], v[136:139]
v_exp_f32 v151, v151
v_mfma_f32_16x16x32_bf16 v[136:139], a[64:67], a[16:19], v[136:139]
v_add_f32 v241, v241, v142
v_cvt_pk_bf16_f32 v202, v148, v149
v_mfma_f32_16x16x32_bf16 v[144:147], a[64:67], a[32:35], v[232:235]
v_exp_f32 v156, v156
v_mfma_f32_16x16x32_bf16 v[144:147], a[68:71], a[36:39], v[144:147]
global_load_lds_dwordx4 v248, s[6:7] offset:1024
ds_read_b64_tr_b16 a[154:155], v251 offset:4224
v_mfma_f32_16x16x32_bf16 v[144:147], a[72:75], a[40:43], v[144:147]
v_exp_f32 v157, v157
v_mfma_f32_16x16x32_bf16 v[144:147], a[76:79], a[44:47], v[144:147]
v_add_f32 v241, v241, v143
v_cvt_pk_bf16_f32 v203, v150, v151
v_mfma_f32_16x16x32_bf16 v[152:155], a[76:79], a[60:63], v[236:239]
s_lshl_b32 s3, s28, 6
v_exp_f32 v158, v158
s_add_u32 s3, s3, 163328
v_mfma_f32_16x16x32_bf16 v[152:155], a[72:75], a[56:59], v[152:155]
global_load_lds_dwordx4 v248, s[4:5] offset:2048
global_load_lds_dwordx4 v248, s[6:7] offset:3072
v_mfma_f32_16x16x32_bf16 v[152:155], a[68:71], a[52:55], v[152:155]
v_exp_f32 v159, v159
v_mfma_f32_16x16x32_bf16 v[152:155], a[64:67], a[48:51], v[152:155]
s_waitcnt lgkmcnt(1)
v_add_f32 v243, v243, v156
v_cvt_pk_bf16_f32 v206, v156, v157
v_mfma_f32_16x16x32_bf16 v[132:135], a[80:83], a[0:3], v[224:227]
v_exp_f32 v128, v128
v_mfma_f32_16x16x32_bf16 v[132:135], a[84:87], a[4:7], v[132:135]
ds_read_b64_tr_b16 a[96:97], v246 offset:1024
ds_read_b64_tr_b16 a[98:99], v246 offset:5120
v_mfma_f32_16x16x32_bf16 v[132:135], a[88:91], a[8:11], v[132:135]
v_exp_f32 v129, v129
v_mfma_f32_16x16x32_bf16 v[132:135], a[92:95], a[12:15], v[132:135]
v_add_f32 v243, v243, v157
v_cvt_pk_bf16_f32 v207, v158, v159
v_mfma_f32_16x16x32_bf16 v[140:143], a[92:95], a[28:31], v[228:231]
s_waitcnt vmcnt(8)
v_exp_f32 v130, v130
s_waitcnt lgkmcnt(2)
v_mfma_f32_16x16x32_bf16 v[140:143], a[88:91], a[24:27], v[140:143]
ds_read_b64_tr_b16 a[100:101], v246 offset:9216
ds_read_b64_tr_b16 a[102:103], v246 offset:13312
v_mfma_f32_16x16x32_bf16 v[140:143], a[84:87], a[20:23], v[140:143]
v_exp_f32 v131, v131
v_mfma_f32_16x16x32_bf16 v[140:143], a[80:83], a[16:19], v[140:143]
v_add_f32 v243, v243, v158
v_cvt_pk_bf16_f32 v208, v128, v129
v_mfma_f32_16x16x32_bf16 a[176:179], a[136:139], a[156:159], 0
v_add_u32 v253, s3, v253
v_mfma_f32_16x16x32_bf16 a[176:179], a[140:143], a[160:163], a[176:179]
v_bfe_u32 v254, v250, 2, 6
v_mfma_f32_16x16x32_bf16 a[176:179], a[144:147], a[164:167], a[176:179]
v_add_u32 v254, 163328, v254
v_mfma_f32_16x16x32_bf16 a[176:179], a[148:151], a[168:171], a[176:179]
v_mfma_f32_16x16x32_bf16 a[176:179], a[152:155], a[172:175], a[176:179]
v_accvgpr_read_b32 v251, a128
v_mfma_f32_16x16x32_bf16 v[148:151], a[80:83], a[32:35], v[232:235]
s_mov_b32 s33, s35
v_exp_f32 v136, v136
s_add_u32 s35, s35, 16384
v_mfma_f32_16x16x32_bf16 v[148:151], a[84:87], a[36:39], v[148:151]
ds_read_b64_tr_b16 a[104:105], v249 offset:1024
ds_read_b64_tr_b16 a[106:107], v249 offset:5120
v_mfma_f32_16x16x32_bf16 v[148:151], a[88:91], a[40:43], v[148:151]
s_and_b32 s35, s35, 0xffff
v_exp_f32 v137, v137
v_mfma_f32_16x16x32_bf16 v[148:151], a[92:95], a[44:47], v[148:151]
v_add_f32 v243, v243, v159
v_cvt_pk_bf16_f32 v209, v130, v131
v_mfma_f32_16x16x32_bf16 v[156:159], a[92:95], a[60:63], v[236:239]
v_exp_f32 v138, v138
v_mfma_f32_16x16x32_bf16 v[156:159], a[88:91], a[56:59], v[156:159]
ds_read_b64_tr_b16 a[108:109], v249 offset:9216
ds_read_b64_tr_b16 a[110:111], v249 offset:13312
v_mfma_f32_16x16x32_bf16 v[156:159], a[84:87], a[52:55], v[156:159]
v_exp_f32 v139, v139
v_mfma_f32_16x16x32_bf16 v[156:159], a[80:83], a[48:51], v[156:159]
s_waitcnt lgkmcnt(4)
v_add_f32 v241, v241, v136
v_cvt_pk_bf16_f32 v212, v136, v137
v_mfma_f32_16x16x32_bf16 v[16:19], a[96:99], v[160:163], v[16:19]
v_exp_f32 v144, v144
v_mfma_f32_16x16x32_bf16 v[16:19], a[100:103], v[176:179], v[16:19]
ds_read_b64_tr_b16 a[80:81], v246 offset:1536
ds_read_b64_tr_b16 a[82:83], v246 offset:5632
v_mfma_f32_16x16x32_bf16 v[48:51], a[100:103], v[180:183], v[48:51]
v_exp_f32 v145, v145
v_mfma_f32_16x16x32_bf16 v[48:51], a[96:99], v[164:167], v[48:51]
v_add_f32 v241, v241, v137
v_cvt_pk_bf16_f32 v213, v138, v139
v_mfma_f32_16x16x32_bf16 v[80:83], a[96:99], v[168:171], v[80:83]
s_add_u32 s42, s78, 0
v_exp_f32 v146, v146
v_mfma_f32_16x16x32_bf16 v[80:83], a[100:103], v[184:187], v[80:83]
ds_read_b64_tr_b16 a[84:85], v246 offset:9728
ds_read_b64_tr_b16 a[86:87], v246 offset:13824
v_mfma_f32_16x16x32_bf16 v[112:115], a[100:103], v[188:191], v[112:115]
s_add_u32 m0, s77, 0
v_exp_f32 v147, v147
v_mfma_f32_16x16x32_bf16 v[112:115], a[96:99], v[172:175], v[112:115]
s_waitcnt lgkmcnt(4)
v_add_f32 v241, v241, v138
v_cvt_pk_bf16_f32 v216, v144, v145
v_mfma_f32_16x16x32_bf16 a[120:123], a[112:115], v[168:171], a[120:123]
buffer_load_dwordx4 v251, s[20:23], s42 offen offset:0 nt lds
v_accvgpr_read_b32 v251, a129
v_mfma_f32_16x16x32_bf16 a[120:123], a[112:115], v[184:187], a[120:123]
v_add_u32 v244, s35, v245
v_mfma_f32_16x16x32_bf16 v[116:119], a[104:107], v[172:175], v[116:119]
s_add_u32 s4, s4, 16384
v_exp_f32 v152, v152
s_addc_u32 s5, s5, 0
v_mfma_f32_16x16x32_bf16 v[116:119], a[108:111], v[188:191], v[116:119]
ds_read_b64_tr_b16 a[88:89], v249 offset:1536
ds_read_b64_tr_b16 a[90:91], v249 offset:5632
v_mfma_f32_16x16x32_bf16 v[84:87], a[108:111], v[184:187], v[84:87]
s_add_u32 s6, s6, 16384
v_exp_f32 v153, v153
s_addc_u32 s7, s7, 0
v_mfma_f32_16x16x32_bf16 v[84:87], a[104:107], v[168:171], v[84:87]
v_add_f32 v241, v241, v139
v_cvt_pk_bf16_f32 v217, v146, v147
v_mfma_f32_16x16x32_bf16 v[52:55], a[104:107], v[164:167], v[52:55]
v_exp_f32 v154, v154
v_mfma_f32_16x16x32_bf16 v[52:55], a[108:111], v[180:183], v[52:55]
ds_read_b64_tr_b16 a[92:93], v249 offset:9728
ds_read_b64_tr_b16 a[94:95], v249 offset:13824
v_mfma_f32_16x16x32_bf16 v[20:23], a[108:111], v[176:179], v[20:23]
v_exp_f32 v155, v155
v_mfma_f32_16x16x32_bf16 v[20:23], a[104:107], v[160:163], v[20:23]
s_waitcnt lgkmcnt(4)
v_add_f32 v243, v243, v152
v_cvt_pk_bf16_f32 v220, v152, v153
v_mfma_f32_16x16x32_bf16 v[24:27], a[80:83], v[160:163], v[24:27]
v_exp_f32 v132, v132
v_mfma_f32_16x16x32_bf16 v[24:27], a[84:87], v[176:179], v[24:27]
ds_read_b128 a[64:67], v244 offset:0
ds_read_b128 a[68:71], v244 offset:512
v_mfma_f32_16x16x32_bf16 v[56:59], a[84:87], v[180:183], v[56:59]
v_exp_f32 v133, v133
v_mfma_f32_16x16x32_bf16 v[56:59], a[80:83], v[164:167], v[56:59]
v_add_f32 v243, v243, v153
v_cvt_pk_bf16_f32 v221, v154, v155
v_mfma_f32_16x16x32_bf16 v[88:91], a[80:83], v[168:171], v[88:91]
v_exp_f32 v134, v134
v_mfma_f32_16x16x32_bf16 v[88:91], a[84:87], v[184:187], v[88:91]
ds_read_b128 a[72:75], v244 offset:1024
ds_read_b128 a[76:79], v244 offset:1536
v_mfma_f32_16x16x32_bf16 v[120:123], a[84:87], v[188:191], v[120:123]
v_exp_f32 v135, v135
v_mfma_f32_16x16x32_bf16 v[120:123], a[80:83], v[172:175], v[120:123]
s_waitcnt lgkmcnt(4)
v_add_f32 v243, v243, v154
v_cvt_pk_bf16_f32 v210, v132, v133
v_mfma_f32_16x16x32_bf16 v[124:127], a[88:91], v[172:175], v[124:127]
v_exp_f32 v140, v140
v_mfma_f32_16x16x32_bf16 v[124:127], a[92:95], v[188:191], v[124:127]
ds_read_b128 a[80:83], v244 offset:4096
v_add_u32 v246, s33, v247
v_mfma_f32_16x16x32_bf16 v[92:95], a[92:95], v[184:187], v[92:95]
v_exp_f32 v141, v141
v_mfma_f32_16x16x32_bf16 v[92:95], a[88:91], v[168:171], v[92:95]
v_add_f32 v243, v243, v155
v_cvt_pk_bf16_f32 v211, v134, v135
v_mfma_f32_16x16x32_bf16 v[60:63], a[88:91], v[164:167], v[60:63]
v_exp_f32 v142, v142
v_mfma_f32_16x16x32_bf16 v[60:63], a[92:95], v[180:183], v[60:63]
ds_read_b128 a[84:87], v244 offset:4608
v_xor_b32 v249, 32, v246
v_mfma_f32_16x16x32_bf16 v[28:31], a[92:95], v[176:179], v[28:31]
v_exp_f32 v143, v143
v_mfma_f32_16x16x32_bf16 v[28:31], a[88:91], v[160:163], v[28:31]
s_waitcnt lgkmcnt(2)
v_add_f32 v241, v241, v140
v_cvt_pk_bf16_f32 v214, v140, v141
v_mfma_f32_16x16x32_bf16 v[128:131], a[64:67], a[0:3], v[224:227]
v_exp_f32 v148, v148
v_mfma_f32_16x16x32_bf16 v[128:131], a[68:71], a[4:7], v[128:131]
ds_read_b128 a[88:91], v244 offset:5120
ds_write_b128 v253, a[176:179]
v_mfma_f32_16x16x32_bf16 v[128:131], a[72:75], a[8:11], v[128:131]
s_add_u32 m0, s39, s31
v_exp_f32 v149, v149
v_mfma_f32_16x16x32_bf16 v[128:131], a[76:79], a[12:15], v[128:131]
v_add_f32 v241, v241, v141
v_cvt_pk_bf16_f32 v215, v142, v143
v_mfma_f32_16x16x32_bf16 v[136:139], a[76:79], a[28:31], v[228:231]
v_exp_f32 v150, v150
v_mfma_f32_16x16x32_bf16 v[136:139], a[72:75], a[24:27], v[136:139]
ds_read_b128 a[92:95], v244 offset:5632
global_load_lds_dwordx4 v248, s[8:9] offset:0
v_mfma_f32_16x16x32_bf16 v[136:139], a[68:71], a[20:23], v[136:139]
v_exp_f32 v151, v151
v_mfma_f32_16x16x32_bf16 v[136:139], a[64:67], a[16:19], v[136:139]
v_add_f32 v241, v241, v142
v_cvt_pk_bf16_f32 v218, v148, v149
v_mfma_f32_16x16x32_bf16 v[144:147], a[64:67], a[32:35], v[232:235]
v_exp_f32 v156, v156
v_mfma_f32_16x16x32_bf16 v[144:147], a[68:71], a[36:39], v[144:147]
global_load_lds_dwordx4 v248, s[10:11] offset:1024
v_mfma_f32_16x16x32_bf16 v[144:147], a[72:75], a[40:43], v[144:147]
v_exp_f32 v157, v157
v_mfma_f32_16x16x32_bf16 v[144:147], a[76:79], a[44:47], v[144:147]
v_add_f32 v241, v241, v143
v_cvt_pk_bf16_f32 v219, v150, v151
v_mfma_f32_16x16x32_bf16 v[152:155], a[76:79], a[60:63], v[236:239]
v_exp_f32 v158, v158
v_mfma_f32_16x16x32_bf16 v[152:155], a[72:75], a[56:59], v[152:155]
global_load_lds_dwordx4 v248, s[8:9] offset:2048
global_load_lds_dwordx4 v248, s[10:11] offset:3072
v_mfma_f32_16x16x32_bf16 v[152:155], a[68:71], a[52:55], v[152:155]
v_exp_f32 v159, v159
v_mfma_f32_16x16x32_bf16 v[152:155], a[64:67], a[48:51], v[152:155]
s_waitcnt lgkmcnt(0)
v_add_f32 v243, v243, v156
v_cvt_pk_bf16_f32 v222, v156, v157
v_mfma_f32_16x16x32_bf16 v[132:135], a[80:83], a[0:3], v[224:227]
v_exp_f32 v128, v128
v_mfma_f32_16x16x32_bf16 v[132:135], a[84:87], a[4:7], v[132:135]
L_m_c0_4:
s_cbranch_execz L_m_c0_8
ds_read_b64_tr_b16 a[96:97], v246 offset:0
ds_read_b64_tr_b16 a[98:99], v246 offset:4096
v_mfma_f32_16x16x32_bf16 v[132:135], a[88:91], a[8:11], v[132:135]
v_exp_f32 v129, v129
v_mfma_f32_16x16x32_bf16 v[132:135], a[92:95], a[12:15], v[132:135]
v_add_f32 v243, v243, v157
v_cvt_pk_bf16_f32 v223, v158, v159
v_mfma_f32_16x16x32_bf16 v[140:143], a[92:95], a[28:31], v[228:231]
v_exp_f32 v130, v130
v_mfma_f32_16x16x32_bf16 v[140:143], a[88:91], a[24:27], v[140:143]
ds_read_b64_tr_b16 a[100:101], v246 offset:8192
ds_read_b64_tr_b16 a[102:103], v246 offset:12288
v_mfma_f32_16x16x32_bf16 v[140:143], a[84:87], a[20:23], v[140:143]
v_exp_f32 v131, v131
v_mfma_f32_16x16x32_bf16 v[140:143], a[80:83], a[16:19], v[140:143]
v_add_f32 v243, v243, v158
v_cvt_pk_bf16_f32 v160, v128, v129
v_mfma_f32_16x16x32_bf16 v[148:151], a[80:83], a[32:35], v[232:235]
v_exp_f32 v136, v136
v_mfma_f32_16x16x32_bf16 v[148:151], a[84:87], a[36:39], v[148:151]
ds_read_b64_tr_b16 a[104:105], v249 offset:0
ds_read_b64_tr_b16 a[106:107], v249 offset:4096
v_mfma_f32_16x16x32_bf16 v[148:151], a[88:91], a[40:43], v[148:151]
v_exp_f32 v137, v137
v_mfma_f32_16x16x32_bf16 v[148:151], a[92:95], a[44:47], v[148:151]
v_add_f32 v243, v243, v159
v_cvt_pk_bf16_f32 v161, v130, v131
v_mfma_f32_16x16x32_bf16 v[156:159], a[92:95], a[60:63], v[236:239]
v_exp_f32 v138, v138
v_mfma_f32_16x16x32_bf16 v[156:159], a[88:91], a[56:59], v[156:159]
ds_read_b64_tr_b16 a[108:109], v249 offset:8192
ds_read_b64_tr_b16 a[110:111], v249 offset:12288
v_mfma_f32_16x16x32_bf16 v[156:159], a[84:87], a[52:55], v[156:159]
v_exp_f32 v139, v139
v_mfma_f32_16x16x32_bf16 v[156:159], a[80:83], a[48:51], v[156:159]
s_waitcnt lgkmcnt(4)
v_add_f32 v241, v241, v136
v_cvt_pk_bf16_f32 v164, v136, v137
v_mfma_f32_16x16x32_bf16 v[0:3], a[96:99], v[192:195], v[0:3]
s_add_u32 s39, s37, 65536
v_exp_f32 v144, v144
s_add_u32 s37, s37, 16384
v_mfma_f32_16x16x32_bf16 v[0:3], a[100:103], v[208:211], v[0:3]
ds_read_b64_tr_b16 a[80:81], v246 offset:512
ds_read_b64_tr_b16 a[82:83], v246 offset:4608
v_mfma_f32_16x16x32_bf16 v[32:35], a[100:103], v[212:215], v[32:35]
s_and_b32 s37, s37, 0xffff
v_exp_f32 v145, v145
v_mfma_f32_16x16x32_bf16 v[32:35], a[96:99], v[196:199], v[32:35]
v_add_f32 v241, v241, v137
v_cvt_pk_bf16_f32 v165, v138, v139
v_mfma_f32_16x16x32_bf16 v[64:67], a[96:99], v[200:203], v[64:67]
s_add_u32 s42, s78, 0
v_exp_f32 v146, v146
v_mfma_f32_16x16x32_bf16 v[64:67], a[100:103], v[216:219], v[64:67]
ds_read_b64_tr_b16 a[84:85], v246 offset:8704
ds_read_b64_tr_b16 a[86:87], v246 offset:12800
v_mfma_f32_16x16x32_bf16 v[96:99], a[100:103], v[220:223], v[96:99]
s_add_u32 m0, s77, 0
v_exp_f32 v147, v147
v_mfma_f32_16x16x32_bf16 v[96:99], a[96:99], v[204:207], v[96:99]
s_waitcnt lgkmcnt(4)
v_add_f32 v241, v241, v138
v_cvt_pk_bf16_f32 v168, v144, v145
v_mfma_f32_16x16x32_bf16 a[116:119], a[112:115], v[192:195], a[116:119]
buffer_load_dwordx4 v251, s[20:23], s42 offen offset:1024 nt lds
v_accvgpr_read_b32 v251, a130
v_mfma_f32_16x16x32_bf16 a[116:119], a[112:115], v[208:211], a[116:119]
v_mfma_f32_16x16x32_bf16 v[100:103], a[104:107], v[204:207], v[100:103]
s_add_u32 s8, s8, 16384
v_exp_f32 v152, v152
s_addc_u32 s9, s9, 0
v_mfma_f32_16x16x32_bf16 v[100:103], a[108:111], v[220:223], v[100:103]
ds_read_b64_tr_b16 a[88:89], v249 offset:512
ds_read_b64_tr_b16 a[90:91], v249 offset:4608
v_mfma_f32_16x16x32_bf16 v[68:71], a[108:111], v[216:219], v[68:71]
s_add_u32 s10, s10, 16384
v_exp_f32 v153, v153
s_addc_u32 s11, s11, 0
v_mfma_f32_16x16x32_bf16 v[68:71], a[104:107], v[200:203], v[68:71]
v_add_f32 v241, v241, v139
v_cvt_pk_bf16_f32 v169, v146, v147
v_mfma_f32_16x16x32_bf16 v[36:39], a[104:107], v[196:199], v[36:39]
v_exp_f32 v154, v154
v_mfma_f32_16x16x32_bf16 v[36:39], a[108:111], v[212:215], v[36:39]
ds_read_b64_tr_b16 a[92:93], v249 offset:8704
ds_read_b64_tr_b16 a[94:95], v249 offset:12800
v_mfma_f32_16x16x32_bf16 v[4:7], a[108:111], v[208:211], v[4:7]
v_exp_f32 v155, v155
v_mfma_f32_16x16x32_bf16 v[4:7], a[104:107], v[192:195], v[4:7]
s_waitcnt lgkmcnt(4)
v_add_f32 v243, v243, v152
v_cvt_pk_bf16_f32 v172, v152, v153
v_mfma_f32_16x16x32_bf16 v[8:11], a[80:83], v[192:195], v[8:11]
v_exp_f32 v132, v132
v_mfma_f32_16x16x32_bf16 v[8:11], a[84:87], v[208:211], v[8:11]
ds_read_b128 a[64:67], v244 offset:8192
ds_read_b128 a[68:71], v244 offset:8704
v_mfma_f32_16x16x32_bf16 v[40:43], a[84:87], v[212:215], v[40:43]
v_exp_f32 v133, v133
v_mfma_f32_16x16x32_bf16 v[40:43], a[80:83], v[196:199], v[40:43]
v_add_f32 v243, v243, v153
v_cvt_pk_bf16_f32 v173, v154, v155
v_mfma_f32_16x16x32_bf16 v[72:75], a[80:83], v[200:203], v[72:75]
v_exp_f32 v134, v134
v_mfma_f32_16x16x32_bf16 v[72:75], a[84:87], v[216:219], v[72:75]
ds_read_b128 a[72:75], v244 offset:9216
ds_read_b128 a[76:79], v244 offset:9728
v_mfma_f32_16x16x32_bf16 v[104:107], a[84:87], v[220:223], v[104:107]
v_exp_f32 v135, v135
v_mfma_f32_16x16x32_bf16 v[104:107], a[80:83], v[204:207], v[104:107]
s_waitcnt lgkmcnt(4)
v_add_f32 v243, v243, v154
v_cvt_pk_bf16_f32 v162, v132, v133
v_mfma_f32_16x16x32_bf16 v[108:111], a[88:91], v[204:207], v[108:111]
s_add_u32 s42, s78, 0
v_exp_f32 v140, v140
s_add_u32 m0, s77, 0
v_mfma_f32_16x16x32_bf16 v[108:111], a[92:95], v[220:223], v[108:111]
ds_read_b128 a[80:83], v244 offset:12288
buffer_load_dwordx4 v251, s[20:23], s42 offen offset:2048 nt lds
v_mfma_f32_16x16x32_bf16 v[76:79], a[92:95], v[216:219], v[76:79]
v_exp_f32 v141, v141
v_mfma_f32_16x16x32_bf16 v[76:79], a[88:91], v[200:203], v[76:79]
v_add_f32 v243, v243, v155
v_cvt_pk_bf16_f32 v163, v134, v135
v_mfma_f32_16x16x32_bf16 v[44:47], a[88:91], v[196:199], v[44:47]
v_exp_f32 v142, v142
v_mfma_f32_16x16x32_bf16 v[44:47], a[92:95], v[212:215], v[44:47]
ds_read_b128 a[84:87], v244 offset:12800
v_accvgpr_read_b32 v251, a131
v_mfma_f32_16x16x32_bf16 v[12:15], a[92:95], v[208:211], v[12:15]
v_exp_f32 v143, v143
v_mfma_f32_16x16x32_bf16 v[12:15], a[88:91], v[192:195], v[12:15]
s_waitcnt lgkmcnt(2)
v_add_f32 v241, v241, v140
v_cvt_pk_bf16_f32 v166, v140, v141
v_mfma_f32_16x16x32_bf16 v[128:131], a[64:67], a[0:3], v[224:227]
s_waitcnt vmcnt(11)
v_exp_f32 v148, v148
s_barrier
v_mfma_f32_16x16x32_bf16 v[128:131], a[68:71], a[4:7], v[128:131]
ds_read_b128 a[88:91], v244 offset:13312
ds_read2_b32 v[252:253], v254 offset1:16
v_mfma_f32_16x16x32_bf16 v[128:131], a[72:75], a[8:11], v[128:131]
s_add_u32 m0, s37, s31
v_exp_f32 v149, v149
v_mfma_f32_16x16x32_bf16 v[128:131], a[76:79], a[12:15], v[128:131]
v_add_f32 v241, v241, v141
v_cvt_pk_bf16_f32 v167, v142, v143
v_mfma_f32_16x16x32_bf16 v[136:139], a[76:79], a[28:31], v[228:231]
v_exp_f32 v150, v150
v_mfma_f32_16x16x32_bf16 v[136:139], a[72:75], a[24:27], v[136:139]
ds_read_b128 a[92:95], v244 offset:13824
global_load_lds_dwordx4 v248, s[4:5] offset:0
v_mfma_f32_16x16x32_bf16 v[136:139], a[68:71], a[20:23], v[136:139]
v_exp_f32 v151, v151
v_mfma_f32_16x16x32_bf16 v[136:139], a[64:67], a[16:19], v[136:139]
v_add_f32 v241, v241, v142
v_cvt_pk_bf16_f32 v170, v148, v149
v_mfma_f32_16x16x32_bf16 v[144:147], a[64:67], a[32:35], v[232:235]
v_exp_f32 v156, v156
v_mfma_f32_16x16x32_bf16 v[144:147], a[68:71], a[36:39], v[144:147]
global_load_lds_dwordx4 v248, s[6:7] offset:1024
buffer_store_dwordx4 a[124:127], v250, s[16:19], s76 offen offset:0 sc1
v_mfma_f32_16x16x32_bf16 v[144:147], a[72:75], a[40:43], v[144:147]
v_exp_f32 v157, v157
v_mfma_f32_16x16x32_bf16 v[144:147], a[76:79], a[44:47], v[144:147]
v_add_f32 v241, v241, v143
v_cvt_pk_bf16_f32 v171, v150, v151
v_mfma_f32_16x16x32_bf16 v[152:155], a[76:79], a[60:63], v[236:239]
v_exp_f32 v158, v158
v_mfma_f32_16x16x32_bf16 v[152:155], a[72:75], a[56:59], v[152:155]
global_load_lds_dwordx4 v248, s[4:5] offset:2048
global_load_lds_dwordx4 v248, s[6:7] offset:3072
v_mfma_f32_16x16x32_bf16 v[152:155], a[68:71], a[52:55], v[152:155]
v_exp_f32 v159, v159
v_mfma_f32_16x16x32_bf16 v[152:155], a[64:67], a[48:51], v[152:155]
s_waitcnt lgkmcnt(0)
v_add_f32 v243, v243, v156
v_cvt_pk_bf16_f32 v174, v156, v157
v_mfma_f32_16x16x32_bf16 v[132:135], a[80:83], a[0:3], v[224:227]
v_exp_f32 v128, v128
v_mfma_f32_16x16x32_bf16 v[132:135], a[84:87], a[4:7], v[132:135]
ds_read_b64_tr_b16 a[96:97], v246 offset:1024
ds_read_b64_tr_b16 a[98:99], v246 offset:5120
v_mfma_f32_16x16x32_bf16 v[132:135], a[88:91], a[8:11], v[132:135]
v_exp_f32 v129, v129
v_mfma_f32_16x16x32_bf16 v[132:135], a[92:95], a[12:15], v[132:135]
v_add_f32 v243, v243, v157
v_cvt_pk_bf16_f32 v175, v158, v159
v_mfma_f32_16x16x32_bf16 v[140:143], a[92:95], a[28:31], v[228:231]
v_exp_f32 v130, v130
v_mfma_f32_16x16x32_bf16 v[140:143], a[88:91], a[24:27], v[140:143]
ds_read_b64_tr_b16 a[100:101], v246 offset:9216
ds_read_b64_tr_b16 a[102:103], v246 offset:13312
v_mfma_f32_16x16x32_bf16 v[140:143], a[84:87], a[20:23], v[140:143]
v_exp_f32 v131, v131
v_mfma_f32_16x16x32_bf16 v[140:143], a[80:83], a[16:19], v[140:143]
v_add_f32 v243, v243, v158
v_cvt_pk_bf16_f32 v176, v128, v129
v_mfma_f32_16x16x32_bf16 v[148:151], a[80:83], a[32:35], v[232:235]
s_mov_b32 s33, s35
v_exp_f32 v136, v136
s_add_u32 s35, s35, 16384
v_mfma_f32_16x16x32_bf16 v[148:151], a[84:87], a[36:39], v[148:151]
ds_read_b64_tr_b16 a[104:105], v249 offset:1024
ds_read_b64_tr_b16 a[106:107], v249 offset:5120
v_mfma_f32_16x16x32_bf16 v[148:151], a[88:91], a[40:43], v[148:151]
s_and_b32 s35, s35, 0xffff
v_exp_f32 v137, v137
v_mfma_f32_16x16x32_bf16 v[148:151], a[92:95], a[44:47], v[148:151]
v_add_f32 v243, v243, v159
v_cvt_pk_bf16_f32 v177, v130, v131
v_mfma_f32_16x16x32_bf16 v[156:159], a[92:95], a[60:63], v[236:239]
v_exp_f32 v138, v138
v_mfma_f32_16x16x32_bf16 v[156:159], a[88:91], a[56:59], v[156:159]
ds_read_b64_tr_b16 a[108:109], v249 offset:9216
ds_read_b64_tr_b16 a[110:111], v249 offset:13312
v_mfma_f32_16x16x32_bf16 v[156:159], a[84:87], a[52:55], v[156:159]
v_exp_f32 v139, v139
v_mfma_f32_16x16x32_bf16 v[156:159], a[80:83], a[48:51], v[156:159]
s_waitcnt lgkmcnt(4)
v_add_f32 v241, v241, v136
v_cvt_pk_bf16_f32 v180, v136, v137
v_mfma_f32_16x16x32_bf16 v[16:19], a[96:99], v[192:195], v[16:19]
s_add_u32 s42, s78, 0
v_exp_f32 v144, v144
v_mfma_f32_16x16x32_bf16 v[16:19], a[100:103], v[208:211], v[16:19]
ds_read_b64_tr_b16 a[80:81], v246 offset:1536
ds_read_b64_tr_b16 a[82:83], v246 offset:5632
v_mfma_f32_16x16x32_bf16 v[48:51], a[100:103], v[212:215], v[48:51]
v_exp_f32 v145, v145
v_mfma_f32_16x16x32_bf16 v[48:51], a[96:99], v[196:199], v[48:51]
v_add_f32 v241, v241, v137
v_cvt_pk_bf16_f32 v181, v138, v139
v_mfma_f32_16x16x32_bf16 v[80:83], a[96:99], v[200:203], v[80:83]
v_exp_f32 v146, v146
v_mfma_f32_16x16x32_bf16 v[80:83], a[100:103], v[216:219], v[80:83]
ds_read_b64_tr_b16 a[84:85], v246 offset:9728
ds_read_b64_tr_b16 a[86:87], v246 offset:13824
v_mfma_f32_16x16x32_bf16 v[112:115], a[100:103], v[220:223], v[112:115]
s_add_u32 m0, s77, 0
v_exp_f32 v147, v147
v_mfma_f32_16x16x32_bf16 v[112:115], a[96:99], v[204:207], v[112:115]
s_waitcnt lgkmcnt(4)
v_add_f32 v241, v241, v138
v_cvt_pk_bf16_f32 v184, v144, v145
v_mfma_f32_16x16x32_bf16 a[120:123], a[112:115], v[200:203], a[120:123]
buffer_load_dwordx4 v251, s[20:23], s42 offen offset:3072 nt lds
v_add_u32 v244, s35, v245
v_mfma_f32_16x16x32_bf16 a[120:123], a[112:115], v[216:219], a[120:123]
v_mfma_f32_16x16x32_bf16 v[116:119], a[104:107], v[204:207], v[116:119]
s_add_u32 s4, s4, 16384
v_exp_f32 v152, v152
s_addc_u32 s5, s5, 0
v_mfma_f32_16x16x32_bf16 v[116:119], a[108:111], v[220:223], v[116:119]
ds_read_b64_tr_b16 a[88:89], v249 offset:1536
ds_read_b64_tr_b16 a[90:91], v249 offset:5632
v_mfma_f32_16x16x32_bf16 v[84:87], a[108:111], v[216:219], v[84:87]
s_add_u32 s6, s6, 16384
v_exp_f32 v153, v153
s_addc_u32 s7, s7, 0
v_mfma_f32_16x16x32_bf16 v[84:87], a[104:107], v[200:203], v[84:87]
v_add_f32 v241, v241, v139
v_cvt_pk_bf16_f32 v185, v146, v147
v_mfma_f32_16x16x32_bf16 v[52:55], a[104:107], v[196:199], v[52:55]
v_exp_f32 v154, v154
v_mfma_f32_16x16x32_bf16 v[52:55], a[108:111], v[212:215], v[52:55]
ds_read_b64_tr_b16 a[92:93], v249 offset:9728
ds_read_b64_tr_b16 a[94:95], v249 offset:13824
v_add_f32 v252, v252, v253
v_mfma_f32_16x16x32_bf16 v[20:23], a[108:111], v[208:211], v[20:23]
v_exp_f32 v155, v155
v_mfma_f32_16x16x32_bf16 v[20:23], a[104:107], v[192:195], v[20:23]
s_waitcnt lgkmcnt(4)
v_add_f32 v243, v243, v152
v_cvt_pk_bf16_f32 v188, v152, v153
v_mfma_f32_16x16x32_bf16 v[24:27], a[80:83], v[192:195], v[24:27]
v_exp_f32 v132, v132
v_mfma_f32_16x16x32_bf16 v[24:27], a[84:87], v[208:211], v[24:27]
ds_read_b128 a[64:67], v244 offset:0
ds_read_b128 a[68:71], v244 offset:512
v_accvgpr_read_b32 v251, a132
v_mfma_f32_16x16x32_bf16 v[56:59], a[84:87], v[212:215], v[56:59]
v_exp_f32 v133, v133
v_mfma_f32_16x16x32_bf16 v[56:59], a[80:83], v[196:199], v[56:59]
v_add_f32 v243, v243, v153
v_cvt_pk_bf16_f32 v189, v154, v155
v_mfma_f32_16x16x32_bf16 v[88:91], a[80:83], v[200:203], v[88:91]
v_exp_f32 v134, v134
v_mfma_f32_16x16x32_bf16 v[88:91], a[84:87], v[216:219], v[88:91]
ds_read_b128 a[72:75], v244 offset:1024
ds_read_b128 a[76:79], v244 offset:1536
v_mfma_f32_16x16x32_bf16 v[120:123], a[84:87], v[220:223], v[120:123]
v_exp_f32 v135, v135
v_mfma_f32_16x16x32_bf16 v[120:123], a[80:83], v[204:207], v[120:123]
s_waitcnt lgkmcnt(4)
v_add_f32 v243, v243, v154
v_cvt_pk_bf16_f32 v178, v132, v133
v_mfma_f32_16x16x32_bf16 v[124:127], a[88:91], v[204:207], v[124:127]
v_exp_f32 v140, v140
v_mfma_f32_16x16x32_bf16 v[124:127], a[92:95], v[220:223], v[124:127]
ds_read_b128 a[80:83], v244 offset:4096
v_add_u32 v246, s33, v247
v_mfma_f32_16x16x32_bf16 v[92:95], a[92:95], v[216:219], v[92:95]
v_exp_f32 v141, v141
v_mfma_f32_16x16x32_bf16 v[92:95], a[88:91], v[200:203], v[92:95]
v_add_f32 v243, v243, v155
v_cvt_pk_bf16_f32 v179, v134, v135
v_mfma_f32_16x16x32_bf16 v[60:63], a[88:91], v[196:199], v[60:63]
v_exp_f32 v142, v142
v_mfma_f32_16x16x32_bf16 v[60:63], a[92:95], v[212:215], v[60:63]
ds_read_b128 a[84:87], v244 offset:4608
v_xor_b32 v249, 32, v246
v_mfma_f32_16x16x32_bf16 v[28:31], a[92:95], v[208:211], v[28:31]
v_exp_f32 v143, v143
v_mfma_f32_16x16x32_bf16 v[28:31], a[88:91], v[192:195], v[28:31]
s_waitcnt lgkmcnt(2)
v_add_f32 v241, v241, v140
v_cvt_pk_bf16_f32 v182, v140, v141
v_mfma_f32_16x16x32_bf16 v[128:131], a[64:67], a[0:3], v[224:227]
v_exp_f32 v148, v148
v_mfma_f32_16x16x32_bf16 v[128:131], a[68:71], a[4:7], v[128:131]
ds_read_b128 a[88:91], v244 offset:5120
ds_read_b32 v253, v254 offset:128
v_mfma_f32_16x16x32_bf16 v[128:131], a[72:75], a[8:11], v[128:131]
s_add_u32 m0, s39, s31
v_exp_f32 v149, v149
v_mfma_f32_16x16x32_bf16 v[128:131], a[76:79], a[12:15], v[128:131]
v_add_f32 v241, v241, v141
v_cvt_pk_bf16_f32 v183, v142, v143
v_mfma_f32_16x16x32_bf16 v[136:139], a[76:79], a[28:31], v[228:231]
v_exp_f32 v150, v150
v_mfma_f32_16x16x32_bf16 v[136:139], a[72:75], a[24:27], v[136:139]
ds_read_b128 a[92:95], v244 offset:5632
global_load_lds_dwordx4 v248, s[8:9] offset:0
v_mfma_f32_16x16x32_bf16 v[136:139], a[68:71], a[20:23], v[136:139]
v_exp_f32 v151, v151
v_mfma_f32_16x16x32_bf16 v[136:139], a[64:67], a[16:19], v[136:139]
v_add_f32 v241, v241, v142
v_cvt_pk_bf16_f32 v186, v148, v149
v_mfma_f32_16x16x32_bf16 v[144:147], a[64:67], a[32:35], v[232:235]
v_exp_f32 v156, v156
v_mfma_f32_16x16x32_bf16 v[144:147], a[68:71], a[36:39], v[144:147]
global_load_lds_dwordx4 v248, s[10:11] offset:1024
ds_read_b32 v254, v254 offset:192
v_mfma_f32_16x16x32_bf16 v[144:147], a[72:75], a[40:43], v[144:147]
v_exp_f32 v157, v157
v_mfma_f32_16x16x32_bf16 v[144:147], a[76:79], a[44:47], v[144:147]
v_add_f32 v241, v241, v143
v_cvt_pk_bf16_f32 v187, v150, v151
v_mfma_f32_16x16x32_bf16 v[152:155], a[76:79], a[60:63], v[236:239]
s_sub_u32 s3, s86, 80
v_exp_f32 v158, v158
v_mfma_f32_16x16x32_bf16 v[152:155], a[72:75], a[56:59], v[152:155]
global_load_lds_dwordx4 v248, s[8:9] offset:2048
global_load_lds_dwordx4 v248, s[10:11] offset:3072
v_mfma_f32_16x16x32_bf16 v[152:155], a[68:71], a[52:55], v[152:155]
s_cmp_lt_u32 s3, 40
v_exp_f32 v159, v159
s_cselect_b32 s43, 1.0, 0
v_mfma_f32_16x16x32_bf16 v[152:155], a[64:67], a[48:51], v[152:155]
s_waitcnt lgkmcnt(1)
v_add_f32 v243, v243, v156
v_cvt_pk_bf16_f32 v190, v156, v157
v_mfma_f32_16x16x32_bf16 v[132:135], a[80:83], a[0:3], v[224:227]
s_lshl_b32 s36, s86, 5
v_exp_f32 v128, v128
s_add_u32 s36, s36, 2648576
v_mfma_f32_16x16x32_bf16 v[132:135], a[84:87], a[4:7], v[132:135]
ds_read_b64_tr_b16 a[96:97], v246 offset:0
ds_read_b64_tr_b16 a[98:99], v246 offset:4096
v_mfma_f32_16x16x32_bf16 v[132:135], a[88:91], a[8:11], v[132:135]
s_lshl_b32 s3, s28, 8
v_exp_f32 v129, v129
s_add_u32 s3, s3, s2
v_mfma_f32_16x16x32_bf16 v[132:135], a[92:95], a[12:15], v[132:135]
v_add_f32 v243, v243, v157
v_cvt_pk_bf16_f32 v191, v158, v159
v_mfma_f32_16x16x32_bf16 v[140:143], a[92:95], a[28:31], v[228:231]
s_cmp_lt_u32 s3, 160
v_exp_f32 v130, v130
s_cselect_b32 s3, 0, 0x7f000000
v_mfma_f32_16x16x32_bf16 v[140:143], a[88:91], a[24:27], v[140:143]
ds_read_b64_tr_b16 a[100:101], v246 offset:8192
ds_read_b64_tr_b16 a[102:103], v246 offset:12288
v_mfma_f32_16x16x32_bf16 v[140:143], a[84:87], a[20:23], v[140:143]
s_waitcnt lgkmcnt(4)
v_exp_f32 v131, v131
v_mfma_f32_16x16x32_bf16 v[140:143], a[80:83], a[16:19], v[140:143]
v_add_f32 v243, v243, v158
v_cvt_pk_bf16_f32 v192, v128, v129
v_mfma_f32_16x16x32_bf16 v[148:151], a[80:83], a[32:35], v[232:235]
v_exp_f32 v136, v136
v_mfma_f32_16x16x32_bf16 v[148:151], a[84:87], a[36:39], v[148:151]
ds_read_b64_tr_b16 a[104:105], v249 offset:0
ds_read_b64_tr_b16 a[106:107], v249 offset:4096
v_mfma_f32_16x16x32_bf16 v[148:151], a[88:91], a[40:43], v[148:151]
v_exp_f32 v137, v137
v_mfma_f32_16x16x32_bf16 v[148:151], a[92:95], a[44:47], v[148:151]
v_add_f32 v243, v243, v159
v_cvt_pk_bf16_f32 v193, v130, v131
v_mfma_f32_16x16x32_bf16 v[156:159], a[92:95], a[60:63], v[236:239]
v_exp_f32 v138, v138
v_mfma_f32_16x16x32_bf16 v[156:159], a[88:91], a[56:59], v[156:159]
ds_read_b64_tr_b16 a[108:109], v249 offset:8192
ds_read_b64_tr_b16 a[110:111], v249 offset:12288
v_mfma_f32_16x16x32_bf16 v[156:159], a[84:87], a[52:55], v[156:159]
v_exp_f32 v139, v139
v_mfma_f32_16x16x32_bf16 v[156:159], a[80:83], a[48:51], v[156:159]
s_waitcnt lgkmcnt(4)
v_add_f32 v241, v241, v136
v_cvt_pk_bf16_f32 v196, v136, v137
v_mfma_f32_16x16x32_bf16 v[0:3], a[96:99], v[160:163], v[0:3]
s_add_u32 s39, s37, 65536
v_exp_f32 v144, v144
s_add_u32 s37, s37, 16384
v_mfma_f32_16x16x32_bf16 v[0:3], a[100:103], v[176:179], v[0:3]
ds_read_b64_tr_b16 a[80:81], v246 offset:512
ds_read_b64_tr_b16 a[82:83], v246 offset:4608
v_mfma_f32_16x16x32_bf16 v[32:35], a[100:103], v[180:183], v[32:35]
s_and_b32 s37, s37, 0xffff
v_exp_f32 v145, v145
v_mfma_f32_16x16x32_bf16 v[32:35], a[96:99], v[164:167], v[32:35]
v_add_f32 v241, v241, v137
v_cvt_pk_bf16_f32 v197, v138, v139
v_mfma_f32_16x16x32_bf16 v[64:67], a[96:99], v[168:171], v[64:67]
s_add_u32 s42, s78, 4096
v_exp_f32 v146, v146
v_mfma_f32_16x16x32_bf16 v[64:67], a[100:103], v[184:187], v[64:67]
ds_read_b64_tr_b16 a[84:85], v246 offset:8704
ds_read_b64_tr_b16 a[86:87], v246 offset:12800
v_mfma_f32_16x16x32_bf16 v[96:99], a[100:103], v[188:191], v[96:99]
s_add_u32 m0, s77, 4096
v_exp_f32 v147, v147
v_mfma_f32_16x16x32_bf16 v[96:99], a[96:99], v[172:175], v[96:99]
s_waitcnt lgkmcnt(4)
v_add_f32 v241, v241, v138
v_cvt_pk_bf16_f32 v200, v144, v145
v_mfma_f32_16x16x32_bf16 a[116:119], a[112:115], v[160:163], a[116:119]
buffer_load_dwordx4 v251, s[20:23], s42 offen offset:0 nt lds
v_add_f32 v253, v253, v254
v_mfma_f32_16x16x32_bf16 a[116:119], a[112:115], v[176:179], a[116:119]
v_add_f32 v252, v252, v253
v_cvt_pk_bf16_f32 v252, v252, v252
v_mfma_f32_16x16x32_bf16 v[100:103], a[104:107], v[172:175], v[100:103]
s_add_u32 s8, s8, 16384
v_exp_f32 v152, v152
s_addc_u32 s9, s9, 0
v_mfma_f32_16x16x32_bf16 v[100:103], a[108:111], v[188:191], v[100:103]
ds_read_b64_tr_b16 a[88:89], v249 offset:512
ds_read_b64_tr_b16 a[90:91], v249 offset:4608
v_mfma_f32_16x16x32_bf16 v[68:71], a[108:111], v[184:187], v[68:71]
s_add_u32 s10, s10, 16384
v_exp_f32 v153, v153
s_addc_u32 s11, s11, 0
v_mfma_f32_16x16x32_bf16 v[68:71], a[104:107], v[168:171], v[68:71]
v_add_f32 v241, v241, v139
v_cvt_pk_bf16_f32 v201, v146, v147
v_mfma_f32_16x16x32_bf16 v[36:39], a[104:107], v[164:167], v[36:39]
v_exp_f32 v154, v154
v_mfma_f32_16x16x32_bf16 v[36:39], a[108:111], v[180:183], v[36:39]
ds_read_b64_tr_b16 a[92:93], v249 offset:8704
ds_read_b64_tr_b16 a[94:95], v249 offset:12800
v_mfma_f32_16x16x32_bf16 v[4:7], a[108:111], v[176:179], v[4:7]
v_exp_f32 v155, v155
v_mfma_f32_16x16x32_bf16 v[4:7], a[104:107], v[160:163], v[4:7]
s_waitcnt lgkmcnt(4)
v_add_f32 v243, v243, v152
v_cvt_pk_bf16_f32 v204, v152, v153
v_mfma_f32_16x16x32_bf16 v[8:11], a[80:83], v[160:163], v[8:11]
v_exp_f32 v132, v132
v_mfma_f32_16x16x32_bf16 v[8:11], a[84:87], v[176:179], v[8:11]
ds_read_b128 a[64:67], v244 offset:8192
ds_read_b128 a[68:71], v244 offset:8704
v_mfma_f32_16x16x32_bf16 v[40:43], a[84:87], v[180:183], v[40:43]
v_exp_f32 v133, v133
v_mfma_f32_16x16x32_bf16 v[40:43], a[80:83], v[164:167], v[40:43]
v_add_f32 v243, v243, v153
v_cvt_pk_bf16_f32 v205, v154, v155
v_mfma_f32_16x16x32_bf16 v[72:75], a[80:83], v[168:171], v[72:75]
v_exp_f32 v134, v134
v_mfma_f32_16x16x32_bf16 v[72:75], a[84:87], v[184:187], v[72:75]
ds_read_b128 a[72:75], v244 offset:9216
ds_read_b128 a[76:79], v244 offset:9728
v_mfma_f32_16x16x32_bf16 v[104:107], a[84:87], v[188:191], v[104:107]
v_exp_f32 v135, v135
v_mfma_f32_16x16x32_bf16 v[104:107], a[80:83], v[172:175], v[104:107]
s_waitcnt lgkmcnt(4)
v_add_f32 v243, v243, v154
v_cvt_pk_bf16_f32 v194, v132, v133
v_mfma_f32_16x16x32_bf16 v[108:111], a[88:91], v[172:175], v[108:111]
v_exp_f32 v140, v140
v_mfma_f32_16x16x32_bf16 v[108:111], a[92:95], v[188:191], v[108:111]
ds_read_b128 a[80:83], v244 offset:12288
v_lshlrev_b32 v252, 16, v252
v_mfma_f32_16x16x32_bf16 v[76:79], a[92:95], v[184:187], v[76:79]
v_exp_f32 v141, v141
v_mfma_f32_16x16x32_bf16 v[76:79], a[88:91], v[168:171], v[76:79]
v_add_f32 v243, v243, v155
v_cvt_pk_bf16_f32 v195, v134, v135
v_mfma_f32_16x16x32_bf16 v[44:47], a[88:91], v[164:167], v[44:47]
v_exp_f32 v142, v142
v_mfma_f32_16x16x32_bf16 v[44:47], a[92:95], v[180:183], v[44:47]
ds_read_b128 a[84:87], v244 offset:12800
v_add_f32 v252, s43, v252
v_mfma_f32_16x16x32_bf16 v[12:15], a[92:95], v[176:179], v[12:15]
v_exp_f32 v143, v143
v_mfma_f32_16x16x32_bf16 v[12:15], a[88:91], v[160:163], v[12:15]
s_waitcnt lgkmcnt(2)
v_add_f32 v241, v241, v140
v_cvt_pk_bf16_f32 v198, v140, v141
v_mfma_f32_16x16x32_bf16 v[128:131], a[64:67], a[0:3], v[224:227]
s_waitcnt vmcnt(13)
v_exp_f32 v148, v148
s_barrier
v_mfma_f32_16x16x32_bf16 v[128:131], a[68:71], a[4:7], v[128:131]
ds_read_b128 a[88:91], v244 offset:13312
v_cvt_pk_bf16_f32 v252, v252, v252
v_mfma_f32_16x16x32_bf16 v[128:131], a[72:75], a[8:11], v[128:131]
s_add_u32 m0, s37, s31
v_exp_f32 v149, v149
v_mfma_f32_16x16x32_bf16 v[128:131], a[76:79], a[12:15], v[128:131]
v_add_f32 v241, v241, v141
v_cvt_pk_bf16_f32 v199, v142, v143
v_mfma_f32_16x16x32_bf16 v[136:139], a[76:79], a[28:31], v[228:231]
v_exp_f32 v150, v150
v_mfma_f32_16x16x32_bf16 v[136:139], a[72:75], a[24:27], v[136:139]
ds_read_b128 a[92:95], v244 offset:13824
global_load_lds_dwordx4 v248, s[4:5] offset:0
v_mfma_f32_16x16x32_bf16 v[136:139], a[68:71], a[20:23], v[136:139]
v_exp_f32 v151, v151
v_mfma_f32_16x16x32_bf16 v[136:139], a[64:67], a[16:19], v[136:139]
v_add_f32 v241, v241, v142
v_cvt_pk_bf16_f32 v202, v148, v149
v_mfma_f32_16x16x32_bf16 v[144:147], a[64:67], a[32:35], v[232:235]
v_exp_f32 v156, v156
v_mfma_f32_16x16x32_bf16 v[144:147], a[68:71], a[36:39], v[144:147]
global_load_lds_dwordx4 v248, s[6:7] offset:1024
v_lshrrev_b32 v253, 3, v250
v_mfma_f32_16x16x32_bf16 v[144:147], a[72:75], a[40:43], v[144:147]
v_exp_f32 v157, v157
v_mfma_f32_16x16x32_bf16 v[144:147], a[76:79], a[44:47], v[144:147]
v_add_f32 v241, v241, v143
v_cvt_pk_bf16_f32 v203, v150, v151
v_mfma_f32_16x16x32_bf16 v[152:155], a[76:79], a[60:63], v[236:239]
v_exp_f32 v158, v158
v_mfma_f32_16x16x32_bf16 v[152:155], a[72:75], a[56:59], v[152:155]
global_load_lds_dwordx4 v248, s[4:5] offset:2048
global_load_lds_dwordx4 v248, s[6:7] offset:3072
v_mfma_f32_16x16x32_bf16 v[152:155], a[68:71], a[52:55], v[152:155]
v_exp_f32 v159, v159
v_mfma_f32_16x16x32_bf16 v[152:155], a[64:67], a[48:51], v[152:155]
s_waitcnt lgkmcnt(0)
v_add_f32 v243, v243, v156
v_cvt_pk_bf16_f32 v206, v156, v157
v_mfma_f32_16x16x32_bf16 v[132:135], a[80:83], a[0:3], v[224:227]
v_exp_f32 v128, v128
v_mfma_f32_16x16x32_bf16 v[132:135], a[84:87], a[4:7], v[132:135]
ds_read_b64_tr_b16 a[96:97], v246 offset:1024
ds_read_b64_tr_b16 a[98:99], v246 offset:5120
v_mfma_f32_16x16x32_bf16 v[132:135], a[88:91], a[8:11], v[132:135]
v_exp_f32 v129, v129
v_mfma_f32_16x16x32_bf16 v[132:135], a[92:95], a[12:15], v[132:135]
v_add_f32 v243, v243, v157
v_cvt_pk_bf16_f32 v207, v158, v159
v_mfma_f32_16x16x32_bf16 v[140:143], a[92:95], a[28:31], v[228:231]
v_exp_f32 v130, v130
v_mfma_f32_16x16x32_bf16 v[140:143], a[88:91], a[24:27], v[140:143]
ds_read_b64_tr_b16 a[100:101], v246 offset:9216
ds_read_b64_tr_b16 a[102:103], v246 offset:13312
v_mfma_f32_16x16x32_bf16 v[140:143], a[84:87], a[20:23], v[140:143]
v_exp_f32 v131, v131
v_mfma_f32_16x16x32_bf16 v[140:143], a[80:83], a[16:19], v[140:143]
v_add_f32 v243, v243, v158
v_cvt_pk_bf16_f32 v208, v128, v129
v_mfma_f32_16x16x32_bf16 v[148:151], a[80:83], a[32:35], v[232:235]
s_mov_b32 s33, s35
v_exp_f32 v136, v136
s_add_u32 s35, s35, 16384
v_mfma_f32_16x16x32_bf16 v[148:151], a[84:87], a[36:39], v[148:151]
ds_read_b64_tr_b16 a[104:105], v249 offset:1024
ds_read_b64_tr_b16 a[106:107], v249 offset:5120
v_mfma_f32_16x16x32_bf16 v[148:151], a[88:91], a[40:43], v[148:151]
s_and_b32 s35, s35, 0xffff
v_exp_f32 v137, v137
v_mfma_f32_16x16x32_bf16 v[148:151], a[92:95], a[44:47], v[148:151]
v_add_f32 v243, v243, v159
v_cvt_pk_bf16_f32 v209, v130, v131
v_mfma_f32_16x16x32_bf16 v[156:159], a[92:95], a[60:63], v[236:239]
v_exp_f32 v138, v138
v_mfma_f32_16x16x32_bf16 v[156:159], a[88:91], a[56:59], v[156:159]
ds_read_b64_tr_b16 a[108:109], v249 offset:9216
ds_read_b64_tr_b16 a[110:111], v249 offset:13312
v_mfma_f32_16x16x32_bf16 v[156:159], a[84:87], a[52:55], v[156:159]
v_exp_f32 v139, v139
v_mfma_f32_16x16x32_bf16 v[156:159], a[80:83], a[48:51], v[156:159]
s_waitcnt lgkmcnt(4)
v_add_f32 v241, v241, v136
v_cvt_pk_bf16_f32 v212, v136, v137
v_mfma_f32_16x16x32_bf16 v[16:19], a[96:99], v[160:163], v[16:19]
v_exp_f32 v144, v144
v_mfma_f32_16x16x32_bf16 v[16:19], a[100:103], v[176:179], v[16:19]
ds_read_b64_tr_b16 a[80:81], v246 offset:1536
ds_read_b64_tr_b16 a[82:83], v246 offset:5632
v_mfma_f32_16x16x32_bf16 v[48:51], a[100:103], v[180:183], v[48:51]
v_exp_f32 v145, v145
v_mfma_f32_16x16x32_bf16 v[48:51], a[96:99], v[164:167], v[48:51]
v_add_f32 v241, v241, v137
v_cvt_pk_bf16_f32 v213, v138, v139
v_mfma_f32_16x16x32_bf16 v[80:83], a[96:99], v[168:171], v[80:83]
v_exp_f32 v146, v146
v_mfma_f32_16x16x32_bf16 v[80:83], a[100:103], v[184:187], v[80:83]
ds_read_b64_tr_b16 a[84:85], v246 offset:9728
ds_read_b64_tr_b16 a[86:87], v246 offset:13824
v_mfma_f32_16x16x32_bf16 v[112:115], a[100:103], v[188:191], v[112:115]
v_exp_f32 v147, v147
v_mfma_f32_16x16x32_bf16 v[112:115], a[96:99], v[172:175], v[112:115]
L_m_c0_5:
s_cbranch_execz L_m_c0_9
s_waitcnt lgkmcnt(4)
v_add_f32 v241, v241, v138
v_cvt_pk_bf16_f32 v216, v144, v145
v_mfma_f32_16x16x32_bf16 a[120:123], a[112:115], v[168:171], a[120:123]
v_add_u32 v253, s3, v253
v_add_u32 v244, s35, v245
v_mfma_f32_16x16x32_bf16 a[120:123], a[112:115], v[184:187], a[120:123]
v_mfma_f32_16x16x32_bf16 v[116:119], a[104:107], v[172:175], v[116:119]
s_add_u32 s4, s4, 16384
v_exp_f32 v152, v152
s_addc_u32 s5, s5, 0
v_mfma_f32_16x16x32_bf16 v[116:119], a[108:111], v[188:191], v[116:119]
ds_read_b64_tr_b16 a[88:89], v249 offset:1536
ds_read_b64_tr_b16 a[90:91], v249 offset:5632
buffer_store_dwordx4 a[124:127], v250, s[16:19], s76 offen offset:1024 sc1
v_mfma_f32_16x16x32_bf16 v[84:87], a[108:111], v[184:187], v[84:87]
s_add_u32 s6, s6, 16384
v_exp_f32 v153, v153
s_addc_u32 s7, s7, 0
v_mfma_f32_16x16x32_bf16 v[84:87], a[104:107], v[168:171], v[84:87]
v_add_f32 v241, v241, v139
v_cvt_pk_bf16_f32 v217, v146, v147
v_mfma_f32_16x16x32_bf16 v[52:55], a[104:107], v[164:167], v[52:55]
v_exp_f32 v154, v154
v_mfma_f32_16x16x32_bf16 v[52:55], a[108:111], v[180:183], v[52:55]
ds_read_b64_tr_b16 a[92:93], v249 offset:9728
ds_read_b64_tr_b16 a[94:95], v249 offset:13824
s_mov_b64 exec, 0xffff
buffer_store_short v252, v253, s[16:19], s36 offen sc1
s_mov_b64 exec, -1
v_mfma_f32_16x16x32_bf16 v[20:23], a[108:111], v[176:179], v[20:23]
s_mov_b32 s88, s60
v_exp_f32 v155, v155
s_mov_b32 s89, s61
v_mfma_f32_16x16x32_bf16 v[20:23], a[104:107], v[160:163], v[20:23]
s_waitcnt lgkmcnt(4)
v_add_f32 v243, v243, v152
v_cvt_pk_bf16_f32 v220, v152, v153
v_mfma_f32_16x16x32_bf16 v[24:27], a[80:83], v[160:163], v[24:27]
s_lshl_b32 s3, s2, 2
v_exp_f32 v132, v132
s_add_u32 s3, s3, s28
v_mfma_f32_16x16x32_bf16 v[24:27], a[84:87], v[176:179], v[24:27]
ds_read_b128 a[64:67], v244 offset:0
ds_read_b128 a[68:71], v244 offset:512
v_mfma_f32_16x16x32_bf16 v[56:59], a[84:87], v[180:183], v[56:59]
s_cmp_lt_u32 s3, 432
v_exp_f32 v133, v133
s_cselect_b32 s90, 2211840, 0
s_cselect_b32 s32, 0, 0x7f000000
v_mfma_f32_16x16x32_bf16 v[56:59], a[80:83], v[164:167], v[56:59]
v_add_f32 v243, v243, v153
v_cvt_pk_bf16_f32 v221, v154, v155
v_mfma_f32_16x16x32_bf16 v[88:91], a[80:83], v[168:171], v[88:91]
s_lshr_b32 s36, s3, 3
v_exp_f32 v134, v134
s_and_b32 s3, s3, 7
v_mfma_f32_16x16x32_bf16 v[88:91], a[84:87], v[184:187], v[88:91]
ds_read_b128 a[72:75], v244 offset:1024
ds_read_b128 a[76:79], v244 offset:1536
v_mfma_f32_16x16x32_bf16 v[120:123], a[84:87], v[188:191], v[120:123]
s_mul_i32 s43, s36, 40960
v_exp_f32 v135, v135
s_mul_i32 s41, s3, 160
v_mfma_f32_16x16x32_bf16 v[120:123], a[80:83], v[172:175], v[120:123]
s_waitcnt lgkmcnt(4)
v_add_f32 v243, v243, v154
v_cvt_pk_bf16_f32 v210, v132, v133
v_mfma_f32_16x16x32_bf16 v[124:127], a[88:91], v[172:175], v[124:127]
s_add_u32 s43, s43, s41
v_exp_f32 v140, v140
s_mul_i32 s3, s3, 54
v_mfma_f32_16x16x32_bf16 v[124:127], a[92:95], v[188:191], v[124:127]
ds_read_b128 a[80:83], v244 offset:4096
v_add_u32 v246, s33, v247
v_mfma_f32_16x16x32_bf16 v[92:95], a[92:95], v[184:187], v[92:95]
s_add_u32 s36, s36, s3
v_exp_f32 v141, v141
s_mul_i32 s36, s36, 5120
v_mfma_f32_16x16x32_bf16 v[92:95], a[88:91], v[168:171], v[92:95]
v_add_f32 v243, v243, v155
v_cvt_pk_bf16_f32 v211, v134, v135
v_mfma_f32_16x16x32_bf16 v[60:63], a[88:91], v[164:167], v[60:63]
s_add_u32 s36, s36, 25165824
v_exp_f32 v142, v142
v_mfma_f32_16x16x32_bf16 v[60:63], a[92:95], v[180:183], v[60:63]
ds_read_b128 a[84:87], v244 offset:4608
v_xor_b32 v249, 32, v246
v_mfma_f32_16x16x32_bf16 v[28:31], a[92:95], v[176:179], v[28:31]
v_exp_f32 v143, v143
v_mfma_f32_16x16x32_bf16 v[28:31], a[88:91], v[160:163], v[28:31]
s_waitcnt lgkmcnt(2)
v_add_f32 v241, v241, v140
v_cvt_pk_bf16_f32 v214, v140, v141
v_mfma_f32_16x16x32_bf16 v[128:131], a[64:67], a[0:3], v[224:227]
v_exp_f32 v148, v148
v_mfma_f32_16x16x32_bf16 v[128:131], a[68:71], a[4:7], v[128:131]
ds_read_b128 a[88:91], v244 offset:5120
v_accvgpr_read_b32 v253, a133
v_mfma_f32_16x16x32_bf16 v[128:131], a[72:75], a[8:11], v[128:131]
s_add_u32 m0, s39, s31
v_exp_f32 v149, v149
v_mfma_f32_16x16x32_bf16 v[128:131], a[76:79], a[12:15], v[128:131]
v_add_f32 v241, v241, v141
v_cvt_pk_bf16_f32 v215, v142, v143
v_mfma_f32_16x16x32_bf16 v[136:139], a[76:79], a[28:31], v[228:231]
v_exp_f32 v150, v150
v_mfma_f32_16x16x32_bf16 v[136:139], a[72:75], a[24:27], v[136:139]
ds_read_b128 a[92:95], v244 offset:5632
global_load_lds_dwordx4 v248, s[8:9] offset:0
v_mfma_f32_16x16x32_bf16 v[136:139], a[68:71], a[20:23], v[136:139]
v_exp_f32 v151, v151
v_mfma_f32_16x16x32_bf16 v[136:139], a[64:67], a[16:19], v[136:139]
v_add_f32 v241, v241, v142
v_cvt_pk_bf16_f32 v218, v148, v149
v_mfma_f32_16x16x32_bf16 v[144:147], a[64:67], a[32:35], v[232:235]
v_exp_f32 v156, v156
v_mfma_f32_16x16x32_bf16 v[144:147], a[68:71], a[36:39], v[144:147]
global_load_lds_dwordx4 v248, s[10:11] offset:1024
v_add_u32 v253, s77, v253
v_mfma_f32_16x16x32_bf16 v[144:147], a[72:75], a[40:43], v[144:147]
v_exp_f32 v157, v157
v_mfma_f32_16x16x32_bf16 v[144:147], a[76:79], a[44:47], v[144:147]
v_add_f32 v241, v241, v143
v_cvt_pk_bf16_f32 v219, v150, v151
v_mfma_f32_16x16x32_bf16 v[152:155], a[76:79], a[60:63], v[236:239]
v_exp_f32 v158, v158
v_mfma_f32_16x16x32_bf16 v[152:155], a[72:75], a[56:59], v[152:155]
global_load_lds_dwordx4 v248, s[8:9] offset:2048
global_load_lds_dwordx4 v248, s[10:11] offset:3072
v_mfma_f32_16x16x32_bf16 v[152:155], a[68:71], a[52:55], v[152:155]
v_exp_f32 v159, v159
v_mfma_f32_16x16x32_bf16 v[152:155], a[64:67], a[48:51], v[152:155]
s_waitcnt lgkmcnt(0)
v_add_f32 v243, v243, v156
v_cvt_pk_bf16_f32 v222, v156, v157
v_mfma_f32_16x16x32_bf16 v[132:135], a[80:83], a[0:3], v[224:227]
v_exp_f32 v128, v128
v_mfma_f32_16x16x32_bf16 v[132:135], a[84:87], a[4:7], v[132:135]
ds_read_b64_tr_b16 a[96:97], v246 offset:0
ds_read_b64_tr_b16 a[98:99], v246 offset:4096
v_mfma_f32_16x16x32_bf16 v[132:135], a[88:91], a[8:11], v[132:135]
v_exp_f32 v129, v129
v_mfma_f32_16x16x32_bf16 v[132:135], a[92:95], a[12:15], v[132:135]
v_add_f32 v243, v243, v157
v_cvt_pk_bf16_f32 v223, v158, v159
v_mfma_f32_16x16x32_bf16 v[140:143], a[92:95], a[28:31], v[228:231]
v_exp_f32 v130, v130
v_mfma_f32_16x16x32_bf16 v[140:143], a[88:91], a[24:27], v[140:143]
ds_read_b64_tr_b16 a[100:101], v246 offset:8192
ds_read_b64_tr_b16 a[102:103], v246 offset:12288
buffer_store_dwordx4 a[124:127], v250, s[16:19], s76 offen offset:2048 sc1
v_mfma_f32_16x16x32_bf16 v[140:143], a[84:87], a[20:23], v[140:143]
v_exp_f32 v131, v131
v_mfma_f32_16x16x32_bf16 v[140:143], a[80:83], a[16:19], v[140:143]
v_add_f32 v243, v243, v158
v_cvt_pk_bf16_f32 v160, v128, v129
v_mfma_f32_16x16x32_bf16 v[148:151], a[80:83], a[32:35], v[232:235]
v_exp_f32 v136, v136
v_mfma_f32_16x16x32_bf16 v[148:151], a[84:87], a[36:39], v[148:151]
ds_read_b64_tr_b16 a[104:105], v249 offset:0
ds_read_b64_tr_b16 a[106:107], v249 offset:4096
v_mfma_f32_16x16x32_bf16 v[148:151], a[88:91], a[40:43], v[148:151]
v_exp_f32 v137, v137
v_mfma_f32_16x16x32_bf16 v[148:151], a[92:95], a[44:47], v[148:151]
v_add_f32 v243, v243, v159
v_cvt_pk_bf16_f32 v161, v130, v131
v_mfma_f32_16x16x32_bf16 v[156:159], a[92:95], a[60:63], v[236:239]
v_exp_f32 v138, v138
v_mfma_f32_16x16x32_bf16 v[156:159], a[88:91], a[56:59], v[156:159]
ds_read_b64_tr_b16 a[108:109], v249 offset:8192
ds_read_b64_tr_b16 a[110:111], v249 offset:12288
v_mfma_f32_16x16x32_bf16 v[156:159], a[84:87], a[52:55], v[156:159]
v_exp_f32 v139, v139
v_mfma_f32_16x16x32_bf16 v[156:159], a[80:83], a[48:51], v[156:159]
s_waitcnt lgkmcnt(4)
v_add_f32 v241, v241, v136
v_cvt_pk_bf16_f32 v164, v136, v137
v_mfma_f32_16x16x32_bf16 v[0:3], a[96:99], v[192:195], v[0:3]
s_add_u32 s39, s37, 65536
v_exp_f32 v144, v144
s_add_u32 s37, s37, 16384
v_mfma_f32_16x16x32_bf16 v[0:3], a[100:103], v[208:211], v[0:3]
ds_read_b64_tr_b16 a[80:81], v246 offset:512
ds_read_b64_tr_b16 a[82:83], v246 offset:4608
v_mfma_f32_16x16x32_bf16 v[32:35], a[100:103], v[212:215], v[32:35]
s_and_b32 s37, s37, 0xffff
v_exp_f32 v145, v145
v_mfma_f32_16x16x32_bf16 v[32:35], a[96:99], v[196:199], v[32:35]
v_add_f32 v241, v241, v137
v_cvt_pk_bf16_f32 v165, v138, v139
v_mfma_f32_16x16x32_bf16 v[64:67], a[96:99], v[200:203], v[64:67]
s_waitcnt vmcnt(11)
v_exp_f32 v146, v146
v_mfma_f32_16x16x32_bf16 v[64:67], a[100:103], v[216:219], v[64:67]
ds_read_b64_tr_b16 a[84:85], v246 offset:8704
ds_read_b64_tr_b16 a[86:87], v246 offset:12800
v_mfma_f32_16x16x32_bf16 v[96:99], a[100:103], v[220:223], v[96:99]
v_exp_f32 v147, v147
v_mfma_f32_16x16x32_bf16 v[96:99], a[96:99], v[204:207], v[96:99]
s_waitcnt lgkmcnt(4)
v_add_f32 v241, v241, v138
v_cvt_pk_bf16_f32 v168, v144, v145
v_mfma_f32_16x16x32_bf16 a[116:119], a[112:115], v[192:195], a[116:119]
ds_read_b64_tr_b16 a[136:137], v253 offset:0
ds_read_b64_tr_b16 a[138:139], v253 offset:2560
v_mfma_f32_16x16x32_bf16 a[116:119], a[112:115], v[208:211], a[116:119]
ds_read_b64_tr_b16 a[140:141], v253 offset:8
ds_read_b64_tr_b16 a[142:143], v253 offset:2568
v_mfma_f32_16x16x32_bf16 v[100:103], a[104:107], v[204:207], v[100:103]
s_add_u32 s8, s8, 16384
v_exp_f32 v152, v152
s_addc_u32 s9, s9, 0
v_mfma_f32_16x16x32_bf16 v[100:103], a[108:111], v[220:223], v[100:103]
ds_read_b64_tr_b16 a[88:89], v249 offset:512
ds_read_b64_tr_b16 a[90:91], v249 offset:4608
v_mfma_f32_16x16x32_bf16 v[68:71], a[108:111], v[216:219], v[68:71]
s_add_u32 s10, s10, 16384
v_exp_f32 v153, v153
s_addc_u32 s11, s11, 0
v_mfma_f32_16x16x32_bf16 v[68:71], a[104:107], v[200:203], v[68:71]
v_add_f32 v241, v241, v139
v_cvt_pk_bf16_f32 v169, v146, v147
v_mfma_f32_16x16x32_bf16 v[36:39], a[104:107], v[196:199], v[36:39]
v_exp_f32 v154, v154
v_mfma_f32_16x16x32_bf16 v[36:39], a[108:111], v[212:215], v[36:39]
ds_read_b64_tr_b16 a[92:93], v249 offset:8704
ds_read_b64_tr_b16 a[94:95], v249 offset:12800
v_mfma_f32_16x16x32_bf16 v[4:7], a[108:111], v[208:211], v[4:7]
v_exp_f32 v155, v155
v_mfma_f32_16x16x32_bf16 v[4:7], a[104:107], v[192:195], v[4:7]
s_waitcnt lgkmcnt(8)
v_add_f32 v243, v243, v152
v_cvt_pk_bf16_f32 v172, v152, v153
v_mfma_f32_16x16x32_bf16 v[8:11], a[80:83], v[192:195], v[8:11]
v_exp_f32 v132, v132
v_mfma_f32_16x16x32_bf16 v[8:11], a[84:87], v[208:211], v[8:11]
ds_read_b128 a[64:67], v244 offset:8192
ds_read_b128 a[68:71], v244 offset:8704
v_mfma_f32_16x16x32_bf16 v[40:43], a[84:87], v[212:215], v[40:43]
v_exp_f32 v133, v133
v_mfma_f32_16x16x32_bf16 v[40:43], a[80:83], v[196:199], v[40:43]
v_add_f32 v243, v243, v153
v_cvt_pk_bf16_f32 v173, v154, v155
v_mfma_f32_16x16x32_bf16 v[72:75], a[80:83], v[200:203], v[72:75]
v_exp_f32 v134, v134
v_mfma_f32_16x16x32_bf16 v[72:75], a[84:87], v[216:219], v[72:75]
ds_read_b128 a[72:75], v244 offset:9216
ds_read_b128 a[76:79], v244 offset:9728
v_mfma_f32_16x16x32_bf16 v[104:107], a[84:87], v[220:223], v[104:107]
v_exp_f32 v135, v135
v_mfma_f32_16x16x32_bf16 v[104:107], a[80:83], v[204:207], v[104:107]
s_waitcnt lgkmcnt(4)
v_add_f32 v243, v243, v154
v_cvt_pk_bf16_f32 v162, v132, v133
v_mfma_f32_16x16x32_bf16 v[108:111], a[88:91], v[204:207], v[108:111]
v_exp_f32 v140, v140
v_mfma_f32_16x16x32_bf16 v[108:111], a[92:95], v[220:223], v[108:111]
ds_read_b128 a[80:83], v244 offset:12288
ds_read_b64_tr_b16 a[144:145], v253 offset:16
v_mfma_f32_16x16x32_bf16 v[76:79], a[92:95], v[216:219], v[76:79]
v_exp_f32 v141, v141
v_mfma_f32_16x16x32_bf16 v[76:79], a[88:91], v[200:203], v[76:79]
v_add_f32 v243, v243, v155
v_cvt_pk_bf16_f32 v163, v134, v135
v_mfma_f32_16x16x32_bf16 v[44:47], a[88:91], v[196:199], v[44:47]
v_exp_f32 v142, v142
v_mfma_f32_16x16x32_bf16 v[44:47], a[92:95], v[212:215], v[44:47]
ds_read_b128 a[84:87], v244 offset:12800
ds_read_b64_tr_b16 a[146:147], v253 offset:2576
v_mfma_f32_16x16x32_bf16 v[12:15], a[92:95], v[208:211], v[12:15]
v_exp_f32 v143, v143
v_mfma_f32_16x16x32_bf16 v[12:15], a[88:91], v[192:195], v[12:15]
s_waitcnt lgkmcnt(4)
v_add_f32 v241, v241, v140
v_cvt_pk_bf16_f32 v166, v140, v141
v_mfma_f32_16x16x32_bf16 v[128:131], a[64:67], a[0:3], v[224:227]
v_exp_f32 v148, v148
s_barrier
v_mfma_f32_16x16x32_bf16 v[128:131], a[68:71], a[4:7], v[128:131]
ds_read_b128 a[88:91], v244 offset:13312
ds_read_b64_tr_b16 a[148:149], v253 offset:24
v_mfma_f32_16x16x32_bf16 v[128:131], a[72:75], a[8:11], v[128:131]
s_add_u32 m0, s37, s31
v_exp_f32 v149, v149
v_mfma_f32_16x16x32_bf16 v[128:131], a[76:79], a[12:15], v[128:131]
v_add_f32 v241, v241, v141
v_cvt_pk_bf16_f32 v167, v142, v143
v_mfma_f32_16x16x32_bf16 v[136:139], a[76:79], a[28:31], v[228:231]
v_exp_f32 v150, v150
v_mfma_f32_16x16x32_bf16 v[136:139], a[72:75], a[24:27], v[136:139]
ds_read_b128 a[92:95], v244 offset:13824
global_load_lds_dwordx4 v248, s[4:5] offset:0
v_mfma_f32_16x16x32_bf16 v[136:139], a[68:71], a[20:23], v[136:139]
v_exp_f32 v151, v151
v_mfma_f32_16x16x32_bf16 v[136:139], a[64:67], a[16:19], v[136:139]
v_add_f32 v241, v241, v142
v_cvt_pk_bf16_f32 v170, v148, v149
v_mfma_f32_16x16x32_bf16 v[144:147], a[64:67], a[32:35], v[232:235]
v_exp_f32 v156, v156
v_mfma_f32_16x16x32_bf16 v[144:147], a[68:71], a[36:39], v[144:147]
global_load_lds_dwordx4 v248, s[6:7] offset:1024
ds_read_b64_tr_b16 a[150:151], v253 offset:2584
v_mfma_f32_16x16x32_bf16 v[144:147], a[72:75], a[40:43], v[144:147]
v_exp_f32 v157, v157
v_mfma_f32_16x16x32_bf16 v[144:147], a[76:79], a[44:47], v[144:147]
v_add_f32 v241, v241, v143
v_cvt_pk_bf16_f32 v171, v150, v151
v_mfma_f32_16x16x32_bf16 v[152:155], a[76:79], a[60:63], v[236:239]
v_exp_f32 v158, v158
v_mfma_f32_16x16x32_bf16 v[152:155], a[72:75], a[56:59], v[152:155]
global_load_lds_dwordx4 v248, s[4:5] offset:2048
global_load_lds_dwordx4 v248, s[6:7] offset:3072
v_mfma_f32_16x16x32_bf16 v[152:155], a[68:71], a[52:55], v[152:155]
v_exp_f32 v159, v159
v_mfma_f32_16x16x32_bf16 v[152:155], a[64:67], a[48:51], v[152:155]
s_waitcnt lgkmcnt(1)
v_add_f32 v243, v243, v156
v_cvt_pk_bf16_f32 v174, v156, v157
v_mfma_f32_16x16x32_bf16 v[132:135], a[80:83], a[0:3], v[224:227]
v_exp_f32 v128, v128
v_mfma_f32_16x16x32_bf16 v[132:135], a[84:87], a[4:7], v[132:135]
ds_read_b64_tr_b16 a[96:97], v246 offset:1024
ds_read_b64_tr_b16 a[98:99], v246 offset:5120
v_mfma_f32_16x16x32_bf16 v[132:135], a[88:91], a[8:11], v[132:135]
v_exp_f32 v129, v129
v_mfma_f32_16x16x32_bf16 v[132:135], a[92:95], a[12:15], v[132:135]
v_add_f32 v243, v243, v157
v_cvt_pk_bf16_f32 v175, v158, v159
v_mfma_f32_16x16x32_bf16 v[140:143], a[92:95], a[28:31], v[228:231]
v_exp_f32 v130, v130
v_mfma_f32_16x16x32_bf16 v[140:143], a[88:91], a[24:27], v[140:143]
ds_read_b64_tr_b16 a[100:101], v246 offset:9216
ds_read_b64_tr_b16 a[102:103], v246 offset:13312
buffer_store_dwordx4 a[124:127], v250, s[16:19], s76 offen offset:3072 sc1
v_mfma_f32_16x16x32_bf16 v[140:143], a[84:87], a[20:23], v[140:143]
v_exp_f32 v131, v131
v_mfma_f32_16x16x32_bf16 v[140:143], a[80:83], a[16:19], v[140:143]
v_add_f32 v243, v243, v158
v_cvt_pk_bf16_f32 v176, v128, v129
v_mfma_f32_16x16x32_bf16 v[148:151], a[80:83], a[32:35], v[232:235]
s_mov_b32 s33, s35
v_exp_f32 v136, v136
s_add_u32 s35, s35, 16384
v_mfma_f32_16x16x32_bf16 v[148:151], a[84:87], a[36:39], v[148:151]
ds_read_b64_tr_b16 a[104:105], v249 offset:1024
ds_read_b64_tr_b16 a[106:107], v249 offset:5120
v_mfma_f32_16x16x32_bf16 v[148:151], a[88:91], a[40:43], v[148:151]
s_and_b32 s35, s35, 0xffff
v_exp_f32 v137, v137
v_mfma_f32_16x16x32_bf16 v[148:151], a[92:95], a[44:47], v[148:151]
v_add_f32 v243, v243, v159
v_cvt_pk_bf16_f32 v177, v130, v131
v_mfma_f32_16x16x32_bf16 v[156:159], a[92:95], a[60:63], v[236:239]
v_exp_f32 v138, v138
v_mfma_f32_16x16x32_bf16 v[156:159], a[88:91], a[56:59], v[156:159]
ds_read_b64_tr_b16 a[108:109], v249 offset:9216
ds_read_b64_tr_b16 a[110:111], v249 offset:13312
v_mfma_f32_16x16x32_bf16 v[156:159], a[84:87], a[52:55], v[156:159]
v_exp_f32 v139, v139
v_mfma_f32_16x16x32_bf16 v[156:159], a[80:83], a[48:51], v[156:159]
s_waitcnt lgkmcnt(4)
v_add_f32 v241, v241, v136
v_cvt_pk_bf16_f32 v180, v136, v137
v_mfma_f32_16x16x32_bf16 v[16:19], a[96:99], v[192:195], v[16:19]
v_exp_f32 v144, v144
v_mfma_f32_16x16x32_bf16 v[16:19], a[100:103], v[208:211], v[16:19]
ds_read_b64_tr_b16 a[80:81], v246 offset:1536
ds_read_b64_tr_b16 a[82:83], v246 offset:5632
v_mfma_f32_16x16x32_bf16 v[48:51], a[100:103], v[212:215], v[48:51]
v_exp_f32 v145, v145
v_mfma_f32_16x16x32_bf16 v[48:51], a[96:99], v[196:199], v[48:51]
v_add_f32 v241, v241, v137
v_cvt_pk_bf16_f32 v181, v138, v139
v_mfma_f32_16x16x32_bf16 v[80:83], a[96:99], v[200:203], v[80:83]
v_exp_f32 v146, v146
v_mfma_f32_16x16x32_bf16 v[80:83], a[100:103], v[216:219], v[80:83]
ds_read_b64_tr_b16 a[84:85], v246 offset:9728
ds_read_b64_tr_b16 a[86:87], v246 offset:13824
v_mfma_f32_16x16x32_bf16 v[112:115], a[100:103], v[220:223], v[112:115]
v_exp_f32 v147, v147
v_mfma_f32_16x16x32_bf16 v[112:115], a[96:99], v[204:207], v[112:115]
s_waitcnt lgkmcnt(4)
v_add_f32 v241, v241, v138
v_cvt_pk_bf16_f32 v184, v144, v145
v_mfma_f32_16x16x32_bf16 a[120:123], a[112:115], v[200:203], a[120:123]
ds_read_b64_tr_b16 a[152:153], v253 offset:32
ds_read_b64_tr_b16 a[154:155], v253 offset:2592
v_mfma_f32_16x16x32_bf16 a[120:123], a[112:115], v[216:219], a[120:123]
v_add_u32 v254, s32, v250
v_add_u32 v244, s35, v245
v_mfma_f32_16x16x32_bf16 v[116:119], a[104:107], v[204:207], v[116:119]
s_add_u32 s4, s4, 16384
v_exp_f32 v152, v152
s_addc_u32 s5, s5, 0
v_mfma_f32_16x16x32_bf16 v[116:119], a[108:111], v[220:223], v[116:119]
ds_read_b64_tr_b16 a[88:89], v249 offset:1536
ds_read_b64_tr_b16 a[90:91], v249 offset:5632
v_mfma_f32_16x16x32_bf16 v[84:87], a[108:111], v[216:219], v[84:87]
s_add_u32 s6, s6, 16384
v_exp_f32 v153, v153
s_addc_u32 s7, s7, 0
v_mfma_f32_16x16x32_bf16 v[84:87], a[104:107], v[200:203], v[84:87]
v_add_f32 v241, v241, v139
v_cvt_pk_bf16_f32 v185, v146, v147
v_mfma_f32_16x16x32_bf16 v[52:55], a[104:107], v[196:199], v[52:55]
v_exp_f32 v154, v154
v_mfma_f32_16x16x32_bf16 v[52:55], a[108:111], v[212:215], v[52:55]
ds_read_b64_tr_b16 a[92:93], v249 offset:9728
ds_read_b64_tr_b16 a[94:95], v249 offset:13824
v_mfma_f32_16x16x32_bf16 v[20:23], a[108:111], v[208:211], v[20:23]
v_exp_f32 v155, v155
v_mfma_f32_16x16x32_bf16 v[20:23], a[104:107], v[192:195], v[20:23]
s_waitcnt lgkmcnt(6)
v_add_f32 v243, v243, v152
v_cvt_pk_bf16_f32 v188, v152, v153
v_mfma_f32_16x16x32_bf16 v[24:27], a[80:83], v[192:195], v[24:27]
v_exp_f32 v132, v132
v_mfma_f32_16x16x32_bf16 v[24:27], a[84:87], v[208:211], v[24:27]
ds_read_b128 a[64:67], v244 offset:0
ds_read_b128 a[68:71], v244 offset:512
v_mfma_f32_16x16x32_bf16 v[56:59], a[84:87], v[212:215], v[56:59]
v_exp_f32 v133, v133
v_mfma_f32_16x16x32_bf16 v[56:59], a[80:83], v[196:199], v[56:59]
v_add_f32 v243, v243, v153
v_cvt_pk_bf16_f32 v189, v154, v155
v_mfma_f32_16x16x32_bf16 v[88:91], a[80:83], v[200:203], v[88:91]
v_exp_f32 v134, v134
v_mfma_f32_16x16x32_bf16 v[88:91], a[84:87], v[216:219], v[88:91]
ds_read_b128 a[72:75], v244 offset:1024
ds_read_b128 a[76:79], v244 offset:1536
v_mfma_f32_16x16x32_bf16 v[120:123], a[84:87], v[220:223], v[120:123]
v_exp_f32 v135, v135
v_mfma_f32_16x16x32_bf16 v[120:123], a[80:83], v[204:207], v[120:123]
s_waitcnt lgkmcnt(4)
v_add_f32 v243, v243, v154
v_cvt_pk_bf16_f32 v178, v132, v133
v_mfma_f32_16x16x32_bf16 v[124:127], a[88:91], v[204:207], v[124:127]
v_exp_f32 v140, v140
v_mfma_f32_16x16x32_bf16 v[124:127], a[92:95], v[220:223], v[124:127]
ds_read_b128 a[80:83], v244 offset:4096
v_add_u32 v246, s33, v247
v_mfma_f32_16x16x32_bf16 v[92:95], a[92:95], v[216:219], v[92:95]
v_exp_f32 v141, v141
v_mfma_f32_16x16x32_bf16 v[92:95], a[88:91], v[200:203], v[92:95]
v_add_f32 v243, v243, v155
v_cvt_pk_bf16_f32 v179, v134, v135
v_mfma_f32_16x16x32_bf16 v[60:63], a[88:91], v[196:199], v[60:63]
v_exp_f32 v142, v142
v_mfma_f32_16x16x32_bf16 v[60:63], a[92:95], v[212:215], v[60:63]
ds_read_b128 a[84:87], v244 offset:4608
v_xor_b32 v249, 32, v246
v_mfma_f32_16x16x32_bf16 v[28:31], a[92:95], v[208:211], v[28:31]
v_exp_f32 v143, v143
v_mfma_f32_16x16x32_bf16 v[28:31], a[88:91], v[192:195], v[28:31]
s_waitcnt lgkmcnt(2)
v_add_f32 v241, v241, v140
v_cvt_pk_bf16_f32 v182, v140, v141
v_mfma_f32_16x16x32_bf16 v[128:131], a[64:67], a[0:3], v[224:227]
v_exp_f32 v148, v148
s_add_u32 s40, s79, 4096
v_mfma_f32_16x16x32_bf16 v[128:131], a[68:71], a[4:7], v[128:131]
ds_read_b128 a[88:91], v244 offset:5120
buffer_store_dwordx4 a[136:139], v250, s[16:19], s79 offen offset:0 sc1
v_mfma_f32_16x16x32_bf16 v[128:131], a[72:75], a[8:11], v[128:131]
s_add_u32 m0, s39, s31
v_exp_f32 v149, v149
v_mfma_f32_16x16x32_bf16 v[128:131], a[76:79], a[12:15], v[128:131]
v_add_f32 v241, v241, v141
v_cvt_pk_bf16_f32 v183, v142, v143
v_mfma_f32_16x16x32_bf16 v[136:139], a[76:79], a[28:31], v[228:231]
v_exp_f32 v150, v150
v_mfma_f32_16x16x32_bf16 v[136:139], a[72:75], a[24:27], v[136:139]
ds_read_b128 a[92:95], v244 offset:5632
global_load_lds_dwordx4 v248, s[8:9] offset:0
v_mfma_f32_16x16x32_bf16 v[136:139], a[68:71], a[20:23], v[136:139]
v_exp_f32 v151, v151
v_mfma_f32_16x16x32_bf16 v[136:139], a[64:67], a[16:19], v[136:139]
v_add_f32 v241, v241, v142
v_cvt_pk_bf16_f32 v186, v148, v149
v_mfma_f32_16x16x32_bf16 v[144:147], a[64:67], a[32:35], v[232:235]
v_exp_f32 v156, v156
v_mfma_f32_16x16x32_bf16 v[144:147], a[68:71], a[36:39], v[144:147]
global_load_lds_dwordx4 v248, s[10:11] offset:1024
v_mfma_f32_16x16x32_bf16 v[144:147], a[72:75], a[40:43], v[144:147]
v_exp_f32 v157, v157
v_mfma_f32_16x16x32_bf16 v[144:147], a[76:79], a[44:47], v[144:147]
v_add_f32 v241, v241, v143
v_cvt_pk_bf16_f32 v187, v150, v151
v_mfma_f32_16x16x32_bf16 v[152:155], a[76:79], a[60:63], v[236:239]
v_exp_f32 v158, v158
v_mfma_f32_16x16x32_bf16 v[152:155], a[72:75], a[56:59], v[152:155]
global_load_lds_dwordx4 v248, s[8:9] offset:2048
global_load_lds_dwordx4 v248, s[10:11] offset:3072
v_mfma_f32_16x16x32_bf16 v[152:155], a[68:71], a[52:55], v[152:155]
v_exp_f32 v159, v159
v_mfma_f32_16x16x32_bf16 v[152:155], a[64:67], a[48:51], v[152:155]
s_waitcnt lgkmcnt(0)
v_add_f32 v243, v243, v156
v_cvt_pk_bf16_f32 v190, v156, v157
v_mfma_f32_16x16x32_bf16 v[132:135], a[80:83], a[0:3], v[224:227]
v_exp_f32 v128, v128
v_mfma_f32_16x16x32_bf16 v[132:135], a[84:87], a[4:7], v[132:135]
ds_read_b64_tr_b16 a[96:97], v246 offset:0
ds_read_b64_tr_b16 a[98:99], v246 offset:4096
v_mfma_f32_16x16x32_bf16 v[132:135], a[88:91], a[8:11], v[132:135]
v_exp_f32 v129, v129
v_mfma_f32_16x16x32_bf16 v[132:135], a[92:95], a[12:15], v[132:135]
v_add_f32 v243, v243, v157
v_cvt_pk_bf16_f32 v191, v158, v159
v_mfma_f32_16x16x32_bf16 v[140:143], a[92:95], a[28:31], v[228:231]
v_exp_f32 v130, v130
v_mfma_f32_16x16x32_bf16 v[140:143], a[88:91], a[24:27], v[140:143]
ds_read_b64_tr_b16 a[100:101], v246 offset:8192
ds_read_b64_tr_b16 a[102:103], v246 offset:12288
v_mfma_f32_16x16x32_bf16 v[140:143], a[84:87], a[20:23], v[140:143]
v_exp_f32 v131, v131
v_mfma_f32_16x16x32_bf16 v[140:143], a[80:83], a[16:19], v[140:143]
v_add_f32 v243, v243, v158
v_cvt_pk_bf16_f32 v192, v128, v129
v_mfma_f32_16x16x32_bf16 v[148:151], a[80:83], a[32:35], v[232:235]
v_exp_f32 v136, v136
v_mfma_f32_16x16x32_bf16 v[148:151], a[84:87], a[36:39], v[148:151]
ds_read_b64_tr_b16 a[104:105], v249 offset:0
ds_read_b64_tr_b16 a[106:107], v249 offset:4096
v_mfma_f32_16x16x32_bf16 v[148:151], a[88:91], a[40:43], v[148:151]
v_exp_f32 v137, v137
v_mfma_f32_16x16x32_bf16 v[148:151], a[92:95], a[44:47], v[148:151]
v_add_f32 v243, v243, v159
v_cvt_pk_bf16_f32 v193, v130, v131
v_mfma_f32_16x16x32_bf16 v[156:159], a[92:95], a[60:63], v[236:239]
v_exp_f32 v138, v138
v_mfma_f32_16x16x32_bf16 v[156:159], a[88:91], a[56:59], v[156:159]
ds_read_b64_tr_b16 a[108:109], v249 offset:8192
ds_read_b64_tr_b16 a[110:111], v249 offset:12288
v_mfma_f32_16x16x32_bf16 v[156:159], a[84:87], a[52:55], v[156:159]
v_exp_f32 v139, v139
v_mfma_f32_16x16x32_bf16 v[156:159], a[80:83], a[48:51], v[156:159]
s_waitcnt lgkmcnt(4)
v_add_f32 v241, v241, v136
v_cvt_pk_bf16_f32 v196, v136, v137
v_mfma_f32_16x16x32_bf16 v[0:3], a[96:99], v[160:163], v[0:3]
s_add_u32 s39, s37, 65536
v_exp_f32 v144, v144
s_add_u32 s37, s37, 16384
v_mfma_f32_16x16x32_bf16 v[0:3], a[100:103], v[176:179], v[0:3]
ds_read_b64_tr_b16 a[80:81], v246 offset:512
ds_read_b64_tr_b16 a[82:83], v246 offset:4608
v_mfma_f32_16x16x32_bf16 v[32:35], a[100:103], v[180:183], v[32:35]
s_and_b32 s37, s37, 0xffff
v_exp_f32 v145, v145
v_mfma_f32_16x16x32_bf16 v[32:35], a[96:99], v[164:167], v[32:35]
v_add_f32 v241, v241, v137
v_cvt_pk_bf16_f32 v197, v138, v139
v_mfma_f32_16x16x32_bf16 v[64:67], a[96:99], v[168:171], v[64:67]
v_exp_f32 v146, v146
v_mfma_f32_16x16x32_bf16 v[64:67], a[100:103], v[184:187], v[64:67]
ds_read_b64_tr_b16 a[84:85], v246 offset:8704
ds_read_b64_tr_b16 a[86:87], v246 offset:12800
v_mfma_f32_16x16x32_bf16 v[96:99], a[100:103], v[188:191], v[96:99]
v_exp_f32 v147, v147
v_mfma_f32_16x16x32_bf16 v[96:99], a[96:99], v[172:175], v[96:99]
s_waitcnt lgkmcnt(4)
v_add_f32 v241, v241, v138
v_cvt_pk_bf16_f32 v200, v144, v145
v_mfma_f32_16x16x32_bf16 a[116:119], a[112:115], v[160:163], a[116:119]
v_accvgpr_read_b32 v251, a128
v_mfma_f32_16x16x32_bf16 a[116:119], a[112:115], v[176:179], a[116:119]
v_mfma_f32_16x16x32_bf16 v[100:103], a[104:107], v[172:175], v[100:103]
s_add_u32 s8, s8, 16384
v_exp_f32 v152, v152
s_addc_u32 s9, s9, 0
v_mfma_f32_16x16x32_bf16 v[100:103], a[108:111], v[188:191], v[100:103]
ds_read_b64_tr_b16 a[88:89], v249 offset:512
ds_read_b64_tr_b16 a[90:91], v249 offset:4608
v_mfma_f32_16x16x32_bf16 v[68:71], a[108:111], v[184:187], v[68:71]
s_add_u32 s10, s10, 16384
v_exp_f32 v153, v153
s_addc_u32 s11, s11, 0
v_mfma_f32_16x16x32_bf16 v[68:71], a[104:107], v[168:171], v[68:71]
v_add_f32 v241, v241, v139
v_cvt_pk_bf16_f32 v201, v146, v147
v_mfma_f32_16x16x32_bf16 v[36:39], a[104:107], v[164:167], v[36:39]
v_exp_f32 v154, v154
v_mfma_f32_16x16x32_bf16 v[36:39], a[108:111], v[180:183], v[36:39]
ds_read_b64_tr_b16 a[92:93], v249 offset:8704
ds_read_b64_tr_b16 a[94:95], v249 offset:12800
v_mfma_f32_16x16x32_bf16 v[4:7], a[108:111], v[176:179], v[4:7]
v_exp_f32 v155, v155
v_mfma_f32_16x16x32_bf16 v[4:7], a[104:107], v[160:163], v[4:7]
s_waitcnt lgkmcnt(4)
v_add_f32 v243, v243, v152
v_cvt_pk_bf16_f32 v204, v152, v153
v_mfma_f32_16x16x32_bf16 v[8:11], a[80:83], v[160:163], v[8:11]
v_exp_f32 v132, v132
v_mfma_f32_16x16x32_bf16 v[8:11], a[84:87], v[176:179], v[8:11]
ds_read_b128 a[64:67], v244 offset:8192
ds_read_b128 a[68:71], v244 offset:8704
v_mfma_f32_16x16x32_bf16 v[40:43], a[84:87], v[180:183], v[40:43]
v_exp_f32 v133, v133
v_mfma_f32_16x16x32_bf16 v[40:43], a[80:83], v[164:167], v[40:43]
v_add_f32 v243, v243, v153
v_cvt_pk_bf16_f32 v205, v154, v155
v_mfma_f32_16x16x32_bf16 v[72:75], a[80:83], v[168:171], v[72:75]
v_exp_f32 v134, v134
v_mfma_f32_16x16x32_bf16 v[72:75], a[84:87], v[184:187], v[72:75]
ds_read_b128 a[72:75], v244 offset:9216
ds_read_b128 a[76:79], v244 offset:9728
v_mfma_f32_16x16x32_bf16 v[104:107], a[84:87], v[188:191], v[104:107]
v_exp_f32 v135, v135
v_mfma_f32_16x16x32_bf16 v[104:107], a[80:83], v[172:175], v[104:107]
s_waitcnt lgkmcnt(4)
v_add_f32 v243, v243, v154
v_cvt_pk_bf16_f32 v194, v132, v133
v_mfma_f32_16x16x32_bf16 v[108:111], a[88:91], v[172:175], v[108:111]
s_add_u32 s42, s43, 0
v_exp_f32 v140, v140
s_add_u32 m0, s77, 0
v_mfma_f32_16x16x32_bf16 v[108:111], a[92:95], v[188:191], v[108:111]
L_m_c0_6:
s_cbranch_execz L_m_c0_10
ds_read_b128 a[80:83], v244 offset:12288
buffer_load_dwordx4 v251, s[88:91], s42 offen offset:0 nt lds
v_mfma_f32_16x16x32_bf16 v[76:79], a[92:95], v[184:187], v[76:79]
v_exp_f32 v141, v141
v_mfma_f32_16x16x32_bf16 v[76:79], a[88:91], v[168:171], v[76:79]
v_add_f32 v243, v243, v155
v_cvt_pk_bf16_f32 v195, v134, v135
v_mfma_f32_16x16x32_bf16 v[44:47], a[88:91], v[164:167], v[44:47]
v_exp_f32 v142, v142
v_mfma_f32_16x16x32_bf16 v[44:47], a[92:95], v[180:183], v[44:47]
ds_read_b128 a[84:87], v244 offset:12800
v_accvgpr_read_b32 v251, a129
v_mfma_f32_16x16x32_bf16 v[12:15], a[92:95], v[176:179], v[12:15]
v_exp_f32 v143, v143
v_mfma_f32_16x16x32_bf16 v[12:15], a[88:91], v[160:163], v[12:15]
s_waitcnt lgkmcnt(2)
v_add_f32 v241, v241, v140
v_cvt_pk_bf16_f32 v198, v140, v141
v_mfma_f32_16x16x32_bf16 v[128:131], a[64:67], a[0:3], v[224:227]
s_waitcnt vmcnt(12)
v_exp_f32 v148, v148
s_barrier
v_mfma_f32_16x16x32_bf16 v[128:131], a[68:71], a[4:7], v[128:131]
ds_read_b128 a[88:91], v244 offset:13312
buffer_store_dwordx4 a[140:143], v250, s[16:19], s79 offen offset:1024 sc1
v_mfma_f32_16x16x32_bf16 v[128:131], a[72:75], a[8:11], v[128:131]
s_add_u32 m0, s37, s31
v_exp_f32 v149, v149
v_mfma_f32_16x16x32_bf16 v[128:131], a[76:79], a[12:15], v[128:131]
v_add_f32 v241, v241, v141
v_cvt_pk_bf16_f32 v199, v142, v143
v_mfma_f32_16x16x32_bf16 v[136:139], a[76:79], a[28:31], v[228:231]
v_exp_f32 v150, v150
v_mfma_f32_16x16x32_bf16 v[136:139], a[72:75], a[24:27], v[136:139]
ds_read_b128 a[92:95], v244 offset:13824
global_load_lds_dwordx4 v248, s[4:5] offset:0
v_mfma_f32_16x16x32_bf16 v[136:139], a[68:71], a[20:23], v[136:139]
v_exp_f32 v151, v151
v_mfma_f32_16x16x32_bf16 v[136:139], a[64:67], a[16:19], v[136:139]
v_add_f32 v241, v241, v142
v_cvt_pk_bf16_f32 v202, v148, v149
v_mfma_f32_16x16x32_bf16 v[144:147], a[64:67], a[32:35], v[232:235]
v_exp_f32 v156, v156
v_mfma_f32_16x16x32_bf16 v[144:147], a[68:71], a[36:39], v[144:147]
global_load_lds_dwordx4 v248, s[6:7] offset:1024
v_mfma_f32_16x16x32_bf16 v[144:147], a[72:75], a[40:43], v[144:147]
v_exp_f32 v157, v157
v_mfma_f32_16x16x32_bf16 v[144:147], a[76:79], a[44:47], v[144:147]
v_add_f32 v241, v241, v143
v_cvt_pk_bf16_f32 v203, v150, v151
v_mfma_f32_16x16x32_bf16 v[152:155], a[76:79], a[60:63], v[236:239]
v_exp_f32 v158, v158
v_mfma_f32_16x16x32_bf16 v[152:155], a[72:75], a[56:59], v[152:155]
global_load_lds_dwordx4 v248, s[4:5] offset:2048
global_load_lds_dwordx4 v248, s[6:7] offset:3072
v_mfma_f32_16x16x32_bf16 v[152:155], a[68:71], a[52:55], v[152:155]
v_exp_f32 v159, v159
v_mfma_f32_16x16x32_bf16 v[152:155], a[64:67], a[48:51], v[152:155]
s_waitcnt lgkmcnt(0)
v_add_f32 v243, v243, v156
v_cvt_pk_bf16_f32 v206, v156, v157
v_mfma_f32_16x16x32_bf16 v[132:135], a[80:83], a[0:3], v[224:227]
v_exp_f32 v128, v128
v_mfma_f32_16x16x32_bf16 v[132:135], a[84:87], a[4:7], v[132:135]
ds_read_b64_tr_b16 a[96:97], v246 offset:1024
ds_read_b64_tr_b16 a[98:99], v246 offset:5120
v_mfma_f32_16x16x32_bf16 v[132:135], a[88:91], a[8:11], v[132:135]
v_exp_f32 v129, v129
v_mfma_f32_16x16x32_bf16 v[132:135], a[92:95], a[12:15], v[132:135]
v_add_f32 v243, v243, v157
v_cvt_pk_bf16_f32 v207, v158, v159
v_mfma_f32_16x16x32_bf16 v[140:143], a[92:95], a[28:31], v[228:231]
v_exp_f32 v130, v130
v_mfma_f32_16x16x32_bf16 v[140:143], a[88:91], a[24:27], v[140:143]
ds_read_b64_tr_b16 a[100:101], v246 offset:9216
ds_read_b64_tr_b16 a[102:103], v246 offset:13312
v_mfma_f32_16x16x32_bf16 v[140:143], a[84:87], a[20:23], v[140:143]
v_exp_f32 v131, v131
v_mfma_f32_16x16x32_bf16 v[140:143], a[80:83], a[16:19], v[140:143]
v_add_f32 v243, v243, v158
v_cvt_pk_bf16_f32 v208, v128, v129
v_mfma_f32_16x16x32_bf16 v[148:151], a[80:83], a[32:35], v[232:235]
s_mov_b32 s33, s35
v_exp_f32 v136, v136
s_add_u32 s35, s35, 16384
v_mfma_f32_16x16x32_bf16 v[148:151], a[84:87], a[36:39], v[148:151]
ds_read_b64_tr_b16 a[104:105], v249 offset:1024
ds_read_b64_tr_b16 a[106:107], v249 offset:5120
v_mfma_f32_16x16x32_bf16 v[148:151], a[88:91], a[40:43], v[148:151]
s_and_b32 s35, s35, 0xffff
v_exp_f32 v137, v137
v_mfma_f32_16x16x32_bf16 v[148:151], a[92:95], a[44:47], v[148:151]
v_add_f32 v243, v243, v159
v_cvt_pk_bf16_f32 v209, v130, v131
v_mfma_f32_16x16x32_bf16 v[156:159], a[92:95], a[60:63], v[236:239]
v_exp_f32 v138, v138
v_mfma_f32_16x16x32_bf16 v[156:159], a[88:91], a[56:59], v[156:159]
ds_read_b64_tr_b16 a[108:109], v249 offset:9216
ds_read_b64_tr_b16 a[110:111], v249 offset:13312
v_mfma_f32_16x16x32_bf16 v[156:159], a[84:87], a[52:55], v[156:159]
v_exp_f32 v139, v139
v_mfma_f32_16x16x32_bf16 v[156:159], a[80:83], a[48:51], v[156:159]
s_waitcnt lgkmcnt(4)
v_add_f32 v241, v241, v136
v_cvt_pk_bf16_f32 v212, v136, v137
v_mfma_f32_16x16x32_bf16 v[16:19], a[96:99], v[160:163], v[16:19]
v_exp_f32 v144, v144
v_mfma_f32_16x16x32_bf16 v[16:19], a[100:103], v[176:179], v[16:19]
ds_read_b64_tr_b16 a[80:81], v246 offset:1536
ds_read_b64_tr_b16 a[82:83], v246 offset:5632
v_mfma_f32_16x16x32_bf16 v[48:51], a[100:103], v[180:183], v[48:51]
v_exp_f32 v145, v145
v_mfma_f32_16x16x32_bf16 v[48:51], a[96:99], v[164:167], v[48:51]
v_add_f32 v241, v241, v137
v_cvt_pk_bf16_f32 v213, v138, v139
v_mfma_f32_16x16x32_bf16 v[80:83], a[96:99], v[168:171], v[80:83]
s_add_u32 s42, s43, 0
v_exp_f32 v146, v146
v_mfma_f32_16x16x32_bf16 v[80:83], a[100:103], v[184:187], v[80:83]
ds_read_b64_tr_b16 a[84:85], v246 offset:9728
ds_read_b64_tr_b16 a[86:87], v246 offset:13824
v_mfma_f32_16x16x32_bf16 v[112:115], a[100:103], v[188:191], v[112:115]
s_add_u32 m0, s77, 0
v_exp_f32 v147, v147
v_mfma_f32_16x16x32_bf16 v[112:115], a[96:99], v[172:175], v[112:115]
s_waitcnt lgkmcnt(4)
v_add_f32 v241, v241, v138
v_cvt_pk_bf16_f32 v216, v144, v145
v_mfma_f32_16x16x32_bf16 a[120:123], a[112:115], v[168:171], a[120:123]
buffer_load_dwordx4 v251, s[88:91], s42 offen offset:1024 nt lds
v_accvgpr_read_b32 v251, a130
v_mfma_f32_16x16x32_bf16 a[120:123], a[112:115], v[184:187], a[120:123]
v_add_u32 v244, s35, v245
v_mfma_f32_16x16x32_bf16 v[116:119], a[104:107], v[172:175], v[116:119]
s_add_u32 s4, s4, 16384
v_exp_f32 v152, v152
s_addc_u32 s5, s5, 0
v_mfma_f32_16x16x32_bf16 v[116:119], a[108:111], v[188:191], v[116:119]
ds_read_b64_tr_b16 a[88:89], v249 offset:1536
ds_read_b64_tr_b16 a[90:91], v249 offset:5632
v_mfma_f32_16x16x32_bf16 v[84:87], a[108:111], v[184:187], v[84:87]
s_add_u32 s6, s6, 16384
v_exp_f32 v153, v153
s_addc_u32 s7, s7, 0
v_mfma_f32_16x16x32_bf16 v[84:87], a[104:107], v[168:171], v[84:87]
v_add_f32 v241, v241, v139
v_cvt_pk_bf16_f32 v217, v146, v147
v_mfma_f32_16x16x32_bf16 v[52:55], a[104:107], v[164:167], v[52:55]
v_exp_f32 v154, v154
v_mfma_f32_16x16x32_bf16 v[52:55], a[108:111], v[180:183], v[52:55]
ds_read_b64_tr_b16 a[92:93], v249 offset:9728
ds_read_b64_tr_b16 a[94:95], v249 offset:13824
v_mfma_f32_16x16x32_bf16 v[20:23], a[108:111], v[176:179], v[20:23]
v_exp_f32 v155, v155
v_mfma_f32_16x16x32_bf16 v[20:23], a[104:107], v[160:163], v[20:23]
s_waitcnt lgkmcnt(4)
v_add_f32 v243, v243, v152
v_cvt_pk_bf16_f32 v220, v152, v153
v_mfma_f32_16x16x32_bf16 v[24:27], a[80:83], v[160:163], v[24:27]
v_exp_f32 v132, v132
v_mfma_f32_16x16x32_bf16 v[24:27], a[84:87], v[176:179], v[24:27]
ds_read_b128 a[64:67], v244 offset:0
ds_read_b128 a[68:71], v244 offset:512
v_mfma_f32_16x16x32_bf16 v[56:59], a[84:87], v[180:183], v[56:59]
v_exp_f32 v133, v133
v_mfma_f32_16x16x32_bf16 v[56:59], a[80:83], v[164:167], v[56:59]
v_add_f32 v243, v243, v153
v_cvt_pk_bf16_f32 v221, v154, v155
v_mfma_f32_16x16x32_bf16 v[88:91], a[80:83], v[168:171], v[88:91]
v_exp_f32 v134, v134
v_mfma_f32_16x16x32_bf16 v[88:91], a[84:87], v[184:187], v[88:91]
ds_read_b128 a[72:75], v244 offset:1024
ds_read_b128 a[76:79], v244 offset:1536
v_mfma_f32_16x16x32_bf16 v[120:123], a[84:87], v[188:191], v[120:123]
v_exp_f32 v135, v135
v_mfma_f32_16x16x32_bf16 v[120:123], a[80:83], v[172:175], v[120:123]
s_waitcnt lgkmcnt(4)
v_add_f32 v243, v243, v154
v_cvt_pk_bf16_f32 v210, v132, v133
v_mfma_f32_16x16x32_bf16 v[124:127], a[88:91], v[172:175], v[124:127]
v_exp_f32 v140, v140
v_mfma_f32_16x16x32_bf16 v[124:127], a[92:95], v[188:191], v[124:127]
ds_read_b128 a[80:83], v244 offset:4096
v_add_u32 v246, s33, v247
v_mfma_f32_16x16x32_bf16 v[92:95], a[92:95], v[184:187], v[92:95]
v_exp_f32 v141, v141
v_mfma_f32_16x16x32_bf16 v[92:95], a[88:91], v[168:171], v[92:95]
v_add_f32 v243, v243, v155
v_cvt_pk_bf16_f32 v211, v134, v135
v_mfma_f32_16x16x32_bf16 v[60:63], a[88:91], v[164:167], v[60:63]
v_exp_f32 v142, v142
v_mfma_f32_16x16x32_bf16 v[60:63], a[92:95], v[180:183], v[60:63]
ds_read_b128 a[84:87], v244 offset:4608
v_xor_b32 v249, 32, v246
v_mfma_f32_16x16x32_bf16 v[28:31], a[92:95], v[176:179], v[28:31]
v_exp_f32 v143, v143
v_mfma_f32_16x16x32_bf16 v[28:31], a[88:91], v[160:163], v[28:31]
s_waitcnt lgkmcnt(2)
v_add_f32 v241, v241, v140
v_cvt_pk_bf16_f32 v214, v140, v141
v_mfma_f32_16x16x32_bf16 v[128:131], a[64:67], a[0:3], v[224:227]
v_exp_f32 v148, v148
v_mfma_f32_16x16x32_bf16 v[128:131], a[68:71], a[4:7], v[128:131]
ds_read_b128 a[88:91], v244 offset:5120
buffer_store_dwordx4 a[144:147], v250, s[16:19], s79 offen offset:2048 sc1
v_mfma_f32_16x16x32_bf16 v[128:131], a[72:75], a[8:11], v[128:131]
s_add_u32 m0, s39, s31
v_exp_f32 v149, v149
v_mfma_f32_16x16x32_bf16 v[128:131], a[76:79], a[12:15], v[128:131]
v_add_f32 v241, v241, v141
v_cvt_pk_bf16_f32 v215, v142, v143
v_mfma_f32_16x16x32_bf16 v[136:139], a[76:79], a[28:31], v[228:231]
v_exp_f32 v150, v150
v_mfma_f32_16x16x32_bf16 v[136:139], a[72:75], a[24:27], v[136:139]
ds_read_b128 a[92:95], v244 offset:5632
global_load_lds_dwordx4 v248, s[8:9] offset:0
v_mfma_f32_16x16x32_bf16 v[136:139], a[68:71], a[20:23], v[136:139]
v_exp_f32 v151, v151
v_mfma_f32_16x16x32_bf16 v[136:139], a[64:67], a[16:19], v[136:139]
v_add_f32 v241, v241, v142
v_cvt_pk_bf16_f32 v218, v148, v149
v_mfma_f32_16x16x32_bf16 v[144:147], a[64:67], a[32:35], v[232:235]
v_exp_f32 v156, v156
v_mfma_f32_16x16x32_bf16 v[144:147], a[68:71], a[36:39], v[144:147]
global_load_lds_dwordx4 v248, s[10:11] offset:1024
v_mfma_f32_16x16x32_bf16 v[144:147], a[72:75], a[40:43], v[144:147]
v_exp_f32 v157, v157
v_mfma_f32_16x16x32_bf16 v[144:147], a[76:79], a[44:47], v[144:147]
v_add_f32 v241, v241, v143
v_cvt_pk_bf16_f32 v219, v150, v151
v_mfma_f32_16x16x32_bf16 v[152:155], a[76:79], a[60:63], v[236:239]
v_exp_f32 v158, v158
v_mfma_f32_16x16x32_bf16 v[152:155], a[72:75], a[56:59], v[152:155]
global_load_lds_dwordx4 v248, s[8:9] offset:2048
global_load_lds_dwordx4 v248, s[10:11] offset:3072
v_mfma_f32_16x16x32_bf16 v[152:155], a[68:71], a[52:55], v[152:155]
v_exp_f32 v159, v159
v_mfma_f32_16x16x32_bf16 v[152:155], a[64:67], a[48:51], v[152:155]
s_waitcnt lgkmcnt(0)
v_add_f32 v243, v243, v156
v_cvt_pk_bf16_f32 v222, v156, v157
v_mfma_f32_16x16x32_bf16 v[132:135], a[80:83], a[0:3], v[224:227]
v_exp_f32 v128, v128
v_mfma_f32_16x16x32_bf16 v[132:135], a[84:87], a[4:7], v[132:135]
ds_read_b64_tr_b16 a[96:97], v246 offset:0
ds_read_b64_tr_b16 a[98:99], v246 offset:4096
v_mfma_f32_16x16x32_bf16 v[132:135], a[88:91], a[8:11], v[132:135]
v_exp_f32 v129, v129
v_mfma_f32_16x16x32_bf16 v[132:135], a[92:95], a[12:15], v[132:135]
v_add_f32 v243, v243, v157
v_cvt_pk_bf16_f32 v223, v158, v159
v_mfma_f32_16x16x32_bf16 v[140:143], a[92:95], a[28:31], v[228:231]
v_exp_f32 v130, v130
v_mfma_f32_16x16x32_bf16 v[140:143], a[88:91], a[24:27], v[140:143]
ds_read_b64_tr_b16 a[100:101], v246 offset:8192
ds_read_b64_tr_b16 a[102:103], v246 offset:12288
v_mfma_f32_16x16x32_bf16 v[140:143], a[84:87], a[20:23], v[140:143]
v_exp_f32 v131, v131
v_mfma_f32_16x16x32_bf16 v[140:143], a[80:83], a[16:19], v[140:143]
v_add_f32 v243, v243, v158
v_cvt_pk_bf16_f32 v160, v128, v129
v_mfma_f32_16x16x32_bf16 v[148:151], a[80:83], a[32:35], v[232:235]
v_exp_f32 v136, v136
v_mfma_f32_16x16x32_bf16 v[148:151], a[84:87], a[36:39], v[148:151]
ds_read_b64_tr_b16 a[104:105], v249 offset:0
ds_read_b64_tr_b16 a[106:107], v249 offset:4096
v_mfma_f32_16x16x32_bf16 v[148:151], a[88:91], a[40:43], v[148:151]
v_exp_f32 v137, v137
v_mfma_f32_16x16x32_bf16 v[148:151], a[92:95], a[44:47], v[148:151]
v_add_f32 v243, v243, v159
v_cvt_pk_bf16_f32 v161, v130, v131
v_mfma_f32_16x16x32_bf16 v[156:159], a[92:95], a[60:63], v[236:239]
v_exp_f32 v138, v138
v_mfma_f32_16x16x32_bf16 v[156:159], a[88:91], a[56:59], v[156:159]
ds_read_b64_tr_b16 a[108:109], v249 offset:8192
ds_read_b64_tr_b16 a[110:111], v249 offset:12288
v_mfma_f32_16x16x32_bf16 v[156:159], a[84:87], a[52:55], v[156:159]
v_exp_f32 v139, v139
v_mfma_f32_16x16x32_bf16 v[156:159], a[80:83], a[48:51], v[156:159]
s_waitcnt lgkmcnt(4)
v_add_f32 v241, v241, v136
v_cvt_pk_bf16_f32 v164, v136, v137
v_mfma_f32_16x16x32_bf16 v[0:3], a[96:99], v[192:195], v[0:3]
s_add_u32 s39, s37, 65536
v_exp_f32 v144, v144
s_add_u32 s37, s37, 16384
v_mfma_f32_16x16x32_bf16 v[0:3], a[100:103], v[208:211], v[0:3]
ds_read_b64_tr_b16 a[80:81], v246 offset:512
ds_read_b64_tr_b16 a[82:83], v246 offset:4608
v_mfma_f32_16x16x32_bf16 v[32:35], a[100:103], v[212:215], v[32:35]
s_and_b32 s37, s37, 0xffff
v_exp_f32 v145, v145
v_mfma_f32_16x16x32_bf16 v[32:35], a[96:99], v[196:199], v[32:35]
v_add_f32 v241, v241, v137
v_cvt_pk_bf16_f32 v165, v138, v139
v_mfma_f32_16x16x32_bf16 v[64:67], a[96:99], v[200:203], v[64:67]
s_add_u32 s42, s43, 0
v_exp_f32 v146, v146
v_mfma_f32_16x16x32_bf16 v[64:67], a[100:103], v[216:219], v[64:67]
ds_read_b64_tr_b16 a[84:85], v246 offset:8704
ds_read_b64_tr_b16 a[86:87], v246 offset:12800
v_mfma_f32_16x16x32_bf16 v[96:99], a[100:103], v[220:223], v[96:99]
s_add_u32 m0, s77, 0
v_exp_f32 v147, v147
v_mfma_f32_16x16x32_bf16 v[96:99], a[96:99], v[204:207], v[96:99]
s_waitcnt lgkmcnt(4)
v_add_f32 v241, v241, v138
v_cvt_pk_bf16_f32 v168, v144, v145
v_mfma_f32_16x16x32_bf16 a[116:119], a[112:115], v[192:195], a[116:119]
buffer_load_dwordx4 v251, s[88:91], s42 offen offset:2048 nt lds
v_accvgpr_read_b32 v251, a131
v_mfma_f32_16x16x32_bf16 a[116:119], a[112:115], v[208:211], a[116:119]
v_mfma_f32_16x16x32_bf16 v[100:103], a[104:107], v[204:207], v[100:103]
s_add_u32 s8, s8, 16384
v_exp_f32 v152, v152
s_addc_u32 s9, s9, 0
v_mfma_f32_16x16x32_bf16 v[100:103], a[108:111], v[220:223], v[100:103]
ds_read_b64_tr_b16 a[88:89], v249 offset:512
ds_read_b64_tr_b16 a[90:91], v249 offset:4608
v_mfma_f32_16x16x32_bf16 v[68:71], a[108:111], v[216:219], v[68:71]
s_add_u32 s10, s10, 16384
v_exp_f32 v153, v153
s_addc_u32 s11, s11, 0
v_mfma_f32_16x16x32_bf16 v[68:71], a[104:107], v[200:203], v[68:71]
v_add_f32 v241, v241, v139
v_cvt_pk_bf16_f32 v169, v146, v147
v_mfma_f32_16x16x32_bf16 v[36:39], a[104:107], v[196:199], v[36:39]
v_exp_f32 v154, v154
v_mfma_f32_16x16x32_bf16 v[36:39], a[108:111], v[212:215], v[36:39]
ds_read_b64_tr_b16 a[92:93], v249 offset:8704
ds_read_b64_tr_b16 a[94:95], v249 offset:12800
v_mfma_f32_16x16x32_bf16 v[4:7], a[108:111], v[208:211], v[4:7]
v_exp_f32 v155, v155
v_mfma_f32_16x16x32_bf16 v[4:7], a[104:107], v[192:195], v[4:7]
s_waitcnt lgkmcnt(4)
v_add_f32 v243, v243, v152
v_cvt_pk_bf16_f32 v172, v152, v153
v_mfma_f32_16x16x32_bf16 v[8:11], a[80:83], v[192:195], v[8:11]
v_exp_f32 v132, v132
v_mfma_f32_16x16x32_bf16 v[8:11], a[84:87], v[208:211], v[8:11]
ds_read_b128 a[64:67], v244 offset:8192
ds_read_b128 a[68:71], v244 offset:8704
v_mfma_f32_16x16x32_bf16 v[40:43], a[84:87], v[212:215], v[40:43]
v_exp_f32 v133, v133
v_mfma_f32_16x16x32_bf16 v[40:43], a[80:83], v[196:199], v[40:43]
v_add_f32 v243, v243, v153
v_cvt_pk_bf16_f32 v173, v154, v155
v_mfma_f32_16x16x32_bf16 v[72:75], a[80:83], v[200:203], v[72:75]
v_exp_f32 v134, v134
v_mfma_f32_16x16x32_bf16 v[72:75], a[84:87], v[216:219], v[72:75]
ds_read_b128 a[72:75], v244 offset:9216
ds_read_b128 a[76:79], v244 offset:9728
v_mfma_f32_16x16x32_bf16 v[104:107], a[84:87], v[220:223], v[104:107]
v_exp_f32 v135, v135
v_mfma_f32_16x16x32_bf16 v[104:107], a[80:83], v[204:207], v[104:107]
s_waitcnt lgkmcnt(4)
v_add_f32 v243, v243, v154
v_cvt_pk_bf16_f32 v162, v132, v133
v_mfma_f32_16x16x32_bf16 v[108:111], a[88:91], v[204:207], v[108:111]
s_add_u32 s42, s43, 0
v_exp_f32 v140, v140
s_add_u32 m0, s77, 0
v_mfma_f32_16x16x32_bf16 v[108:111], a[92:95], v[220:223], v[108:111]
ds_read_b128 a[80:83], v244 offset:12288
buffer_load_dwordx4 v251, s[88:91], s42 offen offset:3072 nt lds
v_mfma_f32_16x16x32_bf16 v[76:79], a[92:95], v[216:219], v[76:79]
v_exp_f32 v141, v141
v_mfma_f32_16x16x32_bf16 v[76:79], a[88:91], v[200:203], v[76:79]
v_add_f32 v243, v243, v155
v_cvt_pk_bf16_f32 v163, v134, v135
v_mfma_f32_16x16x32_bf16 v[44:47], a[88:91], v[196:199], v[44:47]
v_exp_f32 v142, v142
v_mfma_f32_16x16x32_bf16 v[44:47], a[92:95], v[212:215], v[44:47]
ds_read_b128 a[84:87], v244 offset:12800
v_accvgpr_read_b32 v251, a132
v_mfma_f32_16x16x32_bf16 v[12:15], a[92:95], v[208:211], v[12:15]
v_exp_f32 v143, v143
v_mfma_f32_16x16x32_bf16 v[12:15], a[88:91], v[192:195], v[12:15]
s_waitcnt lgkmcnt(2)
v_add_f32 v241, v241, v140
v_cvt_pk_bf16_f32 v166, v140, v141
v_mfma_f32_16x16x32_bf16 v[128:131], a[64:67], a[0:3], v[224:227]
s_waitcnt vmcnt(14)
v_exp_f32 v148, v148
s_barrier
v_mfma_f32_16x16x32_bf16 v[128:131], a[68:71], a[4:7], v[128:131]
ds_read_b128 a[88:91], v244 offset:13312
buffer_store_dwordx4 a[148:151], v250, s[16:19], s79 offen offset:3072 sc1
v_mfma_f32_16x16x32_bf16 v[128:131], a[72:75], a[8:11], v[128:131]
s_add_u32 m0, s37, s31
v_exp_f32 v149, v149
v_mfma_f32_16x16x32_bf16 v[128:131], a[76:79], a[12:15], v[128:131]
v_add_f32 v241, v241, v141
v_cvt_pk_bf16_f32 v167, v142, v143
v_mfma_f32_16x16x32_bf16 v[136:139], a[76:79], a[28:31], v[228:231]
v_exp_f32 v150, v150
v_mfma_f32_16x16x32_bf16 v[136:139], a[72:75], a[24:27], v[136:139]
ds_read_b128 a[92:95], v244 offset:13824
global_load_lds_dwordx4 v248, s[4:5] offset:0
v_mfma_f32_16x16x32_bf16 v[136:139], a[68:71], a[20:23], v[136:139]
v_exp_f32 v151, v151
v_mfma_f32_16x16x32_bf16 v[136:139], a[64:67], a[16:19], v[136:139]
v_add_f32 v241, v241, v142
v_cvt_pk_bf16_f32 v170, v148, v149
v_mfma_f32_16x16x32_bf16 v[144:147], a[64:67], a[32:35], v[232:235]
v_exp_f32 v156, v156
v_mfma_f32_16x16x32_bf16 v[144:147], a[68:71], a[36:39], v[144:147]
global_load_lds_dwordx4 v248, s[6:7] offset:1024
v_mfma_f32_16x16x32_bf16 v[144:147], a[72:75], a[40:43], v[144:147]
v_exp_f32 v157, v157
v_mfma_f32_16x16x32_bf16 v[144:147], a[76:79], a[44:47], v[144:147]
v_add_f32 v241, v241, v143
v_cvt_pk_bf16_f32 v171, v150, v151
v_mfma_f32_16x16x32_bf16 v[152:155], a[76:79], a[60:63], v[236:239]
v_exp_f32 v158, v158
v_mfma_f32_16x16x32_bf16 v[152:155], a[72:75], a[56:59], v[152:155]
global_load_lds_dwordx4 v248, s[4:5] offset:2048
global_load_lds_dwordx4 v248, s[6:7] offset:3072
v_mfma_f32_16x16x32_bf16 v[152:155], a[68:71], a[52:55], v[152:155]
v_exp_f32 v159, v159
v_mfma_f32_16x16x32_bf16 v[152:155], a[64:67], a[48:51], v[152:155]
s_waitcnt lgkmcnt(0)
v_add_f32 v243, v243, v156
v_cvt_pk_bf16_f32 v174, v156, v157
v_mfma_f32_16x16x32_bf16 v[132:135], a[80:83], a[0:3], v[224:227]
v_exp_f32 v128, v128
v_mfma_f32_16x16x32_bf16 v[132:135], a[84:87], a[4:7], v[132:135]
ds_read_b64_tr_b16 a[96:97], v246 offset:1024
ds_read_b64_tr_b16 a[98:99], v246 offset:5120
v_mfma_f32_16x16x32_bf16 v[132:135], a[88:91], a[8:11], v[132:135]
v_exp_f32 v129, v129
v_mfma_f32_16x16x32_bf16 v[132:135], a[92:95], a[12:15], v[132:135]
v_add_f32 v243, v243, v157
v_cvt_pk_bf16_f32 v175, v158, v159
v_mfma_f32_16x16x32_bf16 v[140:143], a[92:95], a[28:31], v[228:231]
v_exp_f32 v130, v130
v_mfma_f32_16x16x32_bf16 v[140:143], a[88:91], a[24:27], v[140:143]
ds_read_b64_tr_b16 a[100:101], v246 offset:9216
ds_read_b64_tr_b16 a[102:103], v246 offset:13312
v_mfma_f32_16x16x32_bf16 v[140:143], a[84:87], a[20:23], v[140:143]
v_exp_f32 v131, v131
v_mfma_f32_16x16x32_bf16 v[140:143], a[80:83], a[16:19], v[140:143]
v_add_f32 v243, v243, v158
v_cvt_pk_bf16_f32 v176, v128, v129
v_mfma_f32_16x16x32_bf16 v[148:151], a[80:83], a[32:35], v[232:235]
s_mov_b32 s33, s35
v_exp_f32 v136, v136
s_add_u32 s35, s35, 16384
v_mfma_f32_16x16x32_bf16 v[148:151], a[84:87], a[36:39], v[148:151]
ds_read_b64_tr_b16 a[104:105], v249 offset:1024
ds_read_b64_tr_b16 a[106:107], v249 offset:5120
v_mfma_f32_16x16x32_bf16 v[148:151], a[88:91], a[40:43], v[148:151]
s_and_b32 s35, s35, 0xffff
v_exp_f32 v137, v137
v_mfma_f32_16x16x32_bf16 v[148:151], a[92:95], a[44:47], v[148:151]
v_add_f32 v243, v243, v159
v_cvt_pk_bf16_f32 v177, v130, v131
v_mfma_f32_16x16x32_bf16 v[156:159], a[92:95], a[60:63], v[236:239]
v_exp_f32 v138, v138
v_mfma_f32_16x16x32_bf16 v[156:159], a[88:91], a[56:59], v[156:159]
ds_read_b64_tr_b16 a[108:109], v249 offset:9216
ds_read_b64_tr_b16 a[110:111], v249 offset:13312
v_mfma_f32_16x16x32_bf16 v[156:159], a[84:87], a[52:55], v[156:159]
v_exp_f32 v139, v139
v_mfma_f32_16x16x32_bf16 v[156:159], a[80:83], a[48:51], v[156:159]
s_waitcnt lgkmcnt(4)
v_add_f32 v241, v241, v136
v_cvt_pk_bf16_f32 v180, v136, v137
v_mfma_f32_16x16x32_bf16 v[16:19], a[96:99], v[192:195], v[16:19]
v_exp_f32 v144, v144
v_mfma_f32_16x16x32_bf16 v[16:19], a[100:103], v[208:211], v[16:19]
ds_read_b64_tr_b16 a[80:81], v246 offset:1536
ds_read_b64_tr_b16 a[82:83], v246 offset:5632
v_mfma_f32_16x16x32_bf16 v[48:51], a[100:103], v[212:215], v[48:51]
v_exp_f32 v145, v145
v_mfma_f32_16x16x32_bf16 v[48:51], a[96:99], v[196:199], v[48:51]
v_add_f32 v241, v241, v137
v_cvt_pk_bf16_f32 v181, v138, v139
v_mfma_f32_16x16x32_bf16 v[80:83], a[96:99], v[200:203], v[80:83]
s_add_u32 s42, s43, 4096
v_exp_f32 v146, v146
v_mfma_f32_16x16x32_bf16 v[80:83], a[100:103], v[216:219], v[80:83]
ds_read_b64_tr_b16 a[84:85], v246 offset:9728
ds_read_b64_tr_b16 a[86:87], v246 offset:13824
v_mfma_f32_16x16x32_bf16 v[112:115], a[100:103], v[220:223], v[112:115]
s_add_u32 m0, s77, 4096
v_exp_f32 v147, v147
v_mfma_f32_16x16x32_bf16 v[112:115], a[96:99], v[204:207], v[112:115]
s_waitcnt lgkmcnt(4)
v_add_f32 v241, v241, v138
v_cvt_pk_bf16_f32 v184, v144, v145
v_mfma_f32_16x16x32_bf16 a[120:123], a[112:115], v[200:203], a[120:123]
buffer_load_dwordx4 v251, s[88:91], s42 offen offset:0 nt lds
v_add_u32 v244, s35, v245
v_mfma_f32_16x16x32_bf16 a[120:123], a[112:115], v[216:219], a[120:123]
v_mfma_f32_16x16x32_bf16 v[116:119], a[104:107], v[204:207], v[116:119]
s_add_u32 s4, s4, 16384
v_exp_f32 v152, v152
s_addc_u32 s5, s5, 0
v_mfma_f32_16x16x32_bf16 v[116:119], a[108:111], v[220:223], v[116:119]
ds_read_b64_tr_b16 a[88:89], v249 offset:1536
ds_read_b64_tr_b16 a[90:91], v249 offset:5632
v_mfma_f32_16x16x32_bf16 v[84:87], a[108:111], v[216:219], v[84:87]
s_add_u32 s6, s6, 16384
v_exp_f32 v153, v153
s_addc_u32 s7, s7, 0
v_mfma_f32_16x16x32_bf16 v[84:87], a[104:107], v[200:203], v[84:87]
v_add_f32 v241, v241, v139
v_cvt_pk_bf16_f32 v185, v146, v147
v_mfma_f32_16x16x32_bf16 v[52:55], a[104:107], v[196:199], v[52:55]
s_mov_b32 s20, s44
v_exp_f32 v154, v154
s_mov_b32 s21, s45
v_mfma_f32_16x16x32_bf16 v[52:55], a[108:111], v[212:215], v[52:55]
ds_read_b64_tr_b16 a[92:93], v249 offset:9728
ds_read_b64_tr_b16 a[94:95], v249 offset:13824
v_mfma_f32_16x16x32_bf16 v[20:23], a[108:111], v[208:211], v[20:23]
s_mov_b32 s22, 2621440
v_exp_f32 v155, v155
s_lshl_b32 s42, s72, 2
v_mfma_f32_16x16x32_bf16 v[20:23], a[104:107], v[192:195], v[20:23]
s_waitcnt lgkmcnt(4)
v_add_f32 v243, v243, v152
v_cvt_pk_bf16_f32 v188, v152, v153
v_mfma_f32_16x16x32_bf16 v[24:27], a[80:83], v[192:195], v[24:27]
s_add_u32 s42, s42, s28
v_exp_f32 v132, v132
s_mul_i32 s42, s42, 20480
v_mfma_f32_16x16x32_bf16 v[24:27], a[84:87], v[208:211], v[24:27]
ds_read_b128 a[64:67], v244 offset:0
ds_read_b128 a[68:71], v244 offset:512
v_mfma_f32_16x16x32_bf16 v[56:59], a[84:87], v[212:215], v[56:59]
s_mul_i32 s3, s73, 160
v_exp_f32 v133, v133
s_add_u32 s42, s42, s3
v_mfma_f32_16x16x32_bf16 v[56:59], a[80:83], v[196:199], v[56:59]
v_add_f32 v243, v243, v153
v_cvt_pk_bf16_f32 v189, v154, v155
v_mfma_f32_16x16x32_bf16 v[88:91], a[80:83], v[200:203], v[88:91]
v_exp_f32 v134, v134
v_mfma_f32_16x16x32_bf16 v[88:91], a[84:87], v[216:219], v[88:91]
ds_read_b128 a[72:75], v244 offset:1024
ds_read_b128 a[76:79], v244 offset:1536
v_mfma_f32_16x16x32_bf16 v[120:123], a[84:87], v[220:223], v[120:123]
v_exp_f32 v135, v135
v_mfma_f32_16x16x32_bf16 v[120:123], a[80:83], v[204:207], v[120:123]
s_waitcnt lgkmcnt(4)
v_add_f32 v243, v243, v154
v_cvt_pk_bf16_f32 v178, v132, v133
v_mfma_f32_16x16x32_bf16 v[124:127], a[88:91], v[204:207], v[124:127]
v_exp_f32 v140, v140
v_mfma_f32_16x16x32_bf16 v[124:127], a[92:95], v[220:223], v[124:127]
ds_read_b128 a[80:83], v244 offset:4096
v_add_u32 v246, s33, v247
v_mfma_f32_16x16x32_bf16 v[92:95], a[92:95], v[216:219], v[92:95]
v_exp_f32 v141, v141
v_mfma_f32_16x16x32_bf16 v[92:95], a[88:91], v[200:203], v[92:95]
v_add_f32 v243, v243, v155
v_cvt_pk_bf16_f32 v179, v134, v135
v_mfma_f32_16x16x32_bf16 v[60:63], a[88:91], v[196:199], v[60:63]
v_exp_f32 v142, v142
v_mfma_f32_16x16x32_bf16 v[60:63], a[92:95], v[212:215], v[60:63]
ds_read_b128 a[84:87], v244 offset:4608
v_xor_b32 v249, 32, v246
v_mfma_f32_16x16x32_bf16 v[28:31], a[92:95], v[208:211], v[28:31]
v_exp_f32 v143, v143
v_mfma_f32_16x16x32_bf16 v[28:31], a[88:91], v[192:195], v[28:31]
s_waitcnt lgkmcnt(2)
v_add_f32 v241, v241, v140
v_cvt_pk_bf16_f32 v182, v140, v141
v_mfma_f32_16x16x32_bf16 v[128:131], a[64:67], a[0:3], v[224:227]
v_exp_f32 v148, v148
v_mfma_f32_16x16x32_bf16 v[128:131], a[68:71], a[4:7], v[128:131]
ds_read_b128 a[88:91], v244 offset:5120
buffer_store_dwordx4 a[152:155], v250, s[16:19], s40 offen offset:0 sc1
v_mfma_f32_16x16x32_bf16 v[128:131], a[72:75], a[8:11], v[128:131]
s_add_u32 m0, s39, s31
v_exp_f32 v149, v149
v_mfma_f32_16x16x32_bf16 v[128:131], a[76:79], a[12:15], v[128:131]
v_add_f32 v241, v241, v141
v_cvt_pk_bf16_f32 v183, v142, v143
v_mfma_f32_16x16x32_bf16 v[136:139], a[76:79], a[28:31], v[228:231]
v_exp_f32 v150, v150
v_mfma_f32_16x16x32_bf16 v[136:139], a[72:75], a[24:27], v[136:139]
ds_read_b128 a[92:95], v244 offset:5632
global_load_lds_dwordx4 v248, s[8:9] offset:0
v_mfma_f32_16x16x32_bf16 v[136:139], a[68:71], a[20:23], v[136:139]
v_exp_f32 v151, v151
v_mfma_f32_16x16x32_bf16 v[136:139], a[64:67], a[16:19], v[136:139]
v_add_f32 v241, v241, v142
v_cvt_pk_bf16_f32 v186, v148, v149
v_mfma_f32_16x16x32_bf16 v[144:147], a[64:67], a[32:35], v[232:235]
v_exp_f32 v156, v156
v_mfma_f32_16x16x32_bf16 v[144:147], a[68:71], a[36:39], v[144:147]
global_load_lds_dwordx4 v248, s[10:11] offset:1024
v_accvgpr_read_b32 v251, a128
v_mfma_f32_16x16x32_bf16 v[144:147], a[72:75], a[40:43], v[144:147]
v_exp_f32 v157, v157
v_mfma_f32_16x16x32_bf16 v[144:147], a[76:79], a[44:47], v[144:147]
v_add_f32 v241, v241, v143
v_cvt_pk_bf16_f32 v187, v150, v151
v_mfma_f32_16x16x32_bf16 v[152:155], a[76:79], a[60:63], v[236:239]
v_exp_f32 v158, v158
v_mfma_f32_16x16x32_bf16 v[152:155], a[72:75], a[56:59], v[152:155]
global_load_lds_dwordx4 v248, s[8:9] offset:2048
global_load_lds_dwordx4 v248, s[10:11] offset:3072
v_mfma_f32_16x16x32_bf16 v[152:155], a[68:71], a[52:55], v[152:155]
v_exp_f32 v159, v159
v_mfma_f32_16x16x32_bf16 v[152:155], a[64:67], a[48:51], v[152:155]
s_waitcnt lgkmcnt(0)
v_add_f32 v243, v243, v156
v_cvt_pk_bf16_f32 v190, v156, v157
v_mfma_f32_16x16x32_bf16 v[132:135], a[80:83], a[0:3], v[224:227]
v_exp_f32 v128, v128
v_mfma_f32_16x16x32_bf16 v[132:135], a[84:87], a[4:7], v[132:135]
ds_read_b64_tr_b16 a[96:97], v246 offset:0
ds_read_b64_tr_b16 a[98:99], v246 offset:4096
v_mfma_f32_16x16x32_bf16 v[132:135], a[88:91], a[8:11], v[132:135]
L_m_c0_7:
s_cbranch_execz L_m_c0_ret
v_exp_f32 v129, v129
v_mfma_f32_16x16x32_bf16 v[132:135], a[92:95], a[12:15], v[132:135]
v_add_f32 v243, v243, v157
v_cvt_pk_bf16_f32 v191, v158, v159
v_mfma_f32_16x16x32_bf16 v[140:143], a[92:95], a[28:31], v[228:231]
v_exp_f32 v130, v130
v_mfma_f32_16x16x32_bf16 v[140:143], a[88:91], a[24:27], v[140:143]
ds_read_b64_tr_b16 a[100:101], v246 offset:8192
ds_read_b64_tr_b16 a[102:103], v246 offset:12288
v_mfma_f32_16x16x32_bf16 v[140:143], a[84:87], a[20:23], v[140:143]
v_exp_f32 v131, v131
v_mfma_f32_16x16x32_bf16 v[140:143], a[80:83], a[16:19], v[140:143]
v_add_f32 v243, v243, v158
v_cvt_pk_bf16_f32 v192, v128, v129
v_mfma_f32_16x16x32_bf16 v[148:151], a[80:83], a[32:35], v[232:235]
v_exp_f32 v136, v136
v_mfma_f32_16x16x32_bf16 v[148:151], a[84:87], a[36:39], v[148:151]
ds_read_b64_tr_b16 a[104:105], v249 offset:0
ds_read_b64_tr_b16 a[106:107], v249 offset:4096
v_mfma_f32_16x16x32_bf16 v[148:151], a[88:91], a[40:43], v[148:151]
v_exp_f32 v137, v137
v_mfma_f32_16x16x32_bf16 v[148:151], a[92:95], a[44:47], v[148:151]
v_add_f32 v243, v243, v159
v_cvt_pk_bf16_f32 v193, v130, v131
v_mfma_f32_16x16x32_bf16 v[156:159], a[92:95], a[60:63], v[236:239]
v_exp_f32 v138, v138
v_mfma_f32_16x16x32_bf16 v[156:159], a[88:91], a[56:59], v[156:159]
ds_read_b64_tr_b16 a[108:109], v249 offset:8192
ds_read_b64_tr_b16 a[110:111], v249 offset:12288
v_mfma_f32_16x16x32_bf16 v[156:159], a[84:87], a[52:55], v[156:159]
v_exp_f32 v139, v139
v_mfma_f32_16x16x32_bf16 v[156:159], a[80:83], a[48:51], v[156:159]
s_waitcnt lgkmcnt(4)
v_add_f32 v241, v241, v136
v_cvt_pk_bf16_f32 v196, v136, v137
v_mfma_f32_16x16x32_bf16 v[0:3], a[96:99], v[160:163], v[0:3]
s_add_u32 s39, s37, 65536
v_exp_f32 v144, v144
s_add_u32 s37, s37, 16384
v_mfma_f32_16x16x32_bf16 v[0:3], a[100:103], v[176:179], v[0:3]
ds_read_b64_tr_b16 a[80:81], v246 offset:512
ds_read_b64_tr_b16 a[82:83], v246 offset:4608
v_mfma_f32_16x16x32_bf16 v[32:35], a[100:103], v[180:183], v[32:35]
s_and_b32 s37, s37, 0xffff
v_exp_f32 v145, v145
v_mfma_f32_16x16x32_bf16 v[32:35], a[96:99], v[164:167], v[32:35]
v_add_f32 v241, v241, v137
v_cvt_pk_bf16_f32 v197, v138, v139
v_mfma_f32_16x16x32_bf16 v[64:67], a[96:99], v[168:171], v[64:67]
v_exp_f32 v146, v146
v_mfma_f32_16x16x32_bf16 v[64:67], a[100:103], v[184:187], v[64:67]
ds_read_b64_tr_b16 a[84:85], v246 offset:8704
ds_read_b64_tr_b16 a[86:87], v246 offset:12800
v_mfma_f32_16x16x32_bf16 v[96:99], a[100:103], v[188:191], v[96:99]
s_add_u32 m0, s77, 5120
v_exp_f32 v147, v147
v_mfma_f32_16x16x32_bf16 v[96:99], a[96:99], v[172:175], v[96:99]
s_waitcnt lgkmcnt(4)
v_add_f32 v241, v241, v138
v_cvt_pk_bf16_f32 v200, v144, v145
v_mfma_f32_16x16x32_bf16 a[116:119], a[112:115], v[160:163], a[116:119]
buffer_load_dwordx4 v251, s[20:23], s42 offen offset:0 nt lds
v_accvgpr_read_b32 v251, a129
v_mfma_f32_16x16x32_bf16 a[116:119], a[112:115], v[176:179], a[116:119]
v_mfma_f32_16x16x32_bf16 v[100:103], a[104:107], v[172:175], v[100:103]
s_add_u32 s8, s8, 16384
v_exp_f32 v152, v152
s_addc_u32 s9, s9, 0
v_mfma_f32_16x16x32_bf16 v[100:103], a[108:111], v[188:191], v[100:103]
ds_read_b64_tr_b16 a[88:89], v249 offset:512
ds_read_b64_tr_b16 a[90:91], v249 offset:4608
v_mfma_f32_16x16x32_bf16 v[68:71], a[108:111], v[184:187], v[68:71]
s_add_u32 s10, s10, 16384
v_exp_f32 v153, v153
s_addc_u32 s11, s11, 0
v_mfma_f32_16x16x32_bf16 v[68:71], a[104:107], v[168:171], v[68:71]
v_add_f32 v241, v241, v139
v_cvt_pk_bf16_f32 v201, v146, v147
v_mfma_f32_16x16x32_bf16 v[36:39], a[104:107], v[164:167], v[36:39]
v_exp_f32 v154, v154
v_mfma_f32_16x16x32_bf16 v[36:39], a[108:111], v[180:183], v[36:39]
ds_read_b64_tr_b16 a[92:93], v249 offset:8704
ds_read_b64_tr_b16 a[94:95], v249 offset:12800
v_mfma_f32_16x16x32_bf16 v[4:7], a[108:111], v[176:179], v[4:7]
v_exp_f32 v155, v155
v_mfma_f32_16x16x32_bf16 v[4:7], a[104:107], v[160:163], v[4:7]
s_waitcnt lgkmcnt(4)
v_add_f32 v243, v243, v152
v_cvt_pk_bf16_f32 v204, v152, v153
v_mfma_f32_16x16x32_bf16 v[8:11], a[80:83], v[160:163], v[8:11]
v_exp_f32 v132, v132
v_mfma_f32_16x16x32_bf16 v[8:11], a[84:87], v[176:179], v[8:11]
ds_read_b128 a[64:67], v244 offset:8192
ds_read_b128 a[68:71], v244 offset:8704
v_mfma_f32_16x16x32_bf16 v[40:43], a[84:87], v[180:183], v[40:43]
v_exp_f32 v133, v133
v_mfma_f32_16x16x32_bf16 v[40:43], a[80:83], v[164:167], v[40:43]
v_add_f32 v243, v243, v153
v_cvt_pk_bf16_f32 v205, v154, v155
v_mfma_f32_16x16x32_bf16 v[72:75], a[80:83], v[168:171], v[72:75]
v_exp_f32 v134, v134
v_mfma_f32_16x16x32_bf16 v[72:75], a[84:87], v[184:187], v[72:75]
ds_read_b128 a[72:75], v244 offset:9216
ds_read_b128 a[76:79], v244 offset:9728
v_mfma_f32_16x16x32_bf16 v[104:107], a[84:87], v[188:191], v[104:107]
v_exp_f32 v135, v135
v_mfma_f32_16x16x32_bf16 v[104:107], a[80:83], v[172:175], v[104:107]
s_waitcnt lgkmcnt(4)
v_add_f32 v243, v243, v154
v_cvt_pk_bf16_f32 v194, v132, v133
v_mfma_f32_16x16x32_bf16 v[108:111], a[88:91], v[172:175], v[108:111]
s_add_u32 m0, s77, 5120
v_exp_f32 v140, v140
v_mfma_f32_16x16x32_bf16 v[108:111], a[92:95], v[188:191], v[108:111]
ds_read_b128 a[80:83], v244 offset:12288
buffer_load_dwordx4 v251, s[20:23], s42 offen offset:1024 nt lds
v_mfma_f32_16x16x32_bf16 v[76:79], a[92:95], v[184:187], v[76:79]
v_exp_f32 v141, v141
v_mfma_f32_16x16x32_bf16 v[76:79], a[88:91], v[168:171], v[76:79]
v_add_f32 v243, v243, v155
v_cvt_pk_bf16_f32 v195, v134, v135
v_mfma_f32_16x16x32_bf16 v[44:47], a[88:91], v[164:167], v[44:47]
v_exp_f32 v142, v142
v_mfma_f32_16x16x32_bf16 v[44:47], a[92:95], v[180:183], v[44:47]
ds_read_b128 a[84:87], v244 offset:12800
v_accvgpr_read_b32 v251, a130
v_mfma_f32_16x16x32_bf16 v[12:15], a[92:95], v[176:179], v[12:15]
v_exp_f32 v143, v143
v_mfma_f32_16x16x32_bf16 v[12:15], a[88:91], v[160:163], v[12:15]
s_waitcnt lgkmcnt(2)
v_add_f32 v241, v241, v140
v_cvt_pk_bf16_f32 v198, v140, v141
v_mfma_f32_16x16x32_bf16 v[128:131], a[64:67], a[0:3], v[224:227]
s_waitcnt vmcnt(15)
v_exp_f32 v148, v148
s_barrier
v_mfma_f32_16x16x32_bf16 v[128:131], a[68:71], a[4:7], v[128:131]
ds_read_b128 a[88:91], v244 offset:13312
v_mfma_f32_16x16x32_bf16 v[128:131], a[72:75], a[8:11], v[128:131]
s_add_u32 m0, s37, s31
v_exp_f32 v149, v149
v_mfma_f32_16x16x32_bf16 v[128:131], a[76:79], a[12:15], v[128:131]
v_add_f32 v241, v241, v141
v_cvt_pk_bf16_f32 v199, v142, v143
v_mfma_f32_16x16x32_bf16 v[136:139], a[76:79], a[28:31], v[228:231]
v_exp_f32 v150, v150
v_mfma_f32_16x16x32_bf16 v[136:139], a[72:75], a[24:27], v[136:139]
ds_read_b128 a[92:95], v244 offset:13824
global_load_lds_dwordx4 v248, s[4:5] offset:0
v_mfma_f32_16x16x32_bf16 v[136:139], a[68:71], a[20:23], v[136:139]
v_exp_f32 v151, v151
v_mfma_f32_16x16x32_bf16 v[136:139], a[64:67], a[16:19], v[136:139]
v_add_f32 v241, v241, v142
v_cvt_pk_bf16_f32 v202, v148, v149
v_mfma_f32_16x16x32_bf16 v[144:147], a[64:67], a[32:35], v[232:235]
s_add_u32 s40, s76, 4096
v_exp_f32 v156, v156
v_mfma_f32_16x16x32_bf16 v[144:147], a[68:71], a[36:39], v[144:147]
global_load_lds_dwordx4 v248, s[6:7] offset:1024
buffer_store_dwordx4 a[124:127], v250, s[16:19], s40 offen offset:0 sc1
v_mfma_f32_16x16x32_bf16 v[144:147], a[72:75], a[40:43], v[144:147]
v_exp_f32 v157, v157
v_mfma_f32_16x16x32_bf16 v[144:147], a[76:79], a[44:47], v[144:147]
v_add_f32 v241, v241, v143
v_cvt_pk_bf16_f32 v203, v150, v151
v_mfma_f32_16x16x32_bf16 v[152:155], a[76:79], a[60:63], v[236:239]
v_exp_f32 v158, v158
v_mfma_f32_16x16x32_bf16 v[152:155], a[72:75], a[56:59], v[152:155]
global_load_lds_dwordx4 v248, s[4:5] offset:2048
global_load_lds_dwordx4 v248, s[6:7] offset:3072
v_mfma_f32_16x16x32_bf16 v[152:155], a[68:71], a[52:55], v[152:155]
v_exp_f32 v159, v159
v_mfma_f32_16x16x32_bf16 v[152:155], a[64:67], a[48:51], v[152:155]
s_waitcnt lgkmcnt(0)
v_add_f32 v243, v243, v156
v_cvt_pk_bf16_f32 v206, v156, v157
v_mfma_f32_16x16x32_bf16 v[132:135], a[80:83], a[0:3], v[224:227]
v_exp_f32 v128, v128
v_mfma_f32_16x16x32_bf16 v[132:135], a[84:87], a[4:7], v[132:135]
ds_read_b64_tr_b16 a[96:97], v246 offset:1024
ds_read_b64_tr_b16 a[98:99], v246 offset:5120
v_mfma_f32_16x16x32_bf16 v[132:135], a[88:91], a[8:11], v[132:135]
v_exp_f32 v129, v129
v_mfma_f32_16x16x32_bf16 v[132:135], a[92:95], a[12:15], v[132:135]
v_add_f32 v243, v243, v157
v_cvt_pk_bf16_f32 v207, v158, v159
v_mfma_f32_16x16x32_bf16 v[140:143], a[92:95], a[28:31], v[228:231]
s_add_u32 m0, s77, 5120
v_exp_f32 v130, v130
v_mfma_f32_16x16x32_bf16 v[140:143], a[88:91], a[24:27], v[140:143]
ds_read_b64_tr_b16 a[100:101], v246 offset:9216
ds_read_b64_tr_b16 a[102:103], v246 offset:13312
s_mov_b32 exec_hi, 0
buffer_load_dwordx4 v251, s[20:23], s42 offen offset:2048 nt lds
s_mov_b64 exec, -1
v_mfma_f32_16x16x32_bf16 v[140:143], a[84:87], a[20:23], v[140:143]
v_exp_f32 v131, v131
v_mfma_f32_16x16x32_bf16 v[140:143], a[80:83], a[16:19], v[140:143]
v_add_f32 v243, v243, v158
v_cvt_pk_bf16_f32 v208, v128, v129
v_mfma_f32_16x16x32_bf16 v[148:151], a[80:83], a[32:35], v[232:235]
s_mov_b32 s33, s35
v_exp_f32 v136, v136
s_add_u32 s35, s35, 16384
v_mfma_f32_16x16x32_bf16 v[148:151], a[84:87], a[36:39], v[148:151]
ds_read_b64_tr_b16 a[104:105], v249 offset:1024
ds_read_b64_tr_b16 a[106:107], v249 offset:5120
v_mfma_f32_16x16x32_bf16 v[148:151], a[88:91], a[40:43], v[148:151]
s_and_b32 s35, s35, 0xffff
v_exp_f32 v137, v137
v_mfma_f32_16x16x32_bf16 v[148:151], a[92:95], a[44:47], v[148:151]
v_add_f32 v243, v243, v159
v_cvt_pk_bf16_f32 v209, v130, v131
v_mfma_f32_16x16x32_bf16 v[156:159], a[92:95], a[60:63], v[236:239]
v_exp_f32 v138, v138
v_mfma_f32_16x16x32_bf16 v[156:159], a[88:91], a[56:59], v[156:159]
ds_read_b64_tr_b16 a[108:109], v249 offset:9216
ds_read_b64_tr_b16 a[110:111], v249 offset:13312
v_mfma_f32_16x16x32_bf16 v[156:159], a[84:87], a[52:55], v[156:159]
v_exp_f32 v139, v139
v_mfma_f32_16x16x32_bf16 v[156:159], a[80:83], a[48:51], v[156:159]
s_waitcnt lgkmcnt(4)
v_add_f32 v241, v241, v136
v_cvt_pk_bf16_f32 v212, v136, v137
v_mfma_f32_16x16x32_bf16 v[16:19], a[96:99], v[160:163], v[16:19]
v_exp_f32 v144, v144
v_mfma_f32_16x16x32_bf16 v[16:19], a[100:103], v[176:179], v[16:19]
ds_read_b64_tr_b16 a[80:81], v246 offset:1536
ds_read_b64_tr_b16 a[82:83], v246 offset:5632
v_mfma_f32_16x16x32_bf16 v[48:51], a[100:103], v[180:183], v[48:51]
v_exp_f32 v145, v145
v_mfma_f32_16x16x32_bf16 v[48:51], a[96:99], v[164:167], v[48:51]
v_add_f32 v241, v241, v137
v_cvt_pk_bf16_f32 v213, v138, v139
v_mfma_f32_16x16x32_bf16 v[80:83], a[96:99], v[168:171], v[80:83]
s_waitcnt vmcnt(13)
v_exp_f32 v146, v146
v_mfma_f32_16x16x32_bf16 v[80:83], a[100:103], v[184:187], v[80:83]
ds_read_b64_tr_b16 a[84:85], v246 offset:9728
ds_read_b64_tr_b16 a[86:87], v246 offset:13824
v_mfma_f32_16x16x32_bf16 v[112:115], a[100:103], v[188:191], v[112:115]
v_exp_f32 v147, v147
v_mfma_f32_16x16x32_bf16 v[112:115], a[96:99], v[172:175], v[112:115]
s_waitcnt lgkmcnt(4)
v_add_f32 v241, v241, v138
v_cvt_pk_bf16_f32 v216, v144, v145
v_mfma_f32_16x16x32_bf16 a[120:123], a[112:115], v[168:171], a[120:123]
ds_read_b64_tr_b16 a[136:137], v253 offset:0
ds_read_b64_tr_b16 a[138:139], v253 offset:2560
v_mfma_f32_16x16x32_bf16 a[120:123], a[112:115], v[184:187], a[120:123]
ds_read_b64_tr_b16 a[140:141], v253 offset:8
v_add_u32 v244, s35, v245
v_mfma_f32_16x16x32_bf16 v[116:119], a[104:107], v[172:175], v[116:119]
s_add_u32 s4, s4, 16384
v_exp_f32 v152, v152
s_addc_u32 s5, s5, 0
v_mfma_f32_16x16x32_bf16 v[116:119], a[108:111], v[188:191], v[116:119]
ds_read_b64_tr_b16 a[88:89], v249 offset:1536
ds_read_b64_tr_b16 a[90:91], v249 offset:5632
v_mfma_f32_16x16x32_bf16 v[84:87], a[108:111], v[184:187], v[84:87]
s_add_u32 s6, s6, 16384
v_exp_f32 v153, v153
s_addc_u32 s7, s7, 0
v_mfma_f32_16x16x32_bf16 v[84:87], a[104:107], v[168:171], v[84:87]
v_add_f32 v241, v241, v139
v_cvt_pk_bf16_f32 v217, v146, v147
v_mfma_f32_16x16x32_bf16 v[52:55], a[104:107], v[164:167], v[52:55]
v_exp_f32 v154, v154
v_mfma_f32_16x16x32_bf16 v[52:55], a[108:111], v[180:183], v[52:55]
ds_read_b64_tr_b16 a[92:93], v249 offset:9728
ds_read_b64_tr_b16 a[94:95], v249 offset:13824
v_mfma_f32_16x16x32_bf16 v[20:23], a[108:111], v[176:179], v[20:23]
v_exp_f32 v155, v155
v_mfma_f32_16x16x32_bf16 v[20:23], a[104:107], v[160:163], v[20:23]
s_waitcnt lgkmcnt(7)
v_add_f32 v243, v243, v152
v_cvt_pk_bf16_f32 v220, v152, v153
v_mfma_f32_16x16x32_bf16 v[24:27], a[80:83], v[160:163], v[24:27]
v_exp_f32 v132, v132
v_mfma_f32_16x16x32_bf16 v[24:27], a[84:87], v[176:179], v[24:27]
ds_read_b128 a[64:67], v244 offset:0
ds_read_b128 a[68:71], v244 offset:512
v_mfma_f32_16x16x32_bf16 v[56:59], a[84:87], v[180:183], v[56:59]
v_exp_f32 v133, v133
v_mfma_f32_16x16x32_bf16 v[56:59], a[80:83], v[164:167], v[56:59]
v_add_f32 v243, v243, v153
v_cvt_pk_bf16_f32 v221, v154, v155
v_mfma_f32_16x16x32_bf16 v[88:91], a[80:83], v[168:171], v[88:91]
v_exp_f32 v134, v134
v_mfma_f32_16x16x32_bf16 v[88:91], a[84:87], v[184:187], v[88:91]
ds_read_b128 a[72:75], v244 offset:1024
ds_read_b128 a[76:79], v244 offset:1536
v_mfma_f32_16x16x32_bf16 v[120:123], a[84:87], v[188:191], v[120:123]
v_exp_f32 v135, v135
v_mfma_f32_16x16x32_bf16 v[120:123], a[80:83], v[172:175], v[120:123]
s_waitcnt lgkmcnt(4)
v_add_f32 v243, v243, v154
v_cvt_pk_bf16_f32 v210, v132, v133
v_mfma_f32_16x16x32_bf16 v[124:127], a[88:91], v[172:175], v[124:127]
v_exp_f32 v140, v140
v_mfma_f32_16x16x32_bf16 v[124:127], a[92:95], v[188:191], v[124:127]
ds_read_b128 a[80:83], v244 offset:4096
v_add_u32 v246, s33, v247
v_mfma_f32_16x16x32_bf16 v[92:95], a[92:95], v[184:187], v[92:95]
v_exp_f32 v141, v141
v_mfma_f32_16x16x32_bf16 v[92:95], a[88:91], v[168:171], v[92:95]
v_add_f32 v243, v243, v155
v_cvt_pk_bf16_f32 v211, v134, v135
v_mfma_f32_16x16x32_bf16 v[60:63], a[88:91], v[164:167], v[60:63]
v_exp_f32 v142, v142
v_mfma_f32_16x16x32_bf16 v[60:63], a[92:95], v[180:183], v[60:63]
ds_read_b128 a[84:87], v244 offset:4608
v_xor_b32 v249, 32, v246
v_mfma_f32_16x16x32_bf16 v[28:31], a[92:95], v[176:179], v[28:31]
v_exp_f32 v143, v143
v_mfma_f32_16x16x32_bf16 v[28:31], a[88:91], v[160:163], v[28:31]
s_waitcnt lgkmcnt(2)
v_add_f32 v241, v241, v140
v_cvt_pk_bf16_f32 v214, v140, v141
v_mfma_f32_16x16x32_bf16 v[128:131], a[64:67], a[0:3], v[224:227]
v_exp_f32 v148, v148
v_mfma_f32_16x16x32_bf16 v[128:131], a[68:71], a[4:7], v[128:131]
ds_read_b128 a[88:91], v244 offset:5120
ds_read_b64_tr_b16 a[142:143], v253 offset:2568
v_mfma_f32_16x16x32_bf16 v[128:131], a[72:75], a[8:11], v[128:131]
s_add_u32 m0, s39, s31
v_exp_f32 v149, v149
v_mfma_f32_16x16x32_bf16 v[128:131], a[76:79], a[12:15], v[128:131]
v_add_f32 v241, v241, v141
v_cvt_pk_bf16_f32 v215, v142, v143
v_mfma_f32_16x16x32_bf16 v[136:139], a[76:79], a[28:31], v[228:231]
v_exp_f32 v150, v150
v_mfma_f32_16x16x32_bf16 v[136:139], a[72:75], a[24:27], v[136:139]
ds_read_b128 a[92:95], v244 offset:5632
global_load_lds_dwordx4 v248, s[8:9] offset:0
v_mfma_f32_16x16x32_bf16 v[136:139], a[68:71], a[20:23], v[136:139]
v_exp_f32 v151, v151
v_mfma_f32_16x16x32_bf16 v[136:139], a[64:67], a[16:19], v[136:139]
v_add_f32 v241, v241, v142
v_cvt_pk_bf16_f32 v218, v148, v149
v_mfma_f32_16x16x32_bf16 v[144:147], a[64:67], a[32:35], v[232:235]
v_exp_f32 v156, v156
v_mfma_f32_16x16x32_bf16 v[144:147], a[68:71], a[36:39], v[144:147]
global_load_lds_dwordx4 v248, s[10:11] offset:1024
ds_read_b64_tr_b16 a[144:145], v253 offset:16
v_mfma_f32_16x16x32_bf16 v[144:147], a[72:75], a[40:43], v[144:147]
v_exp_f32 v157, v157
v_mfma_f32_16x16x32_bf16 v[144:147], a[76:79], a[44:47], v[144:147]
v_add_f32 v241, v241, v143
v_cvt_pk_bf16_f32 v219, v150, v151
v_mfma_f32_16x16x32_bf16 v[152:155], a[76:79], a[60:63], v[236:239]
v_exp_f32 v158, v158
v_mfma_f32_16x16x32_bf16 v[152:155], a[72:75], a[56:59], v[152:155]
global_load_lds_dwordx4 v248, s[8:9] offset:2048
global_load_lds_dwordx4 v248, s[10:11] offset:3072
v_mfma_f32_16x16x32_bf16 v[152:155], a[68:71], a[52:55], v[152:155]
v_exp_f32 v159, v159
v_mfma_f32_16x16x32_bf16 v[152:155], a[64:67], a[48:51], v[152:155]
s_waitcnt lgkmcnt(1)
v_add_f32 v243, v243, v156
v_cvt_pk_bf16_f32 v222, v156, v157
v_mfma_f32_16x16x32_bf16 v[132:135], a[80:83], a[0:3], v[224:227]
v_exp_f32 v128, v128
v_mfma_f32_16x16x32_bf16 v[132:135], a[84:87], a[4:7], v[132:135]
ds_read_b64_tr_b16 a[96:97], v246 offset:0
ds_read_b64_tr_b16 a[98:99], v246 offset:4096
v_mfma_f32_16x16x32_bf16 v[132:135], a[88:91], a[8:11], v[132:135]
v_exp_f32 v129, v129
v_mfma_f32_16x16x32_bf16 v[132:135], a[92:95], a[12:15], v[132:135]
v_add_f32 v243, v243, v157
v_cvt_pk_bf16_f32 v223, v158, v159
v_mfma_f32_16x16x32_bf16 v[140:143], a[92:95], a[28:31], v[228:231]
v_exp_f32 v130, v130
v_mfma_f32_16x16x32_bf16 v[140:143], a[88:91], a[24:27], v[140:143]
ds_read_b64_tr_b16 a[100:101], v246 offset:8192
ds_read_b64_tr_b16 a[102:103], v246 offset:12288
v_mfma_f32_16x16x32_bf16 v[140:143], a[84:87], a[20:23], v[140:143]
v_exp_f32 v131, v131
v_mfma_f32_16x16x32_bf16 v[140:143], a[80:83], a[16:19], v[140:143]
v_add_f32 v243, v243, v158
v_cvt_pk_bf16_f32 v160, v128, v129
v_mfma_f32_16x16x32_bf16 v[148:151], a[80:83], a[32:35], v[232:235]
v_exp_f32 v136, v136
v_mfma_f32_16x16x32_bf16 v[148:151], a[84:87], a[36:39], v[148:151]
ds_read_b64_tr_b16 a[104:105], v249 offset:0
ds_read_b64_tr_b16 a[106:107], v249 offset:4096
v_mfma_f32_16x16x32_bf16 v[148:151], a[88:91], a[40:43], v[148:151]
v_exp_f32 v137, v137
v_mfma_f32_16x16x32_bf16 v[148:151], a[92:95], a[44:47], v[148:151]
v_add_f32 v243, v243, v159
v_cvt_pk_bf16_f32 v161, v130, v131
v_mfma_f32_16x16x32_bf16 v[156:159], a[92:95], a[60:63], v[236:239]
v_exp_f32 v138, v138
v_mfma_f32_16x16x32_bf16 v[156:159], a[88:91], a[56:59], v[156:159]
ds_read_b64_tr_b16 a[108:109], v249 offset:8192
ds_read_b64_tr_b16 a[110:111], v249 offset:12288
v_mfma_f32_16x16x32_bf16 v[156:159], a[84:87], a[52:55], v[156:159]
v_exp_f32 v139, v139
v_mfma_f32_16x16x32_bf16 v[156:159], a[80:83], a[48:51], v[156:159]
s_waitcnt lgkmcnt(4)
v_add_f32 v241, v241, v136
v_cvt_pk_bf16_f32 v164, v136, v137
v_mfma_f32_16x16x32_bf16 v[0:3], a[96:99], v[192:195], v[0:3]
s_add_u32 s39, s37, 65536
v_exp_f32 v144, v144
s_add_u32 s37, s37, 16384
v_mfma_f32_16x16x32_bf16 v[0:3], a[100:103], v[208:211], v[0:3]
ds_read_b64_tr_b16 a[80:81], v246 offset:512
ds_read_b64_tr_b16 a[82:83], v246 offset:4608
v_mfma_f32_16x16x32_bf16 v[32:35], a[100:103], v[212:215], v[32:35]
s_and_b32 s37, s37, 0xffff
v_exp_f32 v145, v145
v_mfma_f32_16x16x32_bf16 v[32:35], a[96:99], v[196:199], v[32:35]
v_add_f32 v241, v241, v137
v_cvt_pk_bf16_f32 v165, v138, v139
v_mfma_f32_16x16x32_bf16 v[64:67], a[96:99], v[200:203], v[64:67]
v_exp_f32 v146, v146
v_mfma_f32_16x16x32_bf16 v[64:67], a[100:103], v[216:219], v[64:67]
ds_read_b64_tr_b16 a[84:85], v246 offset:8704
ds_read_b64_tr_b16 a[86:87], v246 offset:12800
v_mfma_f32_16x16x32_bf16 v[96:99], a[100:103], v[220:223], v[96:99]
v_exp_f32 v147, v147
v_mfma_f32_16x16x32_bf16 v[96:99], a[96:99], v[204:207], v[96:99]
s_waitcnt lgkmcnt(4)
v_add_f32 v241, v241, v138
v_cvt_pk_bf16_f32 v168, v144, v145
v_mfma_f32_16x16x32_bf16 a[116:119], a[112:115], v[192:195], a[116:119]
ds_read_b64_tr_b16 a[146:147], v253 offset:2576
ds_read_b64_tr_b16 a[148:149], v253 offset:24
v_mfma_f32_16x16x32_bf16 a[116:119], a[112:115], v[208:211], a[116:119]
ds_read_b64_tr_b16 a[150:151], v253 offset:2584
ds_read_b64_tr_b16 a[152:153], v253 offset:32
v_mfma_f32_16x16x32_bf16 v[100:103], a[104:107], v[204:207], v[100:103]
s_add_u32 s8, s8, 16384
v_exp_f32 v152, v152
s_addc_u32 s9, s9, 0
v_mfma_f32_16x16x32_bf16 v[100:103], a[108:111], v[220:223], v[100:103]
ds_read_b64_tr_b16 a[88:89], v249 offset:512
ds_read_b64_tr_b16 a[90:91], v249 offset:4608
v_mfma_f32_16x16x32_bf16 v[68:71], a[108:111], v[216:219], v[68:71]
s_add_u32 s10, s10, 16384
v_exp_f32 v153, v153
s_addc_u32 s11, s11, 0
v_mfma_f32_16x16x32_bf16 v[68:71], a[104:107], v[200:203], v[68:71]
v_add_f32 v241, v241, v139
v_cvt_pk_bf16_f32 v169, v146, v147
v_mfma_f32_16x16x32_bf16 v[36:39], a[104:107], v[196:199], v[36:39]
v_exp_f32 v154, v154
v_mfma_f32_16x16x32_bf16 v[36:39], a[108:111], v[212:215], v[36:39]
ds_read_b64_tr_b16 a[92:93], v249 offset:8704
ds_read_b64_tr_b16 a[94:95], v249 offset:12800
ds_read_b64_tr_b16 a[154:155], v253 offset:2592
v_mfma_f32_16x16x32_bf16 v[4:7], a[108:111], v[208:211], v[4:7]
v_exp_f32 v155, v155
v_mfma_f32_16x16x32_bf16 v[4:7], a[104:107], v[192:195], v[4:7]
s_waitcnt lgkmcnt(9)
v_add_f32 v243, v243, v152
v_cvt_pk_bf16_f32 v172, v152, v153
v_mfma_f32_16x16x32_bf16 v[8:11], a[80:83], v[192:195], v[8:11]
v_exp_f32 v132, v132
v_mfma_f32_16x16x32_bf16 v[8:11], a[84:87], v[208:211], v[8:11]
ds_read_b128 a[64:67], v244 offset:8192
ds_read_b128 a[68:71], v244 offset:8704
v_mfma_f32_16x16x32_bf16 v[40:43], a[84:87], v[212:215], v[40:43]
v_exp_f32 v133, v133
v_mfma_f32_16x16x32_bf16 v[40:43], a[80:83], v[196:199], v[40:43]
v_add_f32 v243, v243, v153
v_cvt_pk_bf16_f32 v173, v154, v155
v_mfma_f32_16x16x32_bf16 v[72:75], a[80:83], v[200:203], v[72:75]
v_exp_f32 v134, v134
v_mfma_f32_16x16x32_bf16 v[72:75], a[84:87], v[216:219], v[72:75]
ds_read_b128 a[72:75], v244 offset:9216
ds_read_b128 a[76:79], v244 offset:9728
v_mfma_f32_16x16x32_bf16 v[104:107], a[84:87], v[220:223], v[104:107]
v_exp_f32 v135, v135
v_mfma_f32_16x16x32_bf16 v[104:107], a[80:83], v[204:207], v[104:107]
s_waitcnt lgkmcnt(5)
v_add_f32 v243, v243, v154
v_cvt_pk_bf16_f32 v162, v132, v133
v_mfma_f32_16x16x32_bf16 v[108:111], a[88:91], v[204:207], v[108:111]
s_waitcnt lgkmcnt(4)
v_exp_f32 v140, v140
s_add_u32 s40, s36, 4096
v_mfma_f32_16x16x32_bf16 v[108:111], a[92:95], v[220:223], v[108:111]
ds_read_b128 a[80:83], v244 offset:12288
buffer_store_dwordx4 a[136:139], v254, s[16:19], s36 offen offset:0 sc1
v_mfma_f32_16x16x32_bf16 v[76:79], a[92:95], v[216:219], v[76:79]
v_exp_f32 v141, v141
v_mfma_f32_16x16x32_bf16 v[76:79], a[88:91], v[200:203], v[76:79]
v_add_f32 v243, v243, v155
v_cvt_pk_bf16_f32 v163, v134, v135
v_mfma_f32_16x16x32_bf16 v[44:47], a[88:91], v[196:199], v[44:47]
v_exp_f32 v142, v142
v_mfma_f32_16x16x32_bf16 v[44:47], a[92:95], v[212:215], v[44:47]
ds_read_b128 a[84:87], v244 offset:12800
buffer_store_dwordx4 a[140:143], v254, s[16:19], s36 offen offset:1024 sc1
v_mfma_f32_16x16x32_bf16 v[12:15], a[92:95], v[208:211], v[12:15]
v_exp_f32 v143, v143
v_mfma_f32_16x16x32_bf16 v[12:15], a[88:91], v[192:195], v[12:15]
s_waitcnt lgkmcnt(2)
v_add_f32 v241, v241, v140
v_cvt_pk_bf16_f32 v166, v140, v141
v_mfma_f32_16x16x32_bf16 v[128:131], a[64:67], a[0:3], v[224:227]
s_waitcnt vmcnt(14)
v_exp_f32 v148, v148
s_barrier
v_mfma_f32_16x16x32_bf16 v[128:131], a[68:71], a[4:7], v[128:131]
ds_read_b128 a[88:91], v244 offset:13312
buffer_store_dwordx4 a[144:147], v254, s[16:19], s36 offen offset:2048 sc1
v_mfma_f32_16x16x32_bf16 v[128:131], a[72:75], a[8:11], v[128:131]
s_add_u32 m0, s37, s31
v_exp_f32 v149, v149
v_mfma_f32_16x16x32_bf16 v[128:131], a[76:79], a[12:15], v[128:131]
v_add_f32 v241, v241, v141
v_cvt_pk_bf16_f32 v167, v142, v143
v_mfma_f32_16x16x32_bf16 v[136:139], a[76:79], a[28:31], v[228:231]
v_exp_f32 v150, v150
v_mfma_f32_16x16x32_bf16 v[136:139], a[72:75], a[24:27], v[136:139]
ds_read_b128 a[92:95], v244 offset:13824
global_load_lds_dwordx4 v248, s[4:5] offset:0
v_mfma_f32_16x16x32_bf16 v[136:139], a[68:71], a[20:23], v[136:139]
v_exp_f32 v151, v151
v_mfma_f32_16x16x32_bf16 v[136:139], a[64:67], a[16:19], v[136:139]
v_add_f32 v241, v241, v142
v_cvt_pk_bf16_f32 v170, v148, v149
v_mfma_f32_16x16x32_bf16 v[144:147], a[64:67], a[32:35], v[232:235]
v_exp_f32 v156, v156
v_mfma_f32_16x16x32_bf16 v[144:147], a[68:71], a[36:39], v[144:147]
global_load_lds_dwordx4 v248, s[6:7] offset:1024
buffer_store_dwordx4 a[148:151], v254, s[16:19], s36 offen offset:3072 sc1
v_mfma_f32_16x16x32_bf16 v[144:147], a[72:75], a[40:43], v[144:147]
v_exp_f32 v157, v157
v_mfma_f32_16x16x32_bf16 v[144:147], a[76:79], a[44:47], v[144:147]
v_add_f32 v241, v241, v143
v_cvt_pk_bf16_f32 v171, v150, v151
v_mfma_f32_16x16x32_bf16 v[152:155], a[76:79], a[60:63], v[236:239]
v_exp_f32 v158, v158
v_mfma_f32_16x16x32_bf16 v[152:155], a[72:75], a[56:59], v[152:155]
global_load_lds_dwordx4 v248, s[4:5] offset:2048
global_load_lds_dwordx4 v248, s[6:7] offset:3072
v_mfma_f32_16x16x32_bf16 v[152:155], a[68:71], a[52:55], v[152:155]
v_exp_f32 v159, v159
v_mfma_f32_16x16x32_bf16 v[152:155], a[64:67], a[48:51], v[152:155]
s_waitcnt lgkmcnt(0)
v_add_f32 v243, v243, v156
v_cvt_pk_bf16_f32 v174, v156, v157
v_mfma_f32_16x16x32_bf16 v[132:135], a[80:83], a[0:3], v[224:227]
v_exp_f32 v128, v128
v_mfma_f32_16x16x32_bf16 v[132:135], a[84:87], a[4:7], v[132:135]
ds_read_b64_tr_b16 a[96:97], v246 offset:1024
ds_read_b64_tr_b16 a[98:99], v246 offset:5120
v_mfma_f32_16x16x32_bf16 v[132:135], a[88:91], a[8:11], v[132:135]
v_exp_f32 v129, v129
v_mfma_f32_16x16x32_bf16 v[132:135], a[92:95], a[12:15], v[132:135]
v_add_f32 v243, v243, v157
v_cvt_pk_bf16_f32 v175, v158, v159
v_mfma_f32_16x16x32_bf16 v[140:143], a[92:95], a[28:31], v[228:231]
v_exp_f32 v130, v130
v_mfma_f32_16x16x32_bf16 v[140:143], a[88:91], a[24:27], v[140:143]
ds_read_b64_tr_b16 a[100:101], v246 offset:9216
ds_read_b64_tr_b16 a[102:103], v246 offset:13312
v_mfma_f32_16x16x32_bf16 v[140:143], a[84:87], a[20:23], v[140:143]
v_exp_f32 v131, v131
v_mfma_f32_16x16x32_bf16 v[140:143], a[80:83], a[16:19], v[140:143]
v_add_f32 v243, v243, v158
v_cvt_pk_bf16_f32 v176, v128, v129
v_mfma_f32_16x16x32_bf16 v[148:151], a[80:83], a[32:35], v[232:235]
s_mov_b32 s33, s35
v_exp_f32 v136, v136
s_add_u32 s35, s35, 16384
v_mfma_f32_16x16x32_bf16 v[148:151], a[84:87], a[36:39], v[148:151]
ds_read_b64_tr_b16 a[104:105], v249 offset:1024
ds_read_b64_tr_b16 a[106:107], v249 offset:5120
v_mfma_f32_16x16x32_bf16 v[148:151], a[88:91], a[40:43], v[148:151]
s_and_b32 s35, s35, 0xffff
v_exp_f32 v137, v137
v_mfma_f32_16x16x32_bf16 v[148:151], a[92:95], a[44:47], v[148:151]
v_add_f32 v243, v243, v159
v_cvt_pk_bf16_f32 v177, v130, v131
v_mfma_f32_16x16x32_bf16 v[156:159], a[92:95], a[60:63], v[236:239]
v_exp_f32 v138, v138
v_mfma_f32_16x16x32_bf16 v[156:159], a[88:91], a[56:59], v[156:159]
ds_read_b64_tr_b16 a[108:109], v249 offset:9216
ds_read_b64_tr_b16 a[110:111], v249 offset:13312
v_mfma_f32_16x16x32_bf16 v[156:159], a[84:87], a[52:55], v[156:159]
v_exp_f32 v139, v139
v_mfma_f32_16x16x32_bf16 v[156:159], a[80:83], a[48:51], v[156:159]
s_waitcnt lgkmcnt(4)
v_add_f32 v241, v241, v136
v_cvt_pk_bf16_f32 v180, v136, v137
v_mfma_f32_16x16x32_bf16 v[16:19], a[96:99], v[192:195], v[16:19]
v_exp_f32 v144, v144
v_mfma_f32_16x16x32_bf16 v[16:19], a[100:103], v[208:211], v[16:19]
ds_read_b64_tr_b16 a[80:81], v246 offset:1536
ds_read_b64_tr_b16 a[82:83], v246 offset:5632
v_mfma_f32_16x16x32_bf16 v[48:51], a[100:103], v[212:215], v[48:51]
v_exp_f32 v145, v145
v_mfma_f32_16x16x32_bf16 v[48:51], a[96:99], v[196:199], v[48:51]
v_add_f32 v241, v241, v137
v_cvt_pk_bf16_f32 v181, v138, v139
v_mfma_f32_16x16x32_bf16 v[80:83], a[96:99], v[200:203], v[80:83]
v_exp_f32 v146, v146
v_mfma_f32_16x16x32_bf16 v[80:83], a[100:103], v[216:219], v[80:83]
ds_read_b64_tr_b16 a[84:85], v246 offset:9728
ds_read_b64_tr_b16 a[86:87], v246 offset:13824
v_mfma_f32_16x16x32_bf16 v[112:115], a[100:103], v[220:223], v[112:115]
v_exp_f32 v147, v147
v_mfma_f32_16x16x32_bf16 v[112:115], a[96:99], v[204:207], v[112:115]
s_waitcnt lgkmcnt(4)
v_add_f32 v241, v241, v138
v_cvt_pk_bf16_f32 v184, v144, v145
v_mfma_f32_16x16x32_bf16 a[120:123], a[112:115], v[200:203], a[120:123]
buffer_store_dwordx4 a[152:155], v254, s[16:19], s40 offen offset:0 sc1
v_mov_b32 v253, 1
v_mfma_f32_16x16x32_bf16 a[120:123], a[112:115], v[216:219], a[120:123]
L_m_c0_8:
s_cbranch_execz L_m_c0_ret
v_mov_b32 v252, s80
v_add_u32 v244, s35, v245
v_mfma_f32_16x16x32_bf16 v[116:119], a[104:107], v[204:207], v[116:119]
s_add_u32 s4, s4, 16384
v_exp_f32 v152, v152
s_addc_u32 s5, s5, 0
v_mfma_f32_16x16x32_bf16 v[116:119], a[108:111], v[220:223], v[116:119]
ds_read_b64_tr_b16 a[88:89], v249 offset:1536
ds_read_b64_tr_b16 a[90:91], v249 offset:5632
v_mfma_f32_16x16x32_bf16 v[84:87], a[108:111], v[216:219], v[84:87]
s_add_u32 s6, s6, 16384
v_exp_f32 v153, v153
s_addc_u32 s7, s7, 0
v_mfma_f32_16x16x32_bf16 v[84:87], a[104:107], v[200:203], v[84:87]
v_add_f32 v241, v241, v139
v_cvt_pk_bf16_f32 v185, v146, v147
v_mfma_f32_16x16x32_bf16 v[52:55], a[104:107], v[196:199], v[52:55]
s_bitcmp0_b32 s28, 0
v_exp_f32 v154, v154
s_cselect_b32 s12, s56, s58
s_cselect_b32 s13, s57, s59
v_mfma_f32_16x16x32_bf16 v[52:55], a[108:111], v[212:215], v[52:55]
ds_read_b64_tr_b16 a[92:93], v249 offset:9728
ds_read_b64_tr_b16 a[94:95], v249 offset:13824
v_mfma_f32_16x16x32_bf16 v[20:23], a[108:111], v[208:211], v[20:23]
s_cmp_lt_u32 s74, 27
v_exp_f32 v155, v155
s_cselect_b32 s14, 2211840, 0
v_mfma_f32_16x16x32_bf16 v[20:23], a[104:107], v[192:195], v[20:23]
s_waitcnt lgkmcnt(4)
v_add_f32 v243, v243, v152
v_cvt_pk_bf16_f32 v188, v152, v153
v_mfma_f32_16x16x32_bf16 v[24:27], a[80:83], v[192:195], v[24:27]
s_mov_b32 s88, s12
v_exp_f32 v132, v132
s_mov_b32 s89, s13
v_mfma_f32_16x16x32_bf16 v[24:27], a[84:87], v[208:211], v[24:27]
ds_read_b128 a[64:67], v244 offset:0
ds_read_b128 a[68:71], v244 offset:512
v_mfma_f32_16x16x32_bf16 v[56:59], a[84:87], v[212:215], v[56:59]
s_mov_b32 s90, s14
v_exp_f32 v133, v133
s_lshr_b32 s3, s28, 1
v_mfma_f32_16x16x32_bf16 v[56:59], a[80:83], v[196:199], v[56:59]
v_add_f32 v243, v243, v153
v_cvt_pk_bf16_f32 v189, v154, v155
v_mfma_f32_16x16x32_bf16 v[88:91], a[80:83], v[200:203], v[88:91]
s_lshl_b32 s42, s84, 1
v_exp_f32 v134, v134
s_add_u32 s42, s42, s3
v_mfma_f32_16x16x32_bf16 v[88:91], a[84:87], v[216:219], v[88:91]
ds_read_b128 a[72:75], v244 offset:1024
ds_read_b128 a[76:79], v244 offset:1536
v_mfma_f32_16x16x32_bf16 v[120:123], a[84:87], v[220:223], v[120:123]
s_mul_i32 s42, s42, 138240
v_exp_f32 v135, v135
s_lshl_b32 s3, s74, 7
v_mfma_f32_16x16x32_bf16 v[120:123], a[80:83], v[204:207], v[120:123]
s_waitcnt lgkmcnt(4)
v_add_f32 v243, v243, v154
v_cvt_pk_bf16_f32 v178, v132, v133
v_mfma_f32_16x16x32_bf16 v[124:127], a[88:91], v[204:207], v[124:127]
s_add_u32 s42, s42, s3
v_exp_f32 v140, v140
s_mov_b32 s41, 27648
v_mfma_f32_16x16x32_bf16 v[124:127], a[92:95], v[220:223], v[124:127]
ds_read_b128 a[80:83], v244 offset:4096
v_add_u32 v246, s33, v247
v_mfma_f32_16x16x32_bf16 v[92:95], a[92:95], v[216:219], v[92:95]
s_mov_b32 s43, 16
v_exp_f32 v141, v141
v_mfma_f32_16x16x32_bf16 v[92:95], a[88:91], v[200:203], v[92:95]
v_add_f32 v243, v243, v155
v_cvt_pk_bf16_f32 v179, v134, v135
v_mfma_f32_16x16x32_bf16 v[60:63], a[88:91], v[196:199], v[60:63]
v_exp_f32 v142, v142
v_mfma_f32_16x16x32_bf16 v[60:63], a[92:95], v[212:215], v[60:63]
ds_read_b128 a[84:87], v244 offset:4608
v_xor_b32 v249, 32, v246
v_mfma_f32_16x16x32_bf16 v[28:31], a[92:95], v[208:211], v[28:31]
v_exp_f32 v143, v143
v_mfma_f32_16x16x32_bf16 v[28:31], a[88:91], v[192:195], v[28:31]
s_waitcnt lgkmcnt(2)
v_add_f32 v241, v241, v140
v_cvt_pk_bf16_f32 v182, v140, v141
v_mfma_f32_16x16x32_bf16 v[128:131], a[64:67], a[0:3], v[224:227]
v_exp_f32 v148, v148
v_mfma_f32_16x16x32_bf16 v[128:131], a[68:71], a[4:7], v[128:131]
ds_read_b128 a[88:91], v244 offset:5120
v_mfma_f32_16x16x32_bf16 v[128:131], a[72:75], a[8:11], v[128:131]
s_add_u32 m0, s39, s31
v_exp_f32 v149, v149
v_mfma_f32_16x16x32_bf16 v[128:131], a[76:79], a[12:15], v[128:131]
v_add_f32 v241, v241, v141
v_cvt_pk_bf16_f32 v183, v142, v143
v_mfma_f32_16x16x32_bf16 v[136:139], a[76:79], a[28:31], v[228:231]
v_exp_f32 v150, v150
v_mfma_f32_16x16x32_bf16 v[136:139], a[72:75], a[24:27], v[136:139]
ds_read_b128 a[92:95], v244 offset:5632
global_load_lds_dwordx4 v248, s[8:9] offset:0
v_mfma_f32_16x16x32_bf16 v[136:139], a[68:71], a[20:23], v[136:139]
v_exp_f32 v151, v151
v_mfma_f32_16x16x32_bf16 v[136:139], a[64:67], a[16:19], v[136:139]
v_add_f32 v241, v241, v142
v_cvt_pk_bf16_f32 v186, v148, v149
v_mfma_f32_16x16x32_bf16 v[144:147], a[64:67], a[32:35], v[232:235]
v_exp_f32 v156, v156
v_mfma_f32_16x16x32_bf16 v[144:147], a[68:71], a[36:39], v[144:147]
global_load_lds_dwordx4 v248, s[10:11] offset:1024
v_min_u32 v251, 112, v250
v_mfma_f32_16x16x32_bf16 v[144:147], a[72:75], a[40:43], v[144:147]
v_exp_f32 v157, v157
v_mfma_f32_16x16x32_bf16 v[144:147], a[76:79], a[44:47], v[144:147]
v_add_f32 v241, v241, v143
v_cvt_pk_bf16_f32 v187, v150, v151
v_mfma_f32_16x16x32_bf16 v[152:155], a[76:79], a[60:63], v[236:239]
v_exp_f32 v158, v158
v_mfma_f32_16x16x32_bf16 v[152:155], a[72:75], a[56:59], v[152:155]
global_load_lds_dwordx4 v248, s[8:9] offset:2048
global_load_lds_dwordx4 v248, s[10:11] offset:3072
v_mfma_f32_16x16x32_bf16 v[152:155], a[68:71], a[52:55], v[152:155]
v_exp_f32 v159, v159
v_mfma_f32_16x16x32_bf16 v[152:155], a[64:67], a[48:51], v[152:155]
s_waitcnt lgkmcnt(0)
v_add_f32 v243, v243, v156
v_cvt_pk_bf16_f32 v190, v156, v157
v_mfma_f32_16x16x32_bf16 v[132:135], a[80:83], a[0:3], v[224:227]
v_exp_f32 v128, v128
v_mfma_f32_16x16x32_bf16 v[132:135], a[84:87], a[4:7], v[132:135]
ds_read_b64_tr_b16 a[96:97], v246 offset:0
ds_read_b64_tr_b16 a[98:99], v246 offset:4096
v_mfma_f32_16x16x32_bf16 v[132:135], a[88:91], a[8:11], v[132:135]
v_exp_f32 v129, v129
v_mfma_f32_16x16x32_bf16 v[132:135], a[92:95], a[12:15], v[132:135]
v_add_f32 v243, v243, v157
v_cvt_pk_bf16_f32 v191, v158, v159
v_mfma_f32_16x16x32_bf16 v[140:143], a[92:95], a[28:31], v[228:231]
v_exp_f32 v130, v130
v_mfma_f32_16x16x32_bf16 v[140:143], a[88:91], a[24:27], v[140:143]
ds_read_b64_tr_b16 a[100:101], v246 offset:8192
ds_read_b64_tr_b16 a[102:103], v246 offset:12288
v_mfma_f32_16x16x32_bf16 v[140:143], a[84:87], a[20:23], v[140:143]
v_exp_f32 v131, v131
v_mfma_f32_16x16x32_bf16 v[140:143], a[80:83], a[16:19], v[140:143]
v_add_f32 v243, v243, v158
v_cvt_pk_bf16_f32 v192, v128, v129
v_mfma_f32_16x16x32_bf16 v[148:151], a[80:83], a[32:35], v[232:235]
v_exp_f32 v136, v136
v_mfma_f32_16x16x32_bf16 v[148:151], a[84:87], a[36:39], v[148:151]
ds_read_b64_tr_b16 a[104:105], v249 offset:0
ds_read_b64_tr_b16 a[106:107], v249 offset:4096
v_mfma_f32_16x16x32_bf16 v[148:151], a[88:91], a[40:43], v[148:151]
v_exp_f32 v137, v137
v_mfma_f32_16x16x32_bf16 v[148:151], a[92:95], a[44:47], v[148:151]
v_add_f32 v243, v243, v159
v_cvt_pk_bf16_f32 v193, v130, v131
v_mfma_f32_16x16x32_bf16 v[156:159], a[92:95], a[60:63], v[236:239]
v_exp_f32 v138, v138
v_mfma_f32_16x16x32_bf16 v[156:159], a[88:91], a[56:59], v[156:159]
ds_read_b64_tr_b16 a[108:109], v249 offset:8192
ds_read_b64_tr_b16 a[110:111], v249 offset:12288
v_mfma_f32_16x16x32_bf16 v[156:159], a[84:87], a[52:55], v[156:159]
v_exp_f32 v139, v139
v_mfma_f32_16x16x32_bf16 v[156:159], a[80:83], a[48:51], v[156:159]
s_waitcnt lgkmcnt(4)
v_add_f32 v241, v241, v136
v_cvt_pk_bf16_f32 v196, v136, v137
v_mfma_f32_16x16x32_bf16 v[0:3], a[96:99], v[160:163], v[0:3]
s_add_u32 s39, s37, 65536
v_exp_f32 v144, v144
s_add_u32 s37, s37, 16384
v_mfma_f32_16x16x32_bf16 v[0:3], a[100:103], v[176:179], v[0:3]
ds_read_b64_tr_b16 a[80:81], v246 offset:512
ds_read_b64_tr_b16 a[82:83], v246 offset:4608
v_mfma_f32_16x16x32_bf16 v[32:35], a[100:103], v[180:183], v[32:35]
s_and_b32 s37, s37, 0xffff
v_exp_f32 v145, v145
v_mfma_f32_16x16x32_bf16 v[32:35], a[96:99], v[164:167], v[32:35]
v_add_f32 v241, v241, v137
v_cvt_pk_bf16_f32 v197, v138, v139
v_mfma_f32_16x16x32_bf16 v[64:67], a[96:99], v[168:171], v[64:67]
v_exp_f32 v146, v146
v_mfma_f32_16x16x32_bf16 v[64:67], a[100:103], v[184:187], v[64:67]
ds_read_b64_tr_b16 a[84:85], v246 offset:8704
ds_read_b64_tr_b16 a[86:87], v246 offset:12800
v_mfma_f32_16x16x32_bf16 v[96:99], a[100:103], v[188:191], v[96:99]
v_exp_f32 v147, v147
v_mfma_f32_16x16x32_bf16 v[96:99], a[96:99], v[172:175], v[96:99]
s_waitcnt lgkmcnt(4)
v_add_f32 v241, v241, v138
v_cvt_pk_bf16_f32 v200, v144, v145
v_mfma_f32_16x16x32_bf16 a[116:119], a[112:115], v[160:163], a[116:119]
v_mul_u32_u24 v251, 216, v251
v_mfma_f32_16x16x32_bf16 a[116:119], a[112:115], v[176:179], a[116:119]
v_mfma_f32_16x16x32_bf16 v[100:103], a[104:107], v[172:175], v[100:103]
s_add_u32 s8, s8, 16384
v_exp_f32 v152, v152
s_addc_u32 s9, s9, 0
v_mfma_f32_16x16x32_bf16 v[100:103], a[108:111], v[188:191], v[100:103]
ds_read_b64_tr_b16 a[88:89], v249 offset:512
ds_read_b64_tr_b16 a[90:91], v249 offset:4608
v_mfma_f32_16x16x32_bf16 v[68:71], a[108:111], v[184:187], v[68:71]
s_add_u32 s10, s10, 16384
v_exp_f32 v153, v153
s_addc_u32 s11, s11, 0
v_mfma_f32_16x16x32_bf16 v[68:71], a[104:107], v[168:171], v[68:71]
v_add_f32 v241, v241, v139
v_cvt_pk_bf16_f32 v201, v146, v147
v_mfma_f32_16x16x32_bf16 v[36:39], a[104:107], v[164:167], v[36:39]
v_exp_f32 v154, v154
v_mfma_f32_16x16x32_bf16 v[36:39], a[108:111], v[180:183], v[36:39]
ds_read_b64_tr_b16 a[92:93], v249 offset:8704
ds_read_b64_tr_b16 a[94:95], v249 offset:12800
v_mfma_f32_16x16x32_bf16 v[4:7], a[108:111], v[176:179], v[4:7]
v_exp_f32 v155, v155
v_mfma_f32_16x16x32_bf16 v[4:7], a[104:107], v[160:163], v[4:7]
s_waitcnt lgkmcnt(4)
v_add_f32 v243, v243, v152
v_cvt_pk_bf16_f32 v204, v152, v153
v_mfma_f32_16x16x32_bf16 v[8:11], a[80:83], v[160:163], v[8:11]
v_exp_f32 v132, v132
v_mfma_f32_16x16x32_bf16 v[8:11], a[84:87], v[176:179], v[8:11]
ds_read_b128 a[64:67], v244 offset:8192
ds_read_b128 a[68:71], v244 offset:8704
v_mfma_f32_16x16x32_bf16 v[40:43], a[84:87], v[180:183], v[40:43]
v_exp_f32 v133, v133
v_mfma_f32_16x16x32_bf16 v[40:43], a[80:83], v[164:167], v[40:43]
v_add_f32 v243, v243, v153
v_cvt_pk_bf16_f32 v205, v154, v155
v_mfma_f32_16x16x32_bf16 v[72:75], a[80:83], v[168:171], v[72:75]
v_exp_f32 v134, v134
v_mfma_f32_16x16x32_bf16 v[72:75], a[84:87], v[184:187], v[72:75]
ds_read_b128 a[72:75], v244 offset:9216
ds_read_b128 a[76:79], v244 offset:9728
v_mfma_f32_16x16x32_bf16 v[104:107], a[84:87], v[188:191], v[104:107]
v_exp_f32 v135, v135
v_mfma_f32_16x16x32_bf16 v[104:107], a[80:83], v[172:175], v[104:107]
s_waitcnt lgkmcnt(4)
v_add_f32 v243, v243, v154
v_cvt_pk_bf16_f32 v194, v132, v133
v_mfma_f32_16x16x32_bf16 v[108:111], a[88:91], v[172:175], v[108:111]
v_exp_f32 v140, v140
v_mfma_f32_16x16x32_bf16 v[108:111], a[92:95], v[188:191], v[108:111]
ds_read_b128 a[80:83], v244 offset:12288
v_mfma_f32_16x16x32_bf16 v[76:79], a[92:95], v[184:187], v[76:79]
v_exp_f32 v141, v141
v_mfma_f32_16x16x32_bf16 v[76:79], a[88:91], v[168:171], v[76:79]
v_add_f32 v243, v243, v155
v_cvt_pk_bf16_f32 v195, v134, v135
v_mfma_f32_16x16x32_bf16 v[44:47], a[88:91], v[164:167], v[44:47]
s_waitcnt vmcnt(4)
v_exp_f32 v142, v142
v_mfma_f32_16x16x32_bf16 v[44:47], a[92:95], v[180:183], v[44:47]
ds_read_b128 a[84:87], v244 offset:12800
v_mfma_f32_16x16x32_bf16 v[12:15], a[92:95], v[176:179], v[12:15]
v_exp_f32 v143, v143
v_mfma_f32_16x16x32_bf16 v[12:15], a[88:91], v[160:163], v[12:15]
s_waitcnt lgkmcnt(2)
v_add_f32 v241, v241, v140
v_cvt_pk_bf16_f32 v198, v140, v141
v_mfma_f32_16x16x32_bf16 v[128:131], a[64:67], a[0:3], v[224:227]
v_exp_f32 v148, v148
s_barrier
v_mfma_f32_16x16x32_bf16 v[128:131], a[68:71], a[4:7], v[128:131]
ds_read_b128 a[88:91], v244 offset:13312
v_mfma_f32_16x16x32_bf16 v[128:131], a[72:75], a[8:11], v[128:131]
s_add_u32 m0, s37, s31
v_exp_f32 v149, v149
v_mfma_f32_16x16x32_bf16 v[128:131], a[76:79], a[12:15], v[128:131]
v_add_f32 v241, v241, v141
v_cvt_pk_bf16_f32 v199, v142, v143
v_mfma_f32_16x16x32_bf16 v[136:139], a[76:79], a[28:31], v[228:231]
v_exp_f32 v150, v150
v_mfma_f32_16x16x32_bf16 v[136:139], a[72:75], a[24:27], v[136:139]
ds_read_b128 a[92:95], v244 offset:13824
global_load_lds_dwordx4 v248, s[4:5] offset:0
v_mfma_f32_16x16x32_bf16 v[136:139], a[68:71], a[20:23], v[136:139]
v_exp_f32 v151, v151
v_mfma_f32_16x16x32_bf16 v[136:139], a[64:67], a[16:19], v[136:139]
v_add_f32 v241, v241, v142
v_cvt_pk_bf16_f32 v202, v148, v149
v_mfma_f32_16x16x32_bf16 v[144:147], a[64:67], a[32:35], v[232:235]
v_exp_f32 v156, v156
v_mfma_f32_16x16x32_bf16 v[144:147], a[68:71], a[36:39], v[144:147]
global_load_lds_dwordx4 v248, s[6:7] offset:1024
s_mov_b64 exec, 1
buffer_atomic_add v253, v252, s[24:27], 0 offen sc1
s_mov_b64 exec, -1
v_mfma_f32_16x16x32_bf16 v[144:147], a[72:75], a[40:43], v[144:147]
v_exp_f32 v157, v157
v_mfma_f32_16x16x32_bf16 v[144:147], a[76:79], a[44:47], v[144:147]
v_add_f32 v241, v241, v143
v_cvt_pk_bf16_f32 v203, v150, v151
v_mfma_f32_16x16x32_bf16 v[152:155], a[76:79], a[60:63], v[236:239]
v_exp_f32 v158, v158
v_mfma_f32_16x16x32_bf16 v[152:155], a[72:75], a[56:59], v[152:155]
global_load_lds_dwordx4 v248, s[4:5] offset:2048
global_load_lds_dwordx4 v248, s[6:7] offset:3072
v_mfma_f32_16x16x32_bf16 v[152:155], a[68:71], a[52:55], v[152:155]
v_exp_f32 v159, v159
v_mfma_f32_16x16x32_bf16 v[152:155], a[64:67], a[48:51], v[152:155]
s_waitcnt lgkmcnt(0)
v_add_f32 v243, v243, v156
v_cvt_pk_bf16_f32 v206, v156, v157
v_mfma_f32_16x16x32_bf16 v[132:135], a[80:83], a[0:3], v[224:227]
v_exp_f32 v128, v128
v_mfma_f32_16x16x32_bf16 v[132:135], a[84:87], a[4:7], v[132:135]
ds_read_b64_tr_b16 a[96:97], v246 offset:1024
ds_read_b64_tr_b16 a[98:99], v246 offset:5120
v_mfma_f32_16x16x32_bf16 v[132:135], a[88:91], a[8:11], v[132:135]
v_exp_f32 v129, v129
v_mfma_f32_16x16x32_bf16 v[132:135], a[92:95], a[12:15], v[132:135]
v_add_f32 v243, v243, v157
v_cvt_pk_bf16_f32 v207, v158, v159
v_mfma_f32_16x16x32_bf16 v[140:143], a[92:95], a[28:31], v[228:231]
v_exp_f32 v130, v130
v_mfma_f32_16x16x32_bf16 v[140:143], a[88:91], a[24:27], v[140:143]
ds_read_b64_tr_b16 a[100:101], v246 offset:9216
ds_read_b64_tr_b16 a[102:103], v246 offset:13312
v_mfma_f32_16x16x32_bf16 v[140:143], a[84:87], a[20:23], v[140:143]
v_exp_f32 v131, v131
v_mfma_f32_16x16x32_bf16 v[140:143], a[80:83], a[16:19], v[140:143]
v_add_f32 v243, v243, v158
v_cvt_pk_bf16_f32 v208, v128, v129
v_mfma_f32_16x16x32_bf16 v[148:151], a[80:83], a[32:35], v[232:235]
s_mov_b32 s33, s35
v_exp_f32 v136, v136
s_add_u32 s35, s35, 16384
v_mfma_f32_16x16x32_bf16 v[148:151], a[84:87], a[36:39], v[148:151]
ds_read_b64_tr_b16 a[104:105], v249 offset:1024
ds_read_b64_tr_b16 a[106:107], v249 offset:5120
v_mfma_f32_16x16x32_bf16 v[148:151], a[88:91], a[40:43], v[148:151]
s_and_b32 s35, s35, 0xffff
v_exp_f32 v137, v137
v_mfma_f32_16x16x32_bf16 v[148:151], a[92:95], a[44:47], v[148:151]
v_add_f32 v243, v243, v159
v_cvt_pk_bf16_f32 v209, v130, v131
v_mfma_f32_16x16x32_bf16 v[156:159], a[92:95], a[60:63], v[236:239]
v_exp_f32 v138, v138
v_mfma_f32_16x16x32_bf16 v[156:159], a[88:91], a[56:59], v[156:159]
ds_read_b64_tr_b16 a[108:109], v249 offset:9216
ds_read_b64_tr_b16 a[110:111], v249 offset:13312
v_mfma_f32_16x16x32_bf16 v[156:159], a[84:87], a[52:55], v[156:159]
v_exp_f32 v139, v139
v_mfma_f32_16x16x32_bf16 v[156:159], a[80:83], a[48:51], v[156:159]
s_waitcnt lgkmcnt(4)
v_add_f32 v241, v241, v136
v_cvt_pk_bf16_f32 v212, v136, v137
v_mfma_f32_16x16x32_bf16 v[16:19], a[96:99], v[160:163], v[16:19]
v_exp_f32 v144, v144
v_mfma_f32_16x16x32_bf16 v[16:19], a[100:103], v[176:179], v[16:19]
ds_read_b64_tr_b16 a[80:81], v246 offset:1536
ds_read_b64_tr_b16 a[82:83], v246 offset:5632
v_mfma_f32_16x16x32_bf16 v[48:51], a[100:103], v[180:183], v[48:51]
v_exp_f32 v145, v145
v_mfma_f32_16x16x32_bf16 v[48:51], a[96:99], v[164:167], v[48:51]
v_add_f32 v241, v241, v137
v_cvt_pk_bf16_f32 v213, v138, v139
v_mfma_f32_16x16x32_bf16 v[80:83], a[96:99], v[168:171], v[80:83]
v_exp_f32 v146, v146
v_mfma_f32_16x16x32_bf16 v[80:83], a[100:103], v[184:187], v[80:83]
ds_read_b64_tr_b16 a[84:85], v246 offset:9728
ds_read_b64_tr_b16 a[86:87], v246 offset:13824
v_mfma_f32_16x16x32_bf16 v[112:115], a[100:103], v[188:191], v[112:115]
v_exp_f32 v147, v147
v_mfma_f32_16x16x32_bf16 v[112:115], a[96:99], v[172:175], v[112:115]
s_waitcnt lgkmcnt(4)
v_add_f32 v241, v241, v138
v_cvt_pk_bf16_f32 v216, v144, v145
v_mfma_f32_16x16x32_bf16 a[120:123], a[112:115], v[168:171], a[120:123]
v_add_u32 v244, s35, v245
v_mfma_f32_16x16x32_bf16 a[120:123], a[112:115], v[184:187], a[120:123]
v_mfma_f32_16x16x32_bf16 v[116:119], a[104:107], v[172:175], v[116:119]
s_add_u32 s4, s4, 16384
v_exp_f32 v152, v152
s_addc_u32 s5, s5, 0
v_mfma_f32_16x16x32_bf16 v[116:119], a[108:111], v[188:191], v[116:119]
ds_read_b64_tr_b16 a[88:89], v249 offset:1536
ds_read_b64_tr_b16 a[90:91], v249 offset:5632
v_mfma_f32_16x16x32_bf16 v[84:87], a[108:111], v[184:187], v[84:87]
s_add_u32 s6, s6, 16384
v_exp_f32 v153, v153
s_addc_u32 s7, s7, 0
v_mfma_f32_16x16x32_bf16 v[84:87], a[104:107], v[168:171], v[84:87]
v_add_f32 v241, v241, v139
v_cvt_pk_bf16_f32 v217, v146, v147
v_mfma_f32_16x16x32_bf16 v[52:55], a[104:107], v[164:167], v[52:55]
v_exp_f32 v154, v154
v_mfma_f32_16x16x32_bf16 v[52:55], a[108:111], v[180:183], v[52:55]
ds_read_b64_tr_b16 a[92:93], v249 offset:9728
ds_read_b64_tr_b16 a[94:95], v249 offset:13824
v_mfma_f32_16x16x32_bf16 v[20:23], a[108:111], v[176:179], v[20:23]
v_exp_f32 v155, v155
v_mfma_f32_16x16x32_bf16 v[20:23], a[104:107], v[160:163], v[20:23]
s_waitcnt lgkmcnt(4)
v_add_f32 v243, v243, v152
v_cvt_pk_bf16_f32 v220, v152, v153
v_mfma_f32_16x16x32_bf16 v[24:27], a[80:83], v[160:163], v[24:27]
v_exp_f32 v132, v132
v_mfma_f32_16x16x32_bf16 v[24:27], a[84:87], v[176:179], v[24:27]
ds_read_b128 a[64:67], v244 offset:0
ds_read_b128 a[68:71], v244 offset:512
v_mfma_f32_16x16x32_bf16 v[56:59], a[84:87], v[180:183], v[56:59]
v_exp_f32 v133, v133
v_mfma_f32_16x16x32_bf16 v[56:59], a[80:83], v[164:167], v[56:59]
v_add_f32 v243, v243, v153
v_cvt_pk_bf16_f32 v221, v154, v155
v_mfma_f32_16x16x32_bf16 v[88:91], a[80:83], v[168:171], v[88:91]
v_exp_f32 v134, v134
v_mfma_f32_16x16x32_bf16 v[88:91], a[84:87], v[184:187], v[88:91]
ds_read_b128 a[72:75], v244 offset:1024
ds_read_b128 a[76:79], v244 offset:1536
v_mfma_f32_16x16x32_bf16 v[120:123], a[84:87], v[188:191], v[120:123]
v_exp_f32 v135, v135
v_mfma_f32_16x16x32_bf16 v[120:123], a[80:83], v[172:175], v[120:123]
s_waitcnt lgkmcnt(4)
v_add_f32 v243, v243, v154
v_cvt_pk_bf16_f32 v210, v132, v133
v_mfma_f32_16x16x32_bf16 v[124:127], a[88:91], v[172:175], v[124:127]
v_exp_f32 v140, v140
v_mfma_f32_16x16x32_bf16 v[124:127], a[92:95], v[188:191], v[124:127]
ds_read_b128 a[80:83], v244 offset:4096
v_add_u32 v246, s33, v247
v_mfma_f32_16x16x32_bf16 v[92:95], a[92:95], v[184:187], v[92:95]
v_exp_f32 v141, v141
v_mfma_f32_16x16x32_bf16 v[92:95], a[88:91], v[168:171], v[92:95]
v_add_f32 v243, v243, v155
v_cvt_pk_bf16_f32 v211, v134, v135
v_mfma_f32_16x16x32_bf16 v[60:63], a[88:91], v[164:167], v[60:63]
v_exp_f32 v142, v142
v_mfma_f32_16x16x32_bf16 v[60:63], a[92:95], v[180:183], v[60:63]
ds_read_b128 a[84:87], v244 offset:4608
v_xor_b32 v249, 32, v246
v_mfma_f32_16x16x32_bf16 v[28:31], a[92:95], v[176:179], v[28:31]
v_exp_f32 v143, v143
v_mfma_f32_16x16x32_bf16 v[28:31], a[88:91], v[160:163], v[28:31]
s_waitcnt lgkmcnt(2)
v_add_f32 v241, v241, v140
v_cvt_pk_bf16_f32 v214, v140, v141
v_mfma_f32_16x16x32_bf16 v[128:131], a[64:67], a[0:3], v[224:227]
v_exp_f32 v148, v148
v_mfma_f32_16x16x32_bf16 v[128:131], a[68:71], a[4:7], v[128:131]
ds_read_b128 a[88:91], v244 offset:5120
v_mfma_f32_16x16x32_bf16 v[128:131], a[72:75], a[8:11], v[128:131]
s_add_u32 m0, s39, s31
v_exp_f32 v149, v149
v_mfma_f32_16x16x32_bf16 v[128:131], a[76:79], a[12:15], v[128:131]
v_add_f32 v241, v241, v141
v_cvt_pk_bf16_f32 v215, v142, v143
v_mfma_f32_16x16x32_bf16 v[136:139], a[76:79], a[28:31], v[228:231]
v_exp_f32 v150, v150
v_mfma_f32_16x16x32_bf16 v[136:139], a[72:75], a[24:27], v[136:139]
ds_read_b128 a[92:95], v244 offset:5632
global_load_lds_dwordx4 v248, s[8:9] offset:0
v_mfma_f32_16x16x32_bf16 v[136:139], a[68:71], a[20:23], v[136:139]
v_exp_f32 v151, v151
v_mfma_f32_16x16x32_bf16 v[136:139], a[64:67], a[16:19], v[136:139]
v_add_f32 v241, v241, v142
v_cvt_pk_bf16_f32 v218, v148, v149
v_mfma_f32_16x16x32_bf16 v[144:147], a[64:67], a[32:35], v[232:235]
v_exp_f32 v156, v156
v_mfma_f32_16x16x32_bf16 v[144:147], a[68:71], a[36:39], v[144:147]
global_load_lds_dwordx4 v248, s[10:11] offset:1024
v_mfma_f32_16x16x32_bf16 v[144:147], a[72:75], a[40:43], v[144:147]
v_exp_f32 v157, v157
v_mfma_f32_16x16x32_bf16 v[144:147], a[76:79], a[44:47], v[144:147]
v_add_f32 v241, v241, v143
v_cvt_pk_bf16_f32 v219, v150, v151
v_mfma_f32_16x16x32_bf16 v[152:155], a[76:79], a[60:63], v[236:239]
v_exp_f32 v158, v158
v_mfma_f32_16x16x32_bf16 v[152:155], a[72:75], a[56:59], v[152:155]
global_load_lds_dwordx4 v248, s[8:9] offset:2048
global_load_lds_dwordx4 v248, s[10:11] offset:3072
v_mfma_f32_16x16x32_bf16 v[152:155], a[68:71], a[52:55], v[152:155]
v_exp_f32 v159, v159
v_mfma_f32_16x16x32_bf16 v[152:155], a[64:67], a[48:51], v[152:155]
s_waitcnt lgkmcnt(0)
v_add_f32 v243, v243, v156
v_cvt_pk_bf16_f32 v222, v156, v157
v_mfma_f32_16x16x32_bf16 v[132:135], a[80:83], a[0:3], v[224:227]
v_exp_f32 v128, v128
v_mfma_f32_16x16x32_bf16 v[132:135], a[84:87], a[4:7], v[132:135]
ds_read_b64_tr_b16 a[96:97], v246 offset:0
ds_read_b64_tr_b16 a[98:99], v246 offset:4096
v_mfma_f32_16x16x32_bf16 v[132:135], a[88:91], a[8:11], v[132:135]
v_exp_f32 v129, v129
v_mfma_f32_16x16x32_bf16 v[132:135], a[92:95], a[12:15], v[132:135]
v_add_f32 v243, v243, v157
v_cvt_pk_bf16_f32 v223, v158, v159
v_mfma_f32_16x16x32_bf16 v[140:143], a[92:95], a[28:31], v[228:231]
v_exp_f32 v130, v130
v_mfma_f32_16x16x32_bf16 v[140:143], a[88:91], a[24:27], v[140:143]
ds_read_b64_tr_b16 a[100:101], v246 offset:8192
ds_read_b64_tr_b16 a[102:103], v246 offset:12288
v_mfma_f32_16x16x32_bf16 v[140:143], a[84:87], a[20:23], v[140:143]
v_exp_f32 v131, v131
v_mfma_f32_16x16x32_bf16 v[140:143], a[80:83], a[16:19], v[140:143]
v_add_f32 v243, v243, v158
v_cvt_pk_bf16_f32 v160, v128, v129
v_mfma_f32_16x16x32_bf16 v[148:151], a[80:83], a[32:35], v[232:235]
v_exp_f32 v136, v136
v_mfma_f32_16x16x32_bf16 v[148:151], a[84:87], a[36:39], v[148:151]
ds_read_b64_tr_b16 a[104:105], v249 offset:0
ds_read_b64_tr_b16 a[106:107], v249 offset:4096
v_mfma_f32_16x16x32_bf16 v[148:151], a[88:91], a[40:43], v[148:151]
v_exp_f32 v137, v137
v_mfma_f32_16x16x32_bf16 v[148:151], a[92:95], a[44:47], v[148:151]
v_add_f32 v243, v243, v159
v_cvt_pk_bf16_f32 v161, v130, v131
v_mfma_f32_16x16x32_bf16 v[156:159], a[92:95], a[60:63], v[236:239]
v_exp_f32 v138, v138
v_mfma_f32_16x16x32_bf16 v[156:159], a[88:91], a[56:59], v[156:159]
ds_read_b64_tr_b16 a[108:109], v249 offset:8192
ds_read_b64_tr_b16 a[110:111], v249 offset:12288
v_mfma_f32_16x16x32_bf16 v[156:159], a[84:87], a[52:55], v[156:159]
v_exp_f32 v139, v139
v_mfma_f32_16x16x32_bf16 v[156:159], a[80:83], a[48:51], v[156:159]
s_waitcnt lgkmcnt(4)
v_add_f32 v241, v241, v136
v_cvt_pk_bf16_f32 v164, v136, v137
v_mfma_f32_16x16x32_bf16 v[0:3], a[96:99], v[192:195], v[0:3]
s_add_u32 s39, s37, 65536
v_exp_f32 v144, v144
s_add_u32 s37, s37, 16384
v_mfma_f32_16x16x32_bf16 v[0:3], a[100:103], v[208:211], v[0:3]
ds_read_b64_tr_b16 a[80:81], v246 offset:512
ds_read_b64_tr_b16 a[82:83], v246 offset:4608
v_mfma_f32_16x16x32_bf16 v[32:35], a[100:103], v[212:215], v[32:35]
s_and_b32 s37, s37, 0xffff
v_exp_f32 v145, v145
v_mfma_f32_16x16x32_bf16 v[32:35], a[96:99], v[196:199], v[32:35]
v_add_f32 v241, v241, v137
v_cvt_pk_bf16_f32 v165, v138, v139
v_mfma_f32_16x16x32_bf16 v[64:67], a[96:99], v[200:203], v[64:67]
v_exp_f32 v146, v146
v_mfma_f32_16x16x32_bf16 v[64:67], a[100:103], v[216:219], v[64:67]
ds_read_b64_tr_b16 a[84:85], v246 offset:8704
ds_read_b64_tr_b16 a[86:87], v246 offset:12800
v_mfma_f32_16x16x32_bf16 v[96:99], a[100:103], v[220:223], v[96:99]
v_exp_f32 v147, v147
v_mfma_f32_16x16x32_bf16 v[96:99], a[96:99], v[204:207], v[96:99]
s_waitcnt lgkmcnt(4)
v_add_f32 v241, v241, v138
v_cvt_pk_bf16_f32 v168, v144, v145
v_mfma_f32_16x16x32_bf16 a[116:119], a[112:115], v[192:195], a[116:119]
buffer_load_dword a135, v251, s[88:91], s42 offen sc1
v_mfma_f32_16x16x32_bf16 a[116:119], a[112:115], v[208:211], a[116:119]
v_mfma_f32_16x16x32_bf16 v[100:103], a[104:107], v[204:207], v[100:103]
s_add_u32 s8, s8, 16384
v_exp_f32 v152, v152
s_addc_u32 s9, s9, 0
v_mfma_f32_16x16x32_bf16 v[100:103], a[108:111], v[220:223], v[100:103]
ds_read_b64_tr_b16 a[88:89], v249 offset:512
ds_read_b64_tr_b16 a[90:91], v249 offset:4608
v_mfma_f32_16x16x32_bf16 v[68:71], a[108:111], v[216:219], v[68:71]
s_add_u32 s10, s10, 16384
v_exp_f32 v153, v153
s_addc_u32 s11, s11, 0
v_mfma_f32_16x16x32_bf16 v[68:71], a[104:107], v[200:203], v[68:71]
v_add_f32 v241, v241, v139
v_cvt_pk_bf16_f32 v169, v146, v147
v_mfma_f32_16x16x32_bf16 v[36:39], a[104:107], v[196:199], v[36:39]
s_add_u32 s42, s42, s41
v_exp_f32 v154, v154
v_mfma_f32_16x16x32_bf16 v[36:39], a[108:111], v[212:215], v[36:39]
ds_read_b64_tr_b16 a[92:93], v249 offset:8704
ds_read_b64_tr_b16 a[94:95], v249 offset:12800
v_mfma_f32_16x16x32_bf16 v[4:7], a[108:111], v[208:211], v[4:7]
v_exp_f32 v155, v155
v_mfma_f32_16x16x32_bf16 v[4:7], a[104:107], v[192:195], v[4:7]
s_waitcnt lgkmcnt(4)
v_add_f32 v243, v243, v152
v_cvt_pk_bf16_f32 v172, v152, v153
v_mfma_f32_16x16x32_bf16 v[8:11], a[80:83], v[192:195], v[8:11]
v_exp_f32 v132, v132
v_mfma_f32_16x16x32_bf16 v[8:11], a[84:87], v[208:211], v[8:11]
ds_read_b128 a[64:67], v244 offset:8192
ds_read_b128 a[68:71], v244 offset:8704
v_mfma_f32_16x16x32_bf16 v[40:43], a[84:87], v[212:215], v[40:43]
v_exp_f32 v133, v133
v_mfma_f32_16x16x32_bf16 v[40:43], a[80:83], v[196:199], v[40:43]
v_add_f32 v243, v243, v153
v_cvt_pk_bf16_f32 v173, v154, v155
v_mfma_f32_16x16x32_bf16 v[72:75], a[80:83], v[200:203], v[72:75]
v_exp_f32 v134, v134
v_mfma_f32_16x16x32_bf16 v[72:75], a[84:87], v[216:219], v[72:75]
ds_read_b128 a[72:75], v244 offset:9216
ds_read_b128 a[76:79], v244 offset:9728
v_mfma_f32_16x16x32_bf16 v[104:107], a[84:87], v[220:223], v[104:107]
v_exp_f32 v135, v135
v_mfma_f32_16x16x32_bf16 v[104:107], a[80:83], v[204:207], v[104:107]
s_waitcnt lgkmcnt(4)
v_add_f32 v243, v243, v154
v_cvt_pk_bf16_f32 v162, v132, v133
v_mfma_f32_16x16x32_bf16 v[108:111], a[88:91], v[204:207], v[108:111]
v_exp_f32 v140, v140
v_mfma_f32_16x16x32_bf16 v[108:111], a[92:95], v[220:223], v[108:111]
ds_read_b128 a[80:83], v244 offset:12288
v_mfma_f32_16x16x32_bf16 v[76:79], a[92:95], v[216:219], v[76:79]
v_exp_f32 v141, v141
v_mfma_f32_16x16x32_bf16 v[76:79], a[88:91], v[200:203], v[76:79]
v_add_f32 v243, v243, v155
v_cvt_pk_bf16_f32 v163, v134, v135
v_mfma_f32_16x16x32_bf16 v[44:47], a[88:91], v[196:199], v[44:47]
v_exp_f32 v142, v142
v_mfma_f32_16x16x32_bf16 v[44:47], a[92:95], v[212:215], v[44:47]
ds_read_b128 a[84:87], v244 offset:12800
v_mfma_f32_16x16x32_bf16 v[12:15], a[92:95], v[208:211], v[12:15]
v_exp_f32 v143, v143
v_mfma_f32_16x16x32_bf16 v[12:15], a[88:91], v[192:195], v[12:15]
s_waitcnt lgkmcnt(2)
v_add_f32 v241, v241, v140
v_cvt_pk_bf16_f32 v166, v140, v141
.p2align 6
L_m_loop:
v_mfma_f32_16x16x32_bf16 v[128:131], a[64:67], a[0:3], v[224:227]
L_m_c0_9:
s_cbranch_execz L_m_c0_ret
s_waitcnt vmcnt(10)
v_exp_f32 v148, v148
s_barrier
v_mfma_f32_16x16x32_bf16 v[128:131], a[68:71], a[4:7], v[128:131]
ds_read_b128 a[88:91], v244 offset:13312
v_mfma_f32_16x16x32_bf16 v[128:131], a[72:75], a[8:11], v[128:131]
s_add_u32 m0, s37, s31
v_exp_f32 v149, v149
v_mfma_f32_16x16x32_bf16 v[128:131], a[76:79], a[12:15], v[128:131]
v_add_f32 v241, v241, v141
v_cvt_pk_bf16_f32 v167, v142, v143
v_mfma_f32_16x16x32_bf16 v[136:139], a[76:79], a[28:31], v[228:231]
v_exp_f32 v150, v150
v_mfma_f32_16x16x32_bf16 v[136:139], a[72:75], a[24:27], v[136:139]
ds_read_b128 a[92:95], v244 offset:13824
global_load_lds_dwordx4 v248, s[4:5] offset:0
v_mfma_f32_16x16x32_bf16 v[136:139], a[68:71], a[20:23], v[136:139]
v_exp_f32 v151, v151
v_mfma_f32_16x16x32_bf16 v[136:139], a[64:67], a[16:19], v[136:139]
v_add_f32 v241, v241, v142
v_cvt_pk_bf16_f32 v170, v148, v149
v_mfma_f32_16x16x32_bf16 v[144:147], a[64:67], a[32:35], v[232:235]
v_exp_f32 v156, v156
v_mfma_f32_16x16x32_bf16 v[144:147], a[68:71], a[36:39], v[144:147]
global_load_lds_dwordx4 v248, s[6:7] offset:1024
v_mfma_f32_16x16x32_bf16 v[144:147], a[72:75], a[40:43], v[144:147]
v_exp_f32 v157, v157
v_mfma_f32_16x16x32_bf16 v[144:147], a[76:79], a[44:47], v[144:147]
v_add_f32 v241, v241, v143
v_cvt_pk_bf16_f32 v171, v150, v151
v_mfma_f32_16x16x32_bf16 v[152:155], a[76:79], a[60:63], v[236:239]
v_exp_f32 v158, v158
v_mfma_f32_16x16x32_bf16 v[152:155], a[72:75], a[56:59], v[152:155]
global_load_lds_dwordx4 v248, s[4:5] offset:2048
global_load_lds_dwordx4 v248, s[6:7] offset:3072
v_mfma_f32_16x16x32_bf16 v[152:155], a[68:71], a[52:55], v[152:155]
v_exp_f32 v159, v159
v_mfma_f32_16x16x32_bf16 v[152:155], a[64:67], a[48:51], v[152:155]
s_waitcnt lgkmcnt(0)
v_add_f32 v243, v243, v156
v_cvt_pk_bf16_f32 v174, v156, v157
v_mfma_f32_16x16x32_bf16 v[132:135], a[80:83], a[0:3], v[224:227]
v_exp_f32 v128, v128
v_mfma_f32_16x16x32_bf16 v[132:135], a[84:87], a[4:7], v[132:135]
ds_read_b64_tr_b16 a[96:97], v246 offset:1024
ds_read_b64_tr_b16 a[98:99], v246 offset:5120
v_mfma_f32_16x16x32_bf16 v[132:135], a[88:91], a[8:11], v[132:135]
v_exp_f32 v129, v129
v_mfma_f32_16x16x32_bf16 v[132:135], a[92:95], a[12:15], v[132:135]
v_add_f32 v243, v243, v157
v_cvt_pk_bf16_f32 v175, v158, v159
v_mfma_f32_16x16x32_bf16 v[140:143], a[92:95], a[28:31], v[228:231]
v_exp_f32 v130, v130
v_mfma_f32_16x16x32_bf16 v[140:143], a[88:91], a[24:27], v[140:143]
ds_read_b64_tr_b16 a[100:101], v246 offset:9216
ds_read_b64_tr_b16 a[102:103], v246 offset:13312
v_mfma_f32_16x16x32_bf16 v[140:143], a[84:87], a[20:23], v[140:143]
v_exp_f32 v131, v131
v_mfma_f32_16x16x32_bf16 v[140:143], a[80:83], a[16:19], v[140:143]
v_add_f32 v243, v243, v158
v_cvt_pk_bf16_f32 v176, v128, v129
v_mfma_f32_16x16x32_bf16 v[148:151], a[80:83], a[32:35], v[232:235]
s_mov_b32 s33, s35
v_exp_f32 v136, v136
s_add_u32 s35, s35, 16384
v_mfma_f32_16x16x32_bf16 v[148:151], a[84:87], a[36:39], v[148:151]
ds_read_b64_tr_b16 a[104:105], v249 offset:1024
ds_read_b64_tr_b16 a[106:107], v249 offset:5120
v_mfma_f32_16x16x32_bf16 v[148:151], a[88:91], a[40:43], v[148:151]
s_and_b32 s35, s35, 0xffff
v_exp_f32 v137, v137
v_mfma_f32_16x16x32_bf16 v[148:151], a[92:95], a[44:47], v[148:151]
v_add_f32 v243, v243, v159
v_cvt_pk_bf16_f32 v177, v130, v131
v_mfma_f32_16x16x32_bf16 v[156:159], a[92:95], a[60:63], v[236:239]
v_exp_f32 v138, v138
v_mfma_f32_16x16x32_bf16 v[156:159], a[88:91], a[56:59], v[156:159]
ds_read_b64_tr_b16 a[108:109], v249 offset:9216
ds_read_b64_tr_b16 a[110:111], v249 offset:13312
v_mfma_f32_16x16x32_bf16 v[156:159], a[84:87], a[52:55], v[156:159]
v_exp_f32 v139, v139
v_mfma_f32_16x16x32_bf16 v[156:159], a[80:83], a[48:51], v[156:159]
s_waitcnt lgkmcnt(4)
v_add_f32 v241, v241, v136
v_cvt_pk_bf16_f32 v180, v136, v137
v_mfma_f32_16x16x32_bf16 v[16:19], a[96:99], v[192:195], v[16:19]
v_exp_f32 v144, v144
v_mfma_f32_16x16x32_bf16 v[16:19], a[100:103], v[208:211], v[16:19]
ds_read_b64_tr_b16 a[80:81], v246 offset:1536
ds_read_b64_tr_b16 a[82:83], v246 offset:5632
v_mfma_f32_16x16x32_bf16 v[48:51], a[100:103], v[212:215], v[48:51]
v_exp_f32 v145, v145
v_mfma_f32_16x16x32_bf16 v[48:51], a[96:99], v[196:199], v[48:51]
v_add_f32 v241, v241, v137
v_cvt_pk_bf16_f32 v181, v138, v139
v_mfma_f32_16x16x32_bf16 v[80:83], a[96:99], v[200:203], v[80:83]
v_exp_f32 v146, v146
v_mfma_f32_16x16x32_bf16 v[80:83], a[100:103], v[216:219], v[80:83]
ds_read_b64_tr_b16 a[84:85], v246 offset:9728
ds_read_b64_tr_b16 a[86:87], v246 offset:13824
v_mfma_f32_16x16x32_bf16 v[112:115], a[100:103], v[220:223], v[112:115]
v_exp_f32 v147, v147
v_mfma_f32_16x16x32_bf16 v[112:115], a[96:99], v[204:207], v[112:115]
s_waitcnt lgkmcnt(4)
v_add_f32 v241, v241, v138
v_cvt_pk_bf16_f32 v184, v144, v145
v_mfma_f32_16x16x32_bf16 a[120:123], a[112:115], v[200:203], a[120:123]
v_add_u32 v244, s35, v245
v_mfma_f32_16x16x32_bf16 a[120:123], a[112:115], v[216:219], a[120:123]
v_mfma_f32_16x16x32_bf16 v[116:119], a[104:107], v[204:207], v[116:119]
s_add_u32 s4, s4, 16384
v_exp_f32 v152, v152
s_addc_u32 s5, s5, 0
v_mfma_f32_16x16x32_bf16 v[116:119], a[108:111], v[220:223], v[116:119]
ds_read_b64_tr_b16 a[88:89], v249 offset:1536
ds_read_b64_tr_b16 a[90:91], v249 offset:5632
v_mfma_f32_16x16x32_bf16 v[84:87], a[108:111], v[216:219], v[84:87]
s_add_u32 s6, s6, 16384
v_exp_f32 v153, v153
s_addc_u32 s7, s7, 0
v_mfma_f32_16x16x32_bf16 v[84:87], a[104:107], v[200:203], v[84:87]
v_add_f32 v241, v241, v139
v_cvt_pk_bf16_f32 v185, v146, v147
v_mfma_f32_16x16x32_bf16 v[52:55], a[104:107], v[196:199], v[52:55]
v_exp_f32 v154, v154
v_mfma_f32_16x16x32_bf16 v[52:55], a[108:111], v[212:215], v[52:55]
ds_read_b64_tr_b16 a[92:93], v249 offset:9728
ds_read_b64_tr_b16 a[94:95], v249 offset:13824
v_mfma_f32_16x16x32_bf16 v[20:23], a[108:111], v[208:211], v[20:23]
v_exp_f32 v155, v155
v_mfma_f32_16x16x32_bf16 v[20:23], a[104:107], v[192:195], v[20:23]
s_waitcnt lgkmcnt(4)
v_add_f32 v243, v243, v152
v_cvt_pk_bf16_f32 v188, v152, v153
v_mfma_f32_16x16x32_bf16 v[24:27], a[80:83], v[192:195], v[24:27]
v_exp_f32 v132, v132
v_mfma_f32_16x16x32_bf16 v[24:27], a[84:87], v[208:211], v[24:27]
ds_read_b128 a[64:67], v244 offset:0
ds_read_b128 a[68:71], v244 offset:512
v_mfma_f32_16x16x32_bf16 v[56:59], a[84:87], v[212:215], v[56:59]
v_exp_f32 v133, v133
v_mfma_f32_16x16x32_bf16 v[56:59], a[80:83], v[196:199], v[56:59]
v_add_f32 v243, v243, v153
v_cvt_pk_bf16_f32 v189, v154, v155
v_mfma_f32_16x16x32_bf16 v[88:91], a[80:83], v[200:203], v[88:91]
v_exp_f32 v134, v134
v_mfma_f32_16x16x32_bf16 v[88:91], a[84:87], v[216:219], v[88:91]
ds_read_b128 a[72:75], v244 offset:1024
ds_read_b128 a[76:79], v244 offset:1536
v_mfma_f32_16x16x32_bf16 v[120:123], a[84:87], v[220:223], v[120:123]
v_exp_f32 v135, v135
v_mfma_f32_16x16x32_bf16 v[120:123], a[80:83], v[204:207], v[120:123]
s_waitcnt lgkmcnt(4)
v_add_f32 v243, v243, v154
v_cvt_pk_bf16_f32 v178, v132, v133
v_mfma_f32_16x16x32_bf16 v[124:127], a[88:91], v[204:207], v[124:127]
v_exp_f32 v140, v140
v_mfma_f32_16x16x32_bf16 v[124:127], a[92:95], v[220:223], v[124:127]
ds_read_b128 a[80:83], v244 offset:4096
v_add_u32 v246, s33, v247
v_mfma_f32_16x16x32_bf16 v[92:95], a[92:95], v[216:219], v[92:95]
v_exp_f32 v141, v141
v_mfma_f32_16x16x32_bf16 v[92:95], a[88:91], v[200:203], v[92:95]
v_add_f32 v243, v243, v155
v_cvt_pk_bf16_f32 v179, v134, v135
v_mfma_f32_16x16x32_bf16 v[60:63], a[88:91], v[196:199], v[60:63]
v_exp_f32 v142, v142
v_mfma_f32_16x16x32_bf16 v[60:63], a[92:95], v[212:215], v[60:63]
ds_read_b128 a[84:87], v244 offset:4608
v_xor_b32 v249, 32, v246
v_mfma_f32_16x16x32_bf16 v[28:31], a[92:95], v[208:211], v[28:31]
v_exp_f32 v143, v143
v_mfma_f32_16x16x32_bf16 v[28:31], a[88:91], v[192:195], v[28:31]
s_waitcnt lgkmcnt(2)
v_add_f32 v241, v241, v140
v_cvt_pk_bf16_f32 v182, v140, v141
v_mfma_f32_16x16x32_bf16 v[128:131], a[64:67], a[0:3], v[224:227]
v_exp_f32 v148, v148
v_mfma_f32_16x16x32_bf16 v[128:131], a[68:71], a[4:7], v[128:131]
ds_read_b128 a[88:91], v244 offset:5120
v_mfma_f32_16x16x32_bf16 v[128:131], a[72:75], a[8:11], v[128:131]
s_add_u32 m0, s39, s31
v_exp_f32 v149, v149
v_mfma_f32_16x16x32_bf16 v[128:131], a[76:79], a[12:15], v[128:131]
v_add_f32 v241, v241, v141
v_cvt_pk_bf16_f32 v183, v142, v143
v_mfma_f32_16x16x32_bf16 v[136:139], a[76:79], a[28:31], v[228:231]
v_exp_f32 v150, v150
v_mfma_f32_16x16x32_bf16 v[136:139], a[72:75], a[24:27], v[136:139]
ds_read_b128 a[92:95], v244 offset:5632
global_load_lds_dwordx4 v248, s[8:9] offset:0
v_mfma_f32_16x16x32_bf16 v[136:139], a[68:71], a[20:23], v[136:139]
v_exp_f32 v151, v151
v_mfma_f32_16x16x32_bf16 v[136:139], a[64:67], a[16:19], v[136:139]
v_add_f32 v241, v241, v142
v_cvt_pk_bf16_f32 v186, v148, v149
v_mfma_f32_16x16x32_bf16 v[144:147], a[64:67], a[32:35], v[232:235]
v_exp_f32 v156, v156
v_mfma_f32_16x16x32_bf16 v[144:147], a[68:71], a[36:39], v[144:147]
global_load_lds_dwordx4 v248, s[10:11] offset:1024
v_mfma_f32_16x16x32_bf16 v[144:147], a[72:75], a[40:43], v[144:147]
v_exp_f32 v157, v157
v_mfma_f32_16x16x32_bf16 v[144:147], a[76:79], a[44:47], v[144:147]
v_add_f32 v241, v241, v143
v_cvt_pk_bf16_f32 v187, v150, v151
v_mfma_f32_16x16x32_bf16 v[152:155], a[76:79], a[60:63], v[236:239]
v_exp_f32 v158, v158
v_mfma_f32_16x16x32_bf16 v[152:155], a[72:75], a[56:59], v[152:155]
global_load_lds_dwordx4 v248, s[8:9] offset:2048
global_load_lds_dwordx4 v248, s[10:11] offset:3072
v_mfma_f32_16x16x32_bf16 v[152:155], a[68:71], a[52:55], v[152:155]
v_exp_f32 v159, v159
v_mfma_f32_16x16x32_bf16 v[152:155], a[64:67], a[48:51], v[152:155]
s_waitcnt lgkmcnt(0)
v_add_f32 v243, v243, v156
v_cvt_pk_bf16_f32 v190, v156, v157
v_mfma_f32_16x16x32_bf16 v[132:135], a[80:83], a[0:3], v[224:227]
v_exp_f32 v128, v128
v_mfma_f32_16x16x32_bf16 v[132:135], a[84:87], a[4:7], v[132:135]
ds_read_b64_tr_b16 a[96:97], v246 offset:0
ds_read_b64_tr_b16 a[98:99], v246 offset:4096
v_mfma_f32_16x16x32_bf16 v[132:135], a[88:91], a[8:11], v[132:135]
v_exp_f32 v129, v129
v_mfma_f32_16x16x32_bf16 v[132:135], a[92:95], a[12:15], v[132:135]
v_add_f32 v243, v243, v157
v_cvt_pk_bf16_f32 v191, v158, v159
v_mfma_f32_16x16x32_bf16 v[140:143], a[92:95], a[28:31], v[228:231]
v_exp_f32 v130, v130
v_mfma_f32_16x16x32_bf16 v[140:143], a[88:91], a[24:27], v[140:143]
ds_read_b64_tr_b16 a[100:101], v246 offset:8192
ds_read_b64_tr_b16 a[102:103], v246 offset:12288
v_mfma_f32_16x16x32_bf16 v[140:143], a[84:87], a[20:23], v[140:143]
v_exp_f32 v131, v131
v_mfma_f32_16x16x32_bf16 v[140:143], a[80:83], a[16:19], v[140:143]
v_add_f32 v243, v243, v158
v_cvt_pk_bf16_f32 v192, v128, v129
v_mfma_f32_16x16x32_bf16 v[148:151], a[80:83], a[32:35], v[232:235]
v_exp_f32 v136, v136
v_mfma_f32_16x16x32_bf16 v[148:151], a[84:87], a[36:39], v[148:151]
ds_read_b64_tr_b16 a[104:105], v249 offset:0
ds_read_b64_tr_b16 a[106:107], v249 offset:4096
v_mfma_f32_16x16x32_bf16 v[148:151], a[88:91], a[40:43], v[148:151]
v_exp_f32 v137, v137
v_mfma_f32_16x16x32_bf16 v[148:151], a[92:95], a[44:47], v[148:151]
v_add_f32 v243, v243, v159
v_cvt_pk_bf16_f32 v193, v130, v131
v_mfma_f32_16x16x32_bf16 v[156:159], a[92:95], a[60:63], v[236:239]
v_exp_f32 v138, v138
v_mfma_f32_16x16x32_bf16 v[156:159], a[88:91], a[56:59], v[156:159]
ds_read_b64_tr_b16 a[108:109], v249 offset:8192
ds_read_b64_tr_b16 a[110:111], v249 offset:12288
v_mfma_f32_16x16x32_bf16 v[156:159], a[84:87], a[52:55], v[156:159]
v_exp_f32 v139, v139
v_mfma_f32_16x16x32_bf16 v[156:159], a[80:83], a[48:51], v[156:159]
s_waitcnt lgkmcnt(4)
v_add_f32 v241, v241, v136
v_cvt_pk_bf16_f32 v196, v136, v137
v_mfma_f32_16x16x32_bf16 v[0:3], a[96:99], v[160:163], v[0:3]
s_add_u32 s39, s37, 65536
v_exp_f32 v144, v144
s_add_u32 s37, s37, 16384
v_mfma_f32_16x16x32_bf16 v[0:3], a[100:103], v[176:179], v[0:3]
ds_read_b64_tr_b16 a[80:81], v246 offset:512
ds_read_b64_tr_b16 a[82:83], v246 offset:4608
v_mfma_f32_16x16x32_bf16 v[32:35], a[100:103], v[180:183], v[32:35]
s_and_b32 s37, s37, 0xffff
v_exp_f32 v145, v145
v_mfma_f32_16x16x32_bf16 v[32:35], a[96:99], v[164:167], v[32:35]
v_add_f32 v241, v241, v137
v_cvt_pk_bf16_f32 v197, v138, v139
v_mfma_f32_16x16x32_bf16 v[64:67], a[96:99], v[168:171], v[64:67]
v_exp_f32 v146, v146
v_mfma_f32_16x16x32_bf16 v[64:67], a[100:103], v[184:187], v[64:67]
ds_read_b64_tr_b16 a[84:85], v246 offset:8704
ds_read_b64_tr_b16 a[86:87], v246 offset:12800
v_mfma_f32_16x16x32_bf16 v[96:99], a[100:103], v[188:191], v[96:99]
v_exp_f32 v147, v147
v_mfma_f32_16x16x32_bf16 v[96:99], a[96:99], v[172:175], v[96:99]
s_waitcnt lgkmcnt(4)
v_add_f32 v241, v241, v138
v_cvt_pk_bf16_f32 v200, v144, v145
v_mfma_f32_16x16x32_bf16 a[116:119], a[112:115], v[160:163], a[116:119]
buffer_load_dword a135, v251, s[88:91], s42 offen sc1
v_mfma_f32_16x16x32_bf16 a[116:119], a[112:115], v[176:179], a[116:119]
v_mfma_f32_16x16x32_bf16 v[100:103], a[104:107], v[172:175], v[100:103]
s_add_u32 s8, s8, 16384
v_exp_f32 v152, v152
s_addc_u32 s9, s9, 0
v_mfma_f32_16x16x32_bf16 v[100:103], a[108:111], v[188:191], v[100:103]
ds_read_b64_tr_b16 a[88:89], v249 offset:512
ds_read_b64_tr_b16 a[90:91], v249 offset:4608
v_mfma_f32_16x16x32_bf16 v[68:71], a[108:111], v[184:187], v[68:71]
s_add_u32 s10, s10, 16384
v_exp_f32 v153, v153
s_addc_u32 s11, s11, 0
v_mfma_f32_16x16x32_bf16 v[68:71], a[104:107], v[168:171], v[68:71]
v_add_f32 v241, v241, v139
v_cvt_pk_bf16_f32 v201, v146, v147
v_mfma_f32_16x16x32_bf16 v[36:39], a[104:107], v[164:167], v[36:39]
s_add_u32 s42, s42, s41
v_exp_f32 v154, v154
v_mfma_f32_16x16x32_bf16 v[36:39], a[108:111], v[180:183], v[36:39]
ds_read_b64_tr_b16 a[92:93], v249 offset:8704
ds_read_b64_tr_b16 a[94:95], v249 offset:12800
v_mfma_f32_16x16x32_bf16 v[4:7], a[108:111], v[176:179], v[4:7]
v_exp_f32 v155, v155
v_mfma_f32_16x16x32_bf16 v[4:7], a[104:107], v[160:163], v[4:7]
s_waitcnt lgkmcnt(4)
v_add_f32 v243, v243, v152
v_cvt_pk_bf16_f32 v204, v152, v153
v_mfma_f32_16x16x32_bf16 v[8:11], a[80:83], v[160:163], v[8:11]
v_exp_f32 v132, v132
v_mfma_f32_16x16x32_bf16 v[8:11], a[84:87], v[176:179], v[8:11]
ds_read_b128 a[64:67], v244 offset:8192
ds_read_b128 a[68:71], v244 offset:8704
v_mfma_f32_16x16x32_bf16 v[40:43], a[84:87], v[180:183], v[40:43]
v_exp_f32 v133, v133
v_mfma_f32_16x16x32_bf16 v[40:43], a[80:83], v[164:167], v[40:43]
v_add_f32 v243, v243, v153
v_cvt_pk_bf16_f32 v205, v154, v155
v_mfma_f32_16x16x32_bf16 v[72:75], a[80:83], v[168:171], v[72:75]
v_exp_f32 v134, v134
v_mfma_f32_16x16x32_bf16 v[72:75], a[84:87], v[184:187], v[72:75]
ds_read_b128 a[72:75], v244 offset:9216
ds_read_b128 a[76:79], v244 offset:9728
v_mfma_f32_16x16x32_bf16 v[104:107], a[84:87], v[188:191], v[104:107]
v_exp_f32 v135, v135
v_mfma_f32_16x16x32_bf16 v[104:107], a[80:83], v[172:175], v[104:107]
s_waitcnt lgkmcnt(4)
v_add_f32 v243, v243, v154
v_cvt_pk_bf16_f32 v194, v132, v133
v_mfma_f32_16x16x32_bf16 v[108:111], a[88:91], v[172:175], v[108:111]
v_exp_f32 v140, v140
v_mfma_f32_16x16x32_bf16 v[108:111], a[92:95], v[188:191], v[108:111]
ds_read_b128 a[80:83], v244 offset:12288
v_mfma_f32_16x16x32_bf16 v[76:79], a[92:95], v[184:187], v[76:79]
v_exp_f32 v141, v141
v_mfma_f32_16x16x32_bf16 v[76:79], a[88:91], v[168:171], v[76:79]
v_add_f32 v243, v243, v155
v_cvt_pk_bf16_f32 v195, v134, v135
v_mfma_f32_16x16x32_bf16 v[44:47], a[88:91], v[164:167], v[44:47]
v_exp_f32 v142, v142
v_mfma_f32_16x16x32_bf16 v[44:47], a[92:95], v[180:183], v[44:47]
ds_read_b128 a[84:87], v244 offset:12800
v_mfma_f32_16x16x32_bf16 v[12:15], a[92:95], v[176:179], v[12:15]
v_exp_f32 v143, v143
v_mfma_f32_16x16x32_bf16 v[12:15], a[88:91], v[160:163], v[12:15]
s_waitcnt lgkmcnt(2)
v_add_f32 v241, v241, v140
v_cvt_pk_bf16_f32 v198, v140, v141
v_mfma_f32_16x16x32_bf16 v[128:131], a[64:67], a[0:3], v[224:227]
s_waitcnt vmcnt(10)
v_exp_f32 v148, v148
s_barrier
v_mfma_f32_16x16x32_bf16 v[128:131], a[68:71], a[4:7], v[128:131]
ds_read_b128 a[88:91], v244 offset:13312
v_mfma_f32_16x16x32_bf16 v[128:131], a[72:75], a[8:11], v[128:131]
s_add_u32 m0, s37, s31
v_exp_f32 v149, v149
v_mfma_f32_16x16x32_bf16 v[128:131], a[76:79], a[12:15], v[128:131]
v_add_f32 v241, v241, v141
v_cvt_pk_bf16_f32 v199, v142, v143
v_mfma_f32_16x16x32_bf16 v[136:139], a[76:79], a[28:31], v[228:231]
v_exp_f32 v150, v150
v_mfma_f32_16x16x32_bf16 v[136:139], a[72:75], a[24:27], v[136:139]
ds_read_b128 a[92:95], v244 offset:13824
global_load_lds_dwordx4 v248, s[4:5] offset:0
v_mfma_f32_16x16x32_bf16 v[136:139], a[68:71], a[20:23], v[136:139]
v_exp_f32 v151, v151
v_mfma_f32_16x16x32_bf16 v[136:139], a[64:67], a[16:19], v[136:139]
v_add_f32 v241, v241, v142
v_cvt_pk_bf16_f32 v202, v148, v149
v_mfma_f32_16x16x32_bf16 v[144:147], a[64:67], a[32:35], v[232:235]
v_exp_f32 v156, v156
v_mfma_f32_16x16x32_bf16 v[144:147], a[68:71], a[36:39], v[144:147]
global_load_lds_dwordx4 v248, s[6:7] offset:1024
v_mfma_f32_16x16x32_bf16 v[144:147], a[72:75], a[40:43], v[144:147]
v_exp_f32 v157, v157
v_mfma_f32_16x16x32_bf16 v[144:147], a[76:79], a[44:47], v[144:147]
v_add_f32 v241, v241, v143
v_cvt_pk_bf16_f32 v203, v150, v151
v_mfma_f32_16x16x32_bf16 v[152:155], a[76:79], a[60:63], v[236:239]
v_exp_f32 v158, v158
v_mfma_f32_16x16x32_bf16 v[152:155], a[72:75], a[56:59], v[152:155]
global_load_lds_dwordx4 v248, s[4:5] offset:2048
global_load_lds_dwordx4 v248, s[6:7] offset:3072
v_mfma_f32_16x16x32_bf16 v[152:155], a[68:71], a[52:55], v[152:155]
v_exp_f32 v159, v159
v_mfma_f32_16x16x32_bf16 v[152:155], a[64:67], a[48:51], v[152:155]
s_waitcnt lgkmcnt(0)
v_add_f32 v243, v243, v156
v_cvt_pk_bf16_f32 v206, v156, v157
v_mfma_f32_16x16x32_bf16 v[132:135], a[80:83], a[0:3], v[224:227]
v_exp_f32 v128, v128
v_mfma_f32_16x16x32_bf16 v[132:135], a[84:87], a[4:7], v[132:135]
ds_read_b64_tr_b16 a[96:97], v246 offset:1024
ds_read_b64_tr_b16 a[98:99], v246 offset:5120
v_mfma_f32_16x16x32_bf16 v[132:135], a[88:91], a[8:11], v[132:135]
v_exp_f32 v129, v129
v_mfma_f32_16x16x32_bf16 v[132:135], a[92:95], a[12:15], v[132:135]
v_add_f32 v243, v243, v157
v_cvt_pk_bf16_f32 v207, v158, v159
v_mfma_f32_16x16x32_bf16 v[140:143], a[92:95], a[28:31], v[228:231]
v_exp_f32 v130, v130
v_mfma_f32_16x16x32_bf16 v[140:143], a[88:91], a[24:27], v[140:143]
ds_read_b64_tr_b16 a[100:101], v246 offset:9216
ds_read_b64_tr_b16 a[102:103], v246 offset:13312
v_mfma_f32_16x16x32_bf16 v[140:143], a[84:87], a[20:23], v[140:143]
v_exp_f32 v131, v131
v_mfma_f32_16x16x32_bf16 v[140:143], a[80:83], a[16:19], v[140:143]
v_add_f32 v243, v243, v158
v_cvt_pk_bf16_f32 v208, v128, v129
v_mfma_f32_16x16x32_bf16 v[148:151], a[80:83], a[32:35], v[232:235]
s_mov_b32 s33, s35
v_exp_f32 v136, v136
s_add_u32 s35, s35, 16384
v_mfma_f32_16x16x32_bf16 v[148:151], a[84:87], a[36:39], v[148:151]
ds_read_b64_tr_b16 a[104:105], v249 offset:1024
ds_read_b64_tr_b16 a[106:107], v249 offset:5120
v_mfma_f32_16x16x32_bf16 v[148:151], a[88:91], a[40:43], v[148:151]
s_and_b32 s35, s35, 0xffff
v_exp_f32 v137, v137
v_mfma_f32_16x16x32_bf16 v[148:151], a[92:95], a[44:47], v[148:151]
v_add_f32 v243, v243, v159
v_cvt_pk_bf16_f32 v209, v130, v131
v_mfma_f32_16x16x32_bf16 v[156:159], a[92:95], a[60:63], v[236:239]
v_exp_f32 v138, v138
v_mfma_f32_16x16x32_bf16 v[156:159], a[88:91], a[56:59], v[156:159]
ds_read_b64_tr_b16 a[108:109], v249 offset:9216
ds_read_b64_tr_b16 a[110:111], v249 offset:13312
v_mfma_f32_16x16x32_bf16 v[156:159], a[84:87], a[52:55], v[156:159]
v_exp_f32 v139, v139
v_mfma_f32_16x16x32_bf16 v[156:159], a[80:83], a[48:51], v[156:159]
s_waitcnt lgkmcnt(4)
v_add_f32 v241, v241, v136
v_cvt_pk_bf16_f32 v212, v136, v137
v_mfma_f32_16x16x32_bf16 v[16:19], a[96:99], v[160:163], v[16:19]
v_exp_f32 v144, v144
v_mfma_f32_16x16x32_bf16 v[16:19], a[100:103], v[176:179], v[16:19]
ds_read_b64_tr_b16 a[80:81], v246 offset:1536
ds_read_b64_tr_b16 a[82:83], v246 offset:5632
v_mfma_f32_16x16x32_bf16 v[48:51], a[100:103], v[180:183], v[48:51]
v_exp_f32 v145, v145
v_mfma_f32_16x16x32_bf16 v[48:51], a[96:99], v[164:167], v[48:51]
v_add_f32 v241, v241, v137
v_cvt_pk_bf16_f32 v213, v138, v139
v_mfma_f32_16x16x32_bf16 v[80:83], a[96:99], v[168:171], v[80:83]
v_exp_f32 v146, v146
v_mfma_f32_16x16x32_bf16 v[80:83], a[100:103], v[184:187], v[80:83]
ds_read_b64_tr_b16 a[84:85], v246 offset:9728
ds_read_b64_tr_b16 a[86:87], v246 offset:13824
v_mfma_f32_16x16x32_bf16 v[112:115], a[100:103], v[188:191], v[112:115]
v_exp_f32 v147, v147
v_mfma_f32_16x16x32_bf16 v[112:115], a[96:99], v[172:175], v[112:115]
s_waitcnt lgkmcnt(4)
v_add_f32 v241, v241, v138
v_cvt_pk_bf16_f32 v216, v144, v145
v_mfma_f32_16x16x32_bf16 a[120:123], a[112:115], v[168:171], a[120:123]
v_add_u32 v244, s35, v245
v_mfma_f32_16x16x32_bf16 a[120:123], a[112:115], v[184:187], a[120:123]
v_mfma_f32_16x16x32_bf16 v[116:119], a[104:107], v[172:175], v[116:119]
s_add_u32 s4, s4, 16384
v_exp_f32 v152, v152
s_addc_u32 s5, s5, 0
v_mfma_f32_16x16x32_bf16 v[116:119], a[108:111], v[188:191], v[116:119]
ds_read_b64_tr_b16 a[88:89], v249 offset:1536
ds_read_b64_tr_b16 a[90:91], v249 offset:5632
v_mfma_f32_16x16x32_bf16 v[84:87], a[108:111], v[184:187], v[84:87]
s_add_u32 s6, s6, 16384
v_exp_f32 v153, v153
s_addc_u32 s7, s7, 0
v_mfma_f32_16x16x32_bf16 v[84:87], a[104:107], v[168:171], v[84:87]
v_add_f32 v241, v241, v139
v_cvt_pk_bf16_f32 v217, v146, v147
v_mfma_f32_16x16x32_bf16 v[52:55], a[104:107], v[164:167], v[52:55]
v_exp_f32 v154, v154
v_mfma_f32_16x16x32_bf16 v[52:55], a[108:111], v[180:183], v[52:55]
ds_read_b64_tr_b16 a[92:93], v249 offset:9728
ds_read_b64_tr_b16 a[94:95], v249 offset:13824
v_mfma_f32_16x16x32_bf16 v[20:23], a[108:111], v[176:179], v[20:23]
v_exp_f32 v155, v155
v_mfma_f32_16x16x32_bf16 v[20:23], a[104:107], v[160:163], v[20:23]
s_waitcnt lgkmcnt(4)
v_add_f32 v243, v243, v152
v_cvt_pk_bf16_f32 v220, v152, v153
v_mfma_f32_16x16x32_bf16 v[24:27], a[80:83], v[160:163], v[24:27]
v_exp_f32 v132, v132
v_mfma_f32_16x16x32_bf16 v[24:27], a[84:87], v[176:179], v[24:27]
ds_read_b128 a[64:67], v244 offset:0
ds_read_b128 a[68:71], v244 offset:512
v_mfma_f32_16x16x32_bf16 v[56:59], a[84:87], v[180:183], v[56:59]
v_exp_f32 v133, v133
v_mfma_f32_16x16x32_bf16 v[56:59], a[80:83], v[164:167], v[56:59]
v_add_f32 v243, v243, v153
v_cvt_pk_bf16_f32 v221, v154, v155
v_mfma_f32_16x16x32_bf16 v[88:91], a[80:83], v[168:171], v[88:91]
v_exp_f32 v134, v134
v_mfma_f32_16x16x32_bf16 v[88:91], a[84:87], v[184:187], v[88:91]
ds_read_b128 a[72:75], v244 offset:1024
ds_read_b128 a[76:79], v244 offset:1536
v_mfma_f32_16x16x32_bf16 v[120:123], a[84:87], v[188:191], v[120:123]
v_exp_f32 v135, v135
v_mfma_f32_16x16x32_bf16 v[120:123], a[80:83], v[172:175], v[120:123]
s_waitcnt lgkmcnt(4)
v_add_f32 v243, v243, v154
v_cvt_pk_bf16_f32 v210, v132, v133
v_mfma_f32_16x16x32_bf16 v[124:127], a[88:91], v[172:175], v[124:127]
v_exp_f32 v140, v140
v_mfma_f32_16x16x32_bf16 v[124:127], a[92:95], v[188:191], v[124:127]
ds_read_b128 a[80:83], v244 offset:4096
v_add_u32 v246, s33, v247
v_mfma_f32_16x16x32_bf16 v[92:95], a[92:95], v[184:187], v[92:95]
v_exp_f32 v141, v141
v_mfma_f32_16x16x32_bf16 v[92:95], a[88:91], v[168:171], v[92:95]
v_add_f32 v243, v243, v155
v_cvt_pk_bf16_f32 v211, v134, v135
v_mfma_f32_16x16x32_bf16 v[60:63], a[88:91], v[164:167], v[60:63]
v_exp_f32 v142, v142
v_mfma_f32_16x16x32_bf16 v[60:63], a[92:95], v[180:183], v[60:63]
ds_read_b128 a[84:87], v244 offset:4608
v_xor_b32 v249, 32, v246
v_mfma_f32_16x16x32_bf16 v[28:31], a[92:95], v[176:179], v[28:31]
v_exp_f32 v143, v143
v_mfma_f32_16x16x32_bf16 v[28:31], a[88:91], v[160:163], v[28:31]
s_waitcnt lgkmcnt(2)
v_add_f32 v241, v241, v140
v_cvt_pk_bf16_f32 v214, v140, v141
v_mfma_f32_16x16x32_bf16 v[128:131], a[64:67], a[0:3], v[224:227]
v_exp_f32 v148, v148
v_mfma_f32_16x16x32_bf16 v[128:131], a[68:71], a[4:7], v[128:131]
ds_read_b128 a[88:91], v244 offset:5120
v_mfma_f32_16x16x32_bf16 v[128:131], a[72:75], a[8:11], v[128:131]
s_add_u32 m0, s39, s31
v_exp_f32 v149, v149
v_mfma_f32_16x16x32_bf16 v[128:131], a[76:79], a[12:15], v[128:131]
v_add_f32 v241, v241, v141
v_cvt_pk_bf16_f32 v215, v142, v143
v_mfma_f32_16x16x32_bf16 v[136:139], a[76:79], a[28:31], v[228:231]
v_exp_f32 v150, v150
v_mfma_f32_16x16x32_bf16 v[136:139], a[72:75], a[24:27], v[136:139]
ds_read_b128 a[92:95], v244 offset:5632
global_load_lds_dwordx4 v248, s[8:9] offset:0
v_mfma_f32_16x16x32_bf16 v[136:139], a[68:71], a[20:23], v[136:139]
v_exp_f32 v151, v151
v_mfma_f32_16x16x32_bf16 v[136:139], a[64:67], a[16:19], v[136:139]
v_add_f32 v241, v241, v142
v_cvt_pk_bf16_f32 v218, v148, v149
v_mfma_f32_16x16x32_bf16 v[144:147], a[64:67], a[32:35], v[232:235]
v_exp_f32 v156, v156
v_mfma_f32_16x16x32_bf16 v[144:147], a[68:71], a[36:39], v[144:147]
global_load_lds_dwordx4 v248, s[10:11] offset:1024
v_mfma_f32_16x16x32_bf16 v[144:147], a[72:75], a[40:43], v[144:147]
v_exp_f32 v157, v157
v_mfma_f32_16x16x32_bf16 v[144:147], a[76:79], a[44:47], v[144:147]
v_add_f32 v241, v241, v143
v_cvt_pk_bf16_f32 v219, v150, v151
v_mfma_f32_16x16x32_bf16 v[152:155], a[76:79], a[60:63], v[236:239]
v_exp_f32 v158, v158
v_mfma_f32_16x16x32_bf16 v[152:155], a[72:75], a[56:59], v[152:155]
global_load_lds_dwordx4 v248, s[8:9] offset:2048
global_load_lds_dwordx4 v248, s[10:11] offset:3072
v_mfma_f32_16x16x32_bf16 v[152:155], a[68:71], a[52:55], v[152:155]
v_exp_f32 v159, v159
v_mfma_f32_16x16x32_bf16 v[152:155], a[64:67], a[48:51], v[152:155]
s_waitcnt lgkmcnt(0)
v_add_f32 v243, v243, v156
v_cvt_pk_bf16_f32 v222, v156, v157
v_mfma_f32_16x16x32_bf16 v[132:135], a[80:83], a[0:3], v[224:227]
v_exp_f32 v128, v128
v_mfma_f32_16x16x32_bf16 v[132:135], a[84:87], a[4:7], v[132:135]
ds_read_b64_tr_b16 a[96:97], v246 offset:0
ds_read_b64_tr_b16 a[98:99], v246 offset:4096
v_mfma_f32_16x16x32_bf16 v[132:135], a[88:91], a[8:11], v[132:135]
v_exp_f32 v129, v129
v_mfma_f32_16x16x32_bf16 v[132:135], a[92:95], a[12:15], v[132:135]
v_add_f32 v243, v243, v157
v_cvt_pk_bf16_f32 v223, v158, v159
v_mfma_f32_16x16x32_bf16 v[140:143], a[92:95], a[28:31], v[228:231]
v_exp_f32 v130, v130
v_mfma_f32_16x16x32_bf16 v[140:143], a[88:91], a[24:27], v[140:143]
ds_read_b64_tr_b16 a[100:101], v246 offset:8192
ds_read_b64_tr_b16 a[102:103], v246 offset:12288
v_mfma_f32_16x16x32_bf16 v[140:143], a[84:87], a[20:23], v[140:143]
v_exp_f32 v131, v131
v_mfma_f32_16x16x32_bf16 v[140:143], a[80:83], a[16:19], v[140:143]
v_add_f32 v243, v243, v158
v_cvt_pk_bf16_f32 v160, v128, v129
v_mfma_f32_16x16x32_bf16 v[148:151], a[80:83], a[32:35], v[232:235]
v_exp_f32 v136, v136
v_mfma_f32_16x16x32_bf16 v[148:151], a[84:87], a[36:39], v[148:151]
ds_read_b64_tr_b16 a[104:105], v249 offset:0
ds_read_b64_tr_b16 a[106:107], v249 offset:4096
v_mfma_f32_16x16x32_bf16 v[148:151], a[88:91], a[40:43], v[148:151]
v_exp_f32 v137, v137
v_mfma_f32_16x16x32_bf16 v[148:151], a[92:95], a[44:47], v[148:151]
v_add_f32 v243, v243, v159
v_cvt_pk_bf16_f32 v161, v130, v131
v_mfma_f32_16x16x32_bf16 v[156:159], a[92:95], a[60:63], v[236:239]
v_exp_f32 v138, v138
v_mfma_f32_16x16x32_bf16 v[156:159], a[88:91], a[56:59], v[156:159]
ds_read_b64_tr_b16 a[108:109], v249 offset:8192
ds_read_b64_tr_b16 a[110:111], v249 offset:12288
v_mfma_f32_16x16x32_bf16 v[156:159], a[84:87], a[52:55], v[156:159]
v_exp_f32 v139, v139
v_mfma_f32_16x16x32_bf16 v[156:159], a[80:83], a[48:51], v[156:159]
s_waitcnt lgkmcnt(4)
v_add_f32 v241, v241, v136
v_cvt_pk_bf16_f32 v164, v136, v137
v_mfma_f32_16x16x32_bf16 v[0:3], a[96:99], v[192:195], v[0:3]
s_add_u32 s39, s37, 65536
v_exp_f32 v144, v144
s_add_u32 s37, s37, 16384
v_mfma_f32_16x16x32_bf16 v[0:3], a[100:103], v[208:211], v[0:3]
ds_read_b64_tr_b16 a[80:81], v246 offset:512
ds_read_b64_tr_b16 a[82:83], v246 offset:4608
v_mfma_f32_16x16x32_bf16 v[32:35], a[100:103], v[212:215], v[32:35]
s_and_b32 s37, s37, 0xffff
v_exp_f32 v145, v145
v_mfma_f32_16x16x32_bf16 v[32:35], a[96:99], v[196:199], v[32:35]
L_m_c0_10:
s_cbranch_execz L_m_c0_ret
v_add_f32 v241, v241, v137
v_cvt_pk_bf16_f32 v165, v138, v139
v_mfma_f32_16x16x32_bf16 v[64:67], a[96:99], v[200:203], v[64:67]
v_exp_f32 v146, v146
v_mfma_f32_16x16x32_bf16 v[64:67], a[100:103], v[216:219], v[64:67]
ds_read_b64_tr_b16 a[84:85], v246 offset:8704
ds_read_b64_tr_b16 a[86:87], v246 offset:12800
v_mfma_f32_16x16x32_bf16 v[96:99], a[100:103], v[220:223], v[96:99]
v_exp_f32 v147, v147
v_mfma_f32_16x16x32_bf16 v[96:99], a[96:99], v[204:207], v[96:99]
s_waitcnt lgkmcnt(4)
v_add_f32 v241, v241, v138
v_cvt_pk_bf16_f32 v168, v144, v145
v_mfma_f32_16x16x32_bf16 a[116:119], a[112:115], v[192:195], a[116:119]
buffer_load_dword a135, v251, s[88:91], s42 offen sc1
v_mfma_f32_16x16x32_bf16 a[116:119], a[112:115], v[208:211], a[116:119]
v_mfma_f32_16x16x32_bf16 v[100:103], a[104:107], v[204:207], v[100:103]
s_add_u32 s8, s8, 16384
v_exp_f32 v152, v152
s_addc_u32 s9, s9, 0
v_mfma_f32_16x16x32_bf16 v[100:103], a[108:111], v[220:223], v[100:103]
ds_read_b64_tr_b16 a[88:89], v249 offset:512
ds_read_b64_tr_b16 a[90:91], v249 offset:4608
v_mfma_f32_16x16x32_bf16 v[68:71], a[108:111], v[216:219], v[68:71]
s_add_u32 s10, s10, 16384
v_exp_f32 v153, v153
s_addc_u32 s11, s11, 0
v_mfma_f32_16x16x32_bf16 v[68:71], a[104:107], v[200:203], v[68:71]
v_add_f32 v241, v241, v139
v_cvt_pk_bf16_f32 v169, v146, v147
v_mfma_f32_16x16x32_bf16 v[36:39], a[104:107], v[196:199], v[36:39]
s_add_u32 s42, s42, s41
v_exp_f32 v154, v154
v_mfma_f32_16x16x32_bf16 v[36:39], a[108:111], v[212:215], v[36:39]
ds_read_b64_tr_b16 a[92:93], v249 offset:8704
ds_read_b64_tr_b16 a[94:95], v249 offset:12800
v_mfma_f32_16x16x32_bf16 v[4:7], a[108:111], v[208:211], v[4:7]
v_exp_f32 v155, v155
v_mfma_f32_16x16x32_bf16 v[4:7], a[104:107], v[192:195], v[4:7]
s_waitcnt lgkmcnt(4)
v_add_f32 v243, v243, v152
v_cvt_pk_bf16_f32 v172, v152, v153
v_mfma_f32_16x16x32_bf16 v[8:11], a[80:83], v[192:195], v[8:11]
s_add_u32 s34, s34, 2
v_exp_f32 v132, v132
v_mfma_f32_16x16x32_bf16 v[8:11], a[84:87], v[208:211], v[8:11]
ds_read_b128 a[64:67], v244 offset:8192
ds_read_b128 a[68:71], v244 offset:8704
v_mfma_f32_16x16x32_bf16 v[40:43], a[84:87], v[212:215], v[40:43]
s_cmp_lt_u32 s34, s43
v_exp_f32 v133, v133
v_mfma_f32_16x16x32_bf16 v[40:43], a[80:83], v[196:199], v[40:43]
v_add_f32 v243, v243, v153
v_cvt_pk_bf16_f32 v173, v154, v155
v_mfma_f32_16x16x32_bf16 v[72:75], a[80:83], v[200:203], v[72:75]
v_exp_f32 v134, v134
v_mfma_f32_16x16x32_bf16 v[72:75], a[84:87], v[216:219], v[72:75]
ds_read_b128 a[72:75], v244 offset:9216
ds_read_b128 a[76:79], v244 offset:9728
v_mfma_f32_16x16x32_bf16 v[104:107], a[84:87], v[220:223], v[104:107]
v_exp_f32 v135, v135
v_mfma_f32_16x16x32_bf16 v[104:107], a[80:83], v[204:207], v[104:107]
s_waitcnt lgkmcnt(4)
v_add_f32 v243, v243, v154
v_cvt_pk_bf16_f32 v162, v132, v133
v_mfma_f32_16x16x32_bf16 v[108:111], a[88:91], v[204:207], v[108:111]
v_exp_f32 v140, v140
v_mfma_f32_16x16x32_bf16 v[108:111], a[92:95], v[220:223], v[108:111]
ds_read_b128 a[80:83], v244 offset:12288
v_mfma_f32_16x16x32_bf16 v[76:79], a[92:95], v[216:219], v[76:79]
v_exp_f32 v141, v141
v_mfma_f32_16x16x32_bf16 v[76:79], a[88:91], v[200:203], v[76:79]
v_add_f32 v243, v243, v155
v_cvt_pk_bf16_f32 v163, v134, v135
v_mfma_f32_16x16x32_bf16 v[44:47], a[88:91], v[196:199], v[44:47]
v_exp_f32 v142, v142
v_mfma_f32_16x16x32_bf16 v[44:47], a[92:95], v[212:215], v[44:47]
ds_read_b128 a[84:87], v244 offset:12800
v_mfma_f32_16x16x32_bf16 v[12:15], a[92:95], v[208:211], v[12:15]
v_exp_f32 v143, v143
v_mfma_f32_16x16x32_bf16 v[12:15], a[88:91], v[192:195], v[12:15]
s_waitcnt lgkmcnt(2)
v_add_f32 v241, v241, v140
v_cvt_pk_bf16_f32 v166, v140, v141
s_cbranch_scc1 L_m_loop
s_cmp_eq_u32 s34, 26
s_cbranch_scc1 L_m_peel
s_cmp_eq_u32 s34, 18
s_cbranch_scc1 L_m_blkb
buffer_load_dword v254, off, s[24:27], 0 offset:4 sc1
s_lshr_b32 s3, s2, 3
s_lshl_b32 s3, s3, 2
s_add_u32 s3, s3, s28
s_mul_i32 s3, s3, 384
s_add_u32 s3, s3, L_m_peel-L_m_pc
v_min_u32 v251, 32, v250
v_lshl_add_u32 v251, v251, 3, s3
s_cmp_lt_u32 s30, 16
s_cselect_b32 s88, s46, s48
s_cselect_b32 s89, s47, s49
buffer_load_dword a135, v251, s[92:95], 0 offen
s_mov_b32 s90, 525184
v_min_u32 v251, 176, v250
v_lshlrev_b32 v251, 3, v251
s_and_b32 s42, s30, 15
s_mul_i32 s42, s42, 1536
s_add_u32 s42, s42, 476032
s_mov_b32 s41, 24576
s_mov_b32 s43, 18
s_branch L_m_loop
L_m_blkb:
s_mov_b64 exec, 0
s_cmp_eq_u32 s28, 1
s_cbranch_scc1 L_m_c1_1
s_cmp_eq_u32 s28, 2
s_cbranch_scc1 L_m_c1_2
s_cmp_eq_u32 s28, 3
s_cbranch_scc1 L_m_c1_3
s_branch L_m_c1_0
L_m_c1_3:
L_m_c1_ret:
s_mov_b64 exec, -1
s_waitcnt vmcnt(18)
v_cmp_gt_u32 vcc, 256, v254
v_min_u32 v251, 144, v250
s_lshl_b32 s3, s85, 7
v_lshl_add_u32 v251, v251, 6, s3
s_mov_b32 s88, s16
s_mov_b32 s89, s17
s_mov_b32 s90, s18
s_add_u32 s42, s81, 0
s_mov_b32 s41, 10240
s_mov_b32 s43, 26
s_cmp_eq_u64 vcc, 0
s_cbranch_scc1 L_m_loop
s_mov_b32 s82, 0
L_m_poll9:
buffer_load_dword v254, off, s[24:27], 0 offset:4 sc1
s_waitcnt vmcnt(0)
v_cmp_gt_u32 vcc, 256, v254
s_cmp_eq_u64 vcc, 0
s_cbranch_scc1 L_m_poll9d
s_sleep 32
s_add_u32 s82, s82, 1
s_cmp_lt_u32 s82, 0x40000
s_cbranch_scc1 L_m_poll9
L_m_poll9d:
s_branch L_m_loop
L_m_peel:
v_mfma_f32_16x16x32_bf16 v[128:131], a[64:67], a[0:3], v[224:227]
s_waitcnt vmcnt(10)
v_exp_f32 v148, v148
s_barrier
v_mfma_f32_16x16x32_bf16 v[128:131], a[68:71], a[4:7], v[128:131]
ds_read_b128 a[88:91], v244 offset:13312
v_mfma_f32_16x16x32_bf16 v[128:131], a[72:75], a[8:11], v[128:131]
s_add_u32 m0, s37, s31
v_exp_f32 v149, v149
v_mfma_f32_16x16x32_bf16 v[128:131], a[76:79], a[12:15], v[128:131]
v_add_f32 v241, v241, v141
v_cvt_pk_bf16_f32 v167, v142, v143
v_mfma_f32_16x16x32_bf16 v[136:139], a[76:79], a[28:31], v[228:231]
v_exp_f32 v150, v150
v_mfma_f32_16x16x32_bf16 v[136:139], a[72:75], a[24:27], v[136:139]
ds_read_b128 a[92:95], v244 offset:13824
global_load_lds_dwordx4 v248, s[4:5] offset:0
v_mfma_f32_16x16x32_bf16 v[136:139], a[68:71], a[20:23], v[136:139]
v_exp_f32 v151, v151
v_mfma_f32_16x16x32_bf16 v[136:139], a[64:67], a[16:19], v[136:139]
v_add_f32 v241, v241, v142
v_cvt_pk_bf16_f32 v170, v148, v149
v_mfma_f32_16x16x32_bf16 v[144:147], a[64:67], a[32:35], v[232:235]
v_exp_f32 v156, v156
v_mfma_f32_16x16x32_bf16 v[144:147], a[68:71], a[36:39], v[144:147]
global_load_lds_dwordx4 v248, s[6:7] offset:1024
v_mfma_f32_16x16x32_bf16 v[144:147], a[72:75], a[40:43], v[144:147]
v_exp_f32 v157, v157
v_mfma_f32_16x16x32_bf16 v[144:147], a[76:79], a[44:47], v[144:147]
v_add_f32 v241, v241, v143
v_cvt_pk_bf16_f32 v171, v150, v151
v_mfma_f32_16x16x32_bf16 v[152:155], a[76:79], a[60:63], v[236:239]
v_exp_f32 v158, v158
v_mfma_f32_16x16x32_bf16 v[152:155], a[72:75], a[56:59], v[152:155]
global_load_lds_dwordx4 v248, s[4:5] offset:2048
global_load_lds_dwordx4 v248, s[6:7] offset:3072
v_mfma_f32_16x16x32_bf16 v[152:155], a[68:71], a[52:55], v[152:155]
v_exp_f32 v159, v159
v_mfma_f32_16x16x32_bf16 v[152:155], a[64:67], a[48:51], v[152:155]
s_waitcnt lgkmcnt(0)
v_add_f32 v243, v243, v156
v_cvt_pk_bf16_f32 v174, v156, v157
v_mfma_f32_16x16x32_bf16 v[132:135], a[80:83], a[0:3], v[224:227]
v_exp_f32 v128, v128
v_mfma_f32_16x16x32_bf16 v[132:135], a[84:87], a[4:7], v[132:135]
ds_read_b64_tr_b16 a[96:97], v246 offset:1024
ds_read_b64_tr_b16 a[98:99], v246 offset:5120
v_mfma_f32_16x16x32_bf16 v[132:135], a[88:91], a[8:11], v[132:135]
v_exp_f32 v129, v129
v_mfma_f32_16x16x32_bf16 v[132:135], a[92:95], a[12:15], v[132:135]
v_add_f32 v243, v243, v157
v_cvt_pk_bf16_f32 v175, v158, v159
v_mfma_f32_16x16x32_bf16 v[140:143], a[92:95], a[28:31], v[228:231]
s_mul_i32 s3, s73, 160
v_exp_f32 v130, v130
s_add_u32 s36, s3, 2648576
s_add_u32 m0, s77, 7680
v_mfma_f32_16x16x32_bf16 v[140:143], a[88:91], a[24:27], v[140:143]
ds_read_b64_tr_b16 a[100:101], v246 offset:9216
ds_read_b64_tr_b16 a[102:103], v246 offset:13312
s_mov_b64 exec, 0x3ff
buffer_load_dwordx4 v250, s[16:19], s36 offen sc1 lds
s_mov_b64 exec, -1
v_mfma_f32_16x16x32_bf16 v[140:143], a[84:87], a[20:23], v[140:143]
v_exp_f32 v131, v131
v_mfma_f32_16x16x32_bf16 v[140:143], a[80:83], a[16:19], v[140:143]
v_add_f32 v243, v243, v158
v_cvt_pk_bf16_f32 v176, v128, v129
v_mfma_f32_16x16x32_bf16 v[148:151], a[80:83], a[32:35], v[232:235]
s_mov_b32 s33, s35
v_exp_f32 v136, v136
s_add_u32 s35, s35, 16384
v_mfma_f32_16x16x32_bf16 v[148:151], a[84:87], a[36:39], v[148:151]
ds_read_b64_tr_b16 a[104:105], v249 offset:1024
ds_read_b64_tr_b16 a[106:107], v249 offset:5120
v_mfma_f32_16x16x32_bf16 v[148:151], a[88:91], a[40:43], v[148:151]
s_and_b32 s35, s35, 0xffff
v_exp_f32 v137, v137
v_mfma_f32_16x16x32_bf16 v[148:151], a[92:95], a[44:47], v[148:151]
v_add_f32 v243, v243, v159
v_cvt_pk_bf16_f32 v177, v130, v131
v_mfma_f32_16x16x32_bf16 v[156:159], a[92:95], a[60:63], v[236:239]
v_exp_f32 v138, v138
v_mfma_f32_16x16x32_bf16 v[156:159], a[88:91], a[56:59], v[156:159]
ds_read_b64_tr_b16 a[108:109], v249 offset:9216
ds_read_b64_tr_b16 a[110:111], v249 offset:13312
v_mfma_f32_16x16x32_bf16 v[156:159], a[84:87], a[52:55], v[156:159]
v_exp_f32 v139, v139
v_mfma_f32_16x16x32_bf16 v[156:159], a[80:83], a[48:51], v[156:159]
s_waitcnt lgkmcnt(4)
v_add_f32 v241, v241, v136
v_cvt_pk_bf16_f32 v180, v136, v137
v_mfma_f32_16x16x32_bf16 v[16:19], a[96:99], v[192:195], v[16:19]
v_exp_f32 v144, v144
v_mfma_f32_16x16x32_bf16 v[16:19], a[100:103], v[208:211], v[16:19]
ds_read_b64_tr_b16 a[80:81], v246 offset:1536
ds_read_b64_tr_b16 a[82:83], v246 offset:5632
v_mfma_f32_16x16x32_bf16 v[48:51], a[100:103], v[212:215], v[48:51]
v_exp_f32 v145, v145
v_mfma_f32_16x16x32_bf16 v[48:51], a[96:99], v[196:199], v[48:51]
v_add_f32 v241, v241, v137
v_cvt_pk_bf16_f32 v181, v138, v139
v_mfma_f32_16x16x32_bf16 v[80:83], a[96:99], v[200:203], v[80:83]
s_mul_i32 s3, s73, 160
v_exp_f32 v146, v146
s_add_u32 s36, s3, 2651136
v_mfma_f32_16x16x32_bf16 v[80:83], a[100:103], v[216:219], v[80:83]
ds_read_b64_tr_b16 a[84:85], v246 offset:9728
ds_read_b64_tr_b16 a[86:87], v246 offset:13824
v_mfma_f32_16x16x32_bf16 v[112:115], a[100:103], v[220:223], v[112:115]
s_add_u32 m0, s77, 7840
v_exp_f32 v147, v147
v_mfma_f32_16x16x32_bf16 v[112:115], a[96:99], v[204:207], v[112:115]
s_waitcnt lgkmcnt(4)
v_add_f32 v241, v241, v138
v_cvt_pk_bf16_f32 v184, v144, v145
v_mfma_f32_16x16x32_bf16 a[120:123], a[112:115], v[200:203], a[120:123]
s_mov_b64 exec, 0x3ff
buffer_load_dwordx4 v250, s[16:19], s36 offen sc1 lds
s_mov_b64 exec, -1
v_add_u32 v244, s35, v245
v_mfma_f32_16x16x32_bf16 a[120:123], a[112:115], v[216:219], a[120:123]
v_mfma_f32_16x16x32_bf16 v[116:119], a[104:107], v[204:207], v[116:119]
s_add_u32 s4, s4, 16384
v_exp_f32 v152, v152
s_addc_u32 s5, s5, 0
v_mfma_f32_16x16x32_bf16 v[116:119], a[108:111], v[220:223], v[116:119]
ds_read_b64_tr_b16 a[88:89], v249 offset:1536
ds_read_b64_tr_b16 a[90:91], v249 offset:5632
v_mfma_f32_16x16x32_bf16 v[84:87], a[108:111], v[216:219], v[84:87]
s_add_u32 s6, s6, 16384
v_exp_f32 v153, v153
s_addc_u32 s7, s7, 0
v_mfma_f32_16x16x32_bf16 v[84:87], a[104:107], v[200:203], v[84:87]
v_add_f32 v241, v241, v139
v_cvt_pk_bf16_f32 v185, v146, v147
v_mfma_f32_16x16x32_bf16 v[52:55], a[104:107], v[196:199], v[52:55]
v_exp_f32 v154, v154
v_mfma_f32_16x16x32_bf16 v[52:55], a[108:111], v[212:215], v[52:55]
ds_read_b64_tr_b16 a[92:93], v249 offset:9728
ds_read_b64_tr_b16 a[94:95], v249 offset:13824
v_mfma_f32_16x16x32_bf16 v[20:23], a[108:111], v[208:211], v[20:23]
v_exp_f32 v155, v155
v_mfma_f32_16x16x32_bf16 v[20:23], a[104:107], v[192:195], v[20:23]
s_waitcnt lgkmcnt(4)
v_add_f32 v243, v243, v152
v_cvt_pk_bf16_f32 v188, v152, v153
v_mfma_f32_16x16x32_bf16 v[24:27], a[80:83], v[192:195], v[24:27]
v_exp_f32 v132, v132
v_mfma_f32_16x16x32_bf16 v[24:27], a[84:87], v[208:211], v[24:27]
ds_read_b128 a[64:67], v244 offset:0
ds_read_b128 a[68:71], v244 offset:512
v_mfma_f32_16x16x32_bf16 v[56:59], a[84:87], v[212:215], v[56:59]
v_exp_f32 v133, v133
v_mfma_f32_16x16x32_bf16 v[56:59], a[80:83], v[196:199], v[56:59]
v_add_f32 v243, v243, v153
v_cvt_pk_bf16_f32 v189, v154, v155
v_mfma_f32_16x16x32_bf16 v[88:91], a[80:83], v[200:203], v[88:91]
v_exp_f32 v134, v134
v_mfma_f32_16x16x32_bf16 v[88:91], a[84:87], v[216:219], v[88:91]
ds_read_b128 a[72:75], v244 offset:1024
ds_read_b128 a[76:79], v244 offset:1536
v_mfma_f32_16x16x32_bf16 v[120:123], a[84:87], v[220:223], v[120:123]
v_exp_f32 v135, v135
v_mfma_f32_16x16x32_bf16 v[120:123], a[80:83], v[204:207], v[120:123]
s_waitcnt lgkmcnt(4)
v_add_f32 v243, v243, v154
v_cvt_pk_bf16_f32 v178, v132, v133
v_mfma_f32_16x16x32_bf16 v[124:127], a[88:91], v[204:207], v[124:127]
v_exp_f32 v140, v140
v_mfma_f32_16x16x32_bf16 v[124:127], a[92:95], v[220:223], v[124:127]
ds_read_b128 a[80:83], v244 offset:4096
v_add_u32 v246, s33, v247
v_mfma_f32_16x16x32_bf16 v[92:95], a[92:95], v[216:219], v[92:95]
v_exp_f32 v141, v141
v_mfma_f32_16x16x32_bf16 v[92:95], a[88:91], v[200:203], v[92:95]
v_add_f32 v243, v243, v155
v_cvt_pk_bf16_f32 v179, v134, v135
v_mfma_f32_16x16x32_bf16 v[60:63], a[88:91], v[196:199], v[60:63]
v_exp_f32 v142, v142
v_mfma_f32_16x16x32_bf16 v[60:63], a[92:95], v[212:215], v[60:63]
ds_read_b128 a[84:87], v244 offset:4608
v_xor_b32 v249, 32, v246
v_mfma_f32_16x16x32_bf16 v[28:31], a[92:95], v[208:211], v[28:31]
v_exp_f32 v143, v143
v_mfma_f32_16x16x32_bf16 v[28:31], a[88:91], v[192:195], v[28:31]
s_waitcnt lgkmcnt(2)
v_add_f32 v241, v241, v140
v_cvt_pk_bf16_f32 v182, v140, v141
v_mfma_f32_16x16x32_bf16 v[128:131], a[64:67], a[0:3], v[224:227]
s_add_u32 s43, s81, 20480
v_exp_f32 v148, v148
s_add_u32 s32, s81, 24576
v_mfma_f32_16x16x32_bf16 v[128:131], a[68:71], a[4:7], v[128:131]
ds_read_b128 a[88:91], v244 offset:5120
buffer_load_dwordx4 a[136:139], v250, s[16:19], s43 offen offset:0 sc1
v_mfma_f32_16x16x32_bf16 v[128:131], a[72:75], a[8:11], v[128:131]
s_add_u32 m0, s39, s31
v_exp_f32 v149, v149
v_mfma_f32_16x16x32_bf16 v[128:131], a[76:79], a[12:15], v[128:131]
v_add_f32 v241, v241, v141
v_cvt_pk_bf16_f32 v183, v142, v143
v_mfma_f32_16x16x32_bf16 v[136:139], a[76:79], a[28:31], v[228:231]
v_exp_f32 v150, v150
v_mfma_f32_16x16x32_bf16 v[136:139], a[72:75], a[24:27], v[136:139]
ds_read_b128 a[92:95], v244 offset:5632
global_load_lds_dwordx4 v248, s[8:9] offset:0
v_mfma_f32_16x16x32_bf16 v[136:139], a[68:71], a[20:23], v[136:139]
v_exp_f32 v151, v151
v_mfma_f32_16x16x32_bf16 v[136:139], a[64:67], a[16:19], v[136:139]
v_add_f32 v241, v241, v142
v_cvt_pk_bf16_f32 v186, v148, v149
v_mfma_f32_16x16x32_bf16 v[144:147], a[64:67], a[32:35], v[232:235]
v_exp_f32 v156, v156
v_mfma_f32_16x16x32_bf16 v[144:147], a[68:71], a[36:39], v[144:147]
global_load_lds_dwordx4 v248, s[10:11] offset:1024
buffer_load_dwordx4 a[140:143], v250, s[16:19], s43 offen offset:1024 sc1
v_mfma_f32_16x16x32_bf16 v[144:147], a[72:75], a[40:43], v[144:147]
v_exp_f32 v157, v157
v_mfma_f32_16x16x32_bf16 v[144:147], a[76:79], a[44:47], v[144:147]
v_add_f32 v241, v241, v143
v_cvt_pk_bf16_f32 v187, v150, v151
v_mfma_f32_16x16x32_bf16 v[152:155], a[76:79], a[60:63], v[236:239]
v_exp_f32 v158, v158
v_mfma_f32_16x16x32_bf16 v[152:155], a[72:75], a[56:59], v[152:155]
global_load_lds_dwordx4 v248, s[8:9] offset:2048
global_load_lds_dwordx4 v248, s[10:11] offset:3072
v_mfma_f32_16x16x32_bf16 v[152:155], a[68:71], a[52:55], v[152:155]
v_exp_f32 v159, v159
v_mfma_f32_16x16x32_bf16 v[152:155], a[64:67], a[48:51], v[152:155]
s_waitcnt lgkmcnt(0)
v_add_f32 v243, v243, v156
v_cvt_pk_bf16_f32 v190, v156, v157
v_mfma_f32_16x16x32_bf16 v[132:135], a[80:83], a[0:3], v[224:227]
v_exp_f32 v128, v128
v_mfma_f32_16x16x32_bf16 v[132:135], a[84:87], a[4:7], v[132:135]
ds_read_b64_tr_b16 a[96:97], v246 offset:0
ds_read_b64_tr_b16 a[98:99], v246 offset:4096
v_mfma_f32_16x16x32_bf16 v[132:135], a[88:91], a[8:11], v[132:135]
v_exp_f32 v129, v129
v_mfma_f32_16x16x32_bf16 v[132:135], a[92:95], a[12:15], v[132:135]
v_add_f32 v243, v243, v157
v_cvt_pk_bf16_f32 v191, v158, v159
v_mfma_f32_16x16x32_bf16 v[140:143], a[92:95], a[28:31], v[228:231]
v_exp_f32 v130, v130
v_mfma_f32_16x16x32_bf16 v[140:143], a[88:91], a[24:27], v[140:143]
ds_read_b64_tr_b16 a[100:101], v246 offset:8192
ds_read_b64_tr_b16 a[102:103], v246 offset:12288
v_mfma_f32_16x16x32_bf16 v[140:143], a[84:87], a[20:23], v[140:143]
v_exp_f32 v131, v131
v_mfma_f32_16x16x32_bf16 v[140:143], a[80:83], a[16:19], v[140:143]
v_add_f32 v243, v243, v158
v_cvt_pk_bf16_f32 v192, v128, v129
v_mfma_f32_16x16x32_bf16 v[148:151], a[80:83], a[32:35], v[232:235]
v_exp_f32 v136, v136
v_mfma_f32_16x16x32_bf16 v[148:151], a[84:87], a[36:39], v[148:151]
ds_read_b64_tr_b16 a[104:105], v249 offset:0
ds_read_b64_tr_b16 a[106:107], v249 offset:4096
v_mfma_f32_16x16x32_bf16 v[148:151], a[88:91], a[40:43], v[148:151]
v_exp_f32 v137, v137
v_mfma_f32_16x16x32_bf16 v[148:151], a[92:95], a[44:47], v[148:151]
v_add_f32 v243, v243, v159
v_cvt_pk_bf16_f32 v193, v130, v131
v_mfma_f32_16x16x32_bf16 v[156:159], a[92:95], a[60:63], v[236:239]
v_exp_f32 v138, v138
v_mfma_f32_16x16x32_bf16 v[156:159], a[88:91], a[56:59], v[156:159]
ds_read_b64_tr_b16 a[108:109], v249 offset:8192
ds_read_b64_tr_b16 a[110:111], v249 offset:12288
v_mfma_f32_16x16x32_bf16 v[156:159], a[84:87], a[52:55], v[156:159]
v_exp_f32 v139, v139
v_mfma_f32_16x16x32_bf16 v[156:159], a[80:83], a[48:51], v[156:159]
s_waitcnt lgkmcnt(4)
v_add_f32 v241, v241, v136
v_cvt_pk_bf16_f32 v196, v136, v137
v_mfma_f32_16x16x32_bf16 v[0:3], a[96:99], v[160:163], v[0:3]
s_add_u32 s39, s37, 65536
v_exp_f32 v144, v144
s_add_u32 s37, s37, 16384
v_mfma_f32_16x16x32_bf16 v[0:3], a[100:103], v[176:179], v[0:3]
ds_read_b64_tr_b16 a[80:81], v246 offset:512
ds_read_b64_tr_b16 a[82:83], v246 offset:4608
v_mfma_f32_16x16x32_bf16 v[32:35], a[100:103], v[180:183], v[32:35]
s_and_b32 s37, s37, 0xffff
v_exp_f32 v145, v145
v_mfma_f32_16x16x32_bf16 v[32:35], a[96:99], v[164:167], v[32:35]
v_add_f32 v241, v241, v137
v_cvt_pk_bf16_f32 v197, v138, v139
v_mfma_f32_16x16x32_bf16 v[64:67], a[96:99], v[168:171], v[64:67]
v_exp_f32 v146, v146
v_mfma_f32_16x16x32_bf16 v[64:67], a[100:103], v[184:187], v[64:67]
ds_read_b64_tr_b16 a[84:85], v246 offset:8704
ds_read_b64_tr_b16 a[86:87], v246 offset:12800
v_mfma_f32_16x16x32_bf16 v[96:99], a[100:103], v[188:191], v[96:99]
v_exp_f32 v147, v147
v_mfma_f32_16x16x32_bf16 v[96:99], a[96:99], v[172:175], v[96:99]
s_waitcnt lgkmcnt(4)
v_add_f32 v241, v241, v138
v_cvt_pk_bf16_f32 v200, v144, v145
v_mfma_f32_16x16x32_bf16 a[116:119], a[112:115], v[160:163], a[116:119]
buffer_load_dwordx4 a[144:147], v250, s[16:19], s43 offen offset:2048 sc1
buffer_load_dwordx4 a[148:151], v250, s[16:19], s43 offen offset:3072 sc1
v_mfma_f32_16x16x32_bf16 a[116:119], a[112:115], v[176:179], a[116:119]
buffer_load_dwordx4 a[152:155], v250, s[16:19], s32 offen offset:0 sc1
v_mfma_f32_16x16x32_bf16 v[100:103], a[104:107], v[172:175], v[100:103]
s_add_u32 s8, s8, 16384
v_exp_f32 v152, v152
s_addc_u32 s9, s9, 0
v_mfma_f32_16x16x32_bf16 v[100:103], a[108:111], v[188:191], v[100:103]
ds_read_b64_tr_b16 a[88:89], v249 offset:512
ds_read_b64_tr_b16 a[90:91], v249 offset:4608
v_mfma_f32_16x16x32_bf16 v[68:71], a[108:111], v[184:187], v[68:71]
s_add_u32 s10, s10, 16384
v_exp_f32 v153, v153
s_addc_u32 s11, s11, 0
v_mfma_f32_16x16x32_bf16 v[68:71], a[104:107], v[168:171], v[68:71]
v_add_f32 v241, v241, v139
v_cvt_pk_bf16_f32 v201, v146, v147
v_mfma_f32_16x16x32_bf16 v[36:39], a[104:107], v[164:167], v[36:39]
v_exp_f32 v154, v154
v_mfma_f32_16x16x32_bf16 v[36:39], a[108:111], v[180:183], v[36:39]
ds_read_b64_tr_b16 a[92:93], v249 offset:8704
ds_read_b64_tr_b16 a[94:95], v249 offset:12800
v_mfma_f32_16x16x32_bf16 v[4:7], a[108:111], v[176:179], v[4:7]
v_exp_f32 v155, v155
v_mfma_f32_16x16x32_bf16 v[4:7], a[104:107], v[160:163], v[4:7]
s_waitcnt lgkmcnt(4)
v_add_f32 v243, v243, v152
v_cvt_pk_bf16_f32 v204, v152, v153
v_mfma_f32_16x16x32_bf16 v[8:11], a[80:83], v[160:163], v[8:11]
v_exp_f32 v132, v132
v_mfma_f32_16x16x32_bf16 v[8:11], a[84:87], v[176:179], v[8:11]
ds_read_b128 a[64:67], v244 offset:8192
ds_read_b128 a[68:71], v244 offset:8704
v_mfma_f32_16x16x32_bf16 v[40:43], a[84:87], v[180:183], v[40:43]
v_exp_f32 v133, v133
v_mfma_f32_16x16x32_bf16 v[40:43], a[80:83], v[164:167], v[40:43]
v_add_f32 v243, v243, v153
v_cvt_pk_bf16_f32 v205, v154, v155
v_mfma_f32_16x16x32_bf16 v[72:75], a[80:83], v[168:171], v[72:75]
v_exp_f32 v134, v134
v_mfma_f32_16x16x32_bf16 v[72:75], a[84:87], v[184:187], v[72:75]
ds_read_b128 a[72:75], v244 offset:9216
ds_read_b128 a[76:79], v244 offset:9728
v_mfma_f32_16x16x32_bf16 v[104:107], a[84:87], v[188:191], v[104:107]
v_exp_f32 v135, v135
v_mfma_f32_16x16x32_bf16 v[104:107], a[80:83], v[172:175], v[104:107]
s_waitcnt lgkmcnt(4)
v_add_f32 v243, v243, v154
v_cvt_pk_bf16_f32 v194, v132, v133
v_mfma_f32_16x16x32_bf16 v[108:111], a[88:91], v[172:175], v[108:111]
s_add_u32 s43, s81, 25600
v_exp_f32 v140, v140
s_add_u32 s32, s81, 29696
v_mfma_f32_16x16x32_bf16 v[108:111], a[92:95], v[188:191], v[108:111]
ds_read_b128 a[80:83], v244 offset:12288
buffer_load_dwordx4 a[156:159], v250, s[16:19], s43 offen offset:0 sc1
v_mfma_f32_16x16x32_bf16 v[76:79], a[92:95], v[184:187], v[76:79]
v_exp_f32 v141, v141
v_mfma_f32_16x16x32_bf16 v[76:79], a[88:91], v[168:171], v[76:79]
v_add_f32 v243, v243, v155
v_cvt_pk_bf16_f32 v195, v134, v135
v_mfma_f32_16x16x32_bf16 v[44:47], a[88:91], v[164:167], v[44:47]
v_exp_f32 v142, v142
v_mfma_f32_16x16x32_bf16 v[44:47], a[92:95], v[180:183], v[44:47]
ds_read_b128 a[84:87], v244 offset:12800
buffer_load_dwordx4 a[160:163], v250, s[16:19], s43 offen offset:1024 sc1
v_mfma_f32_16x16x32_bf16 v[12:15], a[92:95], v[176:179], v[12:15]
v_exp_f32 v143, v143
v_mfma_f32_16x16x32_bf16 v[12:15], a[88:91], v[160:163], v[12:15]
s_waitcnt lgkmcnt(2)
v_add_f32 v241, v241, v140
v_cvt_pk_bf16_f32 v198, v140, v141
v_mfma_f32_16x16x32_bf16 v[128:131], a[64:67], a[0:3], v[224:227]
s_waitcnt vmcnt(18)
v_exp_f32 v148, v148
s_barrier
v_mfma_f32_16x16x32_bf16 v[128:131], a[68:71], a[4:7], v[128:131]
ds_read_b128 a[88:91], v244 offset:13312
buffer_load_dwordx4 a[164:167], v250, s[16:19], s43 offen offset:2048 sc1
v_mfma_f32_16x16x32_bf16 v[128:131], a[72:75], a[8:11], v[128:131]
s_add_u32 m0, s37, s31
v_exp_f32 v149, v149
v_mfma_f32_16x16x32_bf16 v[128:131], a[76:79], a[12:15], v[128:131]
v_add_f32 v241, v241, v141
v_cvt_pk_bf16_f32 v199, v142, v143
v_mfma_f32_16x16x32_bf16 v[136:139], a[76:79], a[28:31], v[228:231]
v_exp_f32 v150, v150
v_mfma_f32_16x16x32_bf16 v[136:139], a[72:75], a[24:27], v[136:139]
ds_read_b128 a[92:95], v244 offset:13824
global_load_lds_dwordx4 v248, s[4:5] offset:0
v_mfma_f32_16x16x32_bf16 v[136:139], a[68:71], a[20:23], v[136:139]
v_exp_f32 v151, v151
v_mfma_f32_16x16x32_bf16 v[136:139], a[64:67], a[16:19], v[136:139]
v_add_f32 v241, v241, v142
v_cvt_pk_bf16_f32 v202, v148, v149
v_mfma_f32_16x16x32_bf16 v[144:147], a[64:67], a[32:35], v[232:235]
v_exp_f32 v156, v156
v_mfma_f32_16x16x32_bf16 v[144:147], a[68:71], a[36:39], v[144:147]
global_load_lds_dwordx4 v248, s[6:7] offset:1024
buffer_load_dwordx4 a[168:171], v250, s[16:19], s43 offen offset:3072 sc1
v_mfma_f32_16x16x32_bf16 v[144:147], a[72:75], a[40:43], v[144:147]
v_exp_f32 v157, v157
v_mfma_f32_16x16x32_bf16 v[144:147], a[76:79], a[44:47], v[144:147]
v_add_f32 v241, v241, v143
v_cvt_pk_bf16_f32 v203, v150, v151
v_mfma_f32_16x16x32_bf16 v[152:155], a[76:79], a[60:63], v[236:239]
v_exp_f32 v158, v158
v_mfma_f32_16x16x32_bf16 v[152:155], a[72:75], a[56:59], v[152:155]
global_load_lds_dwordx4 v248, s[4:5] offset:2048
global_load_lds_dwordx4 v248, s[6:7] offset:3072
v_mfma_f32_16x16x32_bf16 v[152:155], a[68:71], a[52:55], v[152:155]
v_exp_f32 v159, v159
v_mfma_f32_16x16x32_bf16 v[152:155], a[64:67], a[48:51], v[152:155]
s_waitcnt lgkmcnt(0)
v_add_f32 v243, v243, v156
v_cvt_pk_bf16_f32 v206, v156, v157
v_mfma_f32_16x16x32_bf16 v[132:135], a[80:83], a[0:3], v[224:227]
v_exp_f32 v128, v128
v_mfma_f32_16x16x32_bf16 v[132:135], a[84:87], a[4:7], v[132:135]
ds_read_b64_tr_b16 a[96:97], v246 offset:1024
ds_read_b64_tr_b16 a[98:99], v246 offset:5120
v_mfma_f32_16x16x32_bf16 v[132:135], a[88:91], a[8:11], v[132:135]
v_exp_f32 v129, v129
v_mfma_f32_16x16x32_bf16 v[132:135], a[92:95], a[12:15], v[132:135]
v_add_f32 v243, v243, v157
v_cvt_pk_bf16_f32 v207, v158, v159
v_mfma_f32_16x16x32_bf16 v[140:143], a[92:95], a[28:31], v[228:231]
v_exp_f32 v130, v130
v_mfma_f32_16x16x32_bf16 v[140:143], a[88:91], a[24:27], v[140:143]
ds_read_b64_tr_b16 a[100:101], v246 offset:9216
ds_read_b64_tr_b16 a[102:103], v246 offset:13312
v_mfma_f32_16x16x32_bf16 v[140:143], a[84:87], a[20:23], v[140:143]
v_exp_f32 v131, v131
v_mfma_f32_16x16x32_bf16 v[140:143], a[80:83], a[16:19], v[140:143]
v_add_f32 v243, v243, v158
v_cvt_pk_bf16_f32 v208, v128, v129
v_mfma_f32_16x16x32_bf16 v[148:151], a[80:83], a[32:35], v[232:235]
s_mov_b32 s33, s35
v_exp_f32 v136, v136
s_add_u32 s35, s35, 16384
v_mfma_f32_16x16x32_bf16 v[148:151], a[84:87], a[36:39], v[148:151]
ds_read_b64_tr_b16 a[104:105], v249 offset:1024
ds_read_b64_tr_b16 a[106:107], v249 offset:5120
buffer_load_dwordx4 a[172:175], v250, s[16:19], s32 offen offset:0 sc1
v_mfma_f32_16x16x32_bf16 v[148:151], a[88:91], a[40:43], v[148:151]
s_and_b32 s35, s35, 0xffff
v_exp_f32 v137, v137
v_mfma_f32_16x16x32_bf16 v[148:151], a[92:95], a[44:47], v[148:151]
v_add_f32 v243, v243, v159
v_cvt_pk_bf16_f32 v209, v130, v131
v_mfma_f32_16x16x32_bf16 v[156:159], a[92:95], a[60:63], v[236:239]
v_exp_f32 v138, v138
v_mfma_f32_16x16x32_bf16 v[156:159], a[88:91], a[56:59], v[156:159]
ds_read_b64_tr_b16 a[108:109], v249 offset:9216
ds_read_b64_tr_b16 a[110:111], v249 offset:13312
v_mfma_f32_16x16x32_bf16 v[156:159], a[84:87], a[52:55], v[156:159]
v_exp_f32 v139, v139
v_mfma_f32_16x16x32_bf16 v[156:159], a[80:83], a[48:51], v[156:159]
s_waitcnt lgkmcnt(4)
v_add_f32 v241, v241, v136
v_cvt_pk_bf16_f32 v212, v136, v137
v_mfma_f32_16x16x32_bf16 v[16:19], a[96:99], v[160:163], v[16:19]
v_exp_f32 v144, v144
v_mfma_f32_16x16x32_bf16 v[16:19], a[100:103], v[176:179], v[16:19]
ds_read_b64_tr_b16 a[80:81], v246 offset:1536
ds_read_b64_tr_b16 a[82:83], v246 offset:5632
v_mfma_f32_16x16x32_bf16 v[48:51], a[100:103], v[180:183], v[48:51]
v_exp_f32 v145, v145
v_mfma_f32_16x16x32_bf16 v[48:51], a[96:99], v[164:167], v[48:51]
v_add_f32 v241, v241, v137
v_cvt_pk_bf16_f32 v213, v138, v139
v_mfma_f32_16x16x32_bf16 v[80:83], a[96:99], v[168:171], v[80:83]
s_add_u32 s43, s81, 30720
v_exp_f32 v146, v146
s_add_u32 s32, s81, 34816
v_mfma_f32_16x16x32_bf16 v[80:83], a[100:103], v[184:187], v[80:83]
ds_read_b64_tr_b16 a[84:85], v246 offset:9728
ds_read_b64_tr_b16 a[86:87], v246 offset:13824
v_mfma_f32_16x16x32_bf16 v[112:115], a[100:103], v[188:191], v[112:115]
v_exp_f32 v147, v147
v_mfma_f32_16x16x32_bf16 v[112:115], a[96:99], v[172:175], v[112:115]
s_waitcnt lgkmcnt(4)
v_add_f32 v241, v241, v138
v_cvt_pk_bf16_f32 v216, v144, v145
v_mfma_f32_16x16x32_bf16 a[120:123], a[112:115], v[168:171], a[120:123]
L_m_c1_0:
s_cbranch_execz L_m_c1_ret
buffer_load_dwordx4 a[176:179], v250, s[16:19], s43 offen offset:0 sc1
buffer_load_dwordx4 a[180:183], v250, s[16:19], s43 offen offset:1024 sc1
v_mfma_f32_16x16x32_bf16 a[120:123], a[112:115], v[184:187], a[120:123]
v_add_u32 v244, s35, v245
v_mfma_f32_16x16x32_bf16 v[116:119], a[104:107], v[172:175], v[116:119]
s_add_u32 s4, s4, 16384
v_exp_f32 v152, v152
s_addc_u32 s5, s5, 0
v_mfma_f32_16x16x32_bf16 v[116:119], a[108:111], v[188:191], v[116:119]
ds_read_b64_tr_b16 a[88:89], v249 offset:1536
ds_read_b64_tr_b16 a[90:91], v249 offset:5632
v_mfma_f32_16x16x32_bf16 v[84:87], a[108:111], v[184:187], v[84:87]
s_add_u32 s6, s6, 16384
v_exp_f32 v153, v153
s_addc_u32 s7, s7, 0
v_mfma_f32_16x16x32_bf16 v[84:87], a[104:107], v[168:171], v[84:87]
v_add_f32 v241, v241, v139
v_cvt_pk_bf16_f32 v217, v146, v147
v_mfma_f32_16x16x32_bf16 v[52:55], a[104:107], v[164:167], v[52:55]
v_exp_f32 v154, v154
v_mfma_f32_16x16x32_bf16 v[52:55], a[108:111], v[180:183], v[52:55]
ds_read_b64_tr_b16 a[92:93], v249 offset:9728
ds_read_b64_tr_b16 a[94:95], v249 offset:13824
v_mfma_f32_16x16x32_bf16 v[20:23], a[108:111], v[176:179], v[20:23]
v_exp_f32 v155, v155
v_mfma_f32_16x16x32_bf16 v[20:23], a[104:107], v[160:163], v[20:23]
s_waitcnt lgkmcnt(4)
v_add_f32 v243, v243, v152
v_cvt_pk_bf16_f32 v220, v152, v153
v_mfma_f32_16x16x32_bf16 v[24:27], a[80:83], v[160:163], v[24:27]
v_exp_f32 v132, v132
v_mfma_f32_16x16x32_bf16 v[24:27], a[84:87], v[176:179], v[24:27]
ds_read_b128 a[64:67], v244 offset:0
ds_read_b128 a[68:71], v244 offset:512
v_mfma_f32_16x16x32_bf16 v[56:59], a[84:87], v[180:183], v[56:59]
v_exp_f32 v133, v133
v_mfma_f32_16x16x32_bf16 v[56:59], a[80:83], v[164:167], v[56:59]
v_add_f32 v243, v243, v153
v_cvt_pk_bf16_f32 v221, v154, v155
v_mfma_f32_16x16x32_bf16 v[88:91], a[80:83], v[168:171], v[88:91]
v_exp_f32 v134, v134
v_mfma_f32_16x16x32_bf16 v[88:91], a[84:87], v[184:187], v[88:91]
ds_read_b128 a[72:75], v244 offset:1024
ds_read_b128 a[76:79], v244 offset:1536
v_mfma_f32_16x16x32_bf16 v[120:123], a[84:87], v[188:191], v[120:123]
v_exp_f32 v135, v135
v_mfma_f32_16x16x32_bf16 v[120:123], a[80:83], v[172:175], v[120:123]
s_waitcnt lgkmcnt(4)
v_add_f32 v243, v243, v154
v_cvt_pk_bf16_f32 v210, v132, v133
v_mfma_f32_16x16x32_bf16 v[124:127], a[88:91], v[172:175], v[124:127]
v_exp_f32 v140, v140
v_mfma_f32_16x16x32_bf16 v[124:127], a[92:95], v[188:191], v[124:127]
ds_read_b128 a[80:83], v244 offset:4096
v_add_u32 v246, s33, v247
v_mfma_f32_16x16x32_bf16 v[92:95], a[92:95], v[184:187], v[92:95]
v_exp_f32 v141, v141
v_mfma_f32_16x16x32_bf16 v[92:95], a[88:91], v[168:171], v[92:95]
v_add_f32 v243, v243, v155
v_cvt_pk_bf16_f32 v211, v134, v135
v_mfma_f32_16x16x32_bf16 v[60:63], a[88:91], v[164:167], v[60:63]
v_exp_f32 v142, v142
v_mfma_f32_16x16x32_bf16 v[60:63], a[92:95], v[180:183], v[60:63]
ds_read_b128 a[84:87], v244 offset:4608
v_xor_b32 v249, 32, v246
v_mfma_f32_16x16x32_bf16 v[28:31], a[92:95], v[176:179], v[28:31]
v_exp_f32 v143, v143
v_mfma_f32_16x16x32_bf16 v[28:31], a[88:91], v[160:163], v[28:31]
s_waitcnt lgkmcnt(2)
v_add_f32 v241, v241, v140
v_cvt_pk_bf16_f32 v214, v140, v141
v_mfma_f32_16x16x32_bf16 v[128:131], a[64:67], a[0:3], v[224:227]
v_exp_f32 v148, v148
v_mfma_f32_16x16x32_bf16 v[128:131], a[68:71], a[4:7], v[128:131]
ds_read_b128 a[88:91], v244 offset:5120
buffer_load_dwordx4 a[184:187], v250, s[16:19], s43 offen offset:2048 sc1
v_mfma_f32_16x16x32_bf16 v[128:131], a[72:75], a[8:11], v[128:131]
s_add_u32 m0, s39, s31
v_exp_f32 v149, v149
v_mfma_f32_16x16x32_bf16 v[128:131], a[76:79], a[12:15], v[128:131]
v_add_f32 v241, v241, v141
v_cvt_pk_bf16_f32 v215, v142, v143
v_mfma_f32_16x16x32_bf16 v[136:139], a[76:79], a[28:31], v[228:231]
v_exp_f32 v150, v150
v_mfma_f32_16x16x32_bf16 v[136:139], a[72:75], a[24:27], v[136:139]
ds_read_b128 a[92:95], v244 offset:5632
global_load_lds_dwordx4 v248, s[8:9] offset:0
v_mfma_f32_16x16x32_bf16 v[136:139], a[68:71], a[20:23], v[136:139]
v_exp_f32 v151, v151
v_mfma_f32_16x16x32_bf16 v[136:139], a[64:67], a[16:19], v[136:139]
v_add_f32 v241, v241, v142
v_cvt_pk_bf16_f32 v218, v148, v149
v_mfma_f32_16x16x32_bf16 v[144:147], a[64:67], a[32:35], v[232:235]
v_exp_f32 v156, v156
v_mfma_f32_16x16x32_bf16 v[144:147], a[68:71], a[36:39], v[144:147]
global_load_lds_dwordx4 v248, s[10:11] offset:1024
buffer_load_dwordx4 a[188:191], v250, s[16:19], s43 offen offset:3072 sc1
v_mfma_f32_16x16x32_bf16 v[144:147], a[72:75], a[40:43], v[144:147]
v_exp_f32 v157, v157
v_mfma_f32_16x16x32_bf16 v[144:147], a[76:79], a[44:47], v[144:147]
v_add_f32 v241, v241, v143
v_cvt_pk_bf16_f32 v219, v150, v151
v_mfma_f32_16x16x32_bf16 v[152:155], a[76:79], a[60:63], v[236:239]
v_exp_f32 v158, v158
v_mfma_f32_16x16x32_bf16 v[152:155], a[72:75], a[56:59], v[152:155]
global_load_lds_dwordx4 v248, s[8:9] offset:2048
global_load_lds_dwordx4 v248, s[10:11] offset:3072
v_mfma_f32_16x16x32_bf16 v[152:155], a[68:71], a[52:55], v[152:155]
v_exp_f32 v159, v159
v_mfma_f32_16x16x32_bf16 v[152:155], a[64:67], a[48:51], v[152:155]
s_waitcnt lgkmcnt(0)
v_add_f32 v243, v243, v156
v_cvt_pk_bf16_f32 v222, v156, v157
v_mfma_f32_16x16x32_bf16 v[132:135], a[80:83], a[0:3], v[224:227]
v_exp_f32 v128, v128
v_mfma_f32_16x16x32_bf16 v[132:135], a[84:87], a[4:7], v[132:135]
ds_read_b64_tr_b16 a[96:97], v246 offset:0
ds_read_b64_tr_b16 a[98:99], v246 offset:4096
v_mfma_f32_16x16x32_bf16 v[132:135], a[88:91], a[8:11], v[132:135]
v_exp_f32 v129, v129
v_mfma_f32_16x16x32_bf16 v[132:135], a[92:95], a[12:15], v[132:135]
v_add_f32 v243, v243, v157
v_cvt_pk_bf16_f32 v223, v158, v159
v_mfma_f32_16x16x32_bf16 v[140:143], a[92:95], a[28:31], v[228:231]
v_exp_f32 v130, v130
v_mfma_f32_16x16x32_bf16 v[140:143], a[88:91], a[24:27], v[140:143]
ds_read_b64_tr_b16 a[100:101], v246 offset:8192
ds_read_b64_tr_b16 a[102:103], v246 offset:12288
v_mfma_f32_16x16x32_bf16 v[140:143], a[84:87], a[20:23], v[140:143]
v_exp_f32 v131, v131
v_mfma_f32_16x16x32_bf16 v[140:143], a[80:83], a[16:19], v[140:143]
v_add_f32 v243, v243, v158
v_cvt_pk_bf16_f32 v160, v128, v129
v_mfma_f32_16x16x32_bf16 v[148:151], a[80:83], a[32:35], v[232:235]
v_exp_f32 v136, v136
v_mfma_f32_16x16x32_bf16 v[148:151], a[84:87], a[36:39], v[148:151]
ds_read_b64_tr_b16 a[104:105], v249 offset:0
ds_read_b64_tr_b16 a[106:107], v249 offset:4096
v_mfma_f32_16x16x32_bf16 v[148:151], a[88:91], a[40:43], v[148:151]
v_exp_f32 v137, v137
v_mfma_f32_16x16x32_bf16 v[148:151], a[92:95], a[44:47], v[148:151]
v_add_f32 v243, v243, v159
v_cvt_pk_bf16_f32 v161, v130, v131
v_mfma_f32_16x16x32_bf16 v[156:159], a[92:95], a[60:63], v[236:239]
v_exp_f32 v138, v138
v_mfma_f32_16x16x32_bf16 v[156:159], a[88:91], a[56:59], v[156:159]
ds_read_b64_tr_b16 a[108:109], v249 offset:8192
ds_read_b64_tr_b16 a[110:111], v249 offset:12288
v_mfma_f32_16x16x32_bf16 v[156:159], a[84:87], a[52:55], v[156:159]
v_exp_f32 v139, v139
v_mfma_f32_16x16x32_bf16 v[156:159], a[80:83], a[48:51], v[156:159]
s_waitcnt lgkmcnt(4)
v_add_f32 v241, v241, v136
v_cvt_pk_bf16_f32 v164, v136, v137
v_mfma_f32_16x16x32_bf16 v[0:3], a[96:99], v[192:195], v[0:3]
s_add_u32 s39, s37, 65536
v_exp_f32 v144, v144
s_add_u32 s37, s37, 16384
v_mfma_f32_16x16x32_bf16 v[0:3], a[100:103], v[208:211], v[0:3]
ds_read_b64_tr_b16 a[80:81], v246 offset:512
ds_read_b64_tr_b16 a[82:83], v246 offset:4608
v_mfma_f32_16x16x32_bf16 v[32:35], a[100:103], v[212:215], v[32:35]
s_and_b32 s37, s37, 0xffff
v_exp_f32 v145, v145
v_mfma_f32_16x16x32_bf16 v[32:35], a[96:99], v[196:199], v[32:35]
v_add_f32 v241, v241, v137
v_cvt_pk_bf16_f32 v165, v138, v139
v_mfma_f32_16x16x32_bf16 v[64:67], a[96:99], v[200:203], v[64:67]
v_exp_f32 v146, v146
v_mfma_f32_16x16x32_bf16 v[64:67], a[100:103], v[216:219], v[64:67]
ds_read_b64_tr_b16 a[84:85], v246 offset:8704
ds_read_b64_tr_b16 a[86:87], v246 offset:12800
v_mfma_f32_16x16x32_bf16 v[96:99], a[100:103], v[220:223], v[96:99]
v_exp_f32 v147, v147
v_mfma_f32_16x16x32_bf16 v[96:99], a[96:99], v[204:207], v[96:99]
s_waitcnt lgkmcnt(4)
v_add_f32 v241, v241, v138
v_cvt_pk_bf16_f32 v168, v144, v145
v_mfma_f32_16x16x32_bf16 a[116:119], a[112:115], v[192:195], a[116:119]
buffer_load_dwordx4 a[192:195], v250, s[16:19], s32 offen offset:0 sc1
v_mfma_f32_16x16x32_bf16 a[116:119], a[112:115], v[208:211], a[116:119]
v_mfma_f32_16x16x32_bf16 v[100:103], a[104:107], v[204:207], v[100:103]
s_add_u32 s8, s8, 16384
v_exp_f32 v152, v152
s_addc_u32 s9, s9, 0
v_mfma_f32_16x16x32_bf16 v[100:103], a[108:111], v[220:223], v[100:103]
ds_read_b64_tr_b16 a[88:89], v249 offset:512
ds_read_b64_tr_b16 a[90:91], v249 offset:4608
v_mfma_f32_16x16x32_bf16 v[68:71], a[108:111], v[216:219], v[68:71]
s_add_u32 s10, s10, 16384
v_exp_f32 v153, v153
s_addc_u32 s11, s11, 0
v_mfma_f32_16x16x32_bf16 v[68:71], a[104:107], v[200:203], v[68:71]
v_add_f32 v241, v241, v139
v_cvt_pk_bf16_f32 v169, v146, v147
v_mfma_f32_16x16x32_bf16 v[36:39], a[104:107], v[196:199], v[36:39]
s_add_u32 s43, s81, 35840
v_exp_f32 v154, v154
s_add_u32 s32, s81, 39936
v_mfma_f32_16x16x32_bf16 v[36:39], a[108:111], v[212:215], v[36:39]
ds_read_b64_tr_b16 a[92:93], v249 offset:8704
ds_read_b64_tr_b16 a[94:95], v249 offset:12800
buffer_load_dwordx4 a[196:199], v250, s[16:19], s43 offen offset:0 sc1
v_mfma_f32_16x16x32_bf16 v[4:7], a[108:111], v[208:211], v[4:7]
v_exp_f32 v155, v155
v_mfma_f32_16x16x32_bf16 v[4:7], a[104:107], v[192:195], v[4:7]
s_waitcnt lgkmcnt(4)
v_add_f32 v243, v243, v152
v_cvt_pk_bf16_f32 v172, v152, v153
v_mfma_f32_16x16x32_bf16 v[8:11], a[80:83], v[192:195], v[8:11]
v_exp_f32 v132, v132
v_mfma_f32_16x16x32_bf16 v[8:11], a[84:87], v[208:211], v[8:11]
ds_read_b128 a[64:67], v244 offset:8192
ds_read_b128 a[68:71], v244 offset:8704
buffer_load_dwordx4 a[200:203], v250, s[16:19], s43 offen offset:1024 sc1
v_mfma_f32_16x16x32_bf16 v[40:43], a[84:87], v[212:215], v[40:43]
v_exp_f32 v133, v133
v_mfma_f32_16x16x32_bf16 v[40:43], a[80:83], v[196:199], v[40:43]
v_add_f32 v243, v243, v153
v_cvt_pk_bf16_f32 v173, v154, v155
v_mfma_f32_16x16x32_bf16 v[72:75], a[80:83], v[200:203], v[72:75]
v_exp_f32 v134, v134
v_mfma_f32_16x16x32_bf16 v[72:75], a[84:87], v[216:219], v[72:75]
ds_read_b128 a[72:75], v244 offset:9216
ds_read_b128 a[76:79], v244 offset:9728
v_mfma_f32_16x16x32_bf16 v[104:107], a[84:87], v[220:223], v[104:107]
v_exp_f32 v135, v135
v_mfma_f32_16x16x32_bf16 v[104:107], a[80:83], v[204:207], v[104:107]
s_waitcnt lgkmcnt(4)
v_add_f32 v243, v243, v154
v_cvt_pk_bf16_f32 v162, v132, v133
v_mfma_f32_16x16x32_bf16 v[108:111], a[88:91], v[204:207], v[108:111]
v_exp_f32 v140, v140
v_mfma_f32_16x16x32_bf16 v[108:111], a[92:95], v[220:223], v[108:111]
ds_read_b128 a[80:83], v244 offset:12288
buffer_load_dwordx4 a[204:207], v250, s[16:19], s43 offen offset:2048 sc1
v_mfma_f32_16x16x32_bf16 v[76:79], a[92:95], v[216:219], v[76:79]
v_exp_f32 v141, v141
v_mfma_f32_16x16x32_bf16 v[76:79], a[88:91], v[200:203], v[76:79]
v_add_f32 v243, v243, v155
v_cvt_pk_bf16_f32 v163, v134, v135
v_mfma_f32_16x16x32_bf16 v[44:47], a[88:91], v[196:199], v[44:47]
v_exp_f32 v142, v142
v_mfma_f32_16x16x32_bf16 v[44:47], a[92:95], v[212:215], v[44:47]
ds_read_b128 a[84:87], v244 offset:12800
buffer_load_dwordx4 a[208:211], v250, s[16:19], s43 offen offset:3072 sc1
v_mfma_f32_16x16x32_bf16 v[12:15], a[92:95], v[208:211], v[12:15]
v_exp_f32 v143, v143
v_mfma_f32_16x16x32_bf16 v[12:15], a[88:91], v[192:195], v[12:15]
s_waitcnt lgkmcnt(2)
v_add_f32 v241, v241, v140
v_cvt_pk_bf16_f32 v166, v140, v141
v_mfma_f32_16x16x32_bf16 v[128:131], a[64:67], a[0:3], v[224:227]
s_waitcnt vmcnt(25)
v_exp_f32 v148, v148
s_barrier
v_mfma_f32_16x16x32_bf16 v[128:131], a[68:71], a[4:7], v[128:131]
ds_read_b128 a[88:91], v244 offset:13312
buffer_load_dwordx4 a[212:215], v250, s[16:19], s32 offen offset:0 sc1
v_mfma_f32_16x16x32_bf16 v[128:131], a[72:75], a[8:11], v[128:131]
s_add_u32 m0, s37, s31
v_exp_f32 v149, v149
v_mfma_f32_16x16x32_bf16 v[128:131], a[76:79], a[12:15], v[128:131]
v_add_f32 v241, v241, v141
v_cvt_pk_bf16_f32 v167, v142, v143
v_mfma_f32_16x16x32_bf16 v[136:139], a[76:79], a[28:31], v[228:231]
v_exp_f32 v150, v150
v_mfma_f32_16x16x32_bf16 v[136:139], a[72:75], a[24:27], v[136:139]
ds_read_b128 a[92:95], v244 offset:13824
global_load_lds_dwordx4 v248, s[4:5] offset:0
v_mfma_f32_16x16x32_bf16 v[136:139], a[68:71], a[20:23], v[136:139]
v_exp_f32 v151, v151
v_mfma_f32_16x16x32_bf16 v[136:139], a[64:67], a[16:19], v[136:139]
v_add_f32 v241, v241, v142
v_cvt_pk_bf16_f32 v170, v148, v149
v_mfma_f32_16x16x32_bf16 v[144:147], a[64:67], a[32:35], v[232:235]
s_add_u32 s43, s81, 40960
v_exp_f32 v156, v156
s_add_u32 s32, s81, 45056
v_mfma_f32_16x16x32_bf16 v[144:147], a[68:71], a[36:39], v[144:147]
global_load_lds_dwordx4 v248, s[6:7] offset:1024
buffer_load_dwordx4 a[216:219], v250, s[16:19], s43 offen offset:0 sc1
v_mfma_f32_16x16x32_bf16 v[144:147], a[72:75], a[40:43], v[144:147]
v_exp_f32 v157, v157
v_mfma_f32_16x16x32_bf16 v[144:147], a[76:79], a[44:47], v[144:147]
v_add_f32 v241, v241, v143
v_cvt_pk_bf16_f32 v171, v150, v151
v_mfma_f32_16x16x32_bf16 v[152:155], a[76:79], a[60:63], v[236:239]
v_exp_f32 v158, v158
v_mfma_f32_16x16x32_bf16 v[152:155], a[72:75], a[56:59], v[152:155]
global_load_lds_dwordx4 v248, s[4:5] offset:2048
global_load_lds_dwordx4 v248, s[6:7] offset:3072
v_mfma_f32_16x16x32_bf16 v[152:155], a[68:71], a[52:55], v[152:155]
v_exp_f32 v159, v159
v_mfma_f32_16x16x32_bf16 v[152:155], a[64:67], a[48:51], v[152:155]
s_waitcnt lgkmcnt(0)
v_add_f32 v243, v243, v156
v_cvt_pk_bf16_f32 v174, v156, v157
v_mfma_f32_16x16x32_bf16 v[132:135], a[80:83], a[0:3], v[224:227]
v_exp_f32 v128, v128
v_mfma_f32_16x16x32_bf16 v[132:135], a[84:87], a[4:7], v[132:135]
ds_read_b64_tr_b16 a[96:97], v246 offset:1024
ds_read_b64_tr_b16 a[98:99], v246 offset:5120
v_mfma_f32_16x16x32_bf16 v[132:135], a[88:91], a[8:11], v[132:135]
v_exp_f32 v129, v129
v_mfma_f32_16x16x32_bf16 v[132:135], a[92:95], a[12:15], v[132:135]
v_add_f32 v243, v243, v157
v_cvt_pk_bf16_f32 v175, v158, v159
v_mfma_f32_16x16x32_bf16 v[140:143], a[92:95], a[28:31], v[228:231]
v_exp_f32 v130, v130
v_mfma_f32_16x16x32_bf16 v[140:143], a[88:91], a[24:27], v[140:143]
ds_read_b64_tr_b16 a[100:101], v246 offset:9216
ds_read_b64_tr_b16 a[102:103], v246 offset:13312
v_mfma_f32_16x16x32_bf16 v[140:143], a[84:87], a[20:23], v[140:143]
v_exp_f32 v131, v131
v_mfma_f32_16x16x32_bf16 v[140:143], a[80:83], a[16:19], v[140:143]
v_add_f32 v243, v243, v158
v_cvt_pk_bf16_f32 v176, v128, v129
v_mfma_f32_16x16x32_bf16 v[148:151], a[80:83], a[32:35], v[232:235]
s_mov_b32 s33, s35
v_exp_f32 v136, v136
s_add_u32 s35, s35, 16384
v_mfma_f32_16x16x32_bf16 v[148:151], a[84:87], a[36:39], v[148:151]
ds_read_b64_tr_b16 a[104:105], v249 offset:1024
ds_read_b64_tr_b16 a[106:107], v249 offset:5120
buffer_load_dwordx4 a[220:223], v250, s[16:19], s43 offen offset:1024 sc1
v_mfma_f32_16x16x32_bf16 v[148:151], a[88:91], a[40:43], v[148:151]
s_and_b32 s35, s35, 0xffff
v_exp_f32 v137, v137
v_mfma_f32_16x16x32_bf16 v[148:151], a[92:95], a[44:47], v[148:151]
v_add_f32 v243, v243, v159
v_cvt_pk_bf16_f32 v177, v130, v131
v_mfma_f32_16x16x32_bf16 v[156:159], a[92:95], a[60:63], v[236:239]
v_exp_f32 v138, v138
v_mfma_f32_16x16x32_bf16 v[156:159], a[88:91], a[56:59], v[156:159]
ds_read_b64_tr_b16 a[108:109], v249 offset:9216
ds_read_b64_tr_b16 a[110:111], v249 offset:13312
v_mfma_f32_16x16x32_bf16 v[156:159], a[84:87], a[52:55], v[156:159]
v_exp_f32 v139, v139
v_mfma_f32_16x16x32_bf16 v[156:159], a[80:83], a[48:51], v[156:159]
s_waitcnt lgkmcnt(4)
v_add_f32 v241, v241, v136
v_cvt_pk_bf16_f32 v180, v136, v137
v_mfma_f32_16x16x32_bf16 v[16:19], a[96:99], v[192:195], v[16:19]
v_exp_f32 v144, v144
v_mfma_f32_16x16x32_bf16 v[16:19], a[100:103], v[208:211], v[16:19]
ds_read_b64_tr_b16 a[80:81], v246 offset:1536
ds_read_b64_tr_b16 a[82:83], v246 offset:5632
v_mfma_f32_16x16x32_bf16 v[48:51], a[100:103], v[212:215], v[48:51]
v_exp_f32 v145, v145
v_mfma_f32_16x16x32_bf16 v[48:51], a[96:99], v[196:199], v[48:51]
v_add_f32 v241, v241, v137
v_cvt_pk_bf16_f32 v181, v138, v139
v_mfma_f32_16x16x32_bf16 v[80:83], a[96:99], v[200:203], v[80:83]
v_exp_f32 v146, v146
v_mfma_f32_16x16x32_bf16 v[80:83], a[100:103], v[216:219], v[80:83]
ds_read_b64_tr_b16 a[84:85], v246 offset:9728
ds_read_b64_tr_b16 a[86:87], v246 offset:13824
v_mfma_f32_16x16x32_bf16 v[112:115], a[100:103], v[220:223], v[112:115]
v_exp_f32 v147, v147
v_mfma_f32_16x16x32_bf16 v[112:115], a[96:99], v[204:207], v[112:115]
s_waitcnt lgkmcnt(4)
v_add_f32 v241, v241, v138
v_cvt_pk_bf16_f32 v184, v144, v145
v_mfma_f32_16x16x32_bf16 a[120:123], a[112:115], v[200:203], a[120:123]
buffer_load_dwordx4 a[224:227], v250, s[16:19], s43 offen offset:2048 sc1
buffer_load_dwordx4 a[228:231], v250, s[16:19], s43 offen offset:3072 sc1
v_mfma_f32_16x16x32_bf16 a[120:123], a[112:115], v[216:219], a[120:123]
v_add_u32 v244, s35, v245
v_mfma_f32_16x16x32_bf16 v[116:119], a[104:107], v[204:207], v[116:119]
v_exp_f32 v152, v152
v_mfma_f32_16x16x32_bf16 v[116:119], a[108:111], v[220:223], v[116:119]
ds_read_b64_tr_b16 a[88:89], v249 offset:1536
ds_read_b64_tr_b16 a[90:91], v249 offset:5632
v_mfma_f32_16x16x32_bf16 v[84:87], a[108:111], v[216:219], v[84:87]
v_exp_f32 v153, v153
v_mfma_f32_16x16x32_bf16 v[84:87], a[104:107], v[200:203], v[84:87]
v_add_f32 v241, v241, v139
v_cvt_pk_bf16_f32 v185, v146, v147
v_mfma_f32_16x16x32_bf16 v[52:55], a[104:107], v[196:199], v[52:55]
v_exp_f32 v154, v154
v_mfma_f32_16x16x32_bf16 v[52:55], a[108:111], v[212:215], v[52:55]
ds_read_b64_tr_b16 a[92:93], v249 offset:9728
ds_read_b64_tr_b16 a[94:95], v249 offset:13824
v_mfma_f32_16x16x32_bf16 v[20:23], a[108:111], v[208:211], v[20:23]
v_exp_f32 v155, v155
v_mfma_f32_16x16x32_bf16 v[20:23], a[104:107], v[192:195], v[20:23]
s_waitcnt lgkmcnt(4)
v_add_f32 v243, v243, v152
v_cvt_pk_bf16_f32 v188, v152, v153
v_mfma_f32_16x16x32_bf16 v[24:27], a[80:83], v[192:195], v[24:27]
v_exp_f32 v132, v132
v_mfma_f32_16x16x32_bf16 v[24:27], a[84:87], v[208:211], v[24:27]
ds_read_b128 a[64:67], v244 offset:0
ds_read_b128 a[68:71], v244 offset:512
v_mfma_f32_16x16x32_bf16 v[56:59], a[84:87], v[212:215], v[56:59]
v_exp_f32 v133, v133
v_mfma_f32_16x16x32_bf16 v[56:59], a[80:83], v[196:199], v[56:59]
v_add_f32 v243, v243, v153
v_cvt_pk_bf16_f32 v189, v154, v155
v_mfma_f32_16x16x32_bf16 v[88:91], a[80:83], v[200:203], v[88:91]
v_exp_f32 v134, v134
v_mfma_f32_16x16x32_bf16 v[88:91], a[84:87], v[216:219], v[88:91]
ds_read_b128 a[72:75], v244 offset:1024
ds_read_b128 a[76:79], v244 offset:1536
v_mfma_f32_16x16x32_bf16 v[120:123], a[84:87], v[220:223], v[120:123]
v_exp_f32 v135, v135
v_mfma_f32_16x16x32_bf16 v[120:123], a[80:83], v[204:207], v[120:123]
s_waitcnt lgkmcnt(4)
v_add_f32 v243, v243, v154
v_cvt_pk_bf16_f32 v178, v132, v133
v_mfma_f32_16x16x32_bf16 v[124:127], a[88:91], v[204:207], v[124:127]
v_exp_f32 v140, v140
v_mfma_f32_16x16x32_bf16 v[124:127], a[92:95], v[220:223], v[124:127]
ds_read_b128 a[80:83], v244 offset:4096
v_add_u32 v246, s33, v247
v_mfma_f32_16x16x32_bf16 v[92:95], a[92:95], v[216:219], v[92:95]
v_exp_f32 v141, v141
v_mfma_f32_16x16x32_bf16 v[92:95], a[88:91], v[200:203], v[92:95]
v_add_f32 v243, v243, v155
v_cvt_pk_bf16_f32 v179, v134, v135
v_mfma_f32_16x16x32_bf16 v[60:63], a[88:91], v[196:199], v[60:63]
v_exp_f32 v142, v142
v_mfma_f32_16x16x32_bf16 v[60:63], a[92:95], v[212:215], v[60:63]
ds_read_b128 a[84:87], v244 offset:4608
v_xor_b32 v249, 32, v246
v_mfma_f32_16x16x32_bf16 v[28:31], a[92:95], v[208:211], v[28:31]
v_exp_f32 v143, v143
v_mfma_f32_16x16x32_bf16 v[28:31], a[88:91], v[192:195], v[28:31]
s_waitcnt lgkmcnt(2)
v_add_f32 v241, v241, v140
v_cvt_pk_bf16_f32 v182, v140, v141
v_mfma_f32_16x16x32_bf16 v[128:131], a[64:67], a[0:3], v[224:227]
v_exp_f32 v148, v148
v_mfma_f32_16x16x32_bf16 v[128:131], a[68:71], a[4:7], v[128:131]
ds_read_b128 a[88:91], v244 offset:5120
buffer_load_dwordx4 a[232:235], v250, s[16:19], s32 offen offset:0 sc1
v_mfma_f32_16x16x32_bf16 v[128:131], a[72:75], a[8:11], v[128:131]
s_add_u32 m0, s39, s31
v_exp_f32 v149, v149
v_mfma_f32_16x16x32_bf16 v[128:131], a[76:79], a[12:15], v[128:131]
v_add_f32 v241, v241, v141
v_cvt_pk_bf16_f32 v183, v142, v143
v_mfma_f32_16x16x32_bf16 v[136:139], a[76:79], a[28:31], v[228:231]
v_exp_f32 v150, v150
v_mfma_f32_16x16x32_bf16 v[136:139], a[72:75], a[24:27], v[136:139]
ds_read_b128 a[92:95], v244 offset:5632
global_load_lds_dwordx4 v248, s[8:9] offset:0
v_mfma_f32_16x16x32_bf16 v[136:139], a[68:71], a[20:23], v[136:139]
v_exp_f32 v151, v151
v_mfma_f32_16x16x32_bf16 v[136:139], a[64:67], a[16:19], v[136:139]
v_add_f32 v241, v241, v142
v_cvt_pk_bf16_f32 v186, v148, v149
v_mfma_f32_16x16x32_bf16 v[144:147], a[64:67], a[32:35], v[232:235]
s_add_u32 s43, s81, 46080
v_exp_f32 v156, v156
s_add_u32 s32, s81, 50176
v_mfma_f32_16x16x32_bf16 v[144:147], a[68:71], a[36:39], v[144:147]
global_load_lds_dwordx4 v248, s[10:11] offset:1024
buffer_load_dwordx4 a[236:239], v250, s[16:19], s43 offen offset:0 sc1
v_mfma_f32_16x16x32_bf16 v[144:147], a[72:75], a[40:43], v[144:147]
v_exp_f32 v157, v157
v_mfma_f32_16x16x32_bf16 v[144:147], a[76:79], a[44:47], v[144:147]
v_add_f32 v241, v241, v143
v_cvt_pk_bf16_f32 v187, v150, v151
v_mfma_f32_16x16x32_bf16 v[152:155], a[76:79], a[60:63], v[236:239]
v_exp_f32 v158, v158
v_mfma_f32_16x16x32_bf16 v[152:155], a[72:75], a[56:59], v[152:155]
global_load_lds_dwordx4 v248, s[8:9] offset:2048
global_load_lds_dwordx4 v248, s[10:11] offset:3072
v_mfma_f32_16x16x32_bf16 v[152:155], a[68:71], a[52:55], v[152:155]
v_exp_f32 v159, v159
v_mfma_f32_16x16x32_bf16 v[152:155], a[64:67], a[48:51], v[152:155]
s_waitcnt lgkmcnt(0)
v_add_f32 v243, v243, v156
v_cvt_pk_bf16_f32 v190, v156, v157
v_mfma_f32_16x16x32_bf16 v[132:135], a[80:83], a[0:3], v[224:227]
v_exp_f32 v128, v128
v_mfma_f32_16x16x32_bf16 v[132:135], a[84:87], a[4:7], v[132:135]
ds_read_b64_tr_b16 a[96:97], v246 offset:0
ds_read_b64_tr_b16 a[98:99], v246 offset:4096
v_mfma_f32_16x16x32_bf16 v[132:135], a[88:91], a[8:11], v[132:135]
v_exp_f32 v129, v129
v_mfma_f32_16x16x32_bf16 v[132:135], a[92:95], a[12:15], v[132:135]
v_add_f32 v243, v243, v157
v_cvt_pk_bf16_f32 v191, v158, v159
v_mfma_f32_16x16x32_bf16 v[140:143], a[92:95], a[28:31], v[228:231]
v_exp_f32 v130, v130
v_mfma_f32_16x16x32_bf16 v[140:143], a[88:91], a[24:27], v[140:143]
ds_read_b64_tr_b16 a[100:101], v246 offset:8192
ds_read_b64_tr_b16 a[102:103], v246 offset:12288
v_mfma_f32_16x16x32_bf16 v[140:143], a[84:87], a[20:23], v[140:143]
v_exp_f32 v131, v131
v_mfma_f32_16x16x32_bf16 v[140:143], a[80:83], a[16:19], v[140:143]
v_add_f32 v243, v243, v158
v_cvt_pk_bf16_f32 v192, v128, v129
v_mfma_f32_16x16x32_bf16 v[148:151], a[80:83], a[32:35], v[232:235]
v_exp_f32 v136, v136
v_mfma_f32_16x16x32_bf16 v[148:151], a[84:87], a[36:39], v[148:151]
ds_read_b64_tr_b16 a[104:105], v249 offset:0
ds_read_b64_tr_b16 a[106:107], v249 offset:4096
v_mfma_f32_16x16x32_bf16 v[148:151], a[88:91], a[40:43], v[148:151]
v_exp_f32 v137, v137
v_mfma_f32_16x16x32_bf16 v[148:151], a[92:95], a[44:47], v[148:151]
v_add_f32 v243, v243, v159
v_cvt_pk_bf16_f32 v193, v130, v131
v_mfma_f32_16x16x32_bf16 v[156:159], a[92:95], a[60:63], v[236:239]
v_exp_f32 v138, v138
v_mfma_f32_16x16x32_bf16 v[156:159], a[88:91], a[56:59], v[156:159]
ds_read_b64_tr_b16 a[108:109], v249 offset:8192
ds_read_b64_tr_b16 a[110:111], v249 offset:12288
v_mfma_f32_16x16x32_bf16 v[156:159], a[84:87], a[52:55], v[156:159]
v_exp_f32 v139, v139
v_mfma_f32_16x16x32_bf16 v[156:159], a[80:83], a[48:51], v[156:159]
s_waitcnt lgkmcnt(4)
v_add_f32 v241, v241, v136
v_cvt_pk_bf16_f32 v196, v136, v137
v_mfma_f32_16x16x32_bf16 v[0:3], a[96:99], v[160:163], v[0:3]
s_add_u32 s39, s37, 65536
v_exp_f32 v144, v144
s_add_u32 s37, s37, 16384
v_mfma_f32_16x16x32_bf16 v[0:3], a[100:103], v[176:179], v[0:3]
ds_read_b64_tr_b16 a[80:81], v246 offset:512
ds_read_b64_tr_b16 a[82:83], v246 offset:4608
v_mfma_f32_16x16x32_bf16 v[32:35], a[100:103], v[180:183], v[32:35]
s_and_b32 s37, s37, 0xffff
v_exp_f32 v145, v145
v_mfma_f32_16x16x32_bf16 v[32:35], a[96:99], v[164:167], v[32:35]
v_add_f32 v241, v241, v137
v_cvt_pk_bf16_f32 v197, v138, v139
v_mfma_f32_16x16x32_bf16 v[64:67], a[96:99], v[168:171], v[64:67]
v_exp_f32 v146, v146
v_mfma_f32_16x16x32_bf16 v[64:67], a[100:103], v[184:187], v[64:67]
ds_read_b64_tr_b16 a[84:85], v246 offset:8704
ds_read_b64_tr_b16 a[86:87], v246 offset:12800
v_mfma_f32_16x16x32_bf16 v[96:99], a[100:103], v[188:191], v[96:99]
v_exp_f32 v147, v147
v_mfma_f32_16x16x32_bf16 v[96:99], a[96:99], v[172:175], v[96:99]
s_waitcnt lgkmcnt(4)
v_add_f32 v241, v241, v138
v_cvt_pk_bf16_f32 v200, v144, v145
v_mfma_f32_16x16x32_bf16 a[116:119], a[112:115], v[160:163], a[116:119]
buffer_load_dwordx4 a[240:243], v250, s[16:19], s43 offen offset:1024 sc1
buffer_load_dwordx4 a[244:247], v250, s[16:19], s43 offen offset:2048 sc1
v_mfma_f32_16x16x32_bf16 a[116:119], a[112:115], v[176:179], a[116:119]
buffer_load_dwordx4 a[248:251], v250, s[16:19], s43 offen offset:3072 sc1
v_mfma_f32_16x16x32_bf16 v[100:103], a[104:107], v[172:175], v[100:103]
s_add_u32 s8, s8, 16384
v_exp_f32 v152, v152
s_addc_u32 s9, s9, 0
v_mfma_f32_16x16x32_bf16 v[100:103], a[108:111], v[188:191], v[100:103]
ds_read_b64_tr_b16 a[88:89], v249 offset:512
ds_read_b64_tr_b16 a[90:91], v249 offset:4608
v_mfma_f32_16x16x32_bf16 v[68:71], a[108:111], v[184:187], v[68:71]
s_add_u32 s10, s10, 16384
v_exp_f32 v153, v153
s_addc_u32 s11, s11, 0
v_mfma_f32_16x16x32_bf16 v[68:71], a[104:107], v[168:171], v[68:71]
v_add_f32 v241, v241, v139
v_cvt_pk_bf16_f32 v201, v146, v147
v_mfma_f32_16x16x32_bf16 v[36:39], a[104:107], v[164:167], v[36:39]
v_exp_f32 v154, v154
v_mfma_f32_16x16x32_bf16 v[36:39], a[108:111], v[180:183], v[36:39]
ds_read_b64_tr_b16 a[92:93], v249 offset:8704
ds_read_b64_tr_b16 a[94:95], v249 offset:12800
v_mfma_f32_16x16x32_bf16 v[4:7], a[108:111], v[176:179], v[4:7]
v_exp_f32 v155, v155
v_mfma_f32_16x16x32_bf16 v[4:7], a[104:107], v[160:163], v[4:7]
s_waitcnt lgkmcnt(4)
v_add_f32 v243, v243, v152
v_cvt_pk_bf16_f32 v204, v152, v153
v_mfma_f32_16x16x32_bf16 v[8:11], a[80:83], v[160:163], v[8:11]
v_exp_f32 v132, v132
v_mfma_f32_16x16x32_bf16 v[8:11], a[84:87], v[176:179], v[8:11]
ds_read_b128 a[64:67], v244 offset:8192
ds_read_b128 a[68:71], v244 offset:8704
v_mfma_f32_16x16x32_bf16 v[40:43], a[84:87], v[180:183], v[40:43]
v_exp_f32 v133, v133
v_mfma_f32_16x16x32_bf16 v[40:43], a[80:83], v[164:167], v[40:43]
v_add_f32 v243, v243, v153
v_cvt_pk_bf16_f32 v205, v154, v155
v_mfma_f32_16x16x32_bf16 v[72:75], a[80:83], v[168:171], v[72:75]
v_exp_f32 v134, v134
v_mfma_f32_16x16x32_bf16 v[72:75], a[84:87], v[184:187], v[72:75]
ds_read_b128 a[72:75], v244 offset:9216
ds_read_b128 a[76:79], v244 offset:9728
v_mfma_f32_16x16x32_bf16 v[104:107], a[84:87], v[188:191], v[104:107]
v_exp_f32 v135, v135
v_mfma_f32_16x16x32_bf16 v[104:107], a[80:83], v[172:175], v[104:107]
s_waitcnt lgkmcnt(4)
v_add_f32 v243, v243, v154
v_cvt_pk_bf16_f32 v194, v132, v133
v_mfma_f32_16x16x32_bf16 v[108:111], a[88:91], v[172:175], v[108:111]
v_exp_f32 v140, v140
v_mfma_f32_16x16x32_bf16 v[108:111], a[92:95], v[188:191], v[108:111]
ds_read_b128 a[80:83], v244 offset:12288
buffer_load_dwordx4 a[252:255], v250, s[16:19], s32 offen offset:0 sc1
v_mfma_f32_16x16x32_bf16 v[76:79], a[92:95], v[184:187], v[76:79]
v_exp_f32 v141, v141
v_mfma_f32_16x16x32_bf16 v[76:79], a[88:91], v[168:171], v[76:79]
v_add_f32 v243, v243, v155
v_cvt_pk_bf16_f32 v195, v134, v135
v_mfma_f32_16x16x32_bf16 v[44:47], a[88:91], v[164:167], v[44:47]
v_exp_f32 v142, v142
v_mfma_f32_16x16x32_bf16 v[44:47], a[92:95], v[180:183], v[44:47]
ds_read_b128 a[84:87], v244 offset:12800
v_mfma_f32_16x16x32_bf16 v[12:15], a[92:95], v[176:179], v[12:15]
v_exp_f32 v143, v143
v_mfma_f32_16x16x32_bf16 v[12:15], a[88:91], v[160:163], v[12:15]
L_m_c1_1:
s_cbranch_execz L_m_c1_ret
s_waitcnt lgkmcnt(2)
v_add_f32 v241, v241, v140
v_cvt_pk_bf16_f32 v198, v140, v141
v_mfma_f32_16x16x32_bf16 v[128:131], a[64:67], a[0:3], v[224:227]
s_waitcnt vmcnt(24)
v_exp_f32 v148, v148
s_barrier
v_mfma_f32_16x16x32_bf16 v[128:131], a[68:71], a[4:7], v[128:131]
ds_read_b128 a[88:91], v244 offset:13312
v_mfma_f32_16x16x32_bf16 v[128:131], a[72:75], a[8:11], v[128:131]
s_add_u32 m0, s37, s31
v_exp_f32 v149, v149
v_mfma_f32_16x16x32_bf16 v[128:131], a[76:79], a[12:15], v[128:131]
v_add_f32 v241, v241, v141
v_cvt_pk_bf16_f32 v199, v142, v143
v_mfma_f32_16x16x32_bf16 v[136:139], a[76:79], a[28:31], v[228:231]
s_add_u32 s40, s81, 0
v_exp_f32 v150, v150
v_mfma_f32_16x16x32_bf16 v[136:139], a[72:75], a[24:27], v[136:139]
ds_read_b128 a[92:95], v244 offset:13824
buffer_load_dwordx4 v250, s[16:19], s40 offen offset:0 sc1 lds
v_mfma_f32_16x16x32_bf16 v[136:139], a[68:71], a[20:23], v[136:139]
v_exp_f32 v151, v151
v_mfma_f32_16x16x32_bf16 v[136:139], a[64:67], a[16:19], v[136:139]
v_add_f32 v241, v241, v142
v_cvt_pk_bf16_f32 v202, v148, v149
v_mfma_f32_16x16x32_bf16 v[144:147], a[64:67], a[32:35], v[232:235]
v_exp_f32 v156, v156
v_mfma_f32_16x16x32_bf16 v[144:147], a[68:71], a[36:39], v[144:147]
buffer_load_dwordx4 v250, s[16:19], s40 offen offset:1024 sc1 lds
v_mfma_f32_16x16x32_bf16 v[144:147], a[72:75], a[40:43], v[144:147]
v_exp_f32 v157, v157
v_mfma_f32_16x16x32_bf16 v[144:147], a[76:79], a[44:47], v[144:147]
v_add_f32 v241, v241, v143
v_cvt_pk_bf16_f32 v203, v150, v151
v_mfma_f32_16x16x32_bf16 v[152:155], a[76:79], a[60:63], v[236:239]
v_exp_f32 v158, v158
v_mfma_f32_16x16x32_bf16 v[152:155], a[72:75], a[56:59], v[152:155]
buffer_load_dwordx4 v250, s[16:19], s40 offen offset:2048 sc1 lds
buffer_load_dwordx4 v250, s[16:19], s40 offen offset:3072 sc1 lds
v_mfma_f32_16x16x32_bf16 v[152:155], a[68:71], a[52:55], v[152:155]
v_exp_f32 v159, v159
v_mfma_f32_16x16x32_bf16 v[152:155], a[64:67], a[48:51], v[152:155]
s_waitcnt lgkmcnt(0)
v_add_f32 v243, v243, v156
v_cvt_pk_bf16_f32 v206, v156, v157
v_mfma_f32_16x16x32_bf16 v[132:135], a[80:83], a[0:3], v[224:227]
v_exp_f32 v128, v128
v_mfma_f32_16x16x32_bf16 v[132:135], a[84:87], a[4:7], v[132:135]
ds_read_b64_tr_b16 a[96:97], v246 offset:1024
ds_read_b64_tr_b16 a[98:99], v246 offset:5120
v_mfma_f32_16x16x32_bf16 v[132:135], a[88:91], a[8:11], v[132:135]
v_exp_f32 v129, v129
v_mfma_f32_16x16x32_bf16 v[132:135], a[92:95], a[12:15], v[132:135]
v_add_f32 v243, v243, v157
v_cvt_pk_bf16_f32 v207, v158, v159
v_mfma_f32_16x16x32_bf16 v[140:143], a[92:95], a[28:31], v[228:231]
v_exp_f32 v130, v130
v_mfma_f32_16x16x32_bf16 v[140:143], a[88:91], a[24:27], v[140:143]
ds_read_b64_tr_b16 a[100:101], v246 offset:9216
ds_read_b64_tr_b16 a[102:103], v246 offset:13312
v_mfma_f32_16x16x32_bf16 v[140:143], a[84:87], a[20:23], v[140:143]
v_exp_f32 v131, v131
v_mfma_f32_16x16x32_bf16 v[140:143], a[80:83], a[16:19], v[140:143]
v_add_f32 v243, v243, v158
v_cvt_pk_bf16_f32 v208, v128, v129
v_mfma_f32_16x16x32_bf16 v[148:151], a[80:83], a[32:35], v[232:235]
s_mov_b32 s33, s35
v_exp_f32 v136, v136
s_add_u32 s35, s35, 16384
v_mfma_f32_16x16x32_bf16 v[148:151], a[84:87], a[36:39], v[148:151]
ds_read_b64_tr_b16 a[104:105], v249 offset:1024
ds_read_b64_tr_b16 a[106:107], v249 offset:5120
v_mfma_f32_16x16x32_bf16 v[148:151], a[88:91], a[40:43], v[148:151]
s_and_b32 s35, s35, 0xffff
v_exp_f32 v137, v137
v_mfma_f32_16x16x32_bf16 v[148:151], a[92:95], a[44:47], v[148:151]
v_add_f32 v243, v243, v159
v_cvt_pk_bf16_f32 v209, v130, v131
v_mfma_f32_16x16x32_bf16 v[156:159], a[92:95], a[60:63], v[236:239]
v_exp_f32 v138, v138
v_mfma_f32_16x16x32_bf16 v[156:159], a[88:91], a[56:59], v[156:159]
ds_read_b64_tr_b16 a[108:109], v249 offset:9216
ds_read_b64_tr_b16 a[110:111], v249 offset:13312
v_mfma_f32_16x16x32_bf16 v[156:159], a[84:87], a[52:55], v[156:159]
v_exp_f32 v139, v139
v_mfma_f32_16x16x32_bf16 v[156:159], a[80:83], a[48:51], v[156:159]
s_waitcnt lgkmcnt(4)
v_add_f32 v241, v241, v136
v_cvt_pk_bf16_f32 v212, v136, v137
v_mfma_f32_16x16x32_bf16 v[16:19], a[96:99], v[160:163], v[16:19]
v_exp_f32 v144, v144
v_mfma_f32_16x16x32_bf16 v[16:19], a[100:103], v[176:179], v[16:19]
ds_read_b64_tr_b16 a[80:81], v246 offset:1536
ds_read_b64_tr_b16 a[82:83], v246 offset:5632
v_mfma_f32_16x16x32_bf16 v[48:51], a[100:103], v[180:183], v[48:51]
v_exp_f32 v145, v145
v_mfma_f32_16x16x32_bf16 v[48:51], a[96:99], v[164:167], v[48:51]
v_add_f32 v241, v241, v137
v_cvt_pk_bf16_f32 v213, v138, v139
v_mfma_f32_16x16x32_bf16 v[80:83], a[96:99], v[168:171], v[80:83]
v_exp_f32 v146, v146
v_mfma_f32_16x16x32_bf16 v[80:83], a[100:103], v[184:187], v[80:83]
ds_read_b64_tr_b16 a[84:85], v246 offset:9728
ds_read_b64_tr_b16 a[86:87], v246 offset:13824
v_mfma_f32_16x16x32_bf16 v[112:115], a[100:103], v[188:191], v[112:115]
v_exp_f32 v147, v147
v_mfma_f32_16x16x32_bf16 v[112:115], a[96:99], v[172:175], v[112:115]
s_waitcnt lgkmcnt(4)
v_add_f32 v241, v241, v138
v_cvt_pk_bf16_f32 v216, v144, v145
v_mfma_f32_16x16x32_bf16 a[120:123], a[112:115], v[168:171], a[120:123]
v_add_u32 v244, s35, v245
v_mfma_f32_16x16x32_bf16 a[120:123], a[112:115], v[184:187], a[120:123]
v_mfma_f32_16x16x32_bf16 v[116:119], a[104:107], v[172:175], v[116:119]
v_exp_f32 v152, v152
v_mfma_f32_16x16x32_bf16 v[116:119], a[108:111], v[188:191], v[116:119]
ds_read_b64_tr_b16 a[88:89], v249 offset:1536
ds_read_b64_tr_b16 a[90:91], v249 offset:5632
v_mfma_f32_16x16x32_bf16 v[84:87], a[108:111], v[184:187], v[84:87]
v_exp_f32 v153, v153
v_mfma_f32_16x16x32_bf16 v[84:87], a[104:107], v[168:171], v[84:87]
v_add_f32 v241, v241, v139
v_cvt_pk_bf16_f32 v217, v146, v147
v_mfma_f32_16x16x32_bf16 v[52:55], a[104:107], v[164:167], v[52:55]
v_exp_f32 v154, v154
v_mfma_f32_16x16x32_bf16 v[52:55], a[108:111], v[180:183], v[52:55]
ds_read_b64_tr_b16 a[92:93], v249 offset:9728
ds_read_b64_tr_b16 a[94:95], v249 offset:13824
v_mfma_f32_16x16x32_bf16 v[20:23], a[108:111], v[176:179], v[20:23]
v_exp_f32 v155, v155
v_mfma_f32_16x16x32_bf16 v[20:23], a[104:107], v[160:163], v[20:23]
s_waitcnt lgkmcnt(4)
v_add_f32 v243, v243, v152
v_cvt_pk_bf16_f32 v220, v152, v153
v_mfma_f32_16x16x32_bf16 v[24:27], a[80:83], v[160:163], v[24:27]
v_exp_f32 v132, v132
v_mfma_f32_16x16x32_bf16 v[24:27], a[84:87], v[176:179], v[24:27]
ds_read_b128 a[64:67], v244 offset:0
ds_read_b128 a[68:71], v244 offset:512
v_mfma_f32_16x16x32_bf16 v[56:59], a[84:87], v[180:183], v[56:59]
v_exp_f32 v133, v133
v_mfma_f32_16x16x32_bf16 v[56:59], a[80:83], v[164:167], v[56:59]
v_add_f32 v243, v243, v153
v_cvt_pk_bf16_f32 v221, v154, v155
v_mfma_f32_16x16x32_bf16 v[88:91], a[80:83], v[168:171], v[88:91]
v_exp_f32 v134, v134
v_mfma_f32_16x16x32_bf16 v[88:91], a[84:87], v[184:187], v[88:91]
ds_read_b128 a[72:75], v244 offset:1024
ds_read_b128 a[76:79], v244 offset:1536
v_mfma_f32_16x16x32_bf16 v[120:123], a[84:87], v[188:191], v[120:123]
v_exp_f32 v135, v135
v_mfma_f32_16x16x32_bf16 v[120:123], a[80:83], v[172:175], v[120:123]
s_waitcnt lgkmcnt(4)
v_add_f32 v243, v243, v154
v_cvt_pk_bf16_f32 v210, v132, v133
v_mfma_f32_16x16x32_bf16 v[124:127], a[88:91], v[172:175], v[124:127]
v_exp_f32 v140, v140
v_mfma_f32_16x16x32_bf16 v[124:127], a[92:95], v[188:191], v[124:127]
ds_read_b128 a[80:83], v244 offset:4096
v_add_u32 v246, s33, v247
v_mfma_f32_16x16x32_bf16 v[92:95], a[92:95], v[184:187], v[92:95]
v_exp_f32 v141, v141
v_mfma_f32_16x16x32_bf16 v[92:95], a[88:91], v[168:171], v[92:95]
v_add_f32 v243, v243, v155
v_cvt_pk_bf16_f32 v211, v134, v135
v_mfma_f32_16x16x32_bf16 v[60:63], a[88:91], v[164:167], v[60:63]
v_exp_f32 v142, v142
v_mfma_f32_16x16x32_bf16 v[60:63], a[92:95], v[180:183], v[60:63]
ds_read_b128 a[84:87], v244 offset:4608
v_xor_b32 v249, 32, v246
v_mfma_f32_16x16x32_bf16 v[28:31], a[92:95], v[176:179], v[28:31]
v_exp_f32 v143, v143
v_mfma_f32_16x16x32_bf16 v[28:31], a[88:91], v[160:163], v[28:31]
s_waitcnt lgkmcnt(2)
v_add_f32 v241, v241, v140
v_cvt_pk_bf16_f32 v214, v140, v141
v_mfma_f32_16x16x32_bf16 v[128:131], a[64:67], a[0:3], v[224:227]
v_exp_f32 v148, v148
v_mfma_f32_16x16x32_bf16 v[128:131], a[68:71], a[4:7], v[128:131]
ds_read_b128 a[88:91], v244 offset:5120
v_mfma_f32_16x16x32_bf16 v[128:131], a[72:75], a[8:11], v[128:131]
s_add_u32 m0, s39, s31
v_exp_f32 v149, v149
v_mfma_f32_16x16x32_bf16 v[128:131], a[76:79], a[12:15], v[128:131]
v_add_f32 v241, v241, v141
v_cvt_pk_bf16_f32 v215, v142, v143
v_mfma_f32_16x16x32_bf16 v[136:139], a[76:79], a[28:31], v[228:231]
v_exp_f32 v150, v150
v_mfma_f32_16x16x32_bf16 v[136:139], a[72:75], a[24:27], v[136:139]
ds_read_b128 a[92:95], v244 offset:5632
global_load_lds_dwordx4 v248, s[8:9] offset:0
v_mfma_f32_16x16x32_bf16 v[136:139], a[68:71], a[20:23], v[136:139]
v_exp_f32 v151, v151
v_mfma_f32_16x16x32_bf16 v[136:139], a[64:67], a[16:19], v[136:139]
v_add_f32 v241, v241, v142
v_cvt_pk_bf16_f32 v218, v148, v149
v_mfma_f32_16x16x32_bf16 v[144:147], a[64:67], a[32:35], v[232:235]
v_exp_f32 v156, v156
v_mfma_f32_16x16x32_bf16 v[144:147], a[68:71], a[36:39], v[144:147]
global_load_lds_dwordx4 v248, s[10:11] offset:1024
v_mfma_f32_16x16x32_bf16 v[144:147], a[72:75], a[40:43], v[144:147]
v_exp_f32 v157, v157
v_mfma_f32_16x16x32_bf16 v[144:147], a[76:79], a[44:47], v[144:147]
v_add_f32 v241, v241, v143
v_cvt_pk_bf16_f32 v219, v150, v151
v_mfma_f32_16x16x32_bf16 v[152:155], a[76:79], a[60:63], v[236:239]
v_exp_f32 v158, v158
v_mfma_f32_16x16x32_bf16 v[152:155], a[72:75], a[56:59], v[152:155]
global_load_lds_dwordx4 v248, s[8:9] offset:2048
global_load_lds_dwordx4 v248, s[10:11] offset:3072
v_mfma_f32_16x16x32_bf16 v[152:155], a[68:71], a[52:55], v[152:155]
v_exp_f32 v159, v159
v_mfma_f32_16x16x32_bf16 v[152:155], a[64:67], a[48:51], v[152:155]
s_waitcnt lgkmcnt(0)
v_add_f32 v243, v243, v156
v_cvt_pk_bf16_f32 v222, v156, v157
v_mfma_f32_16x16x32_bf16 v[132:135], a[80:83], a[0:3], v[224:227]
v_exp_f32 v128, v128
v_mfma_f32_16x16x32_bf16 v[132:135], a[84:87], a[4:7], v[132:135]
ds_read_b64_tr_b16 a[96:97], v246 offset:0
ds_read_b64_tr_b16 a[98:99], v246 offset:4096
v_mfma_f32_16x16x32_bf16 v[132:135], a[88:91], a[8:11], v[132:135]
v_exp_f32 v129, v129
v_mfma_f32_16x16x32_bf16 v[132:135], a[92:95], a[12:15], v[132:135]
v_add_f32 v243, v243, v157
v_cvt_pk_bf16_f32 v223, v158, v159
v_mfma_f32_16x16x32_bf16 v[140:143], a[92:95], a[28:31], v[228:231]
v_exp_f32 v130, v130
v_mfma_f32_16x16x32_bf16 v[140:143], a[88:91], a[24:27], v[140:143]
ds_read_b64_tr_b16 a[100:101], v246 offset:8192
ds_read_b64_tr_b16 a[102:103], v246 offset:12288
v_mfma_f32_16x16x32_bf16 v[140:143], a[84:87], a[20:23], v[140:143]
v_exp_f32 v131, v131
v_mfma_f32_16x16x32_bf16 v[140:143], a[80:83], a[16:19], v[140:143]
v_add_f32 v243, v243, v158
v_cvt_pk_bf16_f32 v160, v128, v129
v_mfma_f32_16x16x32_bf16 v[148:151], a[80:83], a[32:35], v[232:235]
v_exp_f32 v136, v136
v_mfma_f32_16x16x32_bf16 v[148:151], a[84:87], a[36:39], v[148:151]
ds_read_b64_tr_b16 a[104:105], v249 offset:0
ds_read_b64_tr_b16 a[106:107], v249 offset:4096
v_mfma_f32_16x16x32_bf16 v[148:151], a[88:91], a[40:43], v[148:151]
v_exp_f32 v137, v137
v_mfma_f32_16x16x32_bf16 v[148:151], a[92:95], a[44:47], v[148:151]
v_add_f32 v243, v243, v159
v_cvt_pk_bf16_f32 v161, v130, v131
v_mfma_f32_16x16x32_bf16 v[156:159], a[92:95], a[60:63], v[236:239]
v_exp_f32 v138, v138
v_mfma_f32_16x16x32_bf16 v[156:159], a[88:91], a[56:59], v[156:159]
ds_read_b64_tr_b16 a[108:109], v249 offset:8192
ds_read_b64_tr_b16 a[110:111], v249 offset:12288
v_mfma_f32_16x16x32_bf16 v[156:159], a[84:87], a[52:55], v[156:159]
v_exp_f32 v139, v139
v_mfma_f32_16x16x32_bf16 v[156:159], a[80:83], a[48:51], v[156:159]
s_waitcnt lgkmcnt(4)
v_add_f32 v241, v241, v136
v_cvt_pk_bf16_f32 v164, v136, v137
v_mfma_f32_16x16x32_bf16 v[0:3], a[96:99], v[192:195], v[0:3]
s_add_u32 s39, s37, 65536
v_exp_f32 v144, v144
s_add_u32 s37, s37, 16384
v_mfma_f32_16x16x32_bf16 v[0:3], a[100:103], v[208:211], v[0:3]
ds_read_b64_tr_b16 a[80:81], v246 offset:512
ds_read_b64_tr_b16 a[82:83], v246 offset:4608
v_mfma_f32_16x16x32_bf16 v[32:35], a[100:103], v[212:215], v[32:35]
s_and_b32 s37, s37, 0xffff
v_exp_f32 v145, v145
v_mfma_f32_16x16x32_bf16 v[32:35], a[96:99], v[196:199], v[32:35]
v_add_f32 v241, v241, v137
v_cvt_pk_bf16_f32 v165, v138, v139
v_mfma_f32_16x16x32_bf16 v[64:67], a[96:99], v[200:203], v[64:67]
v_exp_f32 v146, v146
v_mfma_f32_16x16x32_bf16 v[64:67], a[100:103], v[216:219], v[64:67]
ds_read_b64_tr_b16 a[84:85], v246 offset:8704
ds_read_b64_tr_b16 a[86:87], v246 offset:12800
v_mfma_f32_16x16x32_bf16 v[96:99], a[100:103], v[220:223], v[96:99]
v_exp_f32 v147, v147
v_mfma_f32_16x16x32_bf16 v[96:99], a[96:99], v[204:207], v[96:99]
s_waitcnt lgkmcnt(4)
v_add_f32 v241, v241, v138
v_cvt_pk_bf16_f32 v168, v144, v145
v_mfma_f32_16x16x32_bf16 a[116:119], a[112:115], v[192:195], a[116:119]
v_mfma_f32_16x16x32_bf16 a[116:119], a[112:115], v[208:211], a[116:119]
v_mfma_f32_16x16x32_bf16 v[100:103], a[104:107], v[204:207], v[100:103]
v_exp_f32 v152, v152
v_mfma_f32_16x16x32_bf16 v[100:103], a[108:111], v[220:223], v[100:103]
ds_read_b64_tr_b16 a[88:89], v249 offset:512
ds_read_b64_tr_b16 a[90:91], v249 offset:4608
v_mfma_f32_16x16x32_bf16 v[68:71], a[108:111], v[216:219], v[68:71]
v_exp_f32 v153, v153
v_mfma_f32_16x16x32_bf16 v[68:71], a[104:107], v[200:203], v[68:71]
v_add_f32 v241, v241, v139
v_cvt_pk_bf16_f32 v169, v146, v147
v_mfma_f32_16x16x32_bf16 v[36:39], a[104:107], v[196:199], v[36:39]
v_exp_f32 v154, v154
v_mfma_f32_16x16x32_bf16 v[36:39], a[108:111], v[212:215], v[36:39]
ds_read_b64_tr_b16 a[92:93], v249 offset:8704
ds_read_b64_tr_b16 a[94:95], v249 offset:12800
v_mfma_f32_16x16x32_bf16 v[4:7], a[108:111], v[208:211], v[4:7]
v_exp_f32 v155, v155
v_mfma_f32_16x16x32_bf16 v[4:7], a[104:107], v[192:195], v[4:7]
s_waitcnt lgkmcnt(4)
v_add_f32 v243, v243, v152
v_cvt_pk_bf16_f32 v172, v152, v153
v_mfma_f32_16x16x32_bf16 v[8:11], a[80:83], v[192:195], v[8:11]
v_exp_f32 v132, v132
v_mfma_f32_16x16x32_bf16 v[8:11], a[84:87], v[208:211], v[8:11]
ds_read_b128 a[64:67], v244 offset:8192
ds_read_b128 a[68:71], v244 offset:8704
v_mfma_f32_16x16x32_bf16 v[40:43], a[84:87], v[212:215], v[40:43]
v_exp_f32 v133, v133
v_mfma_f32_16x16x32_bf16 v[40:43], a[80:83], v[196:199], v[40:43]
v_add_f32 v243, v243, v153
v_cvt_pk_bf16_f32 v173, v154, v155
v_mfma_f32_16x16x32_bf16 v[72:75], a[80:83], v[200:203], v[72:75]
v_exp_f32 v134, v134
v_mfma_f32_16x16x32_bf16 v[72:75], a[84:87], v[216:219], v[72:75]
ds_read_b128 a[72:75], v244 offset:9216
ds_read_b128 a[76:79], v244 offset:9728
v_mfma_f32_16x16x32_bf16 v[104:107], a[84:87], v[220:223], v[104:107]
v_exp_f32 v135, v135
v_mfma_f32_16x16x32_bf16 v[104:107], a[80:83], v[204:207], v[104:107]
s_waitcnt lgkmcnt(4)
v_add_f32 v243, v243, v154
v_cvt_pk_bf16_f32 v162, v132, v133
v_mfma_f32_16x16x32_bf16 v[108:111], a[88:91], v[204:207], v[108:111]
v_exp_f32 v140, v140
v_mfma_f32_16x16x32_bf16 v[108:111], a[92:95], v[220:223], v[108:111]
ds_read_b128 a[80:83], v244 offset:12288
v_mfma_f32_16x16x32_bf16 v[76:79], a[92:95], v[216:219], v[76:79]
v_exp_f32 v141, v141
v_mfma_f32_16x16x32_bf16 v[76:79], a[88:91], v[200:203], v[76:79]
v_add_f32 v243, v243, v155
v_cvt_pk_bf16_f32 v163, v134, v135
v_mfma_f32_16x16x32_bf16 v[44:47], a[88:91], v[196:199], v[44:47]
v_exp_f32 v142, v142
v_mfma_f32_16x16x32_bf16 v[44:47], a[92:95], v[212:215], v[44:47]
ds_read_b128 a[84:87], v244 offset:12800
v_mfma_f32_16x16x32_bf16 v[12:15], a[92:95], v[208:211], v[12:15]
v_exp_f32 v143, v143
v_mfma_f32_16x16x32_bf16 v[12:15], a[88:91], v[192:195], v[12:15]
s_waitcnt lgkmcnt(2)
v_add_f32 v241, v241, v140
v_cvt_pk_bf16_f32 v166, v140, v141
v_mfma_f32_16x16x32_bf16 v[128:131], a[64:67], a[0:3], v[224:227]
s_waitcnt vmcnt(12)
v_exp_f32 v148, v148
s_barrier
v_mfma_f32_16x16x32_bf16 v[128:131], a[68:71], a[4:7], v[128:131]
ds_read_b128 a[88:91], v244 offset:13312
v_mfma_f32_16x16x32_bf16 v[128:131], a[72:75], a[8:11], v[128:131]
s_add_u32 m0, s37, s31
v_exp_f32 v149, v149
v_mfma_f32_16x16x32_bf16 v[128:131], a[76:79], a[12:15], v[128:131]
v_add_f32 v241, v241, v141
v_cvt_pk_bf16_f32 v167, v142, v143
v_mfma_f32_16x16x32_bf16 v[136:139], a[76:79], a[28:31], v[228:231]
s_add_u32 s40, s81, 4096
v_exp_f32 v150, v150
v_mfma_f32_16x16x32_bf16 v[136:139], a[72:75], a[24:27], v[136:139]
ds_read_b128 a[92:95], v244 offset:13824
buffer_load_dwordx4 v250, s[16:19], s40 offen offset:0 sc1 lds
v_mfma_f32_16x16x32_bf16 v[136:139], a[68:71], a[20:23], v[136:139]
v_exp_f32 v151, v151
v_mfma_f32_16x16x32_bf16 v[136:139], a[64:67], a[16:19], v[136:139]
v_add_f32 v241, v241, v142
v_cvt_pk_bf16_f32 v170, v148, v149
v_mfma_f32_16x16x32_bf16 v[144:147], a[64:67], a[32:35], v[232:235]
v_exp_f32 v156, v156
v_mfma_f32_16x16x32_bf16 v[144:147], a[68:71], a[36:39], v[144:147]
buffer_load_dwordx4 v250, s[16:19], s40 offen offset:1024 sc1 lds
v_mfma_f32_16x16x32_bf16 v[144:147], a[72:75], a[40:43], v[144:147]
v_exp_f32 v157, v157
v_mfma_f32_16x16x32_bf16 v[144:147], a[76:79], a[44:47], v[144:147]
v_add_f32 v241, v241, v143
v_cvt_pk_bf16_f32 v171, v150, v151
v_mfma_f32_16x16x32_bf16 v[152:155], a[76:79], a[60:63], v[236:239]
v_exp_f32 v158, v158
v_mfma_f32_16x16x32_bf16 v[152:155], a[72:75], a[56:59], v[152:155]
buffer_load_dwordx4 v250, s[16:19], s40 offen offset:2048 sc1 lds
buffer_load_dwordx4 v250, s[16:19], s40 offen offset:3072 sc1 lds
v_mfma_f32_16x16x32_bf16 v[152:155], a[68:71], a[52:55], v[152:155]
v_exp_f32 v159, v159
v_mfma_f32_16x16x32_bf16 v[152:155], a[64:67], a[48:51], v[152:155]
s_waitcnt lgkmcnt(0)
v_add_f32 v243, v243, v156
v_cvt_pk_bf16_f32 v174, v156, v157
v_mfma_f32_16x16x32_bf16 v[132:135], a[80:83], a[0:3], v[224:227]
v_exp_f32 v128, v128
v_mfma_f32_16x16x32_bf16 v[132:135], a[84:87], a[4:7], v[132:135]
ds_read_b64_tr_b16 a[96:97], v246 offset:1024
ds_read_b64_tr_b16 a[98:99], v246 offset:5120
v_mfma_f32_16x16x32_bf16 v[132:135], a[88:91], a[8:11], v[132:135]
v_exp_f32 v129, v129
v_mfma_f32_16x16x32_bf16 v[132:135], a[92:95], a[12:15], v[132:135]
v_add_f32 v243, v243, v157
v_cvt_pk_bf16_f32 v175, v158, v159
v_mfma_f32_16x16x32_bf16 v[140:143], a[92:95], a[28:31], v[228:231]
v_exp_f32 v130, v130
v_mfma_f32_16x16x32_bf16 v[140:143], a[88:91], a[24:27], v[140:143]
ds_read_b64_tr_b16 a[100:101], v246 offset:9216
ds_read_b64_tr_b16 a[102:103], v246 offset:13312
v_mfma_f32_16x16x32_bf16 v[140:143], a[84:87], a[20:23], v[140:143]
v_exp_f32 v131, v131
v_mfma_f32_16x16x32_bf16 v[140:143], a[80:83], a[16:19], v[140:143]
v_add_f32 v243, v243, v158
v_cvt_pk_bf16_f32 v176, v128, v129
v_mfma_f32_16x16x32_bf16 v[148:151], a[80:83], a[32:35], v[232:235]
s_mov_b32 s33, s35
v_exp_f32 v136, v136
s_add_u32 s35, s35, 16384
v_mfma_f32_16x16x32_bf16 v[148:151], a[84:87], a[36:39], v[148:151]
ds_read_b64_tr_b16 a[104:105], v249 offset:1024
ds_read_b64_tr_b16 a[106:107], v249 offset:5120
v_mfma_f32_16x16x32_bf16 v[148:151], a[88:91], a[40:43], v[148:151]
s_and_b32 s35, s35, 0xffff
v_exp_f32 v137, v137
v_mfma_f32_16x16x32_bf16 v[148:151], a[92:95], a[44:47], v[148:151]
v_add_f32 v243, v243, v159
v_cvt_pk_bf16_f32 v177, v130, v131
v_mfma_f32_16x16x32_bf16 v[156:159], a[92:95], a[60:63], v[236:239]
v_exp_f32 v138, v138
v_mfma_f32_16x16x32_bf16 v[156:159], a[88:91], a[56:59], v[156:159]
ds_read_b64_tr_b16 a[108:109], v249 offset:9216
ds_read_b64_tr_b16 a[110:111], v249 offset:13312
v_mfma_f32_16x16x32_bf16 v[156:159], a[84:87], a[52:55], v[156:159]
v_exp_f32 v139, v139
v_mfma_f32_16x16x32_bf16 v[156:159], a[80:83], a[48:51], v[156:159]
s_waitcnt lgkmcnt(4)
v_add_f32 v241, v241, v136
v_cvt_pk_bf16_f32 v180, v136, v137
v_mfma_f32_16x16x32_bf16 v[16:19], a[96:99], v[192:195], v[16:19]
v_exp_f32 v144, v144
v_mfma_f32_16x16x32_bf16 v[16:19], a[100:103], v[208:211], v[16:19]
ds_read_b64_tr_b16 a[80:81], v246 offset:1536
ds_read_b64_tr_b16 a[82:83], v246 offset:5632
v_mfma_f32_16x16x32_bf16 v[48:51], a[100:103], v[212:215], v[48:51]
v_exp_f32 v145, v145
v_mfma_f32_16x16x32_bf16 v[48:51], a[96:99], v[196:199], v[48:51]
v_add_f32 v241, v241, v137
v_cvt_pk_bf16_f32 v181, v138, v139
v_mfma_f32_16x16x32_bf16 v[80:83], a[96:99], v[200:203], v[80:83]
v_exp_f32 v146, v146
v_mfma_f32_16x16x32_bf16 v[80:83], a[100:103], v[216:219], v[80:83]
ds_read_b64_tr_b16 a[84:85], v246 offset:9728
ds_read_b64_tr_b16 a[86:87], v246 offset:13824
v_mfma_f32_16x16x32_bf16 v[112:115], a[100:103], v[220:223], v[112:115]
v_exp_f32 v147, v147
v_mfma_f32_16x16x32_bf16 v[112:115], a[96:99], v[204:207], v[112:115]
s_waitcnt lgkmcnt(4)
v_add_f32 v241, v241, v138
v_cvt_pk_bf16_f32 v184, v144, v145
v_mfma_f32_16x16x32_bf16 a[120:123], a[112:115], v[200:203], a[120:123]
v_add_u32 v244, s35, v245
v_mfma_f32_16x16x32_bf16 a[120:123], a[112:115], v[216:219], a[120:123]
v_mfma_f32_16x16x32_bf16 v[116:119], a[104:107], v[204:207], v[116:119]
v_exp_f32 v152, v152
v_mfma_f32_16x16x32_bf16 v[116:119], a[108:111], v[220:223], v[116:119]
ds_read_b64_tr_b16 a[88:89], v249 offset:1536
ds_read_b64_tr_b16 a[90:91], v249 offset:5632
v_mfma_f32_16x16x32_bf16 v[84:87], a[108:111], v[216:219], v[84:87]
v_exp_f32 v153, v153
v_mfma_f32_16x16x32_bf16 v[84:87], a[104:107], v[200:203], v[84:87]
v_add_f32 v241, v241, v139
v_cvt_pk_bf16_f32 v185, v146, v147
v_mfma_f32_16x16x32_bf16 v[52:55], a[104:107], v[196:199], v[52:55]
v_exp_f32 v154, v154
v_mfma_f32_16x16x32_bf16 v[52:55], a[108:111], v[212:215], v[52:55]
ds_read_b64_tr_b16 a[92:93], v249 offset:9728
ds_read_b64_tr_b16 a[94:95], v249 offset:13824
v_mfma_f32_16x16x32_bf16 v[20:23], a[108:111], v[208:211], v[20:23]
v_exp_f32 v155, v155
v_mfma_f32_16x16x32_bf16 v[20:23], a[104:107], v[192:195], v[20:23]
s_waitcnt lgkmcnt(4)
v_add_f32 v243, v243, v152
v_cvt_pk_bf16_f32 v188, v152, v153
v_mfma_f32_16x16x32_bf16 v[24:27], a[80:83], v[192:195], v[24:27]
v_exp_f32 v132, v132
v_mfma_f32_16x16x32_bf16 v[24:27], a[84:87], v[208:211], v[24:27]
ds_read_b128 a[64:67], v244 offset:0
ds_read_b128 a[68:71], v244 offset:512
v_mfma_f32_16x16x32_bf16 v[56:59], a[84:87], v[212:215], v[56:59]
v_exp_f32 v133, v133
v_mfma_f32_16x16x32_bf16 v[56:59], a[80:83], v[196:199], v[56:59]
v_add_f32 v243, v243, v153
v_cvt_pk_bf16_f32 v189, v154, v155
v_mfma_f32_16x16x32_bf16 v[88:91], a[80:83], v[200:203], v[88:91]
v_exp_f32 v134, v134
v_mfma_f32_16x16x32_bf16 v[88:91], a[84:87], v[216:219], v[88:91]
ds_read_b128 a[72:75], v244 offset:1024
ds_read_b128 a[76:79], v244 offset:1536
v_mfma_f32_16x16x32_bf16 v[120:123], a[84:87], v[220:223], v[120:123]
v_exp_f32 v135, v135
v_mfma_f32_16x16x32_bf16 v[120:123], a[80:83], v[204:207], v[120:123]
s_waitcnt lgkmcnt(4)
v_add_f32 v243, v243, v154
v_cvt_pk_bf16_f32 v178, v132, v133
v_mfma_f32_16x16x32_bf16 v[124:127], a[88:91], v[204:207], v[124:127]
v_exp_f32 v140, v140
v_mfma_f32_16x16x32_bf16 v[124:127], a[92:95], v[220:223], v[124:127]
ds_read_b128 a[80:83], v244 offset:4096
v_add_u32 v246, s33, v247
v_mfma_f32_16x16x32_bf16 v[92:95], a[92:95], v[216:219], v[92:95]
v_exp_f32 v141, v141
v_mfma_f32_16x16x32_bf16 v[92:95], a[88:91], v[200:203], v[92:95]
v_add_f32 v243, v243, v155
v_cvt_pk_bf16_f32 v179, v134, v135
v_mfma_f32_16x16x32_bf16 v[60:63], a[88:91], v[196:199], v[60:63]
v_exp_f32 v142, v142
v_mfma_f32_16x16x32_bf16 v[60:63], a[92:95], v[212:215], v[60:63]
ds_read_b128 a[84:87], v244 offset:4608
v_xor_b32 v249, 32, v246
v_mfma_f32_16x16x32_bf16 v[28:31], a[92:95], v[208:211], v[28:31]
v_exp_f32 v143, v143
v_mfma_f32_16x16x32_bf16 v[28:31], a[88:91], v[192:195], v[28:31]
s_waitcnt lgkmcnt(2)
v_add_f32 v241, v241, v140
v_cvt_pk_bf16_f32 v182, v140, v141
v_mfma_f32_16x16x32_bf16 v[128:131], a[64:67], a[0:3], v[224:227]
v_exp_f32 v148, v148
v_mfma_f32_16x16x32_bf16 v[128:131], a[68:71], a[4:7], v[128:131]
ds_read_b128 a[88:91], v244 offset:5120
v_mfma_f32_16x16x32_bf16 v[128:131], a[72:75], a[8:11], v[128:131]
s_add_u32 m0, s39, s31
v_exp_f32 v149, v149
v_mfma_f32_16x16x32_bf16 v[128:131], a[76:79], a[12:15], v[128:131]
v_add_f32 v241, v241, v141
v_cvt_pk_bf16_f32 v183, v142, v143
v_mfma_f32_16x16x32_bf16 v[136:139], a[76:79], a[28:31], v[228:231]
s_add_u32 s40, s81, 8192
v_exp_f32 v150, v150
v_mfma_f32_16x16x32_bf16 v[136:139], a[72:75], a[24:27], v[136:139]
ds_read_b128 a[92:95], v244 offset:5632
buffer_load_dwordx4 v250, s[16:19], s40 offen offset:0 sc1 lds
v_mfma_f32_16x16x32_bf16 v[136:139], a[68:71], a[20:23], v[136:139]
v_exp_f32 v151, v151
v_mfma_f32_16x16x32_bf16 v[136:139], a[64:67], a[16:19], v[136:139]
v_add_f32 v241, v241, v142
v_cvt_pk_bf16_f32 v186, v148, v149
v_mfma_f32_16x16x32_bf16 v[144:147], a[64:67], a[32:35], v[232:235]
v_exp_f32 v156, v156
v_mfma_f32_16x16x32_bf16 v[144:147], a[68:71], a[36:39], v[144:147]
buffer_load_dwordx4 v250, s[16:19], s40 offen offset:1024 sc1 lds
v_mfma_f32_16x16x32_bf16 v[144:147], a[72:75], a[40:43], v[144:147]
v_exp_f32 v157, v157
v_mfma_f32_16x16x32_bf16 v[144:147], a[76:79], a[44:47], v[144:147]
v_add_f32 v241, v241, v143
v_cvt_pk_bf16_f32 v187, v150, v151
v_mfma_f32_16x16x32_bf16 v[152:155], a[76:79], a[60:63], v[236:239]
v_exp_f32 v158, v158
v_mfma_f32_16x16x32_bf16 v[152:155], a[72:75], a[56:59], v[152:155]
buffer_load_dwordx4 v250, s[16:19], s40 offen offset:2048 sc1 lds
buffer_load_dwordx4 v250, s[16:19], s40 offen offset:3072 sc1 lds
v_mfma_f32_16x16x32_bf16 v[152:155], a[68:71], a[52:55], v[152:155]
v_exp_f32 v159, v159
v_mfma_f32_16x16x32_bf16 v[152:155], a[64:67], a[48:51], v[152:155]
s_waitcnt lgkmcnt(0)
v_add_f32 v243, v243, v156
v_cvt_pk_bf16_f32 v190, v156, v157
v_mfma_f32_16x16x32_bf16 v[132:135], a[80:83], a[0:3], v[224:227]
v_exp_f32 v128, v128
v_mfma_f32_16x16x32_bf16 v[132:135], a[84:87], a[4:7], v[132:135]
ds_read_b64_tr_b16 a[96:97], v246 offset:0
ds_read_b64_tr_b16 a[98:99], v246 offset:4096
v_mfma_f32_16x16x32_bf16 v[132:135], a[88:91], a[8:11], v[132:135]
v_exp_f32 v129, v129
v_mfma_f32_16x16x32_bf16 v[132:135], a[92:95], a[12:15], v[132:135]
v_add_f32 v243, v243, v157
v_cvt_pk_bf16_f32 v191, v158, v159
v_mfma_f32_16x16x32_bf16 v[140:143], a[92:95], a[28:31], v[228:231]
v_exp_f32 v130, v130
v_mfma_f32_16x16x32_bf16 v[140:143], a[88:91], a[24:27], v[140:143]
ds_read_b64_tr_b16 a[100:101], v246 offset:8192
ds_read_b64_tr_b16 a[102:103], v246 offset:12288
v_mfma_f32_16x16x32_bf16 v[140:143], a[84:87], a[20:23], v[140:143]
v_exp_f32 v131, v131
v_mfma_f32_16x16x32_bf16 v[140:143], a[80:83], a[16:19], v[140:143]
v_add_f32 v243, v243, v158
v_cvt_pk_bf16_f32 v192, v128, v129
v_mfma_f32_16x16x32_bf16 v[148:151], a[80:83], a[32:35], v[232:235]
v_exp_f32 v136, v136
v_mfma_f32_16x16x32_bf16 v[148:151], a[84:87], a[36:39], v[148:151]
ds_read_b64_tr_b16 a[104:105], v249 offset:0
ds_read_b64_tr_b16 a[106:107], v249 offset:4096
v_mfma_f32_16x16x32_bf16 v[148:151], a[88:91], a[40:43], v[148:151]
v_exp_f32 v137, v137
v_mfma_f32_16x16x32_bf16 v[148:151], a[92:95], a[44:47], v[148:151]
v_add_f32 v243, v243, v159
v_cvt_pk_bf16_f32 v193, v130, v131
v_mfma_f32_16x16x32_bf16 v[156:159], a[92:95], a[60:63], v[236:239]
v_exp_f32 v138, v138
v_mfma_f32_16x16x32_bf16 v[156:159], a[88:91], a[56:59], v[156:159]
ds_read_b64_tr_b16 a[108:109], v249 offset:8192
ds_read_b64_tr_b16 a[110:111], v249 offset:12288
v_mfma_f32_16x16x32_bf16 v[156:159], a[84:87], a[52:55], v[156:159]
v_exp_f32 v139, v139
v_mfma_f32_16x16x32_bf16 v[156:159], a[80:83], a[48:51], v[156:159]
s_waitcnt lgkmcnt(4)
v_add_f32 v241, v241, v136
v_cvt_pk_bf16_f32 v196, v136, v137
v_mfma_f32_16x16x32_bf16 v[0:3], a[96:99], v[160:163], v[0:3]
s_add_u32 s39, s37, 65536
v_exp_f32 v144, v144
s_add_u32 s37, s37, 16384
v_mfma_f32_16x16x32_bf16 v[0:3], a[100:103], v[176:179], v[0:3]
v_mfma_f32_16x16x32_bf16 v[32:35], a[100:103], v[180:183], v[32:35]
s_and_b32 s37, s37, 0xffff
v_exp_f32 v145, v145
v_mfma_f32_16x16x32_bf16 v[32:35], a[96:99], v[164:167], v[32:35]
v_add_f32 v241, v241, v137
v_cvt_pk_bf16_f32 v197, v138, v139
v_mfma_f32_16x16x32_bf16 v[64:67], a[96:99], v[168:171], v[64:67]
v_exp_f32 v146, v146
v_mfma_f32_16x16x32_bf16 v[64:67], a[100:103], v[184:187], v[64:67]
v_mfma_f32_16x16x32_bf16 v[96:99], a[100:103], v[188:191], v[96:99]
v_exp_f32 v147, v147
v_mfma_f32_16x16x32_bf16 v[96:99], a[96:99], v[172:175], v[96:99]
L_m_c1_2:
s_cbranch_execz L_m_c1_ret
s_waitcnt lgkmcnt(0)
v_add_f32 v241, v241, v138
v_cvt_pk_bf16_f32 v200, v144, v145
v_mfma_f32_16x16x32_bf16 a[116:119], a[112:115], v[160:163], a[116:119]
v_mfma_f32_16x16x32_bf16 a[116:119], a[112:115], v[176:179], a[116:119]
v_mfma_f32_16x16x32_bf16 v[100:103], a[104:107], v[172:175], v[100:103]
v_exp_f32 v152, v152
v_mfma_f32_16x16x32_bf16 v[100:103], a[108:111], v[188:191], v[100:103]
v_mfma_f32_16x16x32_bf16 v[68:71], a[108:111], v[184:187], v[68:71]
v_exp_f32 v153, v153
v_mfma_f32_16x16x32_bf16 v[68:71], a[104:107], v[168:171], v[68:71]
v_add_f32 v241, v241, v139
v_cvt_pk_bf16_f32 v201, v146, v147
v_mfma_f32_16x16x32_bf16 v[36:39], a[104:107], v[164:167], v[36:39]
v_exp_f32 v154, v154
v_mfma_f32_16x16x32_bf16 v[36:39], a[108:111], v[180:183], v[36:39]
v_mfma_f32_16x16x32_bf16 v[4:7], a[108:111], v[176:179], v[4:7]
v_exp_f32 v155, v155
v_mfma_f32_16x16x32_bf16 v[4:7], a[104:107], v[160:163], v[4:7]
v_add_f32 v243, v243, v152
v_cvt_pk_bf16_f32 v204, v152, v153
v_exp_f32 v132, v132
ds_read_b128 a[64:67], v244 offset:8192
ds_read_b128 a[68:71], v244 offset:8704
v_exp_f32 v133, v133
v_add_f32 v243, v243, v153
v_cvt_pk_bf16_f32 v205, v154, v155
v_exp_f32 v134, v134
ds_read_b128 a[72:75], v244 offset:9216
ds_read_b128 a[76:79], v244 offset:9728
v_exp_f32 v135, v135
v_add_f32 v243, v243, v154
v_cvt_pk_bf16_f32 v194, v132, v133
v_exp_f32 v140, v140
ds_read_b128 a[80:83], v244 offset:12288
v_exp_f32 v141, v141
v_add_f32 v243, v243, v155
v_cvt_pk_bf16_f32 v195, v134, v135
v_exp_f32 v142, v142
ds_read_b128 a[84:87], v244 offset:12800
v_exp_f32 v143, v143
s_waitcnt lgkmcnt(2)
v_add_f32 v241, v241, v140
v_cvt_pk_bf16_f32 v198, v140, v141
v_mfma_f32_16x16x32_bf16 v[128:131], a[64:67], a[0:3], v[224:227]
s_waitcnt vmcnt(8)
v_exp_f32 v148, v148
s_barrier
v_mfma_f32_16x16x32_bf16 v[128:131], a[68:71], a[4:7], v[128:131]
ds_read_b128 a[88:91], v244 offset:13312
v_mfma_f32_16x16x32_bf16 v[128:131], a[72:75], a[8:11], v[128:131]
s_add_u32 m0, s37, s31
v_exp_f32 v149, v149
v_mfma_f32_16x16x32_bf16 v[128:131], a[76:79], a[12:15], v[128:131]
v_add_f32 v241, v241, v141
v_cvt_pk_bf16_f32 v199, v142, v143
v_mfma_f32_16x16x32_bf16 v[136:139], a[76:79], a[28:31], v[228:231]
s_add_u32 s40, s81, 12288
v_exp_f32 v150, v150
v_mfma_f32_16x16x32_bf16 v[136:139], a[72:75], a[24:27], v[136:139]
ds_read_b128 a[92:95], v244 offset:13824
buffer_load_dwordx4 v250, s[16:19], s40 offen offset:0 sc1 lds
v_mfma_f32_16x16x32_bf16 v[136:139], a[68:71], a[20:23], v[136:139]
v_exp_f32 v151, v151
v_mfma_f32_16x16x32_bf16 v[136:139], a[64:67], a[16:19], v[136:139]
v_add_f32 v241, v241, v142
v_cvt_pk_bf16_f32 v202, v148, v149
v_mfma_f32_16x16x32_bf16 v[144:147], a[64:67], a[32:35], v[232:235]
v_exp_f32 v156, v156
v_mfma_f32_16x16x32_bf16 v[144:147], a[68:71], a[36:39], v[144:147]
buffer_load_dwordx4 v250, s[16:19], s40 offen offset:1024 sc1 lds
v_mfma_f32_16x16x32_bf16 v[144:147], a[72:75], a[40:43], v[144:147]
v_exp_f32 v157, v157
v_mfma_f32_16x16x32_bf16 v[144:147], a[76:79], a[44:47], v[144:147]
v_add_f32 v241, v241, v143
v_cvt_pk_bf16_f32 v203, v150, v151
v_mfma_f32_16x16x32_bf16 v[152:155], a[76:79], a[60:63], v[236:239]
v_exp_f32 v158, v158
v_mfma_f32_16x16x32_bf16 v[152:155], a[72:75], a[56:59], v[152:155]
buffer_load_dwordx4 v250, s[16:19], s40 offen offset:2048 sc1 lds
buffer_load_dwordx4 v250, s[16:19], s40 offen offset:3072 sc1 lds
v_mfma_f32_16x16x32_bf16 v[152:155], a[68:71], a[52:55], v[152:155]
v_exp_f32 v159, v159
v_mfma_f32_16x16x32_bf16 v[152:155], a[64:67], a[48:51], v[152:155]
s_waitcnt lgkmcnt(0)
v_add_f32 v243, v243, v156
v_cvt_pk_bf16_f32 v206, v156, v157
v_mfma_f32_16x16x32_bf16 v[132:135], a[80:83], a[0:3], v[224:227]
v_exp_f32 v128, v128
v_mfma_f32_16x16x32_bf16 v[132:135], a[84:87], a[4:7], v[132:135]
ds_read_b64_tr_b16 a[96:97], v246 offset:16384
ds_read_b64_tr_b16 a[98:99], v246 offset:20480
v_mfma_f32_16x16x32_bf16 v[132:135], a[88:91], a[8:11], v[132:135]
v_exp_f32 v129, v129
v_mfma_f32_16x16x32_bf16 v[132:135], a[92:95], a[12:15], v[132:135]
v_add_f32 v243, v243, v157
v_cvt_pk_bf16_f32 v207, v158, v159
v_mfma_f32_16x16x32_bf16 v[140:143], a[92:95], a[28:31], v[228:231]
v_exp_f32 v130, v130
v_mfma_f32_16x16x32_bf16 v[140:143], a[88:91], a[24:27], v[140:143]
ds_read_b64_tr_b16 a[104:105], v249 offset:16384
ds_read_b64_tr_b16 a[106:107], v249 offset:20480
v_mfma_f32_16x16x32_bf16 v[140:143], a[84:87], a[20:23], v[140:143]
v_exp_f32 v131, v131
v_mfma_f32_16x16x32_bf16 v[140:143], a[80:83], a[16:19], v[140:143]
v_add_f32 v243, v243, v158
v_cvt_pk_bf16_f32 v208, v128, v129
v_mfma_f32_16x16x32_bf16 v[148:151], a[80:83], a[32:35], v[232:235]
s_mov_b32 s33, s35
v_exp_f32 v136, v136
s_add_u32 s35, s35, 16384
v_mfma_f32_16x16x32_bf16 v[148:151], a[84:87], a[36:39], v[148:151]
ds_read_b64_tr_b16 a[100:101], v246 offset:24576
ds_read_b64_tr_b16 a[102:103], v246 offset:28672
v_mfma_f32_16x16x32_bf16 v[148:151], a[88:91], a[40:43], v[148:151]
s_and_b32 s35, s35, 0xffff
v_exp_f32 v137, v137
v_mfma_f32_16x16x32_bf16 v[148:151], a[92:95], a[44:47], v[148:151]
v_add_f32 v243, v243, v159
v_cvt_pk_bf16_f32 v209, v130, v131
v_mfma_f32_16x16x32_bf16 v[156:159], a[92:95], a[60:63], v[236:239]
v_exp_f32 v138, v138
v_mfma_f32_16x16x32_bf16 v[156:159], a[88:91], a[56:59], v[156:159]
ds_read_b64_tr_b16 a[108:109], v249 offset:24576
ds_read_b64_tr_b16 a[110:111], v249 offset:28672
v_mfma_f32_16x16x32_bf16 v[156:159], a[84:87], a[52:55], v[156:159]
v_exp_f32 v139, v139
v_mfma_f32_16x16x32_bf16 v[156:159], a[80:83], a[48:51], v[156:159]
s_waitcnt lgkmcnt(2)
v_add_f32 v241, v241, v136
v_cvt_pk_bf16_f32 v212, v136, v137
v_mfma_f32_16x16x32_bf16 v[0:3], a[96:99], v[192:195], v[0:3]
v_exp_f32 v144, v144
v_mfma_f32_16x16x32_bf16 v[32:35], a[96:99], v[196:199], v[32:35]
v_mfma_f32_16x16x32_bf16 v[64:67], a[96:99], v[200:203], v[64:67]
v_exp_f32 v145, v145
v_mfma_f32_16x16x32_bf16 v[96:99], a[96:99], v[204:207], v[96:99]
s_waitcnt lgkmcnt(0)
v_add_f32 v241, v241, v137
v_cvt_pk_bf16_f32 v213, v138, v139
v_mfma_f32_16x16x32_bf16 v[100:103], a[104:107], v[204:207], v[100:103]
s_add_u32 s42, s81, 16384
v_exp_f32 v146, v146
s_add_u32 m0, s31, 81920
v_mfma_f32_16x16x32_bf16 v[68:71], a[104:107], v[200:203], v[68:71]
buffer_load_dwordx4 v250, s[16:19], s42 offen offset:0 sc1 lds
buffer_load_dwordx4 v250, s[16:19], s42 offen offset:1024 sc1 lds
v_mfma_f32_16x16x32_bf16 v[36:39], a[104:107], v[196:199], v[36:39]
v_exp_f32 v147, v147
v_mfma_f32_16x16x32_bf16 v[4:7], a[104:107], v[192:195], v[4:7]
v_add_f32 v241, v241, v138
v_cvt_pk_bf16_f32 v216, v144, v145
v_mfma_f32_16x16x32_bf16 a[120:123], a[112:115], v[168:171], a[120:123]
buffer_load_dwordx4 v250, s[16:19], s42 offen offset:2048 sc1 lds
buffer_load_dwordx4 v250, s[16:19], s42 offen offset:3072 sc1 lds
v_mfma_f32_16x16x32_bf16 a[120:123], a[112:115], v[184:187], a[120:123]
v_exp_f32 v152, v152
v_exp_f32 v153, v153
v_add_f32 v241, v241, v139
v_cvt_pk_bf16_f32 v217, v146, v147
v_exp_f32 v154, v154
v_exp_f32 v155, v155
v_add_f32 v243, v243, v152
v_cvt_pk_bf16_f32 v220, v152, v153
v_exp_f32 v132, v132
ds_read_b64_tr_b16 a[64:65], v246 offset:512
ds_read_b64_tr_b16 a[66:67], v246 offset:4608
v_exp_f32 v133, v133
v_add_f32 v243, v243, v153
v_cvt_pk_bf16_f32 v221, v154, v155
v_exp_f32 v134, v134
ds_read_b64_tr_b16 a[68:69], v246 offset:8704
ds_read_b64_tr_b16 a[70:71], v246 offset:12800
v_exp_f32 v135, v135
v_add_f32 v243, v243, v154
v_cvt_pk_bf16_f32 v210, v132, v133
v_exp_f32 v140, v140
ds_read_b64_tr_b16 a[72:73], v246 offset:16896
ds_read_b64_tr_b16 a[74:75], v246 offset:20992
v_exp_f32 v141, v141
v_add_f32 v243, v243, v155
v_cvt_pk_bf16_f32 v211, v134, v135
v_exp_f32 v142, v142
ds_read_b64_tr_b16 a[76:77], v246 offset:25088
ds_read_b64_tr_b16 a[78:79], v246 offset:29184
v_exp_f32 v143, v143
v_add_f32 v241, v241, v140
v_cvt_pk_bf16_f32 v214, v140, v141
L_m_tail:
v_mfma_f32_16x16x32_bf16 a[116:119], a[112:115], v[192:195], a[116:119]
v_exp_f32 v148, v148
v_mfma_f32_16x16x32_bf16 a[116:119], a[112:115], v[208:211], a[116:119]
v_exp_f32 v149, v149
v_cvt_pk_bf16_f32 v215, v142, v143
v_exp_f32 v150, v150
v_exp_f32 v151, v151
v_cvt_pk_bf16_f32 v218, v148, v149
v_exp_f32 v156, v156
v_exp_f32 v157, v157
v_cvt_pk_bf16_f32 v219, v150, v151
v_exp_f32 v158, v158
v_exp_f32 v159, v159
v_cvt_pk_bf16_f32 v222, v156, v157
v_add_f32 v241, v241, v141
v_cvt_pk_bf16_f32 v223, v158, v159
v_add_f32 v241, v241, v142
v_add_f32 v241, v241, v143
v_mfma_f32_16x16x32_bf16 a[120:123], a[112:115], v[200:203], a[120:123]
s_lshl_b32 s42, s30, 5
v_add_f32 v243, v243, v156
v_add_f32 v243, v243, v157
v_mfma_f32_16x16x32_bf16 a[120:123], a[112:115], v[216:219], a[120:123]
s_add_u32 s42, s42, s29
v_add_f32 v243, v243, v158
v_add_f32 v243, v243, v159
v_mfma_f32_16x16x32_bf16 v[0:3], a[100:103], v[208:211], v[0:3]
s_lshl_b32 s41, s42, 14
v_mov_b32 v225, v241
v_mov_b32 v227, v243
v_mfma_f32_16x16x32_bf16 v[32:35], a[100:103], v[212:215], v[32:35]
s_add_u32 s41, s41, 3145728
v_accvgpr_read_b32 v240, a116
v_mfma_f32_16x16x32_bf16 v[64:67], a[100:103], v[216:219], v[64:67]
s_add_u32 s36, s41, 4096
v_permlane16_swap_b32 v241, v225
v_permlane16_swap_b32 v243, v227
v_mfma_f32_16x16x32_bf16 v[96:99], a[100:103], v[220:223], v[96:99]
s_add_u32 s37, s41, 8192
v_add_f32 v241, v241, v225
v_add_f32 v243, v243, v227
v_mfma_f32_16x16x32_bf16 v[100:103], a[108:111], v[220:223], v[100:103]
s_add_u32 s39, s41, 12288
v_mov_b32 v225, v241
v_mov_b32 v227, v243
v_mfma_f32_16x16x32_bf16 v[68:71], a[108:111], v[216:219], v[68:71]
s_lshl_b32 s42, s42, 7
v_accvgpr_read_b32 v242, a120
v_mfma_f32_16x16x32_bf16 v[36:39], a[108:111], v[212:215], v[36:39]
s_add_u32 s42, s42, 40960000
v_permlane32_swap_b32 v241, v225
v_permlane32_swap_b32 v243, v227
v_mfma_f32_16x16x32_bf16 v[4:7], a[108:111], v[208:211], v[4:7]
s_waitcnt vmcnt(24)
v_add_f32 v241, v241, v225
v_add_f32 v243, v243, v227
ds_read_b64_tr_b16 a[80:81], v249 offset:512
ds_read_b64_tr_b16 a[82:83], v249 offset:4608
ds_read_b64_tr_b16 a[84:85], v249 offset:8704
ds_read_b64_tr_b16 a[86:87], v249 offset:12800
ds_read_b64_tr_b16 a[88:89], v249 offset:16896
ds_read_b64_tr_b16 a[90:91], v249 offset:20992
ds_read_b64_tr_b16 a[92:93], v249 offset:25088
ds_read_b64_tr_b16 a[94:95], v249 offset:29184
v_rcp_f32 v232, v240
v_rcp_f32 v238, v243
v_rcp_f32 v234, v241
v_rcp_f32 v236, v242
v_pk_mul_f32 v[96:97], v[96:97], v[238:239] op_sel_hi:[1,0]
v_pk_mul_f32 v[98:99], v[98:99], v[238:239] op_sel_hi:[1,0]
v_pk_mul_f32 v[100:101], v[100:101], v[238:239] op_sel_hi:[1,0]
v_pk_mul_f32 v[102:103], v[102:103], v[238:239] op_sel_hi:[1,0]
v_cvt_pk_bf16_f32 v128, v96, v97
v_cvt_pk_bf16_f32 v129, v98, v99
v_cvt_pk_bf16_f32 v130, v100, v101
v_cvt_pk_bf16_f32 v131, v102, v103
buffer_store_dwordx4 v[128:131], v250, s[16:19], s39 offen offset:3072 sc1
v_pk_mul_f32 v[64:65], v[64:65], v[236:237] op_sel_hi:[1,0]
v_pk_mul_f32 v[66:67], v[66:67], v[236:237] op_sel_hi:[1,0]
v_pk_mul_f32 v[68:69], v[68:69], v[236:237] op_sel_hi:[1,0]
v_pk_mul_f32 v[70:71], v[70:71], v[236:237] op_sel_hi:[1,0]
v_cvt_pk_bf16_f32 v132, v64, v65
v_cvt_pk_bf16_f32 v133, v66, v67
v_cvt_pk_bf16_f32 v134, v68, v69
v_cvt_pk_bf16_f32 v135, v70, v71
buffer_store_dwordx4 v[132:135], v250, s[16:19], s37 offen offset:2048 sc1
v_pk_mul_f32 v[32:33], v[32:33], v[234:235] op_sel_hi:[1,0]
v_pk_mul_f32 v[34:35], v[34:35], v[234:235] op_sel_hi:[1,0]
v_pk_mul_f32 v[36:37], v[36:37], v[234:235] op_sel_hi:[1,0]
v_pk_mul_f32 v[38:39], v[38:39], v[234:235] op_sel_hi:[1,0]
v_cvt_pk_bf16_f32 v136, v32, v33
v_cvt_pk_bf16_f32 v137, v34, v35
v_cvt_pk_bf16_f32 v138, v36, v37
v_cvt_pk_bf16_f32 v139, v38, v39
buffer_store_dwordx4 v[136:139], v250, s[16:19], s36 offen offset:1024 sc1
v_pk_mul_f32 v[0:1], v[0:1], v[232:233] op_sel_hi:[1,0]
v_pk_mul_f32 v[2:3], v[2:3], v[232:233] op_sel_hi:[1,0]
v_pk_mul_f32 v[4:5], v[4:5], v[232:233] op_sel_hi:[1,0]
v_pk_mul_f32 v[6:7], v[6:7], v[232:233] op_sel_hi:[1,0]
v_cvt_pk_bf16_f32 v140, v0, v1
v_cvt_pk_bf16_f32 v141, v2, v3
v_cvt_pk_bf16_f32 v142, v4, v5
v_cvt_pk_bf16_f32 v143, v6, v7
buffer_store_dwordx4 v[140:143], v250, s[16:19], s41 offen offset:0 sc1
s_waitcnt lgkmcnt(8)
v_mfma_f32_16x16x32_bf16 v[8:11], a[64:67], v[160:163], v[8:11]
ds_read_b64_tr_b16 a[96:97], v246 offset:1024
ds_read_b64_tr_b16 a[98:99], v246 offset:5120
v_mfma_f32_16x16x32_bf16 v[8:11], a[68:71], v[176:179], v[8:11]
ds_read_b64_tr_b16 a[100:101], v246 offset:9216
ds_read_b64_tr_b16 a[102:103], v246 offset:13312
v_mfma_f32_16x16x32_bf16 v[8:11], a[72:75], v[192:195], v[8:11]
ds_read_b64_tr_b16 a[104:105], v246 offset:17408
ds_read_b64_tr_b16 a[106:107], v246 offset:21504
v_mfma_f32_16x16x32_bf16 v[8:11], a[76:79], v[208:211], v[8:11]
ds_read_b64_tr_b16 a[108:109], v246 offset:25600
ds_read_b64_tr_b16 a[110:111], v246 offset:29696
v_mfma_f32_16x16x32_bf16 v[40:43], a[76:79], v[212:215], v[40:43]
v_add_f32 v224, v240, v241
v_add_f32 v225, v242, v243
v_mfma_f32_16x16x32_bf16 v[40:43], a[72:75], v[196:199], v[40:43]
v_mov_b32 v229, 163584
v_add_f32 v224, v224, v225
v_mfma_f32_16x16x32_bf16 v[40:43], a[68:71], v[180:183], v[40:43]
v_mov_b32 v228, 1
v_cmp_ngt_f32 vcc, 0x63800000, v224
v_mfma_f32_16x16x32_bf16 v[40:43], a[64:67], v[164:167], v[40:43]
s_mov_b64 exec, vcc
ds_write_b32 v229, v228
s_mov_b64 exec, -1
v_mfma_f32_16x16x32_bf16 v[72:75], a[64:67], v[168:171], v[72:75]
v_mfma_f32_16x16x32_bf16 v[72:75], a[68:71], v[184:187], v[72:75]
v_mfma_f32_16x16x32_bf16 v[72:75], a[72:75], v[200:203], v[72:75]
v_mfma_f32_16x16x32_bf16 v[72:75], a[76:79], v[216:219], v[72:75]
v_mfma_f32_16x16x32_bf16 v[104:107], a[76:79], v[220:223], v[104:107]
v_mfma_f32_16x16x32_bf16 v[104:107], a[72:75], v[204:207], v[104:107]
v_mfma_f32_16x16x32_bf16 v[104:107], a[68:71], v[188:191], v[104:107]
v_mfma_f32_16x16x32_bf16 v[104:107], a[64:67], v[172:175], v[104:107]
s_waitcnt lgkmcnt(9)
v_mfma_f32_16x16x32_bf16 v[108:111], a[80:83], v[172:175], v[108:111]
ds_read_b64_tr_b16 a[64:65], v249 offset:1024
ds_read_b64_tr_b16 a[66:67], v249 offset:5120
v_mfma_f32_16x16x32_bf16 v[108:111], a[84:87], v[188:191], v[108:111]
ds_read_b64_tr_b16 a[68:69], v249 offset:9216
ds_read_b64_tr_b16 a[70:71], v249 offset:13312
v_mfma_f32_16x16x32_bf16 v[108:111], a[88:91], v[204:207], v[108:111]
ds_read_b64_tr_b16 a[72:73], v249 offset:17408
ds_read_b64_tr_b16 a[74:75], v249 offset:21504
v_mfma_f32_16x16x32_bf16 v[108:111], a[92:95], v[220:223], v[108:111]
ds_read_b64_tr_b16 a[76:77], v249 offset:25600
ds_read_b64_tr_b16 a[78:79], v249 offset:29696
v_mfma_f32_16x16x32_bf16 v[76:79], a[92:95], v[216:219], v[76:79]
v_mfma_f32_16x16x32_bf16 v[76:79], a[88:91], v[200:203], v[76:79]
v_mfma_f32_16x16x32_bf16 v[76:79], a[84:87], v[184:187], v[76:79]
v_mfma_f32_16x16x32_bf16 v[76:79], a[80:83], v[168:171], v[76:79]
v_mfma_f32_16x16x32_bf16 v[44:47], a[80:83], v[164:167], v[44:47]
v_mfma_f32_16x16x32_bf16 v[44:47], a[84:87], v[180:183], v[44:47]
v_mfma_f32_16x16x32_bf16 v[44:47], a[88:91], v[196:199], v[44:47]
v_mfma_f32_16x16x32_bf16 v[44:47], a[92:95], v[212:215], v[44:47]
v_mfma_f32_16x16x32_bf16 v[12:15], a[92:95], v[208:211], v[12:15]
v_mfma_f32_16x16x32_bf16 v[12:15], a[88:91], v[192:195], v[12:15]
v_mfma_f32_16x16x32_bf16 v[12:15], a[84:87], v[176:179], v[12:15]
v_mfma_f32_16x16x32_bf16 v[12:15], a[80:83], v[160:163], v[12:15]
s_waitcnt lgkmcnt(9)
v_mfma_f32_16x16x32_bf16 v[16:19], a[96:99], v[160:163], v[16:19]
ds_read_b64_tr_b16 a[80:81], v246 offset:1536
ds_read_b64_tr_b16 a[82:83], v246 offset:5632
v_mfma_f32_16x16x32_bf16 v[16:19], a[100:103], v[176:179], v[16:19]
ds_read_b64_tr_b16 a[84:85], v246 offset:9728
ds_read_b64_tr_b16 a[86:87], v246 offset:13824
v_mfma_f32_16x16x32_bf16 v[16:19], a[104:107], v[192:195], v[16:19]
ds_read_b64_tr_b16 a[88:89], v246 offset:17920
ds_read_b64_tr_b16 a[90:91], v246 offset:22016
v_mfma_f32_16x16x32_bf16 v[16:19], a[108:111], v[208:211], v[16:19]
ds_read_b64_tr_b16 a[92:93], v246 offset:26112
ds_read_b64_tr_b16 a[94:95], v246 offset:30208
v_mfma_f32_16x16x32_bf16 v[48:51], a[108:111], v[212:215], v[48:51]
v_mul_f32 v104, v104, v238
v_mul_f32 v105, v105, v238
v_mfma_f32_16x16x32_bf16 v[48:51], a[104:107], v[196:199], v[48:51]
v_mul_f32 v106, v106, v238
v_mul_f32 v107, v107, v238
v_mfma_f32_16x16x32_bf16 v[48:51], a[100:103], v[180:183], v[48:51]
v_mul_f32 v108, v108, v238
v_mul_f32 v109, v109, v238
v_mfma_f32_16x16x32_bf16 v[48:51], a[96:99], v[164:167], v[48:51]
v_mul_f32 v110, v110, v238
v_mul_f32 v111, v111, v238
v_mfma_f32_16x16x32_bf16 v[80:83], a[96:99], v[168:171], v[80:83]
v_cvt_pk_bf16_f32 v144, v104, v105
v_cvt_pk_bf16_f32 v145, v106, v107
v_mfma_f32_16x16x32_bf16 v[80:83], a[100:103], v[184:187], v[80:83]
v_cvt_pk_bf16_f32 v146, v108, v109
v_cvt_pk_bf16_f32 v147, v110, v111
v_mfma_f32_16x16x32_bf16 v[80:83], a[104:107], v[200:203], v[80:83]
buffer_store_dwordx4 v[144:147], v250, s[16:19], s39 offen offset:0 sc1
v_mfma_f32_16x16x32_bf16 v[80:83], a[108:111], v[216:219], v[80:83]
v_mul_f32 v72, v72, v236
v_mul_f32 v73, v73, v236
v_mfma_f32_16x16x32_bf16 v[112:115], a[108:111], v[220:223], v[112:115]
v_mul_f32 v74, v74, v236
v_mul_f32 v75, v75, v236
v_mfma_f32_16x16x32_bf16 v[112:115], a[104:107], v[204:207], v[112:115]
v_mul_f32 v76, v76, v236
v_mul_f32 v77, v77, v236
v_mfma_f32_16x16x32_bf16 v[112:115], a[100:103], v[188:191], v[112:115]
v_mul_f32 v78, v78, v236
v_mul_f32 v79, v79, v236
v_mfma_f32_16x16x32_bf16 v[112:115], a[96:99], v[172:175], v[112:115]
v_cvt_pk_bf16_f32 v148, v72, v73
v_cvt_pk_bf16_f32 v149, v74, v75
s_waitcnt lgkmcnt(8)
v_mfma_f32_16x16x32_bf16 v[116:119], a[64:67], v[172:175], v[116:119]
ds_read_b64_tr_b16 a[96:97], v249 offset:1536
ds_read_b64_tr_b16 a[98:99], v249 offset:5632
v_mfma_f32_16x16x32_bf16 v[116:119], a[68:71], v[188:191], v[116:119]
ds_read_b64_tr_b16 a[100:101], v249 offset:9728
ds_read_b64_tr_b16 a[102:103], v249 offset:13824
v_mfma_f32_16x16x32_bf16 v[116:119], a[72:75], v[204:207], v[116:119]
ds_read_b64_tr_b16 a[104:105], v249 offset:17920
ds_read_b64_tr_b16 a[106:107], v249 offset:22016
v_mfma_f32_16x16x32_bf16 v[116:119], a[76:79], v[220:223], v[116:119]
ds_read_b64_tr_b16 a[108:109], v249 offset:26112
ds_read_b64_tr_b16 a[110:111], v249 offset:30208
v_mfma_f32_16x16x32_bf16 v[84:87], a[76:79], v[216:219], v[84:87]
v_cvt_pk_bf16_f32 v150, v76, v77
v_cvt_pk_bf16_f32 v151, v78, v79
v_mfma_f32_16x16x32_bf16 v[84:87], a[72:75], v[200:203], v[84:87]
buffer_store_dwordx4 v[148:151], v250, s[16:19], s37 offen offset:3072 sc1
v_mfma_f32_16x16x32_bf16 v[84:87], a[68:71], v[184:187], v[84:87]
v_mul_f32 v40, v40, v234
v_mul_f32 v41, v41, v234
v_mfma_f32_16x16x32_bf16 v[84:87], a[64:67], v[168:171], v[84:87]
v_mul_f32 v42, v42, v234
v_mul_f32 v43, v43, v234
v_mfma_f32_16x16x32_bf16 v[52:55], a[64:67], v[164:167], v[52:55]
v_mul_f32 v44, v44, v234
v_mul_f32 v45, v45, v234
v_mfma_f32_16x16x32_bf16 v[52:55], a[68:71], v[180:183], v[52:55]
v_mul_f32 v46, v46, v234
v_mul_f32 v47, v47, v234
v_mfma_f32_16x16x32_bf16 v[52:55], a[72:75], v[196:199], v[52:55]
v_cvt_pk_bf16_f32 v152, v40, v41
v_cvt_pk_bf16_f32 v153, v42, v43
v_mfma_f32_16x16x32_bf16 v[52:55], a[76:79], v[212:215], v[52:55]
v_cvt_pk_bf16_f32 v154, v44, v45
v_cvt_pk_bf16_f32 v155, v46, v47
v_mfma_f32_16x16x32_bf16 v[20:23], a[76:79], v[208:211], v[20:23]
buffer_store_dwordx4 v[152:155], v250, s[16:19], s36 offen offset:2048 sc1
v_mfma_f32_16x16x32_bf16 v[20:23], a[72:75], v[192:195], v[20:23]
v_mul_f32 v8, v8, v232
v_mul_f32 v9, v9, v232
v_mfma_f32_16x16x32_bf16 v[20:23], a[68:71], v[176:179], v[20:23]
v_mul_f32 v10, v10, v232
v_mul_f32 v11, v11, v232
v_mfma_f32_16x16x32_bf16 v[20:23], a[64:67], v[160:163], v[20:23]
v_mul_f32 v12, v12, v232
v_mul_f32 v13, v13, v232
s_waitcnt lgkmcnt(8)
v_mfma_f32_16x16x32_bf16 v[24:27], a[80:83], v[160:163], v[24:27]
v_mul_f32 v14, v14, v232
v_mul_f32 v15, v15, v232
v_mfma_f32_16x16x32_bf16 v[24:27], a[84:87], v[176:179], v[24:27]
v_cvt_pk_bf16_f32 v156, v8, v9
v_cvt_pk_bf16_f32 v157, v10, v11
v_mfma_f32_16x16x32_bf16 v[24:27], a[88:91], v[192:195], v[24:27]
v_cvt_pk_bf16_f32 v158, v12, v13
v_cvt_pk_bf16_f32 v159, v14, v15
v_mfma_f32_16x16x32_bf16 v[24:27], a[92:95], v[208:211], v[24:27]
buffer_store_dwordx4 v[156:159], v250, s[16:19], s41 offen offset:1024 sc1
v_mfma_f32_16x16x32_bf16 v[56:59], a[92:95], v[212:215], v[56:59]
v_mul_f32 v112, v112, v238
v_mul_f32 v113, v113, v238
v_mfma_f32_16x16x32_bf16 v[56:59], a[88:91], v[196:199], v[56:59]
v_mul_f32 v114, v114, v238
v_mul_f32 v115, v115, v238
v_mfma_f32_16x16x32_bf16 v[56:59], a[84:87], v[180:183], v[56:59]
v_mul_f32 v116, v116, v238
v_mul_f32 v117, v117, v238
v_mfma_f32_16x16x32_bf16 v[56:59], a[80:83], v[164:167], v[56:59]
v_mul_f32 v118, v118, v238
v_mul_f32 v119, v119, v238
v_mfma_f32_16x16x32_bf16 v[88:91], a[80:83], v[168:171], v[88:91]
v_cvt_pk_bf16_f32 v128, v112, v113
v_cvt_pk_bf16_f32 v129, v114, v115
v_mfma_f32_16x16x32_bf16 v[88:91], a[84:87], v[184:187], v[88:91]
v_cvt_pk_bf16_f32 v130, v116, v117
v_cvt_pk_bf16_f32 v131, v118, v119
v_mfma_f32_16x16x32_bf16 v[88:91], a[88:91], v[200:203], v[88:91]
buffer_store_dwordx4 v[128:131], v250, s[16:19], s39 offen offset:1024 sc1
v_mfma_f32_16x16x32_bf16 v[88:91], a[92:95], v[216:219], v[88:91]
v_mul_f32 v80, v80, v236
v_mul_f32 v81, v81, v236
v_mfma_f32_16x16x32_bf16 v[120:123], a[92:95], v[220:223], v[120:123]
v_mul_f32 v82, v82, v236
v_mul_f32 v83, v83, v236
v_mfma_f32_16x16x32_bf16 v[120:123], a[88:91], v[204:207], v[120:123]
v_mul_f32 v84, v84, v236
v_mul_f32 v85, v85, v236
v_mfma_f32_16x16x32_bf16 v[120:123], a[84:87], v[188:191], v[120:123]
v_mul_f32 v86, v86, v236
v_mul_f32 v87, v87, v236
v_mfma_f32_16x16x32_bf16 v[120:123], a[80:83], v[172:175], v[120:123]
v_cvt_pk_bf16_f32 v132, v80, v81
v_cvt_pk_bf16_f32 v133, v82, v83
s_waitcnt lgkmcnt(0)
v_mfma_f32_16x16x32_bf16 v[124:127], a[96:99], v[172:175], v[124:127]
v_cvt_pk_bf16_f32 v134, v84, v85
v_cvt_pk_bf16_f32 v135, v86, v87
v_mfma_f32_16x16x32_bf16 v[124:127], a[100:103], v[188:191], v[124:127]
buffer_store_dwordx4 v[132:135], v250, s[16:19], s37 offen offset:0 sc1
v_mfma_f32_16x16x32_bf16 v[124:127], a[104:107], v[204:207], v[124:127]
v_mul_f32 v48, v48, v234
v_mul_f32 v49, v49, v234
v_mfma_f32_16x16x32_bf16 v[124:127], a[108:111], v[220:223], v[124:127]
v_mul_f32 v50, v50, v234
v_mul_f32 v51, v51, v234
v_mfma_f32_16x16x32_bf16 v[92:95], a[108:111], v[216:219], v[92:95]
v_mul_f32 v52, v52, v234
v_mul_f32 v53, v53, v234
v_mfma_f32_16x16x32_bf16 v[92:95], a[104:107], v[200:203], v[92:95]
v_mul_f32 v54, v54, v234
v_mul_f32 v55, v55, v234
v_mfma_f32_16x16x32_bf16 v[92:95], a[100:103], v[184:187], v[92:95]
v_cvt_pk_bf16_f32 v136, v48, v49
v_cvt_pk_bf16_f32 v137, v50, v51
v_mfma_f32_16x16x32_bf16 v[92:95], a[96:99], v[168:171], v[92:95]
v_cvt_pk_bf16_f32 v138, v52, v53
v_cvt_pk_bf16_f32 v139, v54, v55
v_mfma_f32_16x16x32_bf16 v[60:63], a[96:99], v[164:167], v[60:63]
buffer_store_dwordx4 v[136:139], v250, s[16:19], s36 offen offset:3072 sc1
v_mfma_f32_16x16x32_bf16 v[60:63], a[100:103], v[180:183], v[60:63]
v_mul_f32 v16, v16, v232
v_mul_f32 v17, v17, v232
v_mfma_f32_16x16x32_bf16 v[60:63], a[104:107], v[196:199], v[60:63]
v_mul_f32 v18, v18, v232
v_mul_f32 v19, v19, v232
v_mfma_f32_16x16x32_bf16 v[60:63], a[108:111], v[212:215], v[60:63]
v_mul_f32 v20, v20, v232
v_mul_f32 v21, v21, v232
v_mfma_f32_16x16x32_bf16 v[28:31], a[108:111], v[208:211], v[28:31]
v_mul_f32 v22, v22, v232
v_mul_f32 v23, v23, v232
v_mfma_f32_16x16x32_bf16 v[28:31], a[104:107], v[192:195], v[28:31]
v_cvt_pk_bf16_f32 v140, v16, v17
v_cvt_pk_bf16_f32 v141, v18, v19
v_mfma_f32_16x16x32_bf16 v[28:31], a[100:103], v[176:179], v[28:31]
v_cvt_pk_bf16_f32 v142, v20, v21
v_cvt_pk_bf16_f32 v143, v22, v23
v_mfma_f32_16x16x32_bf16 v[28:31], a[96:99], v[160:163], v[28:31]
buffer_store_dwordx4 v[140:143], v250, s[16:19], s41 offen offset:2048 sc1
s_waitcnt lgkmcnt(0)
s_barrier
ds_read_b32 v230, v229
v_pk_mul_f32 v[120:121], v[120:121], v[238:239] op_sel_hi:[1,0]
v_pk_mul_f32 v[122:123], v[122:123], v[238:239] op_sel_hi:[1,0]
v_pk_mul_f32 v[124:125], v[124:125], v[238:239] op_sel_hi:[1,0]
v_pk_mul_f32 v[126:127], v[126:127], v[238:239] op_sel_hi:[1,0]
v_cvt_pk_bf16_f32 v144, v120, v121
v_cvt_pk_bf16_f32 v145, v122, v123
v_cvt_pk_bf16_f32 v146, v124, v125
v_cvt_pk_bf16_f32 v147, v126, v127
buffer_store_dwordx4 v[144:147], v250, s[16:19], s39 offen offset:2048 sc1
v_pk_mul_f32 v[88:89], v[88:89], v[236:237] op_sel_hi:[1,0]
v_pk_mul_f32 v[90:91], v[90:91], v[236:237] op_sel_hi:[1,0]
v_pk_mul_f32 v[92:93], v[92:93], v[236:237] op_sel_hi:[1,0]
v_pk_mul_f32 v[94:95], v[94:95], v[236:237] op_sel_hi:[1,0]
v_cvt_pk_bf16_f32 v148, v88, v89
v_cvt_pk_bf16_f32 v149, v90, v91
v_cvt_pk_bf16_f32 v150, v92, v93
v_cvt_pk_bf16_f32 v151, v94, v95
buffer_store_dwordx4 v[148:151], v250, s[16:19], s37 offen offset:1024 sc1
v_pk_mul_f32 v[56:57], v[56:57], v[234:235] op_sel_hi:[1,0]
v_pk_mul_f32 v[58:59], v[58:59], v[234:235] op_sel_hi:[1,0]
v_pk_mul_f32 v[60:61], v[60:61], v[234:235] op_sel_hi:[1,0]
v_pk_mul_f32 v[62:63], v[62:63], v[234:235] op_sel_hi:[1,0]
v_cvt_pk_bf16_f32 v152, v56, v57
v_cvt_pk_bf16_f32 v153, v58, v59
v_cvt_pk_bf16_f32 v154, v60, v61
v_cvt_pk_bf16_f32 v155, v62, v63
buffer_store_dwordx4 v[152:155], v250, s[16:19], s36 offen offset:0 sc1
v_pk_mul_f32 v[24:25], v[24:25], v[232:233] op_sel_hi:[1,0]
v_pk_mul_f32 v[26:27], v[26:27], v[232:233] op_sel_hi:[1,0]
v_pk_mul_f32 v[28:29], v[28:29], v[232:233] op_sel_hi:[1,0]
v_pk_mul_f32 v[30:31], v[30:31], v[232:233] op_sel_hi:[1,0]
v_cvt_pk_bf16_f32 v156, v24, v25
v_cvt_pk_bf16_f32 v157, v26, v27
v_cvt_pk_bf16_f32 v158, v28, v29
v_cvt_pk_bf16_f32 v159, v30, v31
buffer_store_dwordx4 v[156:159], v250, s[16:19], s41 offen offset:3072 sc1
s_waitcnt lgkmcnt(0)
v_readfirstlane_b32 s3, v230
s_cmp_gt_u32 s3, s38
s_cbranch_scc1 L_m_fallback
s_mov_b64 exec, 0
s_cmp_eq_u32 s28, 1
s_cbranch_scc1 L_m_c2_1
s_cmp_eq_u32 s28, 2
s_cbranch_scc1 L_m_c2_2
s_cmp_eq_u32 s28, 3
s_cbranch_scc1 L_m_c2_3
s_branch L_m_c2_0
L_m_c2_ret:
s_mov_b64 exec, -1
s_waitcnt vmcnt(0)
v_mov_b32 v0, 1
s_mov_b64 exec, 1
buffer_store_dword v0, off, s[16:19], s42 sc1
s_mov_b64 exec, -1
s_lshl_b32 s3, s75, 4
s_mul_i32 s35, s72, 128
s_add_u32 s35, s35, s3
s_lshl_b32 s35, s35, 12
s_add_u32 s35, s35, 3145728
s_add_u32 s33, s81, 51200
buffer_load_dwordx4 a[0:3], v250, s[16:19], s33 offen offset:0 sc1
v_bfe_u32 v2, v250, 4, 4
v_lshrrev_b32 v3, 8, v250
v_mul_u32_u24 v85, 1280, v2
v_mad_u32_u24 v85, v3, 40, v85
v_mul_u32_u24 v86, 40, v3
buffer_load_dwordx4 a[4:7], v250, s[16:19], s33 offen offset:1024 sc1
s_lshl_b32 s40, s72, 2
s_add_u32 s40, s40, s28
s_mul_i32 s41, s40, 20480
s_mul_i32 s3, s73, 160
s_add_u32 s41, s41, s3
buffer_load_dwordx4 a[8:11], v250, s[16:19], s33 offen offset:2048 sc1
s_add_u32 s37, s3, 2648576
s_add_u32 s39, s37, 2560
s_mul_i32 s3, s28, 15360
s_add_u32 s3, s3, 102400
v_lshrrev_b32 v91, 1, v250
buffer_load_dwordx4 a[12:15], v250, s[16:19], s33 offen offset:3072 sc1
v_add_u32 v90, s3, v250
s_add_u32 s3, s28, 0
s_and_b32 s36, s3, 3
s_lshl_b32 s3, s36, 10
v_add_u32 v80, s3, v250
L_m_c2_0:
s_cbranch_execz L_m_c2_4
s_add_u32 s34, s81, 55296
buffer_load_dwordx4 a[16:19], v250, s[16:19], s34 offen offset:0 sc1
s_add_u32 s3, s28, 1
s_and_b32 s36, s3, 3
s_lshl_b32 s3, s36, 10
v_add_u32 v81, s3, v250
s_mul_i32 s3, s36, 15360
s_add_u32 s33, s81, 56320
buffer_load_dwordx4 a[20:23], v250, s[16:19], s33 offen offset:0 sc1
s_add_u32 s3, s3, 102400
v_add_u32 v87, s3, v250
s_add_u32 s3, s28, 2
s_and_b32 s36, s3, 3
s_lshl_b32 s3, s36, 10
buffer_load_dwordx4 a[24:27], v250, s[16:19], s33 offen offset:1024 sc1
v_add_u32 v82, s3, v250
s_mul_i32 s3, s36, 15360
s_add_u32 s3, s3, 107520
v_add_u32 v88, s3, v250
s_add_u32 s3, s28, 3
buffer_load_dwordx4 a[28:31], v250, s[16:19], s33 offen offset:2048 sc1
s_and_b32 s36, s3, 3
s_lshl_b32 s3, s36, 10
v_add_u32 v83, s3, v250
s_mul_i32 s3, s36, 15360
s_add_u32 s3, s3, 112640
buffer_load_dwordx4 a[32:35], v250, s[16:19], s33 offen offset:3072 sc1
v_add_u32 v89, s3, v250
v_and_b32 v4, 3, v2
v_lshlrev_b32 v4, 7, v4
v_and_b32 v5, 4, v2
v_lshl_add_u32 v4, v5, 10, v4
s_add_u32 s34, s81, 60416
buffer_load_dwordx4 a[36:39], v250, s[16:19], s34 offen offset:0 sc1
s_lshr_b32 s36, s72, 1
s_lshl_b32 s36, s36, 13
s_lshl_b32 s3, s75, 9
s_add_u32 s36, s36, s3
s_add_u32 s36, s36, 40960000
s_add_u32 s33, s81, 61440
buffer_load_dwordx4 a[40:43], v250, s[16:19], s33 offen offset:0 sc1
s_sub_u32 s39, s35, 3145728
s_xor_b32 s39, s39, 0x80000
s_add_u32 s39, s39, 3145728
s_add_u32 s3, s28, 0
buffer_load_dwordx4 a[44:47], v250, s[16:19], s33 offen offset:1024 sc1
s_and_b32 s3, s3, 3
s_lshl_b32 s3, s3, 12
s_add_u32 s4, s39, s3
s_add_u32 s8, s35, s3
s_add_u32 s3, s28, 1
buffer_load_dwordx4 a[48:51], v250, s[16:19], s33 offen offset:2048 sc1
s_and_b32 s3, s3, 3
s_lshl_b32 s3, s3, 12
s_add_u32 s5, s39, s3
s_add_u32 s9, s35, s3
s_add_u32 s3, s28, 2
buffer_load_dwordx4 a[52:55], v250, s[16:19], s33 offen offset:3072 sc1
s_and_b32 s3, s3, 3
s_lshl_b32 s3, s3, 12
s_add_u32 s6, s39, s3
s_add_u32 s10, s35, s3
s_add_u32 s3, s28, 3
s_add_u32 s34, s81, 65536
buffer_load_dwordx4 a[56:59], v250, s[16:19], s34 offen offset:0 sc1
s_and_b32 s3, s3, 3
s_lshl_b32 s3, s3, 12
s_add_u32 s7, s39, s3
s_add_u32 s11, s35, s3
s_lshl_b32 s3, s72, 3
s_add_u32 s33, s81, 66560
buffer_load_dwordx4 a[60:63], v250, s[16:19], s33 offen offset:0 sc1
s_add_u32 s3, s3, s73
s_lshl_b32 s3, s3, 2
s_add_u32 s3, s3, s28
s_mul_i32 s86, s3, 5120
s_add_u32 s86, s86, 42991616
buffer_load_dwordx4 a[64:67], v250, s[16:19], s33 offen offset:1024 sc1
s_xor_b32 s3, s3, 32
s_mul_i32 s41, s3, 5120
s_add_u32 s41, s41, 42991616
s_add_u32 s37, s41, 4096
s_add_u32 s3, s77, 5120
v_add_u32 v86, s3, v86
v_mul_u32_u24 v85, 160, v2
v_add_u32 v85, v85, v86
v_add_u32 v102, s31, v250
v_add_u32 v103, 0x10000, v102
v_bfe_u32 v5, v250, 6, 3
v_and_b32 v6, 0xff, v248
v_mul_u32_u24 v5, 3456, v5
v_add_u32 v249, v5, v6
s_lshr_b32 s3, s28, 1
s_mul_i32 s89, s3, 138240
s_lshl_b32 s90, s74, 7
s_add_u32 s89, s89, s90
s_mul_i32 s90, s3, 10240
s_and_b32 s3, s28, 1
s_lshl_b32 s3, s3, 10
s_add_u32 s90, s90, s3
s_lshr_b32 s78, s73, 1
s_mul_i32 s78, s78, 5
s_mul_i32 s3, s72, 20
s_add_u32 s78, s78, s3
s_lshl_b32 s78, s78, 2
s_add_u32 s78, s78, s28
s_lshl_b32 s78, s78, 10
s_add_u32 s78, s78, 27787264
s_and_b32 s3, s73, 1
s_lshl_b32 s75, s3, 13
s_add_u32 s75, s75, s78
s_add_u32 s76, s75, 4096
s_lshl_b32 s3, s3, 9
s_add_u32 s78, s78, s3
s_add_u32 s78, s78, 16384
s_lshl_b32 s79, s40, 10
s_lshl_b32 s3, s73, 7
s_add_u32 s79, s79, s3
s_add_u32 s79, s79, 33030144
s_lshl_b32 s80, s72, 3
s_add_u32 s80, s80, s73
s_lshl_b32 s80, s80, 7
s_add_u32 s80, s80, 41091072
buffer_load_dword v5, v4, s[16:19], s36 offen sc1
buffer_load_dwordx4 a[68:71], v250, s[16:19], s33 offen offset:2048 sc1
buffer_load_dwordx4 a[72:75], v250, s[16:19], s33 offen offset:3072 sc1
s_add_u32 s34, s81, 70656
buffer_load_dwordx4 a[76:79], v250, s[16:19], s34 offen offset:0 sc1
s_add_u32 s33, s81, 71680
buffer_load_dwordx4 a[80:83], v250, s[16:19], s33 offen offset:0 sc1
buffer_load_dwordx4 a[84:87], v250, s[16:19], s33 offen offset:1024 sc1
buffer_load_dwordx4 a[88:91], v250, s[16:19], s33 offen offset:2048 sc1
buffer_load_dwordx4 a[92:95], v250, s[16:19], s33 offen offset:3072 sc1
s_add_u32 s34, s81, 75776
buffer_load_dwordx4 a[96:99], v250, s[16:19], s34 offen offset:0 sc1
s_waitcnt vmcnt(8)
v_cmp_eq_u32 vcc, 0, v5
s_cmp_eq_u64 vcc, 0
s_cbranch_scc1 L_m_q3
s_mov_b32 s82, 0
L_m_poll10:
buffer_load_dword v5, v4, s[16:19], s36 offen sc1
s_waitcnt vmcnt(0)
v_cmp_gt_u32 vcc, 1, v5
s_cmp_eq_u64 vcc, 0
s_cbranch_scc1 L_m_poll10d
s_sleep 3
s_add_u32 s82, s82, 1
s_cmp_lt_u32 s82, 0x40000
s_cbranch_scc1 L_m_poll10
L_m_poll10d:
L_m_q3:
s_add_u32 s32, s5, 16384
buffer_load_dwordx4 v[164:167], v81, s[16:19], s32 offen sc1
buffer_load_dwordx4 v[168:171], v82, s[16:19], s32 offen sc1
buffer_load_dwordx4 v[172:175], v83, s[16:19], s32 offen sc1
buffer_load_dwordx4 v[176:179], v80, s[16:19], s32 offen sc1
s_add_u32 s32, s6, 16384
buffer_load_dwordx4 v[180:183], v82, s[16:19], s32 offen sc1
buffer_load_dwordx4 v[184:187], v83, s[16:19], s32 offen sc1
buffer_load_dwordx4 v[188:191], v80, s[16:19], s32 offen sc1
buffer_load_dwordx4 v[192:195], v81, s[16:19], s32 offen sc1
s_add_u32 s32, s7, 16384
buffer_load_dwordx4 v[196:199], v83, s[16:19], s32 offen sc1
buffer_load_dwordx4 v[200:203], v80, s[16:19], s32 offen sc1
buffer_load_dwordx4 v[204:207], v81, s[16:19], s32 offen sc1
buffer_load_dwordx4 v[208:211], v82, s[16:19], s32 offen sc1
s_add_u32 s33, s81, 76800
buffer_load_dwordx4 a[100:103], v250, s[16:19], s33 offen offset:0 sc1
buffer_load_dwordx4 a[104:107], v250, s[16:19], s33 offen offset:1024 sc1
buffer_load_dwordx4 a[108:111], v250, s[16:19], s33 offen offset:2048 sc1
buffer_load_dwordx4 a[112:115], v250, s[16:19], s33 offen offset:3072 sc1
s_add_u32 s34, s81, 80896
buffer_load_dwordx4 a[116:119], v250, s[16:19], s34 offen offset:0 sc1
s_mov_b32 s38, 0xffff0000
s_waitcnt vmcnt(13)
v_mfma_f32_16x16x32_bf16 v[20:23], a[136:139], v[164:167], 0
s_add_u32 s32, s4, 16384
buffer_load_dwordx4 v[212:215], v80, s[16:19], s32 offen sc1
v_mfma_f32_16x16x32_bf16 v[20:23], a[156:159], v[168:171], v[20:23]
v_mfma_f32_16x16x32_bf16 v[20:23], a[176:179], v[172:175], v[20:23]
buffer_load_dwordx4 v[216:219], v81, s[16:19], s32 offen sc1
v_mfma_f32_16x16x32_bf16 v[20:23], a[196:199], v[176:179], v[20:23]
v_mfma_f32_16x16x32_bf16 v[24:27], a[200:203], v[176:179], 0
buffer_load_dwordx4 v[220:223], v82, s[16:19], s32 offen sc1
v_mfma_f32_16x16x32_bf16 v[24:27], a[180:183], v[172:175], v[24:27]
v_mfma_f32_16x16x32_bf16 v[24:27], a[160:163], v[168:171], v[24:27]
buffer_load_dwordx4 v[224:227], v83, s[16:19], s32 offen sc1
v_mfma_f32_16x16x32_bf16 v[24:27], a[140:143], v[164:167], v[24:27]
v_mfma_f32_16x16x32_bf16 v[28:31], a[144:147], v[164:167], 0
v_mfma_f32_16x16x32_bf16 v[28:31], a[164:167], v[168:171], v[28:31]
v_mfma_f32_16x16x32_bf16 v[28:31], a[184:187], v[172:175], v[28:31]
v_mfma_f32_16x16x32_bf16 v[28:31], a[204:207], v[176:179], v[28:31]
v_mfma_f32_16x16x32_bf16 v[32:35], a[208:211], v[176:179], 0
v_mfma_f32_16x16x32_bf16 v[32:35], a[188:191], v[172:175], v[32:35]
v_mfma_f32_16x16x32_bf16 v[32:35], a[168:171], v[168:171], v[32:35]
v_mfma_f32_16x16x32_bf16 v[32:35], a[148:151], v[164:167], v[32:35]
v_mfma_f32_16x16x32_bf16 v[36:39], a[152:155], v[164:167], 0
v_mfma_f32_16x16x32_bf16 v[36:39], a[172:175], v[168:171], v[36:39]
v_mfma_f32_16x16x32_bf16 v[36:39], a[192:195], v[172:175], v[36:39]
v_mfma_f32_16x16x32_bf16 v[36:39], a[212:215], v[176:179], v[36:39]
s_waitcnt vmcnt(13)
v_mfma_f32_16x16x32_bf16 v[56:59], a[212:215], v[192:195], 0
s_add_u32 s32, s4, 0
buffer_load_dwordx4 v[164:167], v80, s[16:19], s32 offen sc1
ds_read_b64 v[92:93], v85 offset:0
v_mfma_f32_16x16x32_bf16 v[56:59], a[192:195], v[188:191], v[56:59]
ds_read_b64 v[94:95], v85 offset:8
ds_read_b64 v[96:97], v85 offset:16
v_mfma_f32_16x16x32_bf16 v[56:59], a[172:175], v[184:187], v[56:59]
s_add_u32 s32, s5, 0
buffer_load_dwordx4 v[168:171], v81, s[16:19], s32 offen sc1
ds_read_b64 v[98:99], v85 offset:24
v_mfma_f32_16x16x32_bf16 v[56:59], a[152:155], v[180:183], v[56:59]
ds_read_b64 v[100:101], v85 offset:32
ds_read_b64 v[228:229], v86 offset:2560
v_mfma_f32_16x16x32_bf16 v[52:55], a[148:151], v[180:183], 0
s_add_u32 s32, s6, 0
buffer_load_dwordx4 v[172:175], v82, s[16:19], s32 offen sc1
ds_read_b64 v[230:231], v86 offset:2568
v_mfma_f32_16x16x32_bf16 v[52:55], a[168:171], v[184:187], v[52:55]
ds_read_b64 v[232:233], v86 offset:2576
ds_read_b64 v[234:235], v86 offset:2584
v_mfma_f32_16x16x32_bf16 v[52:55], a[188:191], v[188:191], v[52:55]
s_add_u32 s32, s7, 0
buffer_load_dwordx4 v[176:179], v83, s[16:19], s32 offen sc1
ds_read_b64 v[236:237], v86 offset:2592
v_mfma_f32_16x16x32_bf16 v[52:55], a[208:211], v[192:195], v[52:55]
ds_read_b64 v[238:239], v86 offset:2720
ds_read_b64 v[240:241], v86 offset:2728
v_mfma_f32_16x16x32_bf16 v[48:51], a[204:207], v[192:195], 0
ds_read_b64 v[242:243], v86 offset:2736
ds_read_b64 v[244:245], v86 offset:2744
v_mfma_f32_16x16x32_bf16 v[48:51], a[184:187], v[188:191], v[48:51]
ds_read_b64 v[246:247], v86 offset:2752
v_mfma_f32_16x16x32_bf16 v[48:51], a[164:167], v[184:187], v[48:51]
v_mfma_f32_16x16x32_bf16 v[48:51], a[144:147], v[180:183], v[48:51]
v_mfma_f32_16x16x32_bf16 v[44:47], a[140:143], v[180:183], 0
v_mfma_f32_16x16x32_bf16 v[44:47], a[160:163], v[184:187], v[44:47]
v_mfma_f32_16x16x32_bf16 v[44:47], a[180:183], v[188:191], v[44:47]
v_mfma_f32_16x16x32_bf16 v[44:47], a[200:203], v[192:195], v[44:47]
v_mfma_f32_16x16x32_bf16 v[40:43], a[196:199], v[192:195], 0
v_mfma_f32_16x16x32_bf16 v[40:43], a[176:179], v[188:191], v[40:43]
v_mfma_f32_16x16x32_bf16 v[40:43], a[156:159], v[184:187], v[40:43]
v_mfma_f32_16x16x32_bf16 v[40:43], a[136:139], v[180:183], v[40:43]
s_waitcnt vmcnt(13)
v_mfma_f32_16x16x32_bf16 v[60:63], a[136:139], v[196:199], 0
s_add_u32 s32, s4, 0
buffer_load_dwordx4 v[180:183], v81, s[16:19], s32 offen sc1
v_mfma_f32_16x16x32_bf16 v[60:63], a[156:159], v[200:203], v[60:63]
v_mfma_f32_16x16x32_bf16 v[60:63], a[176:179], v[204:207], v[60:63]
s_add_u32 s32, s5, 0
buffer_load_dwordx4 v[184:187], v82, s[16:19], s32 offen sc1
v_mfma_f32_16x16x32_bf16 v[60:63], a[196:199], v[208:211], v[60:63]
v_mfma_f32_16x16x32_bf16 v[64:67], a[200:203], v[208:211], 0
s_add_u32 s32, s6, 0
buffer_load_dwordx4 v[188:191], v83, s[16:19], s32 offen sc1
v_mfma_f32_16x16x32_bf16 v[64:67], a[180:183], v[204:207], v[64:67]
v_mfma_f32_16x16x32_bf16 v[64:67], a[160:163], v[200:203], v[64:67]
s_add_u32 s32, s7, 0
buffer_load_dwordx4 v[192:195], v80, s[16:19], s32 offen sc1
v_mfma_f32_16x16x32_bf16 v[64:67], a[140:143], v[196:199], v[64:67]
v_mfma_f32_16x16x32_bf16 v[68:71], a[144:147], v[196:199], 0
v_mfma_f32_16x16x32_bf16 v[68:71], a[164:167], v[200:203], v[68:71]
v_mfma_f32_16x16x32_bf16 v[68:71], a[184:187], v[204:207], v[68:71]
v_mfma_f32_16x16x32_bf16 v[68:71], a[204:207], v[208:211], v[68:71]
v_mfma_f32_16x16x32_bf16 v[72:75], a[208:211], v[208:211], 0
v_mfma_f32_16x16x32_bf16 v[72:75], a[188:191], v[204:207], v[72:75]
v_mfma_f32_16x16x32_bf16 v[72:75], a[168:171], v[200:203], v[72:75]
v_mfma_f32_16x16x32_bf16 v[72:75], a[148:151], v[196:199], v[72:75]
v_mfma_f32_16x16x32_bf16 v[76:79], a[152:155], v[196:199], 0
v_mfma_f32_16x16x32_bf16 v[76:79], a[172:175], v[200:203], v[76:79]
v_mfma_f32_16x16x32_bf16 v[76:79], a[192:195], v[204:207], v[76:79]
v_mfma_f32_16x16x32_bf16 v[76:79], a[212:215], v[208:211], v[76:79]
s_waitcnt vmcnt(8)
v_mfma_f32_16x16x32_bf16 v[120:123], a[212:215], v[224:227], 0
s_add_u32 s32, s4, 0
buffer_load_dwordx4 v[196:199], v82, s[16:19], s32 offen sc1
v_mfma_f32_16x16x32_bf16 v[120:123], a[192:195], v[220:223], v[120:123]
v_mfma_f32_16x16x32_bf16 v[120:123], a[172:175], v[216:219], v[120:123]
s_add_u32 s32, s5, 0
buffer_load_dwordx4 v[200:203], v83, s[16:19], s32 offen sc1
v_mfma_f32_16x16x32_bf16 v[120:123], a[152:155], v[212:215], v[120:123]
v_mfma_f32_16x16x32_bf16 v[116:119], a[148:151], v[212:215], 0
s_add_u32 s32, s6, 0
buffer_load_dwordx4 v[204:207], v80, s[16:19], s32 offen sc1
v_mfma_f32_16x16x32_bf16 v[116:119], a[168:171], v[216:219], v[116:119]
v_mfma_f32_16x16x32_bf16 v[116:119], a[188:191], v[220:223], v[116:119]
s_add_u32 s32, s7, 0
buffer_load_dwordx4 v[208:211], v81, s[16:19], s32 offen sc1
v_mfma_f32_16x16x32_bf16 v[116:119], a[208:211], v[224:227], v[116:119]
v_mfma_f32_16x16x32_bf16 v[112:115], a[204:207], v[224:227], 0
v_mfma_f32_16x16x32_bf16 v[112:115], a[184:187], v[220:223], v[112:115]
ds_read_b128 a[120:123], v102 offset:0
v_mfma_f32_16x16x32_bf16 v[112:115], a[164:167], v[216:219], v[112:115]
v_mfma_f32_16x16x32_bf16 v[112:115], a[144:147], v[212:215], v[112:115]
v_mfma_f32_16x16x32_bf16 v[108:111], a[140:143], v[212:215], 0
v_mfma_f32_16x16x32_bf16 v[108:111], a[160:163], v[216:219], v[108:111]
ds_read_b128 a[124:127], v102 offset:1024
v_mfma_f32_16x16x32_bf16 v[108:111], a[180:183], v[220:223], v[108:111]
v_mfma_f32_16x16x32_bf16 v[108:111], a[200:203], v[224:227], v[108:111]
v_mfma_f32_16x16x32_bf16 v[104:107], a[196:199], v[224:227], 0
v_mfma_f32_16x16x32_bf16 v[104:107], a[176:179], v[220:223], v[104:107]
ds_read_b128 a[128:131], v102 offset:2048
v_mfma_f32_16x16x32_bf16 v[104:107], a[156:159], v[216:219], v[104:107]
v_mfma_f32_16x16x32_bf16 v[104:107], a[136:139], v[212:215], v[104:107]
s_waitcnt vmcnt(8)
s_waitcnt lgkmcnt(2)
v_mfma_f32_16x16x32_bf16 v[104:107], a[120:123], v[164:167], v[104:107]
s_add_u32 s32, s4, 0
buffer_load_dwordx4 v[212:215], v83, s[16:19], s32 offen sc1
v_mfma_f32_16x16x32_bf16 v[20:23], a[120:123], v[168:171], v[20:23]
ds_read_b128 a[132:135], v102 offset:3072
v_mfma_f32_16x16x32_bf16 v[40:43], a[120:123], v[172:175], v[40:43]
s_add_u32 s32, s5, 0
buffer_load_dwordx4 v[216:219], v80, s[16:19], s32 offen sc1
v_mfma_f32_16x16x32_bf16 v[60:63], a[120:123], v[176:179], v[60:63]
s_waitcnt lgkmcnt(2)
v_mfma_f32_16x16x32_bf16 v[64:67], a[124:127], v[176:179], v[64:67]
s_add_u32 s32, s6, 0
buffer_load_dwordx4 v[220:223], v81, s[16:19], s32 offen sc1
v_mfma_f32_16x16x32_bf16 v[44:47], a[124:127], v[172:175], v[44:47]
ds_read_b128 a[120:123], v102 offset:16384
v_mfma_f32_16x16x32_bf16 v[24:27], a[124:127], v[168:171], v[24:27]
s_add_u32 s32, s7, 0
buffer_load_dwordx4 v[224:227], v82, s[16:19], s32 offen sc1
v_mfma_f32_16x16x32_bf16 v[108:111], a[124:127], v[164:167], v[108:111]
s_waitcnt lgkmcnt(2)
v_mfma_f32_16x16x32_bf16 v[112:115], a[128:131], v[164:167], v[112:115]
v_mfma_f32_16x16x32_bf16 v[28:31], a[128:131], v[168:171], v[28:31]
ds_read_b128 a[124:127], v102 offset:17408
v_mfma_f32_16x16x32_bf16 v[48:51], a[128:131], v[172:175], v[48:51]
v_mfma_f32_16x16x32_bf16 v[68:71], a[128:131], v[176:179], v[68:71]
s_waitcnt lgkmcnt(2)
v_mfma_f32_16x16x32_bf16 v[72:75], a[132:135], v[176:179], v[72:75]
v_mfma_f32_16x16x32_bf16 v[52:55], a[132:135], v[172:175], v[52:55]
ds_read_b128 a[128:131], v102 offset:18432
v_mfma_f32_16x16x32_bf16 v[32:35], a[132:135], v[168:171], v[32:35]
v_mfma_f32_16x16x32_bf16 v[116:119], a[132:135], v[164:167], v[116:119]
s_waitcnt lgkmcnt(2)
v_mfma_f32_16x16x32_bf16 v[120:123], a[120:123], v[164:167], v[120:123]
v_mfma_f32_16x16x32_bf16 v[36:39], a[120:123], v[168:171], v[36:39]
ds_read_b128 a[132:135], v102 offset:19456
v_mfma_f32_16x16x32_bf16 v[56:59], a[120:123], v[172:175], v[56:59]
v_mfma_f32_16x16x32_bf16 v[76:79], a[120:123], v[176:179], v[76:79]
s_waitcnt vmcnt(8)
s_waitcnt lgkmcnt(2)
v_mfma_f32_16x16x32_bf16 v[104:107], a[124:127], v[180:183], v[104:107]
s_add_u32 s32, s5, 32768
buffer_load_dwordx4 v[164:167], v81, s[16:19], s32 offen sc1
v_mfma_f32_16x16x32_bf16 v[20:23], a[124:127], v[184:187], v[20:23]
ds_read_b128 a[120:123], v103 offset:0
v_mfma_f32_16x16x32_bf16 v[40:43], a[124:127], v[188:191], v[40:43]
buffer_load_dwordx4 v[168:171], v82, s[16:19], s32 offen sc1
v_mfma_f32_16x16x32_bf16 v[60:63], a[124:127], v[192:195], v[60:63]
s_waitcnt lgkmcnt(2)
v_mfma_f32_16x16x32_bf16 v[64:67], a[128:131], v[192:195], v[64:67]
buffer_load_dwordx4 v[172:175], v83, s[16:19], s32 offen sc1
v_mfma_f32_16x16x32_bf16 v[44:47], a[128:131], v[188:191], v[44:47]
ds_read_b128 a[124:127], v103 offset:1024
v_mfma_f32_16x16x32_bf16 v[24:27], a[128:131], v[184:187], v[24:27]
buffer_load_dwordx4 v[176:179], v80, s[16:19], s32 offen sc1
v_mfma_f32_16x16x32_bf16 v[108:111], a[128:131], v[180:183], v[108:111]
s_waitcnt lgkmcnt(2)
v_mfma_f32_16x16x32_bf16 v[112:115], a[132:135], v[180:183], v[112:115]
v_mfma_f32_16x16x32_bf16 v[28:31], a[132:135], v[184:187], v[28:31]
ds_read_b128 a[128:131], v103 offset:2048
v_mfma_f32_16x16x32_bf16 v[48:51], a[132:135], v[188:191], v[48:51]
v_mfma_f32_16x16x32_bf16 v[68:71], a[132:135], v[192:195], v[68:71]
s_waitcnt lgkmcnt(2)
v_mfma_f32_16x16x32_bf16 v[72:75], a[120:123], v[192:195], v[72:75]
v_mfma_f32_16x16x32_bf16 v[52:55], a[120:123], v[188:191], v[52:55]
ds_read_b128 a[132:135], v103 offset:3072
v_mfma_f32_16x16x32_bf16 v[32:35], a[120:123], v[184:187], v[32:35]
v_mfma_f32_16x16x32_bf16 v[116:119], a[120:123], v[180:183], v[116:119]
s_waitcnt lgkmcnt(2)
v_mfma_f32_16x16x32_bf16 v[120:123], a[124:127], v[180:183], v[120:123]
v_mfma_f32_16x16x32_bf16 v[36:39], a[124:127], v[184:187], v[36:39]
ds_read_b128 a[120:123], v102 offset:32768
v_mfma_f32_16x16x32_bf16 v[56:59], a[124:127], v[188:191], v[56:59]
v_mfma_f32_16x16x32_bf16 v[76:79], a[124:127], v[192:195], v[76:79]
s_waitcnt vmcnt(8)
s_waitcnt lgkmcnt(2)
v_mfma_f32_16x16x32_bf16 v[104:107], a[128:131], v[196:199], v[104:107]
s_add_u32 s32, s6, 32768
buffer_load_dwordx4 v[180:183], v82, s[16:19], s32 offen sc1
v_mfma_f32_16x16x32_bf16 v[20:23], a[128:131], v[200:203], v[20:23]
ds_read_b128 a[124:127], v102 offset:33792
v_mfma_f32_16x16x32_bf16 v[40:43], a[128:131], v[204:207], v[40:43]
buffer_load_dwordx4 v[184:187], v83, s[16:19], s32 offen sc1
v_mfma_f32_16x16x32_bf16 v[60:63], a[128:131], v[208:211], v[60:63]
s_waitcnt lgkmcnt(2)
v_mfma_f32_16x16x32_bf16 v[64:67], a[132:135], v[208:211], v[64:67]
buffer_load_dwordx4 v[188:191], v80, s[16:19], s32 offen sc1
v_mfma_f32_16x16x32_bf16 v[44:47], a[132:135], v[204:207], v[44:47]
ds_read_b128 a[128:131], v102 offset:34816
v_mfma_f32_16x16x32_bf16 v[24:27], a[132:135], v[200:203], v[24:27]
buffer_load_dwordx4 v[192:195], v81, s[16:19], s32 offen sc1
v_mfma_f32_16x16x32_bf16 v[108:111], a[132:135], v[196:199], v[108:111]
s_waitcnt lgkmcnt(2)
v_mfma_f32_16x16x32_bf16 v[112:115], a[120:123], v[196:199], v[112:115]
v_mfma_f32_16x16x32_bf16 v[28:31], a[120:123], v[200:203], v[28:31]
ds_read_b128 a[132:135], v102 offset:35840
v_mfma_f32_16x16x32_bf16 v[48:51], a[120:123], v[204:207], v[48:51]
v_mfma_f32_16x16x32_bf16 v[68:71], a[120:123], v[208:211], v[68:71]
s_waitcnt lgkmcnt(2)
v_mfma_f32_16x16x32_bf16 v[72:75], a[124:127], v[208:211], v[72:75]
v_mfma_f32_16x16x32_bf16 v[52:55], a[124:127], v[204:207], v[52:55]
ds_read_b128 a[120:123], v103 offset:16384
v_mfma_f32_16x16x32_bf16 v[32:35], a[124:127], v[200:203], v[32:35]
v_mfma_f32_16x16x32_bf16 v[116:119], a[124:127], v[196:199], v[116:119]
s_waitcnt lgkmcnt(2)
v_mfma_f32_16x16x32_bf16 v[120:123], a[128:131], v[196:199], v[120:123]
v_mfma_f32_16x16x32_bf16 v[36:39], a[128:131], v[200:203], v[36:39]
ds_read_b128 a[124:127], v103 offset:17408
v_mfma_f32_16x16x32_bf16 v[56:59], a[128:131], v[204:207], v[56:59]
v_mfma_f32_16x16x32_bf16 v[76:79], a[128:131], v[208:211], v[76:79]
s_waitcnt vmcnt(8)
s_waitcnt lgkmcnt(2)
v_mfma_f32_16x16x32_bf16 v[104:107], a[132:135], v[212:215], v[104:107]
s_add_u32 s32, s7, 32768
buffer_load_dwordx4 v[196:199], v83, s[16:19], s32 offen sc1
v_mfma_f32_16x16x32_bf16 v[20:23], a[132:135], v[216:219], v[20:23]
ds_read_b128 a[128:131], v103 offset:18432
v_mfma_f32_16x16x32_bf16 v[40:43], a[132:135], v[220:223], v[40:43]
buffer_load_dwordx4 v[200:203], v80, s[16:19], s32 offen sc1
v_mfma_f32_16x16x32_bf16 v[60:63], a[132:135], v[224:227], v[60:63]
s_waitcnt lgkmcnt(2)
v_mfma_f32_16x16x32_bf16 v[64:67], a[120:123], v[224:227], v[64:67]
buffer_load_dwordx4 v[204:207], v81, s[16:19], s32 offen sc1
v_mfma_f32_16x16x32_bf16 v[44:47], a[120:123], v[220:223], v[44:47]
ds_read_b128 a[132:135], v103 offset:19456
v_mfma_f32_16x16x32_bf16 v[24:27], a[120:123], v[216:219], v[24:27]
buffer_load_dwordx4 v[208:211], v82, s[16:19], s32 offen sc1
v_mfma_f32_16x16x32_bf16 v[108:111], a[120:123], v[212:215], v[108:111]
s_waitcnt lgkmcnt(2)
v_mfma_f32_16x16x32_bf16 v[112:115], a[124:127], v[212:215], v[112:115]
v_mfma_f32_16x16x32_bf16 v[28:31], a[124:127], v[216:219], v[28:31]
v_mfma_f32_16x16x32_bf16 v[48:51], a[124:127], v[220:223], v[48:51]
v_mfma_f32_16x16x32_bf16 v[68:71], a[124:127], v[224:227], v[68:71]
s_waitcnt lgkmcnt(1)
v_mfma_f32_16x16x32_bf16 v[72:75], a[128:131], v[224:227], v[72:75]
v_mfma_f32_16x16x32_bf16 v[52:55], a[128:131], v[220:223], v[52:55]
v_mfma_f32_16x16x32_bf16 v[32:35], a[128:131], v[216:219], v[32:35]
v_mfma_f32_16x16x32_bf16 v[116:119], a[128:131], v[212:215], v[116:119]
s_waitcnt lgkmcnt(0)
v_mfma_f32_16x16x32_bf16 v[120:123], a[132:135], v[212:215], v[120:123]
v_mfma_f32_16x16x32_bf16 v[36:39], a[132:135], v[216:219], v[36:39]
v_mfma_f32_16x16x32_bf16 v[56:59], a[132:135], v[220:223], v[56:59]
v_mfma_f32_16x16x32_bf16 v[76:79], a[132:135], v[224:227], v[76:79]
s_waitcnt vmcnt(8)
v_mfma_f32_16x16x32_bf16 v[20:23], a[216:219], v[164:167], v[20:23]
s_add_u32 s32, s4, 32768
buffer_load_dwordx4 v[212:215], v80, s[16:19], s32 offen sc1
v_mfma_f32_16x16x32_bf16 v[20:23], a[236:239], v[168:171], v[20:23]
v_mfma_f32_16x16x32_bf16 v[20:23], a[0:3], v[172:175], v[20:23]
buffer_load_dwordx4 v[216:219], v81, s[16:19], s32 offen sc1
v_mfma_f32_16x16x32_bf16 v[20:23], a[20:23], v[176:179], v[20:23]
v_mfma_f32_16x16x32_bf16 v[24:27], a[24:27], v[176:179], v[24:27]
buffer_load_dwordx4 v[220:223], v82, s[16:19], s32 offen sc1
v_mfma_f32_16x16x32_bf16 v[24:27], a[4:7], v[172:175], v[24:27]
v_mfma_f32_16x16x32_bf16 v[24:27], a[240:243], v[168:171], v[24:27]
buffer_load_dwordx4 v[224:227], v83, s[16:19], s32 offen sc1
v_mfma_f32_16x16x32_bf16 v[24:27], a[220:223], v[164:167], v[24:27]
v_mfma_f32_16x16x32_bf16 v[28:31], a[224:227], v[164:167], v[28:31]
v_mfma_f32_16x16x32_bf16 v[28:31], a[244:247], v[168:171], v[28:31]
v_mfma_f32_16x16x32_bf16 v[28:31], a[8:11], v[172:175], v[28:31]
v_mfma_f32_16x16x32_bf16 v[28:31], a[28:31], v[176:179], v[28:31]
v_mfma_f32_16x16x32_bf16 v[32:35], a[32:35], v[176:179], v[32:35]
v_mfma_f32_16x16x32_bf16 v[32:35], a[12:15], v[172:175], v[32:35]
v_mfma_f32_16x16x32_bf16 v[32:35], a[248:251], v[168:171], v[32:35]
v_mfma_f32_16x16x32_bf16 v[32:35], a[228:231], v[164:167], v[32:35]
v_mfma_f32_16x16x32_bf16 v[36:39], a[232:235], v[164:167], v[36:39]
v_mfma_f32_16x16x32_bf16 v[36:39], a[252:255], v[168:171], v[36:39]
v_mfma_f32_16x16x32_bf16 v[36:39], a[16:19], v[172:175], v[36:39]
v_mfma_f32_16x16x32_bf16 v[36:39], a[36:39], v[176:179], v[36:39]
s_waitcnt vmcnt(8)
v_mfma_f32_16x16x32_bf16 v[56:59], a[36:39], v[192:195], v[56:59]
s_add_u32 s32, s5, 49152
buffer_load_dwordx4 v[164:167], v81, s[16:19], s32 offen sc1
v_mfma_f32_16x16x32_bf16 v[56:59], a[16:19], v[188:191], v[56:59]
v_mfma_f32_16x16x32_bf16 v[56:59], a[252:255], v[184:187], v[56:59]
buffer_load_dwordx4 v[168:171], v82, s[16:19], s32 offen sc1
v_mfma_f32_16x16x32_bf16 v[56:59], a[232:235], v[180:183], v[56:59]
v_mfma_f32_16x16x32_bf16 v[52:55], a[228:231], v[180:183], v[52:55]
buffer_load_dwordx4 v[172:175], v83, s[16:19], s32 offen sc1
v_mfma_f32_16x16x32_bf16 v[52:55], a[248:251], v[184:187], v[52:55]
v_mfma_f32_16x16x32_bf16 v[52:55], a[12:15], v[188:191], v[52:55]
buffer_load_dwordx4 v[176:179], v80, s[16:19], s32 offen sc1
v_mfma_f32_16x16x32_bf16 v[52:55], a[32:35], v[192:195], v[52:55]
v_mfma_f32_16x16x32_bf16 v[48:51], a[28:31], v[192:195], v[48:51]
v_mfma_f32_16x16x32_bf16 v[48:51], a[8:11], v[188:191], v[48:51]
v_mfma_f32_16x16x32_bf16 v[48:51], a[244:247], v[184:187], v[48:51]
v_mfma_f32_16x16x32_bf16 v[48:51], a[224:227], v[180:183], v[48:51]
v_mfma_f32_16x16x32_bf16 v[44:47], a[220:223], v[180:183], v[44:47]
v_mfma_f32_16x16x32_bf16 v[44:47], a[240:243], v[184:187], v[44:47]
v_mfma_f32_16x16x32_bf16 v[44:47], a[4:7], v[188:191], v[44:47]
v_mfma_f32_16x16x32_bf16 v[44:47], a[24:27], v[192:195], v[44:47]
v_mfma_f32_16x16x32_bf16 v[40:43], a[20:23], v[192:195], v[40:43]
v_mfma_f32_16x16x32_bf16 v[40:43], a[0:3], v[188:191], v[40:43]
v_mfma_f32_16x16x32_bf16 v[40:43], a[236:239], v[184:187], v[40:43]
v_mfma_f32_16x16x32_bf16 v[40:43], a[216:219], v[180:183], v[40:43]
s_waitcnt vmcnt(8)
v_mfma_f32_16x16x32_bf16 v[60:63], a[216:219], v[196:199], v[60:63]
s_add_u32 s32, s6, 49152
buffer_load_dwordx4 v[180:183], v82, s[16:19], s32 offen sc1
v_mfma_f32_16x16x32_bf16 v[60:63], a[236:239], v[200:203], v[60:63]
v_mfma_f32_16x16x32_bf16 v[60:63], a[0:3], v[204:207], v[60:63]
buffer_load_dwordx4 v[184:187], v83, s[16:19], s32 offen sc1
v_mfma_f32_16x16x32_bf16 v[60:63], a[20:23], v[208:211], v[60:63]
v_mfma_f32_16x16x32_bf16 v[64:67], a[24:27], v[208:211], v[64:67]
buffer_load_dwordx4 v[188:191], v80, s[16:19], s32 offen sc1
v_mfma_f32_16x16x32_bf16 v[64:67], a[4:7], v[204:207], v[64:67]
v_mfma_f32_16x16x32_bf16 v[64:67], a[240:243], v[200:203], v[64:67]
buffer_load_dwordx4 v[192:195], v81, s[16:19], s32 offen sc1
v_mfma_f32_16x16x32_bf16 v[64:67], a[220:223], v[196:199], v[64:67]
v_mfma_f32_16x16x32_bf16 v[68:71], a[224:227], v[196:199], v[68:71]
v_mfma_f32_16x16x32_bf16 v[68:71], a[244:247], v[200:203], v[68:71]
v_mfma_f32_16x16x32_bf16 v[68:71], a[8:11], v[204:207], v[68:71]
v_mfma_f32_16x16x32_bf16 v[68:71], a[28:31], v[208:211], v[68:71]
v_mfma_f32_16x16x32_bf16 v[72:75], a[32:35], v[208:211], v[72:75]
v_mfma_f32_16x16x32_bf16 v[72:75], a[12:15], v[204:207], v[72:75]
v_mfma_f32_16x16x32_bf16 v[72:75], a[248:251], v[200:203], v[72:75]
v_mfma_f32_16x16x32_bf16 v[72:75], a[228:231], v[196:199], v[72:75]
v_mfma_f32_16x16x32_bf16 v[76:79], a[232:235], v[196:199], v[76:79]
v_mfma_f32_16x16x32_bf16 v[76:79], a[252:255], v[200:203], v[76:79]
v_mfma_f32_16x16x32_bf16 v[76:79], a[16:19], v[204:207], v[76:79]
v_mfma_f32_16x16x32_bf16 v[76:79], a[36:39], v[208:211], v[76:79]
s_waitcnt vmcnt(8)
v_mfma_f32_16x16x32_bf16 v[120:123], a[36:39], v[224:227], v[120:123]
s_add_u32 s32, s7, 49152
buffer_load_dwordx4 v[196:199], v83, s[16:19], s32 offen sc1
v_mfma_f32_16x16x32_bf16 v[120:123], a[16:19], v[220:223], v[120:123]
v_mfma_f32_16x16x32_bf16 v[120:123], a[252:255], v[216:219], v[120:123]
buffer_load_dwordx4 v[200:203], v80, s[16:19], s32 offen sc1
v_mfma_f32_16x16x32_bf16 v[120:123], a[232:235], v[212:215], v[120:123]
v_mfma_f32_16x16x32_bf16 v[116:119], a[228:231], v[212:215], v[116:119]
buffer_load_dwordx4 v[204:207], v81, s[16:19], s32 offen sc1
v_mfma_f32_16x16x32_bf16 v[116:119], a[248:251], v[216:219], v[116:119]
v_mfma_f32_16x16x32_bf16 v[116:119], a[12:15], v[220:223], v[116:119]
buffer_load_dwordx4 v[208:211], v82, s[16:19], s32 offen sc1
v_mfma_f32_16x16x32_bf16 v[116:119], a[32:35], v[224:227], v[116:119]
v_mfma_f32_16x16x32_bf16 v[112:115], a[28:31], v[224:227], v[112:115]
v_mfma_f32_16x16x32_bf16 v[112:115], a[8:11], v[220:223], v[112:115]
v_mfma_f32_16x16x32_bf16 v[112:115], a[244:247], v[216:219], v[112:115]
v_mfma_f32_16x16x32_bf16 v[112:115], a[224:227], v[212:215], v[112:115]
v_mfma_f32_16x16x32_bf16 v[108:111], a[220:223], v[212:215], v[108:111]
v_mfma_f32_16x16x32_bf16 v[108:111], a[240:243], v[216:219], v[108:111]
v_mfma_f32_16x16x32_bf16 v[108:111], a[4:7], v[220:223], v[108:111]
v_mfma_f32_16x16x32_bf16 v[108:111], a[24:27], v[224:227], v[108:111]
v_mfma_f32_16x16x32_bf16 v[104:107], a[20:23], v[224:227], v[104:107]
v_mfma_f32_16x16x32_bf16 v[104:107], a[0:3], v[220:223], v[104:107]
v_mfma_f32_16x16x32_bf16 v[104:107], a[236:239], v[216:219], v[104:107]
v_mfma_f32_16x16x32_bf16 v[104:107], a[216:219], v[212:215], v[104:107]
s_waitcnt vmcnt(8)
v_mfma_f32_16x16x32_bf16 v[20:23], a[40:43], v[164:167], v[20:23]
s_add_u32 s32, s4, 49152
buffer_load_dwordx4 v[212:215], v80, s[16:19], s32 offen sc1
v_mfma_f32_16x16x32_bf16 v[20:23], a[60:63], v[168:171], v[20:23]
v_mfma_f32_16x16x32_bf16 v[20:23], a[80:83], v[172:175], v[20:23]
buffer_load_dwordx4 v[216:219], v81, s[16:19], s32 offen sc1
v_mfma_f32_16x16x32_bf16 v[20:23], a[100:103], v[176:179], v[20:23]
v_mfma_f32_16x16x32_bf16 v[24:27], a[104:107], v[176:179], v[24:27]
buffer_load_dwordx4 v[220:223], v82, s[16:19], s32 offen sc1
v_mfma_f32_16x16x32_bf16 v[24:27], a[84:87], v[172:175], v[24:27]
v_mfma_f32_16x16x32_bf16 v[24:27], a[64:67], v[168:171], v[24:27]
buffer_load_dwordx4 v[224:227], v83, s[16:19], s32 offen sc1
v_mfma_f32_16x16x32_bf16 v[24:27], a[44:47], v[164:167], v[24:27]
v_mfma_f32_16x16x32_bf16 v[28:31], a[48:51], v[164:167], v[28:31]
v_mfma_f32_16x16x32_bf16 v[28:31], a[68:71], v[168:171], v[28:31]
v_mfma_f32_16x16x32_bf16 v[28:31], a[88:91], v[172:175], v[28:31]
v_mfma_f32_16x16x32_bf16 v[28:31], a[108:111], v[176:179], v[28:31]
v_mfma_f32_16x16x32_bf16 v[32:35], a[112:115], v[176:179], v[32:35]
v_mfma_f32_16x16x32_bf16 v[32:35], a[92:95], v[172:175], v[32:35]
v_mfma_f32_16x16x32_bf16 v[32:35], a[72:75], v[168:171], v[32:35]
v_mfma_f32_16x16x32_bf16 v[32:35], a[52:55], v[164:167], v[32:35]
v_mfma_f32_16x16x32_bf16 v[36:39], a[56:59], v[164:167], v[36:39]
v_mfma_f32_16x16x32_bf16 v[36:39], a[76:79], v[168:171], v[36:39]
L_m_c2_1:
s_cbranch_execz L_m_c2_5
v_mfma_f32_16x16x32_bf16 v[36:39], a[96:99], v[172:175], v[36:39]
v_mfma_f32_16x16x32_bf16 v[36:39], a[116:119], v[176:179], v[36:39]
s_barrier
s_waitcnt vmcnt(8)
v_mfma_f32_16x16x32_bf16 v[56:59], a[116:119], v[192:195], v[56:59]
s_add_u32 s32, s8, 0
buffer_load_dwordx4 v[164:167], v80, s[16:19], s32 offen sc1
v_mfma_f32_16x16x32_bf16 v[56:59], a[96:99], v[188:191], v[56:59]
v_mfma_f32_16x16x32_bf16 v[56:59], a[76:79], v[184:187], v[56:59]
s_add_u32 s32, s9, 0
buffer_load_dwordx4 v[168:171], v81, s[16:19], s32 offen sc1
v_mfma_f32_16x16x32_bf16 v[56:59], a[56:59], v[180:183], v[56:59]
ds_write_b128 v87, v[20:23] offset:0
v_mfma_f32_16x16x32_bf16 v[52:55], a[52:55], v[180:183], v[52:55]
s_add_u32 s32, s10, 0
buffer_load_dwordx4 v[172:175], v82, s[16:19], s32 offen sc1
v_mfma_f32_16x16x32_bf16 v[52:55], a[72:75], v[184:187], v[52:55]
v_mfma_f32_16x16x32_bf16 v[52:55], a[92:95], v[188:191], v[52:55]
s_add_u32 s32, s11, 0
buffer_load_dwordx4 v[176:179], v83, s[16:19], s32 offen sc1
v_mfma_f32_16x16x32_bf16 v[52:55], a[112:115], v[192:195], v[52:55]
ds_write_b128 v87, v[24:27] offset:1024
v_mfma_f32_16x16x32_bf16 v[48:51], a[108:111], v[192:195], v[48:51]
v_mfma_f32_16x16x32_bf16 v[48:51], a[88:91], v[188:191], v[48:51]
v_mfma_f32_16x16x32_bf16 v[48:51], a[68:71], v[184:187], v[48:51]
v_mfma_f32_16x16x32_bf16 v[48:51], a[48:51], v[180:183], v[48:51]
ds_write_b128 v87, v[28:31] offset:2048
v_mfma_f32_16x16x32_bf16 v[44:47], a[44:47], v[180:183], v[44:47]
v_mfma_f32_16x16x32_bf16 v[44:47], a[64:67], v[184:187], v[44:47]
v_mfma_f32_16x16x32_bf16 v[44:47], a[84:87], v[188:191], v[44:47]
v_mfma_f32_16x16x32_bf16 v[44:47], a[104:107], v[192:195], v[44:47]
ds_write_b128 v87, v[32:35] offset:3072
v_mfma_f32_16x16x32_bf16 v[40:43], a[100:103], v[192:195], v[40:43]
v_mfma_f32_16x16x32_bf16 v[40:43], a[80:83], v[188:191], v[40:43]
v_mfma_f32_16x16x32_bf16 v[40:43], a[60:63], v[184:187], v[40:43]
v_mfma_f32_16x16x32_bf16 v[40:43], a[40:43], v[180:183], v[40:43]
ds_write_b128 v87, v[36:39] offset:4096
s_waitcnt vmcnt(8)
v_mfma_f32_16x16x32_bf16 v[60:63], a[40:43], v[196:199], v[60:63]
s_add_u32 s32, s8, 0
buffer_load_dwordx4 v[180:183], v81, s[16:19], s32 offen sc1
v_mfma_f32_16x16x32_bf16 v[60:63], a[60:63], v[200:203], v[60:63]
v_mfma_f32_16x16x32_bf16 v[60:63], a[80:83], v[204:207], v[60:63]
s_add_u32 s32, s9, 0
buffer_load_dwordx4 v[184:187], v82, s[16:19], s32 offen sc1
v_mfma_f32_16x16x32_bf16 v[60:63], a[100:103], v[208:211], v[60:63]
ds_write_b128 v88, v[56:59] offset:4096
v_mfma_f32_16x16x32_bf16 v[64:67], a[104:107], v[208:211], v[64:67]
s_add_u32 s32, s10, 0
buffer_load_dwordx4 v[188:191], v83, s[16:19], s32 offen sc1
v_mfma_f32_16x16x32_bf16 v[64:67], a[84:87], v[204:207], v[64:67]
v_mfma_f32_16x16x32_bf16 v[64:67], a[64:67], v[200:203], v[64:67]
s_add_u32 s32, s11, 0
buffer_load_dwordx4 v[192:195], v80, s[16:19], s32 offen sc1
v_mfma_f32_16x16x32_bf16 v[64:67], a[44:47], v[196:199], v[64:67]
ds_write_b128 v88, v[52:55] offset:3072
v_mfma_f32_16x16x32_bf16 v[68:71], a[48:51], v[196:199], v[68:71]
v_mfma_f32_16x16x32_bf16 v[68:71], a[68:71], v[200:203], v[68:71]
v_mfma_f32_16x16x32_bf16 v[68:71], a[88:91], v[204:207], v[68:71]
v_mfma_f32_16x16x32_bf16 v[68:71], a[108:111], v[208:211], v[68:71]
ds_write_b128 v88, v[48:51] offset:2048
v_mfma_f32_16x16x32_bf16 v[72:75], a[112:115], v[208:211], v[72:75]
v_mfma_f32_16x16x32_bf16 v[72:75], a[92:95], v[204:207], v[72:75]
v_mfma_f32_16x16x32_bf16 v[72:75], a[72:75], v[200:203], v[72:75]
v_mfma_f32_16x16x32_bf16 v[72:75], a[52:55], v[196:199], v[72:75]
ds_write_b128 v88, v[44:47] offset:1024
v_mfma_f32_16x16x32_bf16 v[76:79], a[56:59], v[196:199], v[76:79]
v_mfma_f32_16x16x32_bf16 v[76:79], a[76:79], v[200:203], v[76:79]
v_mfma_f32_16x16x32_bf16 v[76:79], a[96:99], v[204:207], v[76:79]
v_mfma_f32_16x16x32_bf16 v[76:79], a[116:119], v[208:211], v[76:79]
ds_write_b128 v88, v[40:43] offset:0
s_waitcnt vmcnt(8)
v_mfma_f32_16x16x32_bf16 v[120:123], a[116:119], v[224:227], v[120:123]
s_add_u32 s32, s8, 0
buffer_load_dwordx4 v[196:199], v82, s[16:19], s32 offen sc1
v_mfma_f32_16x16x32_bf16 v[120:123], a[96:99], v[220:223], v[120:123]
v_mfma_f32_16x16x32_bf16 v[120:123], a[76:79], v[216:219], v[120:123]
s_add_u32 s32, s9, 0
buffer_load_dwordx4 v[200:203], v83, s[16:19], s32 offen sc1
v_mfma_f32_16x16x32_bf16 v[120:123], a[56:59], v[212:215], v[120:123]
ds_write_b128 v89, v[60:63] offset:0
v_mfma_f32_16x16x32_bf16 v[116:119], a[52:55], v[212:215], v[116:119]
s_add_u32 s32, s10, 0
buffer_load_dwordx4 v[204:207], v80, s[16:19], s32 offen sc1
v_mfma_f32_16x16x32_bf16 v[116:119], a[72:75], v[216:219], v[116:119]
v_mfma_f32_16x16x32_bf16 v[116:119], a[92:95], v[220:223], v[116:119]
s_add_u32 s32, s11, 0
buffer_load_dwordx4 v[208:211], v81, s[16:19], s32 offen sc1
v_mfma_f32_16x16x32_bf16 v[116:119], a[112:115], v[224:227], v[116:119]
ds_write_b128 v89, v[64:67] offset:1024
v_mfma_f32_16x16x32_bf16 v[112:115], a[108:111], v[224:227], v[112:115]
v_mfma_f32_16x16x32_bf16 v[112:115], a[88:91], v[220:223], v[112:115]
ds_read_b128 a[120:123], v102 offset:0
v_mfma_f32_16x16x32_bf16 v[112:115], a[68:71], v[216:219], v[112:115]
v_mfma_f32_16x16x32_bf16 v[112:115], a[48:51], v[212:215], v[112:115]
ds_write_b128 v89, v[68:71] offset:2048
v_mfma_f32_16x16x32_bf16 v[108:111], a[44:47], v[212:215], v[108:111]
v_mfma_f32_16x16x32_bf16 v[108:111], a[64:67], v[216:219], v[108:111]
ds_read_b128 a[124:127], v102 offset:1024
v_mfma_f32_16x16x32_bf16 v[108:111], a[84:87], v[220:223], v[108:111]
v_mfma_f32_16x16x32_bf16 v[108:111], a[104:107], v[224:227], v[108:111]
ds_write_b128 v89, v[72:75] offset:3072
v_mfma_f32_16x16x32_bf16 v[104:107], a[100:103], v[224:227], v[104:107]
v_mfma_f32_16x16x32_bf16 v[104:107], a[80:83], v[220:223], v[104:107]
ds_read_b128 a[128:131], v102 offset:2048
v_mfma_f32_16x16x32_bf16 v[104:107], a[60:63], v[216:219], v[104:107]
v_mfma_f32_16x16x32_bf16 v[104:107], a[40:43], v[212:215], v[104:107]
ds_write_b128 v89, v[76:79] offset:4096
s_waitcnt vmcnt(8)
s_waitcnt lgkmcnt(5)
v_mfma_f32_16x16x32_bf16 v[0:3], a[120:123], v[164:167], 0
s_add_u32 s32, s8, 0
buffer_load_dwordx4 v[212:215], v83, s[16:19], s32 offen sc1
v_mfma_f32_16x16x32_bf16 v[20:23], a[120:123], v[168:171], 0
ds_read_b128 a[132:135], v102 offset:3072
v_mfma_f32_16x16x32_bf16 v[40:43], a[120:123], v[172:175], 0
s_add_u32 s32, s9, 0
buffer_load_dwordx4 v[216:219], v80, s[16:19], s32 offen sc1
v_mfma_f32_16x16x32_bf16 v[60:63], a[120:123], v[176:179], 0
s_waitcnt lgkmcnt(4)
v_mfma_f32_16x16x32_bf16 v[64:67], a[124:127], v[176:179], 0
s_add_u32 s32, s10, 0
buffer_load_dwordx4 v[220:223], v81, s[16:19], s32 offen sc1
v_mfma_f32_16x16x32_bf16 v[44:47], a[124:127], v[172:175], 0
ds_read_b128 a[120:123], v102 offset:16384
s_waitcnt lgkmcnt(2)
s_barrier
ds_read_b128 v[124:127], v90 offset:0
v_mfma_f32_16x16x32_bf16 v[24:27], a[124:127], v[168:171], 0
s_add_u32 s32, s11, 0
buffer_load_dwordx4 v[224:227], v82, s[16:19], s32 offen sc1
ds_read_b128 v[128:131], v90 offset:1024
v_mfma_f32_16x16x32_bf16 v[4:7], a[124:127], v[164:167], 0
ds_read_b128 v[132:135], v90 offset:2048
ds_read_b128 v[136:139], v90 offset:3072
v_mfma_f32_16x16x32_bf16 v[8:11], a[128:131], v[164:167], 0
ds_read_b128 v[140:143], v90 offset:4096
ds_read_b128 v[144:147], v90 offset:5120
v_mfma_f32_16x16x32_bf16 v[28:31], a[128:131], v[168:171], 0
ds_read_b128 a[124:127], v102 offset:17408
ds_read_b128 v[148:151], v90 offset:6144
v_mfma_f32_16x16x32_bf16 v[48:51], a[128:131], v[172:175], 0
ds_read_b128 v[152:155], v90 offset:7168
ds_read_b128 v[156:159], v90 offset:8192
v_mfma_f32_16x16x32_bf16 v[68:71], a[128:131], v[176:179], 0
ds_read_b128 v[160:163], v90 offset:9216
s_waitcnt lgkmcnt(12)
v_mfma_f32_16x16x32_bf16 v[72:75], a[132:135], v[176:179], 0
v_mfma_f32_16x16x32_bf16 v[52:55], a[132:135], v[172:175], 0
ds_read_b128 a[128:131], v102 offset:18432
v_mfma_f32_16x16x32_bf16 v[32:35], a[132:135], v[168:171], 0
v_mfma_f32_16x16x32_bf16 v[12:15], a[132:135], v[164:167], 0
s_waitcnt lgkmcnt(7)
v_add_f32 v104, v104, v124
v_add_f32 v105, v105, v125
v_mfma_f32_16x16x32_bf16 v[16:19], a[120:123], v[164:167], 0
v_add_f32 v106, v106, v126
v_add_f32 v107, v107, v127
v_mfma_f32_16x16x32_bf16 v[36:39], a[120:123], v[168:171], 0
ds_read_b128 a[132:135], v102 offset:19456
v_add_f32 v108, v108, v128
v_mfma_f32_16x16x32_bf16 v[56:59], a[120:123], v[172:175], 0
v_add_f32 v109, v109, v129
v_add_f32 v110, v110, v130
v_mfma_f32_16x16x32_bf16 v[76:79], a[120:123], v[176:179], 0
v_add_f32 v111, v111, v131
v_add_f32 v112, v112, v132
s_waitcnt vmcnt(8)
s_waitcnt lgkmcnt(6)
v_mfma_f32_16x16x32_bf16 v[0:3], a[124:127], v[180:183], v[0:3]
s_add_u32 s32, s9, 16384
buffer_load_dwordx4 v[164:167], v81, s[16:19], s32 offen sc1
v_add_f32 v113, v113, v133
v_mfma_f32_16x16x32_bf16 v[20:23], a[124:127], v[184:187], v[20:23]
ds_read_b128 a[120:123], v103 offset:0
v_add_f32 v114, v114, v134
v_mfma_f32_16x16x32_bf16 v[40:43], a[124:127], v[188:191], v[40:43]
buffer_load_dwordx4 v[168:171], v82, s[16:19], s32 offen sc1
v_add_f32 v115, v115, v135
v_mfma_f32_16x16x32_bf16 v[60:63], a[124:127], v[192:195], v[60:63]
v_add_f32 v116, v116, v136
v_add_f32 v117, v117, v137
s_waitcnt lgkmcnt(2)
v_mfma_f32_16x16x32_bf16 v[64:67], a[128:131], v[192:195], v[64:67]
buffer_load_dwordx4 v[172:175], v83, s[16:19], s32 offen sc1
v_add_f32 v118, v118, v138
v_mfma_f32_16x16x32_bf16 v[44:47], a[128:131], v[188:191], v[44:47]
ds_read_b128 a[124:127], v103 offset:1024
v_add_f32 v119, v119, v139
v_mfma_f32_16x16x32_bf16 v[24:27], a[128:131], v[184:187], v[24:27]
buffer_load_dwordx4 v[176:179], v80, s[16:19], s32 offen sc1
v_add_f32 v120, v120, v140
v_mfma_f32_16x16x32_bf16 v[4:7], a[128:131], v[180:183], v[4:7]
v_add_f32 v121, v121, v141
v_add_f32 v122, v122, v142
s_waitcnt lgkmcnt(2)
v_mfma_f32_16x16x32_bf16 v[8:11], a[132:135], v[180:183], v[8:11]
v_add_f32 v123, v123, v143
v_mfma_f32_16x16x32_bf16 v[28:31], a[132:135], v[184:187], v[28:31]
ds_read_b128 a[128:131], v103 offset:2048
ds_read_b128 v[124:127], v90 offset:10240
v_mfma_f32_16x16x32_bf16 v[48:51], a[132:135], v[188:191], v[48:51]
ds_read_b128 v[128:131], v90 offset:11264
ds_read_b128 v[132:135], v90 offset:12288
v_mfma_f32_16x16x32_bf16 v[68:71], a[132:135], v[192:195], v[68:71]
ds_read_b128 v[136:139], v90 offset:13312
ds_read_b128 v[140:143], v90 offset:14336
s_waitcnt lgkmcnt(7)
v_mfma_f32_16x16x32_bf16 v[72:75], a[120:123], v[192:195], v[72:75]
v_add_f32 v104, v104, v144
v_add_f32 v105, v105, v145
v_mfma_f32_16x16x32_bf16 v[52:55], a[120:123], v[188:191], v[52:55]
ds_read_b128 a[132:135], v103 offset:3072
v_add_f32 v106, v106, v146
v_mfma_f32_16x16x32_bf16 v[32:35], a[120:123], v[184:187], v[32:35]
v_add_f32 v107, v107, v147
v_add_f32 v108, v108, v148
v_mfma_f32_16x16x32_bf16 v[12:15], a[120:123], v[180:183], v[12:15]
v_add_f32 v109, v109, v149
v_add_f32 v110, v110, v150
s_waitcnt lgkmcnt(7)
v_mfma_f32_16x16x32_bf16 v[16:19], a[124:127], v[180:183], v[16:19]
v_add_f32 v111, v111, v151
v_add_f32 v112, v112, v152
v_mfma_f32_16x16x32_bf16 v[36:39], a[124:127], v[184:187], v[36:39]
ds_read_b128 a[120:123], v102 offset:32768
v_add_f32 v113, v113, v153
v_mfma_f32_16x16x32_bf16 v[56:59], a[124:127], v[188:191], v[56:59]
v_add_f32 v114, v114, v154
v_add_f32 v115, v115, v155
v_mfma_f32_16x16x32_bf16 v[76:79], a[124:127], v[192:195], v[76:79]
v_add_f32 v116, v116, v156
v_add_f32 v117, v117, v157
s_waitcnt vmcnt(8)
s_waitcnt lgkmcnt(7)
v_mfma_f32_16x16x32_bf16 v[0:3], a[128:131], v[196:199], v[0:3]
s_add_u32 s32, s10, 16384
buffer_load_dwordx4 v[180:183], v82, s[16:19], s32 offen sc1
v_add_f32 v118, v118, v158
v_mfma_f32_16x16x32_bf16 v[20:23], a[128:131], v[200:203], v[20:23]
ds_read_b128 a[124:127], v102 offset:33792
v_add_f32 v119, v119, v159
v_mfma_f32_16x16x32_bf16 v[40:43], a[128:131], v[204:207], v[40:43]
buffer_load_dwordx4 v[184:187], v83, s[16:19], s32 offen sc1
v_add_f32 v120, v120, v160
v_mfma_f32_16x16x32_bf16 v[60:63], a[128:131], v[208:211], v[60:63]
v_add_f32 v121, v121, v161
v_add_f32 v122, v122, v162
s_waitcnt lgkmcnt(2)
v_mfma_f32_16x16x32_bf16 v[64:67], a[132:135], v[208:211], v[64:67]
buffer_load_dwordx4 v[188:191], v80, s[16:19], s32 offen sc1
v_add_f32 v123, v123, v163
v_mfma_f32_16x16x32_bf16 v[44:47], a[132:135], v[204:207], v[44:47]
ds_read_b128 a[128:131], v102 offset:34816
v_add_f32 v104, v104, v124
v_mfma_f32_16x16x32_bf16 v[24:27], a[132:135], v[200:203], v[24:27]
buffer_load_dwordx4 v[192:195], v81, s[16:19], s32 offen sc1
v_add_f32 v105, v105, v125
v_mfma_f32_16x16x32_bf16 v[4:7], a[132:135], v[196:199], v[4:7]
v_add_f32 v106, v106, v126
v_add_f32 v107, v107, v127
s_waitcnt lgkmcnt(2)
v_mfma_f32_16x16x32_bf16 v[8:11], a[120:123], v[196:199], v[8:11]
v_add_f32 v108, v108, v128
v_add_f32 v109, v109, v129
v_mfma_f32_16x16x32_bf16 v[28:31], a[120:123], v[200:203], v[28:31]
ds_read_b128 a[132:135], v102 offset:35840
v_add_f32 v110, v110, v130
v_mfma_f32_16x16x32_bf16 v[48:51], a[120:123], v[204:207], v[48:51]
v_add_f32 v111, v111, v131
v_add_f32 v112, v112, v132
v_mfma_f32_16x16x32_bf16 v[68:71], a[120:123], v[208:211], v[68:71]
v_add_f32 v113, v113, v133
v_add_f32 v114, v114, v134
s_waitcnt lgkmcnt(2)
v_mfma_f32_16x16x32_bf16 v[72:75], a[124:127], v[208:211], v[72:75]
v_add_f32 v115, v115, v135
v_add_f32 v116, v116, v136
v_mfma_f32_16x16x32_bf16 v[52:55], a[124:127], v[204:207], v[52:55]
ds_read_b128 a[120:123], v103 offset:16384
v_add_f32 v117, v117, v137
v_mfma_f32_16x16x32_bf16 v[32:35], a[124:127], v[200:203], v[32:35]
v_add_f32 v118, v118, v138
v_add_f32 v119, v119, v139
v_mfma_f32_16x16x32_bf16 v[12:15], a[124:127], v[196:199], v[12:15]
v_add_f32 v120, v120, v140
v_add_f32 v121, v121, v141
s_waitcnt lgkmcnt(2)
v_mfma_f32_16x16x32_bf16 v[16:19], a[128:131], v[196:199], v[16:19]
v_add_f32 v122, v122, v142
v_add_f32 v123, v123, v143
v_mfma_f32_16x16x32_bf16 v[36:39], a[128:131], v[200:203], v[36:39]
ds_read_b128 a[124:127], v103 offset:17408
v_or_b32 v104, 1, v104
v_mfma_f32_16x16x32_bf16 v[56:59], a[128:131], v[204:207], v[56:59]
v_or_b32 v105, 1, v105
v_or_b32 v106, 1, v106
v_mfma_f32_16x16x32_bf16 v[76:79], a[128:131], v[208:211], v[76:79]
v_or_b32 v107, 1, v107
v_or_b32 v108, 1, v108
s_waitcnt vmcnt(8)
s_waitcnt lgkmcnt(2)
v_mfma_f32_16x16x32_bf16 v[0:3], a[132:135], v[212:215], v[0:3]
s_add_u32 s32, s11, 16384
buffer_load_dwordx4 v[196:199], v83, s[16:19], s32 offen sc1
v_or_b32 v109, 1, v109
v_mfma_f32_16x16x32_bf16 v[20:23], a[132:135], v[216:219], v[20:23]
ds_read_b128 a[128:131], v103 offset:18432
v_or_b32 v110, 1, v110
v_mfma_f32_16x16x32_bf16 v[40:43], a[132:135], v[220:223], v[40:43]
buffer_load_dwordx4 v[200:203], v80, s[16:19], s32 offen sc1
v_or_b32 v111, 1, v111
v_mfma_f32_16x16x32_bf16 v[60:63], a[132:135], v[224:227], v[60:63]
v_or_b32 v112, 1, v112
v_or_b32 v113, 1, v113
s_waitcnt lgkmcnt(2)
v_mfma_f32_16x16x32_bf16 v[64:67], a[120:123], v[224:227], v[64:67]
buffer_load_dwordx4 v[204:207], v81, s[16:19], s32 offen sc1
v_or_b32 v114, 1, v114
v_mfma_f32_16x16x32_bf16 v[44:47], a[120:123], v[220:223], v[44:47]
ds_read_b128 a[132:135], v103 offset:19456
v_or_b32 v115, 1, v115
v_mfma_f32_16x16x32_bf16 v[24:27], a[120:123], v[216:219], v[24:27]
buffer_load_dwordx4 v[208:211], v82, s[16:19], s32 offen sc1
v_or_b32 v116, 1, v116
v_mfma_f32_16x16x32_bf16 v[4:7], a[120:123], v[212:215], v[4:7]
v_or_b32 v117, 1, v117
v_or_b32 v118, 1, v118
s_waitcnt lgkmcnt(2)
v_mfma_f32_16x16x32_bf16 v[8:11], a[124:127], v[212:215], v[8:11]
v_or_b32 v119, 1, v119
v_or_b32 v120, 1, v120
v_mfma_f32_16x16x32_bf16 v[28:31], a[124:127], v[216:219], v[28:31]
v_or_b32 v121, 1, v121
v_or_b32 v122, 1, v122
v_mfma_f32_16x16x32_bf16 v[48:51], a[124:127], v[220:223], v[48:51]
v_or_b32 v123, 1, v123
v_mfma_f32_16x16x32_bf16 v[68:71], a[124:127], v[224:227], v[68:71]
s_waitcnt lgkmcnt(1)
v_mfma_f32_16x16x32_bf16 v[72:75], a[128:131], v[224:227], v[72:75]
v_mfma_f32_16x16x32_bf16 v[52:55], a[128:131], v[220:223], v[52:55]
v_mfma_f32_16x16x32_bf16 v[32:35], a[128:131], v[216:219], v[32:35]
v_mfma_f32_16x16x32_bf16 v[12:15], a[128:131], v[212:215], v[12:15]
s_waitcnt lgkmcnt(0)
v_mfma_f32_16x16x32_bf16 v[16:19], a[132:135], v[212:215], v[16:19]
v_mfma_f32_16x16x32_bf16 v[36:39], a[132:135], v[216:219], v[36:39]
v_mfma_f32_16x16x32_bf16 v[56:59], a[132:135], v[220:223], v[56:59]
v_mfma_f32_16x16x32_bf16 v[76:79], a[132:135], v[224:227], v[76:79]
s_waitcnt vmcnt(8)
v_mfma_f32_16x16x32_bf16 v[20:23], a[136:139], v[164:167], v[20:23]
s_add_u32 s32, s8, 16384
buffer_load_dwordx4 v[212:215], v80, s[16:19], s32 offen sc1
v_mfma_f32_16x16x32_bf16 v[20:23], a[156:159], v[168:171], v[20:23]
v_mfma_f32_16x16x32_bf16 v[20:23], a[176:179], v[172:175], v[20:23]
buffer_load_dwordx4 v[216:219], v81, s[16:19], s32 offen sc1
v_mfma_f32_16x16x32_bf16 v[20:23], a[196:199], v[176:179], v[20:23]
v_mfma_f32_16x16x32_bf16 v[24:27], a[200:203], v[176:179], v[24:27]
buffer_load_dwordx4 v[220:223], v82, s[16:19], s32 offen sc1
v_mfma_f32_16x16x32_bf16 v[24:27], a[180:183], v[172:175], v[24:27]
v_mfma_f32_16x16x32_bf16 v[24:27], a[160:163], v[168:171], v[24:27]
buffer_load_dwordx4 v[224:227], v83, s[16:19], s32 offen sc1
v_mfma_f32_16x16x32_bf16 v[24:27], a[140:143], v[164:167], v[24:27]
v_mfma_f32_16x16x32_bf16 v[28:31], a[144:147], v[164:167], v[28:31]
buffer_store_dwordx4 v[104:107], v250, s[16:19], s41 offen offset:0 sc1
v_mfma_f32_16x16x32_bf16 v[28:31], a[164:167], v[168:171], v[28:31]
v_mfma_f32_16x16x32_bf16 v[28:31], a[184:187], v[172:175], v[28:31]
buffer_store_dwordx4 v[108:111], v250, s[16:19], s41 offen offset:1024 sc1
v_mfma_f32_16x16x32_bf16 v[28:31], a[204:207], v[176:179], v[28:31]
v_mfma_f32_16x16x32_bf16 v[32:35], a[208:211], v[176:179], v[32:35]
buffer_store_dwordx4 v[112:115], v250, s[16:19], s41 offen offset:2048 sc1
v_mfma_f32_16x16x32_bf16 v[32:35], a[188:191], v[172:175], v[32:35]
v_mfma_f32_16x16x32_bf16 v[32:35], a[168:171], v[168:171], v[32:35]
buffer_store_dwordx4 v[116:119], v250, s[16:19], s41 offen offset:3072 sc1
v_mfma_f32_16x16x32_bf16 v[32:35], a[148:151], v[164:167], v[32:35]
v_mfma_f32_16x16x32_bf16 v[36:39], a[152:155], v[164:167], v[36:39]
buffer_store_dwordx4 v[120:123], v250, s[16:19], s37 offen offset:0 sc1
v_mfma_f32_16x16x32_bf16 v[36:39], a[172:175], v[168:171], v[36:39]
v_mfma_f32_16x16x32_bf16 v[36:39], a[192:195], v[172:175], v[36:39]
v_mfma_f32_16x16x32_bf16 v[36:39], a[212:215], v[176:179], v[36:39]
s_waitcnt vmcnt(13)
v_mfma_f32_16x16x32_bf16 v[56:59], a[212:215], v[192:195], v[56:59]
s_add_u32 s32, s9, 32768
buffer_load_dwordx4 v[164:167], v81, s[16:19], s32 offen sc1
v_mfma_f32_16x16x32_bf16 v[56:59], a[192:195], v[188:191], v[56:59]
v_mfma_f32_16x16x32_bf16 v[56:59], a[172:175], v[184:187], v[56:59]
buffer_load_dwordx4 v[168:171], v82, s[16:19], s32 offen sc1
v_mfma_f32_16x16x32_bf16 v[56:59], a[152:155], v[180:183], v[56:59]
v_mfma_f32_16x16x32_bf16 v[52:55], a[148:151], v[180:183], v[52:55]
buffer_load_dwordx4 v[172:175], v83, s[16:19], s32 offen sc1
v_mfma_f32_16x16x32_bf16 v[52:55], a[168:171], v[184:187], v[52:55]
v_mfma_f32_16x16x32_bf16 v[52:55], a[188:191], v[188:191], v[52:55]
buffer_load_dwordx4 v[176:179], v80, s[16:19], s32 offen sc1
v_mfma_f32_16x16x32_bf16 v[52:55], a[208:211], v[192:195], v[52:55]
v_mfma_f32_16x16x32_bf16 v[48:51], a[204:207], v[192:195], v[48:51]
v_mfma_f32_16x16x32_bf16 v[48:51], a[184:187], v[188:191], v[48:51]
v_mfma_f32_16x16x32_bf16 v[48:51], a[164:167], v[184:187], v[48:51]
v_mfma_f32_16x16x32_bf16 v[48:51], a[144:147], v[180:183], v[48:51]
v_mfma_f32_16x16x32_bf16 v[44:47], a[140:143], v[180:183], v[44:47]
v_mfma_f32_16x16x32_bf16 v[44:47], a[160:163], v[184:187], v[44:47]
v_mfma_f32_16x16x32_bf16 v[44:47], a[180:183], v[188:191], v[44:47]
v_mfma_f32_16x16x32_bf16 v[44:47], a[200:203], v[192:195], v[44:47]
v_mfma_f32_16x16x32_bf16 v[40:43], a[196:199], v[192:195], v[40:43]
v_mfma_f32_16x16x32_bf16 v[40:43], a[176:179], v[188:191], v[40:43]
v_mfma_f32_16x16x32_bf16 v[40:43], a[156:159], v[184:187], v[40:43]
v_mfma_f32_16x16x32_bf16 v[40:43], a[136:139], v[180:183], v[40:43]
s_waitcnt vmcnt(13)
v_mfma_f32_16x16x32_bf16 v[60:63], a[136:139], v[196:199], v[60:63]
s_add_u32 s32, s10, 32768
buffer_load_dwordx4 v[180:183], v82, s[16:19], s32 offen sc1
v_mfma_f32_16x16x32_bf16 v[60:63], a[156:159], v[200:203], v[60:63]
v_mfma_f32_16x16x32_bf16 v[60:63], a[176:179], v[204:207], v[60:63]
buffer_load_dwordx4 v[184:187], v83, s[16:19], s32 offen sc1
v_mfma_f32_16x16x32_bf16 v[60:63], a[196:199], v[208:211], v[60:63]
v_mfma_f32_16x16x32_bf16 v[64:67], a[200:203], v[208:211], v[64:67]
buffer_load_dwordx4 v[188:191], v80, s[16:19], s32 offen sc1
v_mfma_f32_16x16x32_bf16 v[64:67], a[180:183], v[204:207], v[64:67]
v_mfma_f32_16x16x32_bf16 v[64:67], a[160:163], v[200:203], v[64:67]
buffer_load_dwordx4 v[192:195], v81, s[16:19], s32 offen sc1
v_mfma_f32_16x16x32_bf16 v[64:67], a[140:143], v[196:199], v[64:67]
v_mfma_f32_16x16x32_bf16 v[68:71], a[144:147], v[196:199], v[68:71]
v_mfma_f32_16x16x32_bf16 v[68:71], a[164:167], v[200:203], v[68:71]
v_mfma_f32_16x16x32_bf16 v[68:71], a[184:187], v[204:207], v[68:71]
v_mfma_f32_16x16x32_bf16 v[68:71], a[204:207], v[208:211], v[68:71]
v_mfma_f32_16x16x32_bf16 v[72:75], a[208:211], v[208:211], v[72:75]
v_mfma_f32_16x16x32_bf16 v[72:75], a[188:191], v[204:207], v[72:75]
v_mfma_f32_16x16x32_bf16 v[72:75], a[168:171], v[200:203], v[72:75]
v_mfma_f32_16x16x32_bf16 v[72:75], a[148:151], v[196:199], v[72:75]
v_mfma_f32_16x16x32_bf16 v[76:79], a[152:155], v[196:199], v[76:79]
v_mfma_f32_16x16x32_bf16 v[76:79], a[172:175], v[200:203], v[76:79]
v_mfma_f32_16x16x32_bf16 v[76:79], a[192:195], v[204:207], v[76:79]
v_mfma_f32_16x16x32_bf16 v[76:79], a[212:215], v[208:211], v[76:79]
s_waitcnt vmcnt(13)
v_mfma_f32_16x16x32_bf16 v[16:19], a[212:215], v[224:227], v[16:19]
s_add_u32 s32, s11, 32768
buffer_load_dwordx4 v[196:199], v83, s[16:19], s32 offen sc1
v_lshlrev_b32 v144, 16, v92
v_mfma_f32_16x16x32_bf16 v[16:19], a[192:195], v[220:223], v[16:19]
v_and_b32 v145, s38, v92
v_lshlrev_b32 v146, 16, v93
v_mfma_f32_16x16x32_bf16 v[16:19], a[172:175], v[216:219], v[16:19]
buffer_load_dwordx4 v[200:203], v80, s[16:19], s32 offen sc1
v_and_b32 v147, s38, v93
v_mfma_f32_16x16x32_bf16 v[16:19], a[152:155], v[212:215], v[16:19]
v_lshlrev_b32 v148, 16, v94
v_and_b32 v149, s38, v94
v_mfma_f32_16x16x32_bf16 v[12:15], a[148:151], v[212:215], v[12:15]
buffer_load_dwordx4 v[204:207], v81, s[16:19], s32 offen sc1
v_lshlrev_b32 v150, 16, v95
v_mfma_f32_16x16x32_bf16 v[12:15], a[168:171], v[216:219], v[12:15]
v_and_b32 v151, s38, v95
v_lshlrev_b32 v152, 16, v96
v_mfma_f32_16x16x32_bf16 v[12:15], a[188:191], v[220:223], v[12:15]
buffer_load_dwordx4 v[208:211], v82, s[16:19], s32 offen sc1
v_and_b32 v153, s38, v96
v_mfma_f32_16x16x32_bf16 v[12:15], a[208:211], v[224:227], v[12:15]
v_lshlrev_b32 v154, 16, v97
v_and_b32 v155, s38, v97
v_mfma_f32_16x16x32_bf16 v[8:11], a[204:207], v[224:227], v[8:11]
v_lshlrev_b32 v156, 16, v98
v_and_b32 v157, s38, v98
v_mfma_f32_16x16x32_bf16 v[8:11], a[184:187], v[220:223], v[8:11]
v_lshlrev_b32 v158, 16, v99
v_and_b32 v159, s38, v99
v_mfma_f32_16x16x32_bf16 v[8:11], a[164:167], v[216:219], v[8:11]
v_lshlrev_b32 v160, 16, v100
v_and_b32 v161, s38, v100
v_mfma_f32_16x16x32_bf16 v[8:11], a[144:147], v[212:215], v[8:11]
v_lshlrev_b32 v162, 16, v101
v_and_b32 v163, s38, v101
v_mfma_f32_16x16x32_bf16 v[4:7], a[140:143], v[212:215], v[4:7]
v_lshlrev_b32 v124, 16, v238
v_and_b32 v125, s38, v238
v_mfma_f32_16x16x32_bf16 v[4:7], a[160:163], v[216:219], v[4:7]
v_lshlrev_b32 v126, 16, v239
v_and_b32 v127, s38, v239
v_mfma_f32_16x16x32_bf16 v[4:7], a[180:183], v[220:223], v[4:7]
v_lshlrev_b32 v128, 16, v240
v_and_b32 v129, s38, v240
v_mfma_f32_16x16x32_bf16 v[4:7], a[200:203], v[224:227], v[4:7]
v_lshlrev_b32 v130, 16, v241
v_and_b32 v131, s38, v241
v_mfma_f32_16x16x32_bf16 v[0:3], a[196:199], v[224:227], v[0:3]
v_lshlrev_b32 v132, 16, v242
v_and_b32 v133, s38, v242
v_mfma_f32_16x16x32_bf16 v[0:3], a[176:179], v[220:223], v[0:3]
v_lshlrev_b32 v134, 16, v243
v_and_b32 v135, s38, v243
v_mfma_f32_16x16x32_bf16 v[0:3], a[156:159], v[216:219], v[0:3]
v_lshlrev_b32 v136, 16, v244
v_and_b32 v137, s38, v244
v_mfma_f32_16x16x32_bf16 v[0:3], a[136:139], v[212:215], v[0:3]
v_lshlrev_b32 v138, 16, v245
v_and_b32 v139, s38, v245
s_waitcnt vmcnt(8)
v_mfma_f32_16x16x32_bf16 v[20:23], a[216:219], v[164:167], v[20:23]
s_add_u32 s32, s9, 49152
buffer_load_dwordx4 v[212:215], v81, s[16:19], s32 offen sc1
v_lshlrev_b32 v140, 16, v246
v_mfma_f32_16x16x32_bf16 v[20:23], a[236:239], v[168:171], v[20:23]
v_and_b32 v141, s38, v246
v_lshlrev_b32 v142, 16, v247
v_mfma_f32_16x16x32_bf16 v[20:23], a[0:3], v[172:175], v[20:23]
buffer_load_dwordx4 v[216:219], v82, s[16:19], s32 offen sc1
v_and_b32 v143, s38, v247
v_mfma_f32_16x16x32_bf16 v[20:23], a[20:23], v[176:179], v[20:23]
v_lshlrev_b32 v104, 16, v228
v_and_b32 v105, s38, v228
v_mfma_f32_16x16x32_bf16 v[24:27], a[24:27], v[176:179], v[24:27]
buffer_load_dwordx4 v[220:223], v83, s[16:19], s32 offen sc1
v_lshlrev_b32 v106, 16, v229
v_mfma_f32_16x16x32_bf16 v[24:27], a[4:7], v[172:175], v[24:27]
v_and_b32 v107, s38, v229
v_lshlrev_b32 v108, 16, v230
v_mfma_f32_16x16x32_bf16 v[24:27], a[240:243], v[168:171], v[24:27]
buffer_load_dwordx4 v[224:227], v80, s[16:19], s32 offen sc1
v_and_b32 v109, s38, v230
v_mfma_f32_16x16x32_bf16 v[24:27], a[220:223], v[164:167], v[24:27]
v_lshlrev_b32 v110, 16, v231
v_and_b32 v111, s38, v231
v_mfma_f32_16x16x32_bf16 v[28:31], a[224:227], v[164:167], v[28:31]
v_lshlrev_b32 v112, 16, v232
v_and_b32 v113, s38, v232
v_mfma_f32_16x16x32_bf16 v[28:31], a[244:247], v[168:171], v[28:31]
v_lshlrev_b32 v114, 16, v233
v_and_b32 v115, s38, v233
v_mfma_f32_16x16x32_bf16 v[28:31], a[8:11], v[172:175], v[28:31]
v_lshlrev_b32 v116, 16, v234
v_and_b32 v117, s38, v234
v_mfma_f32_16x16x32_bf16 v[28:31], a[28:31], v[176:179], v[28:31]
v_lshlrev_b32 v118, 16, v235
v_and_b32 v119, s38, v235
v_mfma_f32_16x16x32_bf16 v[32:35], a[32:35], v[176:179], v[32:35]
v_lshlrev_b32 v120, 16, v236
v_and_b32 v121, s38, v236
v_mfma_f32_16x16x32_bf16 v[32:35], a[12:15], v[172:175], v[32:35]
v_lshlrev_b32 v122, 16, v237
v_and_b32 v123, s38, v237
v_mfma_f32_16x16x32_bf16 v[32:35], a[248:251], v[168:171], v[32:35]
v_mfma_f32_16x16x32_bf16 v[32:35], a[228:231], v[164:167], v[32:35]
v_mfma_f32_16x16x32_bf16 v[36:39], a[232:235], v[164:167], v[36:39]
v_mfma_f32_16x16x32_bf16 v[36:39], a[252:255], v[168:171], v[36:39]
v_mfma_f32_16x16x32_bf16 v[36:39], a[16:19], v[172:175], v[36:39]
v_mfma_f32_16x16x32_bf16 v[36:39], a[36:39], v[176:179], v[36:39]
s_waitcnt vmcnt(8)
v_mfma_f32_16x16x32_bf16 v[56:59], a[36:39], v[192:195], v[56:59]
s_add_u32 s32, s10, 49152
buffer_load_dwordx4 v[164:167], v82, s[16:19], s32 offen sc1
v_mfma_f32_16x16x32_bf16 v[56:59], a[16:19], v[188:191], v[56:59]
v_mfma_f32_16x16x32_bf16 v[56:59], a[252:255], v[184:187], v[56:59]
buffer_load_dwordx4 v[168:171], v83, s[16:19], s32 offen sc1
v_mfma_f32_16x16x32_bf16 v[56:59], a[232:235], v[180:183], v[56:59]
v_mfma_f32_16x16x32_bf16 v[52:55], a[228:231], v[180:183], v[52:55]
buffer_load_dwordx4 v[172:175], v80, s[16:19], s32 offen sc1
v_mfma_f32_16x16x32_bf16 v[52:55], a[248:251], v[184:187], v[52:55]
v_mfma_f32_16x16x32_bf16 v[52:55], a[12:15], v[188:191], v[52:55]
buffer_load_dwordx4 v[176:179], v81, s[16:19], s32 offen sc1
v_mfma_f32_16x16x32_bf16 v[52:55], a[32:35], v[192:195], v[52:55]
v_mfma_f32_16x16x32_bf16 v[48:51], a[28:31], v[192:195], v[48:51]
v_mfma_f32_16x16x32_bf16 v[48:51], a[8:11], v[188:191], v[48:51]
v_mfma_f32_16x16x32_bf16 v[48:51], a[244:247], v[184:187], v[48:51]
v_mfma_f32_16x16x32_bf16 v[48:51], a[224:227], v[180:183], v[48:51]
v_mfma_f32_16x16x32_bf16 v[44:47], a[220:223], v[180:183], v[44:47]
v_mfma_f32_16x16x32_bf16 v[44:47], a[240:243], v[184:187], v[44:47]
v_mfma_f32_16x16x32_bf16 v[44:47], a[4:7], v[188:191], v[44:47]
v_mfma_f32_16x16x32_bf16 v[44:47], a[24:27], v[192:195], v[44:47]
v_mfma_f32_16x16x32_bf16 v[40:43], a[20:23], v[192:195], v[40:43]
v_mfma_f32_16x16x32_bf16 v[40:43], a[0:3], v[188:191], v[40:43]
v_mfma_f32_16x16x32_bf16 v[40:43], a[236:239], v[184:187], v[40:43]
v_mfma_f32_16x16x32_bf16 v[40:43], a[216:219], v[180:183], v[40:43]
s_waitcnt vmcnt(8)
v_mfma_f32_16x16x32_bf16 v[60:63], a[216:219], v[196:199], v[60:63]
s_add_u32 s32, s11, 49152
buffer_load_dwordx4 v[180:183], v83, s[16:19], s32 offen sc1
v_mfma_f32_16x16x32_bf16 v[60:63], a[236:239], v[200:203], v[60:63]
v_mfma_f32_16x16x32_bf16 v[60:63], a[0:3], v[204:207], v[60:63]
buffer_load_dwordx4 v[184:187], v80, s[16:19], s32 offen sc1
v_mfma_f32_16x16x32_bf16 v[60:63], a[20:23], v[208:211], v[60:63]
v_mfma_f32_16x16x32_bf16 v[64:67], a[24:27], v[208:211], v[64:67]
buffer_load_dwordx4 v[188:191], v81, s[16:19], s32 offen sc1
v_mfma_f32_16x16x32_bf16 v[64:67], a[4:7], v[204:207], v[64:67]
v_mfma_f32_16x16x32_bf16 v[64:67], a[240:243], v[200:203], v[64:67]
buffer_load_dwordx4 v[192:195], v82, s[16:19], s32 offen sc1
v_mfma_f32_16x16x32_bf16 v[64:67], a[220:223], v[196:199], v[64:67]
v_mfma_f32_16x16x32_bf16 v[68:71], a[224:227], v[196:199], v[68:71]
v_mfma_f32_16x16x32_bf16 v[68:71], a[244:247], v[200:203], v[68:71]
v_mfma_f32_16x16x32_bf16 v[68:71], a[8:11], v[204:207], v[68:71]
v_mfma_f32_16x16x32_bf16 v[68:71], a[28:31], v[208:211], v[68:71]
v_mfma_f32_16x16x32_bf16 v[72:75], a[32:35], v[208:211], v[72:75]
v_mfma_f32_16x16x32_bf16 v[72:75], a[12:15], v[204:207], v[72:75]
v_mfma_f32_16x16x32_bf16 v[72:75], a[248:251], v[200:203], v[72:75]
v_mfma_f32_16x16x32_bf16 v[72:75], a[228:231], v[196:199], v[72:75]
v_mfma_f32_16x16x32_bf16 v[76:79], a[232:235], v[196:199], v[76:79]
v_mfma_f32_16x16x32_bf16 v[76:79], a[252:255], v[200:203], v[76:79]
v_mfma_f32_16x16x32_bf16 v[76:79], a[16:19], v[204:207], v[76:79]
v_mfma_f32_16x16x32_bf16 v[76:79], a[36:39], v[208:211], v[76:79]
s_waitcnt vmcnt(8)
v_mfma_f32_16x16x32_bf16 v[36:39], a[116:119], v[224:227], v[36:39]
s_add_u32 s32, s8, 32768
buffer_load_dwordx4 v[196:199], v80, s[16:19], s32 offen sc1
v_mfma_f32_16x16x32_bf16 v[36:39], a[96:99], v[220:223], v[36:39]
v_mfma_f32_16x16x32_bf16 v[36:39], a[76:79], v[216:219], v[36:39]
buffer_load_dwordx4 v[200:203], v81, s[16:19], s32 offen sc1
v_mfma_f32_16x16x32_bf16 v[36:39], a[56:59], v[212:215], v[36:39]
v_mfma_f32_16x16x32_bf16 v[32:35], a[52:55], v[212:215], v[32:35]
buffer_load_dwordx4 v[204:207], v82, s[16:19], s32 offen sc1
v_mfma_f32_16x16x32_bf16 v[32:35], a[72:75], v[216:219], v[32:35]
v_mfma_f32_16x16x32_bf16 v[32:35], a[92:95], v[220:223], v[32:35]
buffer_load_dwordx4 v[208:211], v83, s[16:19], s32 offen sc1
v_mfma_f32_16x16x32_bf16 v[32:35], a[112:115], v[224:227], v[32:35]
L_m_c2_2:
s_cbranch_execz L_m_c2_6
v_mfma_f32_16x16x32_bf16 v[28:31], a[108:111], v[224:227], v[28:31]
v_mfma_f32_16x16x32_bf16 v[28:31], a[88:91], v[220:223], v[28:31]
v_mfma_f32_16x16x32_bf16 v[28:31], a[68:71], v[216:219], v[28:31]
v_mfma_f32_16x16x32_bf16 v[28:31], a[48:51], v[212:215], v[28:31]
v_mfma_f32_16x16x32_bf16 v[24:27], a[44:47], v[212:215], v[24:27]
v_mfma_f32_16x16x32_bf16 v[24:27], a[64:67], v[216:219], v[24:27]
v_mfma_f32_16x16x32_bf16 v[24:27], a[84:87], v[220:223], v[24:27]
v_mfma_f32_16x16x32_bf16 v[24:27], a[104:107], v[224:227], v[24:27]
v_mfma_f32_16x16x32_bf16 v[20:23], a[100:103], v[224:227], v[20:23]
v_mfma_f32_16x16x32_bf16 v[20:23], a[80:83], v[220:223], v[20:23]
v_mfma_f32_16x16x32_bf16 v[20:23], a[60:63], v[216:219], v[20:23]
v_mfma_f32_16x16x32_bf16 v[20:23], a[40:43], v[212:215], v[20:23]
s_barrier
s_waitcnt vmcnt(8)
v_mfma_f32_16x16x32_bf16 v[40:43], a[40:43], v[164:167], v[40:43]
s_add_u32 s32, s8, 49152
buffer_load_dwordx4 v[212:215], v80, s[16:19], s32 offen sc1
v_mfma_f32_16x16x32_bf16 v[40:43], a[60:63], v[168:171], v[40:43]
v_mfma_f32_16x16x32_bf16 v[40:43], a[80:83], v[172:175], v[40:43]
buffer_load_dwordx4 v[216:219], v81, s[16:19], s32 offen sc1
v_mfma_f32_16x16x32_bf16 v[40:43], a[100:103], v[176:179], v[40:43]
ds_write_b128 v87, v[36:39] offset:4096
v_mfma_f32_16x16x32_bf16 v[44:47], a[104:107], v[176:179], v[44:47]
buffer_load_dwordx4 v[220:223], v82, s[16:19], s32 offen sc1
v_mfma_f32_16x16x32_bf16 v[44:47], a[84:87], v[172:175], v[44:47]
v_mfma_f32_16x16x32_bf16 v[44:47], a[64:67], v[168:171], v[44:47]
buffer_load_dwordx4 v[224:227], v83, s[16:19], s32 offen sc1
v_mfma_f32_16x16x32_bf16 v[44:47], a[44:47], v[164:167], v[44:47]
ds_write_b128 v87, v[32:35] offset:3072
v_mfma_f32_16x16x32_bf16 v[48:51], a[48:51], v[164:167], v[48:51]
v_mfma_f32_16x16x32_bf16 v[48:51], a[68:71], v[168:171], v[48:51]
v_mfma_f32_16x16x32_bf16 v[48:51], a[88:91], v[172:175], v[48:51]
v_mfma_f32_16x16x32_bf16 v[48:51], a[108:111], v[176:179], v[48:51]
ds_write_b128 v87, v[28:31] offset:2048
v_mfma_f32_16x16x32_bf16 v[52:55], a[112:115], v[176:179], v[52:55]
v_mfma_f32_16x16x32_bf16 v[52:55], a[92:95], v[172:175], v[52:55]
v_mfma_f32_16x16x32_bf16 v[52:55], a[72:75], v[168:171], v[52:55]
v_mfma_f32_16x16x32_bf16 v[52:55], a[52:55], v[164:167], v[52:55]
ds_write_b128 v87, v[24:27] offset:1024
v_mfma_f32_16x16x32_bf16 v[56:59], a[56:59], v[164:167], v[56:59]
v_mfma_f32_16x16x32_bf16 v[56:59], a[76:79], v[168:171], v[56:59]
v_mfma_f32_16x16x32_bf16 v[56:59], a[96:99], v[172:175], v[56:59]
v_mfma_f32_16x16x32_bf16 v[56:59], a[116:119], v[176:179], v[56:59]
ds_write_b128 v87, v[20:23] offset:0
s_waitcnt vmcnt(8)
v_mfma_f32_16x16x32_bf16 v[76:79], a[116:119], v[192:195], v[76:79]
s_add_u32 s34, s86, 4096
buffer_load_dwordx4 v[228:231], v250, s[16:19], s86 offen offset:0 sc1
v_mfma_f32_16x16x32_bf16 v[76:79], a[96:99], v[188:191], v[76:79]
v_mfma_f32_16x16x32_bf16 v[76:79], a[76:79], v[184:187], v[76:79]
buffer_load_dwordx4 v[232:235], v250, s[16:19], s86 offen offset:1024 sc1
v_mfma_f32_16x16x32_bf16 v[76:79], a[56:59], v[180:183], v[76:79]
ds_write_b128 v88, v[40:43] offset:0
v_mfma_f32_16x16x32_bf16 v[72:75], a[52:55], v[180:183], v[72:75]
buffer_load_dwordx4 v[236:239], v250, s[16:19], s86 offen offset:2048 sc1
v_mfma_f32_16x16x32_bf16 v[72:75], a[72:75], v[184:187], v[72:75]
v_mfma_f32_16x16x32_bf16 v[72:75], a[92:95], v[188:191], v[72:75]
buffer_load_dwordx4 v[240:243], v250, s[16:19], s86 offen offset:3072 sc1
v_mfma_f32_16x16x32_bf16 v[72:75], a[112:115], v[192:195], v[72:75]
ds_write_b128 v88, v[44:47] offset:1024
v_mfma_f32_16x16x32_bf16 v[68:71], a[108:111], v[192:195], v[68:71]
buffer_load_dwordx4 v[244:247], v250, s[16:19], s34 offen offset:0 sc1
v_mfma_f32_16x16x32_bf16 v[68:71], a[88:91], v[188:191], v[68:71]
v_mfma_f32_16x16x32_bf16 v[68:71], a[68:71], v[184:187], v[68:71]
v_mfma_f32_16x16x32_bf16 v[68:71], a[48:51], v[180:183], v[68:71]
ds_write_b128 v88, v[48:51] offset:2048
v_mfma_f32_16x16x32_bf16 v[64:67], a[44:47], v[180:183], v[64:67]
v_mfma_f32_16x16x32_bf16 v[64:67], a[64:67], v[184:187], v[64:67]
v_mfma_f32_16x16x32_bf16 v[64:67], a[84:87], v[188:191], v[64:67]
v_mfma_f32_16x16x32_bf16 v[64:67], a[104:107], v[192:195], v[64:67]
ds_write_b128 v88, v[52:55] offset:3072
v_mfma_f32_16x16x32_bf16 v[60:63], a[100:103], v[192:195], v[60:63]
v_mfma_f32_16x16x32_bf16 v[60:63], a[80:83], v[188:191], v[60:63]
v_mfma_f32_16x16x32_bf16 v[60:63], a[60:63], v[184:187], v[60:63]
v_mfma_f32_16x16x32_bf16 v[60:63], a[40:43], v[180:183], v[60:63]
ds_write_b128 v88, v[56:59] offset:4096
s_waitcnt vmcnt(9)
v_mfma_f32_16x16x32_bf16 v[0:3], a[216:219], v[196:199], v[0:3]
s_add_u32 m0, s90, 0
s_add_u32 s91, s89, 0
buffer_load_dwordx4 v249, s[12:15], s91 offen lds
v_mfma_f32_16x16x32_bf16 v[0:3], a[236:239], v[200:203], v[0:3]
v_mfma_f32_16x16x32_bf16 v[0:3], a[0:3], v[204:207], v[0:3]
s_add_u32 m0, s90, 2048
s_add_u32 s91, s89, 27648
buffer_load_dwordx4 v249, s[12:15], s91 offen lds
v_mfma_f32_16x16x32_bf16 v[0:3], a[20:23], v[208:211], v[0:3]
ds_write_b128 v89, v[76:79] offset:4096
v_mfma_f32_16x16x32_bf16 v[4:7], a[24:27], v[208:211], v[4:7]
s_add_u32 m0, s90, 4096
s_add_u32 s91, s89, 55296
buffer_load_dwordx4 v249, s[12:15], s91 offen lds
v_mfma_f32_16x16x32_bf16 v[4:7], a[4:7], v[204:207], v[4:7]
v_mfma_f32_16x16x32_bf16 v[4:7], a[240:243], v[200:203], v[4:7]
v_mfma_f32_16x16x32_bf16 v[4:7], a[220:223], v[196:199], v[4:7]
ds_write_b128 v89, v[72:75] offset:3072
v_mfma_f32_16x16x32_bf16 v[8:11], a[224:227], v[196:199], v[8:11]
v_mfma_f32_16x16x32_bf16 v[8:11], a[244:247], v[200:203], v[8:11]
v_mfma_f32_16x16x32_bf16 v[8:11], a[8:11], v[204:207], v[8:11]
v_mfma_f32_16x16x32_bf16 v[8:11], a[28:31], v[208:211], v[8:11]
ds_write_b128 v89, v[68:71] offset:2048
v_mfma_f32_16x16x32_bf16 v[12:15], a[32:35], v[208:211], v[12:15]
v_mfma_f32_16x16x32_bf16 v[12:15], a[12:15], v[204:207], v[12:15]
v_mfma_f32_16x16x32_bf16 v[12:15], a[248:251], v[200:203], v[12:15]
v_mfma_f32_16x16x32_bf16 v[12:15], a[228:231], v[196:199], v[12:15]
ds_write_b128 v89, v[64:67] offset:1024
v_mfma_f32_16x16x32_bf16 v[16:19], a[232:235], v[196:199], v[16:19]
v_mfma_f32_16x16x32_bf16 v[16:19], a[252:255], v[200:203], v[16:19]
v_mfma_f32_16x16x32_bf16 v[16:19], a[16:19], v[204:207], v[16:19]
v_mfma_f32_16x16x32_bf16 v[16:19], a[36:39], v[208:211], v[16:19]
ds_write_b128 v89, v[60:63] offset:0
s_waitcnt vmcnt(8)
v_mfma_f32_16x16x32_bf16 v[16:19], a[116:119], v[224:227], v[16:19]
s_add_u32 m0, s90, 6144
s_add_u32 s91, s89, 82944
buffer_load_dwordx4 v249, s[12:15], s91 offen lds
v_mfma_f32_16x16x32_bf16 v[16:19], a[96:99], v[220:223], v[16:19]
s_waitcnt lgkmcnt(0)
s_barrier
ds_read_b128 v[20:23], v90 offset:0
v_mfma_f32_16x16x32_bf16 v[16:19], a[76:79], v[216:219], v[16:19]
s_add_u32 m0, s90, 8192
s_add_u32 s91, s89, 110592
buffer_load_dwordx4 v249, s[12:15], s91 offen lds
ds_read_b128 v[24:27], v90 offset:1024
v_mfma_f32_16x16x32_bf16 v[16:19], a[56:59], v[212:215], v[16:19]
ds_read_b128 v[28:31], v90 offset:2048
ds_read_b128 v[32:35], v90 offset:3072
v_mfma_f32_16x16x32_bf16 v[12:15], a[52:55], v[212:215], v[12:15]
s_add_u32 m0, s90, 20480
s_add_u32 s91, s89, 276480
buffer_load_dwordx4 v249, s[12:15], s91 offen lds
ds_read_b128 v[36:39], v90 offset:4096
v_mfma_f32_16x16x32_bf16 v[12:15], a[72:75], v[216:219], v[12:15]
ds_read_b128 v[40:43], v90 offset:5120
ds_read_b128 v[44:47], v90 offset:6144
v_mfma_f32_16x16x32_bf16 v[12:15], a[92:95], v[220:223], v[12:15]
ds_read_b128 v[48:51], v90 offset:7168
ds_read_b128 v[52:55], v90 offset:8192
v_mfma_f32_16x16x32_bf16 v[12:15], a[112:115], v[224:227], v[12:15]
ds_read_b128 v[56:59], v90 offset:9216
ds_read_b128 v[60:63], v90 offset:10240
v_mfma_f32_16x16x32_bf16 v[8:11], a[108:111], v[224:227], v[8:11]
ds_read_b128 v[64:67], v90 offset:11264
ds_read_b128 v[68:71], v90 offset:12288
v_mfma_f32_16x16x32_bf16 v[8:11], a[88:91], v[220:223], v[8:11]
ds_read_b128 v[72:75], v90 offset:13312
ds_read_b128 v[76:79], v90 offset:14336
v_mfma_f32_16x16x32_bf16 v[8:11], a[68:71], v[216:219], v[8:11]
v_mfma_f32_16x16x32_bf16 v[8:11], a[48:51], v[212:215], v[8:11]
v_mfma_f32_16x16x32_bf16 v[4:7], a[44:47], v[212:215], v[4:7]
s_waitcnt lgkmcnt(5)
v_add_f32 v20, v20, v40
v_add_f32 v21, v21, v41
v_mfma_f32_16x16x32_bf16 v[4:7], a[64:67], v[216:219], v[4:7]
v_add_f32 v22, v22, v42
v_add_f32 v23, v23, v43
v_mfma_f32_16x16x32_bf16 v[4:7], a[84:87], v[220:223], v[4:7]
v_add_f32 v24, v24, v44
v_add_f32 v25, v25, v45
v_mfma_f32_16x16x32_bf16 v[4:7], a[104:107], v[224:227], v[4:7]
v_add_f32 v26, v26, v46
v_add_f32 v27, v27, v47
v_mfma_f32_16x16x32_bf16 v[0:3], a[100:103], v[224:227], v[0:3]
v_add_f32 v28, v28, v48
v_add_f32 v29, v29, v49
v_mfma_f32_16x16x32_bf16 v[0:3], a[80:83], v[220:223], v[0:3]
v_add_f32 v30, v30, v50
v_add_f32 v31, v31, v51
v_mfma_f32_16x16x32_bf16 v[0:3], a[60:63], v[216:219], v[0:3]
v_add_f32 v32, v32, v52
v_add_f32 v33, v33, v53
v_mfma_f32_16x16x32_bf16 v[0:3], a[40:43], v[212:215], v[0:3]
v_add_f32 v34, v34, v54
v_add_f32 v35, v35, v55
s_add_u32 m0, s90, 22528
s_add_u32 s91, s89, 304128
buffer_load_dwordx4 v249, s[12:15], s91 offen lds
s_add_u32 m0, s90, 24576
s_add_u32 s91, s89, 331776
buffer_load_dwordx4 v249, s[12:15], s91 offen lds
v_add_f32 v36, v36, v56
v_add_f32 v37, v37, v57
v_add_f32 v38, v38, v58
v_add_f32 v39, v39, v59
v_pk_add_f32 v[16:17], v[16:17], v[36:37]
v_pk_add_f32 v[18:19], v[18:19], v[38:39]
v_pk_add_f32 v[12:13], v[12:13], v[32:33]
v_pk_add_f32 v[14:15], v[14:15], v[34:35]
s_add_u32 m0, s90, 26624
s_add_u32 s91, s89, 359424
buffer_load_dwordx4 v249, s[12:15], s91 offen lds
v_pk_add_f32 v[8:9], v[8:9], v[28:29]
v_pk_add_f32 v[10:11], v[10:11], v[30:31]
v_pk_add_f32 v[4:5], v[4:5], v[24:25]
v_pk_add_f32 v[6:7], v[6:7], v[26:27]
v_pk_add_f32 v[0:1], v[0:1], v[20:21]
v_pk_add_f32 v[2:3], v[2:3], v[22:23]
s_waitcnt lgkmcnt(0)
v_pk_add_f32 v[16:17], v[16:17], v[76:77]
v_pk_add_f32 v[18:19], v[18:19], v[78:79]
s_add_u32 m0, s90, 28672
s_add_u32 s91, s89, 387072
buffer_load_dwordx4 v249, s[12:15], s91 offen lds
v_pk_add_f32 v[12:13], v[12:13], v[72:73]
v_pk_add_f32 v[14:15], v[14:15], v[74:75]
v_pk_add_f32 v[8:9], v[8:9], v[68:69]
v_pk_add_f32 v[10:11], v[10:11], v[70:71]
v_pk_add_f32 v[4:5], v[4:5], v[64:65]
v_pk_add_f32 v[6:7], v[6:7], v[66:67]
v_pk_add_f32 v[0:1], v[0:1], v[60:61]
v_pk_add_f32 v[2:3], v[2:3], v[62:63]
s_waitcnt vmcnt(10)
s_add_u32 m0, s90, 40960
s_add_u32 s91, s89, 552960
buffer_load_dwordx4 v249, s[12:15], s91 offen lds
v_bitop3_b32 v84, 1, v228, v229 bitop3:0x80
v_bitop3_b32 v84, v84, v230, v231 bitop3:0x80
v_bitop3_b32 v84, v84, v232, v233 bitop3:0x80
v_bitop3_b32 v84, v84, v234, v235 bitop3:0x80
v_bitop3_b32 v84, v84, v236, v237 bitop3:0x80
v_bitop3_b32 v84, v84, v238, v239 bitop3:0x80
v_bitop3_b32 v84, v84, v240, v241 bitop3:0x80
v_bitop3_b32 v84, v84, v242, v243 bitop3:0x80
v_bitop3_b32 v84, v84, v244, v245 bitop3:0x80
s_add_u32 m0, s90, 43008
s_add_u32 s91, s89, 580608
buffer_load_dwordx4 v249, s[12:15], s91 offen lds
v_bitop3_b32 v84, v84, v246, v247 bitop3:0x80
v_cmp_eq_u32 vcc, 0, v84
s_cmp_eq_u64 vcc, 0
s_cbranch_scc1 L_m_qx
s_mov_b32 s82, 0
L_m_poll11:
buffer_load_dwordx4 v[228:231], v250, s[16:19], s86 offen offset:0 sc1
buffer_load_dwordx4 v[232:235], v250, s[16:19], s86 offen offset:1024 sc1
buffer_load_dwordx4 v[236:239], v250, s[16:19], s86 offen offset:2048 sc1
buffer_load_dwordx4 v[240:243], v250, s[16:19], s86 offen offset:3072 sc1
buffer_load_dwordx4 v[244:247], v250, s[16:19], s34 offen offset:0 sc1
s_waitcnt vmcnt(0)
v_bitop3_b32 v84, 1, v228, v229 bitop3:0x80
v_bitop3_b32 v84, v84, v230, v231 bitop3:0x80
v_bitop3_b32 v84, v84, v232, v233 bitop3:0x80
v_bitop3_b32 v84, v84, v234, v235 bitop3:0x80
v_bitop3_b32 v84, v84, v236, v237 bitop3:0x80
v_bitop3_b32 v84, v84, v238, v239 bitop3:0x80
v_bitop3_b32 v84, v84, v240, v241 bitop3:0x80
v_bitop3_b32 v84, v84, v242, v243 bitop3:0x80
v_bitop3_b32 v84, v84, v244, v245 bitop3:0x80
v_bitop3_b32 v84, v84, v246, v247 bitop3:0x80
v_cmp_gt_u32 vcc, 1, v84
s_cmp_eq_u64 vcc, 0
s_cbranch_scc1 L_m_poll11d
s_sleep 4
s_add_u32 s82, s82, 1
s_cmp_lt_u32 s82, 0x40000
s_cbranch_scc1 L_m_poll11
L_m_poll11d:
L_m_qx:
v_pk_add_f32 v[0:1], v[0:1], v[228:229]
v_pk_add_f32 v[2:3], v[2:3], v[230:231]
v_pk_add_f32 v[4:5], v[4:5], v[232:233]
v_pk_add_f32 v[6:7], v[6:7], v[234:235]
v_pk_add_f32 v[8:9], v[8:9], v[236:237]
v_pk_add_f32 v[10:11], v[10:11], v[238:239]
v_pk_add_f32 v[12:13], v[12:13], v[240:241]
v_pk_add_f32 v[14:15], v[14:15], v[242:243]
v_pk_add_f32 v[16:17], v[16:17], v[244:245]
s_add_u32 m0, s90, 45056
s_add_u32 s91, s89, 608256
buffer_load_dwordx4 v249, s[12:15], s91 offen lds
v_pk_add_f32 v[18:19], v[18:19], v[246:247]
v_pk_fma_f32 v[0:1], v[0:1], v[104:105], v[144:145]
v_pk_fma_f32 v[2:3], v[2:3], v[106:107], v[146:147]
v_pk_fma_f32 v[4:5], v[4:5], v[108:109], v[148:149]
v_pk_fma_f32 v[6:7], v[6:7], v[110:111], v[150:151]
v_pk_fma_f32 v[8:9], v[8:9], v[112:113], v[152:153]
v_pk_fma_f32 v[10:11], v[10:11], v[114:115], v[154:155]
v_pk_fma_f32 v[12:13], v[12:13], v[116:117], v[156:157]
v_pk_fma_f32 v[14:15], v[14:15], v[118:119], v[158:159]
s_add_u32 m0, s90, 47104
s_add_u32 s91, s89, 635904
buffer_load_dwordx4 v249, s[12:15], s91 offen lds
v_pk_fma_f32 v[16:17], v[16:17], v[120:121], v[160:161]
v_pk_fma_f32 v[18:19], v[18:19], v[122:123], v[162:163]
v_cvt_pk_bf16_f32 v92, v0, v1
v_cvt_pk_bf16_f32 v93, v2, v3
v_cvt_pk_bf16_f32 v94, v4, v5
v_cvt_pk_bf16_f32 v95, v6, v7
v_cvt_pk_bf16_f32 v96, v8, v9
v_cvt_pk_bf16_f32 v97, v10, v11
v_cvt_pk_bf16_f32 v98, v12, v13
s_add_u32 m0, s90, 49152
s_add_u32 s91, s89, 663552
buffer_load_dwordx4 v249, s[12:15], s91 offen lds
v_cvt_pk_bf16_f32 v99, v14, v15
v_cvt_pk_bf16_f32 v100, v16, v17
v_cvt_pk_bf16_f32 v101, v18, v19
v_lshlrev_b32 v144, 16, v92
v_and_b32 v145, s38, v92
v_lshlrev_b32 v146, 16, v93
v_and_b32 v147, s38, v93
v_lshlrev_b32 v148, 16, v94
v_and_b32 v149, s38, v94
v_lshlrev_b32 v150, 16, v95
v_and_b32 v151, s38, v95
v_lshlrev_b32 v152, 16, v96
s_add_u32 m0, s90, 61440
s_add_u32 s91, s89, 829440
buffer_load_dwordx4 v249, s[12:15], s91 offen lds
v_and_b32 v153, s38, v96
v_lshlrev_b32 v154, 16, v97
v_and_b32 v155, s38, v97
v_lshlrev_b32 v156, 16, v98
v_and_b32 v157, s38, v98
v_lshlrev_b32 v158, 16, v99
v_and_b32 v159, s38, v99
v_lshlrev_b32 v160, 16, v100
v_and_b32 v161, s38, v100
s_add_u32 m0, s90, 63488
s_add_u32 s91, s89, 857088
buffer_load_dwordx4 v249, s[12:15], s91 offen lds
v_lshlrev_b32 v162, 16, v101
v_and_b32 v163, s38, v101
v_pk_add_f32 v[0:1], v[144:145], v[146:147]
v_pk_add_f32 v[2:3], v[148:149], v[150:151]
v_pk_add_f32 v[0:1], v[0:1], v[152:153]
v_pk_add_f32 v[2:3], v[2:3], v[154:155]
v_pk_add_f32 v[0:1], v[0:1], v[156:157]
v_pk_add_f32 v[2:3], v[2:3], v[158:159]
v_pk_add_f32 v[0:1], v[0:1], v[160:161]
s_add_u32 m0, s90, 65536
s_add_u32 s91, s89, 884736
buffer_load_dwordx4 v249, s[12:15], s91 offen lds
v_pk_add_f32 v[2:3], v[2:3], v[162:163]
v_pk_add_f32 v[0:1], v[0:1], v[2:3]
v_add_f32 v0, v0, v1
v_mov_b32 v1, v0
v_pk_mul_f32 v[124:125], v[124:125], v[144:145]
v_pk_mul_f32 v[126:127], v[126:127], v[146:147]
v_pk_mul_f32 v[128:129], v[128:129], v[148:149]
v_permlane16_swap_b32 v0, v1
v_pk_mul_f32 v[130:131], v[130:131], v[150:151]
s_add_u32 m0, s90, 67584
s_add_u32 s91, s89, 912384
buffer_load_dwordx4 v249, s[12:15], s91 offen lds
v_pk_mul_f32 v[132:133], v[132:133], v[152:153]
v_add_f32 v0, v0, v1
v_mov_b32 v1, v0
v_pk_mul_f32 v[134:135], v[134:135], v[154:155]
v_pk_mul_f32 v[136:137], v[136:137], v[156:157]
v_pk_mul_f32 v[138:139], v[138:139], v[158:159]
v_permlane32_swap_b32 v0, v1
v_pk_mul_f32 v[140:141], v[140:141], v[160:161]
v_pk_mul_f32 v[142:143], v[142:143], v[162:163]
s_add_u32 m0, s90, 69632
s_add_u32 s91, s89, 940032
buffer_load_dwordx4 v249, s[12:15], s91 offen lds
v_add_f32 v0, v0, v1
v_mul_f32 v2, 0xbc4ccccd, v0
v_pk_add_f32 v[144:145], v[144:145], v[2:3] op_sel_hi:[1,0]
v_pk_add_f32 v[146:147], v[146:147], v[2:3] op_sel_hi:[1,0]
v_pk_add_f32 v[148:149], v[148:149], v[2:3] op_sel_hi:[1,0]
v_pk_add_f32 v[150:151], v[150:151], v[2:3] op_sel_hi:[1,0]
v_pk_add_f32 v[152:153], v[152:153], v[2:3] op_sel_hi:[1,0]
v_pk_add_f32 v[154:155], v[154:155], v[2:3] op_sel_hi:[1,0]
v_pk_add_f32 v[156:157], v[156:157], v[2:3] op_sel_hi:[1,0]
v_pk_add_f32 v[158:159], v[158:159], v[2:3] op_sel_hi:[1,0]
v_pk_add_f32 v[160:161], v[160:161], v[2:3] op_sel_hi:[1,0]
v_pk_add_f32 v[162:163], v[162:163], v[2:3] op_sel_hi:[1,0]
v_pk_mul_f32 v[4:5], v[144:145], v[144:145]
v_pk_mul_f32 v[6:7], v[146:147], v[146:147]
v_pk_fma_f32 v[4:5], v[148:149], v[148:149], v[4:5]
v_pk_fma_f32 v[6:7], v[150:151], v[150:151], v[6:7]
v_pk_fma_f32 v[4:5], v[152:153], v[152:153], v[4:5]
v_pk_fma_f32 v[6:7], v[154:155], v[154:155], v[6:7]
v_pk_fma_f32 v[4:5], v[156:157], v[156:157], v[4:5]
v_pk_fma_f32 v[6:7], v[158:159], v[158:159], v[6:7]
v_pk_fma_f32 v[4:5], v[160:161], v[160:161], v[4:5]
v_pk_fma_f32 v[6:7], v[162:163], v[162:163], v[6:7]
v_pk_add_f32 v[4:5], v[4:5], v[6:7]
v_add_f32 v1, v4, v5
v_mov_b32 v2, v1
v_cvt_pk_bf16_f32 v20, v124, v125
v_cvt_pk_bf16_f32 v21, v126, v127
v_cvt_pk_bf16_f32 v22, v128, v129
v_permlane16_swap_b32 v1, v2
v_cvt_pk_bf16_f32 v23, v130, v131
v_cvt_pk_bf16_f32 v24, v132, v133
v_add_f32 v1, v1, v2
v_mov_b32 v2, v1
v_cvt_pk_bf16_f32 v25, v134, v135
v_cvt_pk_bf16_f32 v26, v136, v137
v_cvt_pk_bf16_f32 v27, v138, v139
v_permlane32_swap_b32 v1, v2
v_cvt_pk_bf16_f32 v28, v140, v141
v_cvt_pk_bf16_f32 v29, v142, v143
v_add_f32 v1, v1, v2
buffer_store_dwordx4 v[20:23], v250, s[16:19], s75 offen sc1
buffer_store_dwordx4 v[24:27], v250, s[16:19], s76 offen sc1
buffer_store_dwordx2 v[28:29], v91, s[16:19], s78 offen sc1
s_mov_b64 exec, 0xffff
buffer_store_dwordx2 v[0:1], v91, s[16:19], s79 offen sc1
s_mov_b64 exec, -1
v_accvgpr_write_b32 a244, v92
v_accvgpr_write_b32 a245, v93
v_accvgpr_write_b32 a246, v94
v_accvgpr_write_b32 a247, v95
v_accvgpr_write_b32 a248, v96
v_accvgpr_write_b32 a249, v97
v_accvgpr_write_b32 a250, v98
v_accvgpr_write_b32 a251, v99
v_accvgpr_write_b32 a252, v100
v_accvgpr_write_b32 a253, v101
v_lshrrev_b32 v4, 8, v250
v_bfe_u32 v2, v250, 4, 4
v_mul_u32_u24 v5, 40, v4
v_and_b32 v6, 1, v2
v_mul_u32_u24 v6, 1280, v6
v_sub_u32 v5, v5, v6
v_add_u32 v5, 1280, v5
v_lshrrev_b32 v6, 2, v2
v_mul_u32_u24 v6, 160, v6
v_and_b32 v11, 2, v2
v_lshl_add_u32 v6, v11, 3, v6
v_add_u32 v224, v5, v6
v_bfe_u32 v6, v2, 1, 2
v_mul_u32_u24 v6, 320, v6
v_add_u32 v225, v5, v6
s_lshl_b32 s30, s84, 2
s_add_u32 s30, s30, s28
s_mul_i32 s35, s30, 81920
s_add_u32 s35, s35, 27787264
s_mov_b32 s37, 2649856
v_lshlrev_b32 v3, 3, v2
v_lshl_add_u32 v227, v4, 8, v3
v_lshrrev_b32 v247, 1, v250
s_lshl_b32 s38, s30, 12
s_add_u32 s38, s38, 33030144
s_mov_b32 s39, 0x3c4ccccd
s_mov_b32 s40, 0x3acccccd
v_mov_b32 v226, 0x3727c5ac
v_bfe_u32 v7, v250, 4, 3
v_lshlrev_b32 v7, 7, v7
s_lshl_b32 s36, s30, 10
s_add_u32 s36, s36, 41091072
v_and_b32 v8, 3, v2
v_lshrrev_b32 v9, 2, v2
v_lshlrev_b32 v9, 6, v9
v_lshl_add_u32 v8, v8, 3, v9
s_lshl_b32 s3, s28, 9
v_mad_u32_u24 v5, v4, 5, 0
v_lshrrev_b32 v6, 1, v5
v_and_b32 v5, 1, v5
v_mul_u32_u24 v5, 288, v5
v_lshl_add_u32 v5, v6, 11, v5
v_add_u32 v216, v5, v8
v_xor_b32 v217, 32, v216
v_add_u32 v220, s3, v216
v_add_u32 v221, s3, v217
v_mad_u32_u24 v5, v4, 5, 1
v_lshrrev_b32 v6, 1, v5
v_and_b32 v5, 1, v5
v_mul_u32_u24 v5, 288, v5
v_lshl_add_u32 v5, v6, 11, v5
v_add_u32 v218, v5, v8
v_xor_b32 v219, 32, v218
v_add_u32 v222, s3, v218
v_add_u32 v223, s3, v219
v_and_b32 v245, 3, v2
v_lshlrev_b32 v245, 7, v245
s_lshl_b32 s88, s74, 9
s_add_u32 s88, s88, 41287680
s_lshl_b32 s86, s74, 10
s_add_u32 s86, s86, 31457280
s_mul_i32 s81, s73, 54
s_add_u32 s81, s81, s87
s_mul_i32 s81, s81, 5120
s_add_u32 s81, s81, 25165824
s_mov_b32 s20, s70
s_mov_b32 s21, s71
s_mov_b32 s22, 50331648
s_mov_b32 s23, 0x20000
s_cmp_ge_u32 s28, 2
s_cselect_b32 s22, 0, s22
s_waitcnt vmcnt(0)
s_barrier
s_cmp_lg_u32 s28, 0
s_cbranch_scc1 L_m_nofy
v_mov_b32 v10, 1
s_mov_b64 exec, 1
buffer_store_dword v10, off, s[16:19], s80 sc1
s_mov_b64 exec, -1
L_m_nofy:
s_cmp_ge_u32 s2, 216
s_cbranch_scc1 L_m_idle4
s_add_u32 m0, s90, 81920
s_add_u32 s91, s89, 1105920
buffer_load_dwordx4 v249, s[12:15], s91 offen lds
s_add_u32 m0, s90, 83968
s_add_u32 s91, s89, 1133568
buffer_load_dwordx4 v249, s[12:15], s91 offen lds
s_add_u32 m0, s90, 86016
s_add_u32 s91, s89, 1161216
buffer_load_dwordx4 v249, s[12:15], s91 offen lds
s_add_u32 m0, s90, 88064
s_add_u32 s91, s89, 1188864
buffer_load_dwordx4 v249, s[12:15], s91 offen lds
s_add_u32 m0, s90, 90112
s_add_u32 s91, s89, 1216512
buffer_load_dwordx4 v249, s[12:15], s91 offen lds
s_add_u32 m0, s90, 102400
s_add_u32 s91, s89, 1382400
buffer_load_dwordx4 v249, s[12:15], s91 offen lds
s_add_u32 m0, s90, 104448
s_add_u32 s91, s89, 1410048
buffer_load_dwordx4 v249, s[12:15], s91 offen lds
s_add_u32 m0, s90, 106496
s_add_u32 s91, s89, 1437696
buffer_load_dwordx4 v249, s[12:15], s91 offen lds
s_add_u32 m0, s90, 108544
s_add_u32 s91, s89, 1465344
buffer_load_dwordx4 v249, s[12:15], s91 offen lds
s_add_u32 m0, s90, 110592
s_add_u32 s91, s89, 1492992
buffer_load_dwordx4 v249, s[12:15], s91 offen lds
s_add_u32 m0, s90, 122880
s_add_u32 s91, s89, 1658880
buffer_load_dwordx4 v249, s[12:15], s91 offen lds
s_add_u32 m0, s90, 124928
s_add_u32 s91, s89, 1686528
buffer_load_dwordx4 v249, s[12:15], s91 offen lds
s_add_u32 m0, s90, 126976
s_add_u32 s91, s89, 1714176
buffer_load_dwordx4 v249, s[12:15], s91 offen lds
s_add_u32 m0, s90, 129024
s_add_u32 s91, s89, 1741824
buffer_load_dwordx4 v249, s[12:15], s91 offen lds
ds_read_b64_tr_b16 a[216:217], v216 offset:0
ds_read_b64_tr_b16 a[218:219], v218 offset:0
ds_read_b64_tr_b16 a[220:221], v216 offset:2048
ds_read_b64_tr_b16 a[222:223], v218 offset:2048
ds_read_b64_tr_b16 a[224:225], v216 offset:1024
ds_read_b64_tr_b16 a[226:227], v218 offset:1024
ds_read_b64_tr_b16 a[228:229], v216 offset:3072
ds_read_b64_tr_b16 a[230:231], v218 offset:3072
s_mov_b32 s82, 0
L_m_poll12:
buffer_load_dword v5, v7, s[16:19], s36 offen sc1
s_waitcnt vmcnt(0)
v_cmp_gt_u32 vcc, 1, v5
s_cmp_eq_u64 vcc, 0
s_cbranch_scc1 L_m_poll12d
s_sleep 1
s_add_u32 s82, s82, 1
s_cmp_lt_u32 s82, 0x40000
s_cbranch_scc1 L_m_poll12
L_m_poll12d:
s_add_u32 s32, s35, 0
buffer_load_dwordx4 a[184:187], v250, s[16:19], s32 offen offset:0 sc1
buffer_load_dwordx4 a[188:191], v250, s[16:19], s32 offen offset:1024 sc1
buffer_load_dwordx4 a[192:195], v250, s[16:19], s32 offen offset:2048 sc1
buffer_load_dwordx4 a[196:199], v250, s[16:19], s32 offen offset:3072 sc1
s_add_u32 s32, s35, 4096
buffer_load_dwordx4 a[200:203], v250, s[16:19], s32 offen offset:0 sc1
buffer_load_dwordx4 a[204:207], v250, s[16:19], s32 offen offset:1024 sc1
buffer_load_dwordx4 a[208:211], v250, s[16:19], s32 offen offset:2048 sc1
buffer_load_dwordx4 a[212:215], v250, s[16:19], s32 offen offset:3072 sc1
s_add_u32 s32, s35, 8192
buffer_load_dwordx4 a[120:123], v250, s[16:19], s32 offen offset:0 sc1
buffer_load_dwordx4 a[124:127], v250, s[16:19], s32 offen offset:1024 sc1
buffer_load_dwordx4 a[128:131], v250, s[16:19], s32 offen offset:2048 sc1
buffer_load_dwordx4 a[132:135], v250, s[16:19], s32 offen offset:3072 sc1
s_waitcnt vmcnt(4)
s_waitcnt lgkmcnt(4)
v_mfma_f32_16x16x32_bf16 v[0:3], a[216:219], a[184:187], 0
ds_read_b64_tr_b16 a[232:233], v217 offset:0
ds_read_b64_tr_b16 a[234:235], v219 offset:0
v_mfma_f32_16x16x32_bf16 v[0:3], a[220:223], a[200:203], v[0:3]
v_mfma_f32_16x16x32_bf16 v[32:35], a[220:223], a[204:207], 0
s_add_u32 s32, s35, 12288
buffer_load_dwordx4 a[136:139], v250, s[16:19], s32 offen offset:0 sc1
buffer_load_dwordx4 a[140:143], v250, s[16:19], s32 offen offset:1024 sc1
v_mfma_f32_16x16x32_bf16 v[32:35], a[216:219], a[188:191], v[32:35]
v_mfma_f32_16x16x32_bf16 v[64:67], a[216:219], a[192:195], 0
L_m_c2_3:
s_cbranch_execz L_m_c2_7
ds_read_b64_tr_b16 a[236:237], v217 offset:2048
ds_read_b64_tr_b16 a[238:239], v219 offset:2048
v_mfma_f32_16x16x32_bf16 v[64:67], a[220:223], a[208:211], v[64:67]
v_mfma_f32_16x16x32_bf16 v[96:99], a[220:223], a[212:215], 0
buffer_load_dwordx4 a[144:147], v250, s[16:19], s32 offen offset:2048 sc1
buffer_load_dwordx4 a[148:151], v250, s[16:19], s32 offen offset:3072 sc1
v_mfma_f32_16x16x32_bf16 v[96:99], a[216:219], a[196:199], v[96:99]
s_waitcnt lgkmcnt(4)
v_mfma_f32_16x16x32_bf16 v[112:115], a[224:227], a[196:199], 0
ds_read_b64_tr_b16 a[216:217], v217 offset:1024
ds_read_b64_tr_b16 a[218:219], v219 offset:1024
v_mfma_f32_16x16x32_bf16 v[112:115], a[228:231], a[212:215], v[112:115]
v_mfma_f32_16x16x32_bf16 v[80:83], a[228:231], a[208:211], 0
s_add_u32 s32, s35, 16384
buffer_load_dwordx2 a[152:153], v247, s[16:19], s32 offen offset:0 sc1
buffer_load_dwordx2 a[154:155], v247, s[16:19], s32 offen offset:512 sc1
v_mfma_f32_16x16x32_bf16 v[80:83], a[224:227], a[192:195], v[80:83]
v_mfma_f32_16x16x32_bf16 v[48:51], a[224:227], a[188:191], 0
ds_read_b64_tr_b16 a[220:221], v217 offset:3072
ds_read_b64_tr_b16 a[222:223], v219 offset:3072
v_mfma_f32_16x16x32_bf16 v[48:51], a[228:231], a[204:207], v[48:51]
v_mfma_f32_16x16x32_bf16 v[16:19], a[228:231], a[200:203], 0
buffer_load_dwordx2 a[156:157], v247, s[16:19], s32 offen offset:1024 sc1
buffer_load_dwordx2 a[158:159], v247, s[16:19], s32 offen offset:1536 sc1
v_mfma_f32_16x16x32_bf16 v[16:19], a[224:227], a[184:187], v[16:19]
s_waitcnt lgkmcnt(4)
v_mfma_f32_16x16x32_bf16 v[4:7], a[232:235], a[184:187], 0
ds_read_b64_tr_b16 a[224:225], v216 offset:512
ds_read_b64_tr_b16 a[226:227], v218 offset:512
v_mfma_f32_16x16x32_bf16 v[4:7], a[236:239], a[200:203], v[4:7]
v_mfma_f32_16x16x32_bf16 v[36:39], a[236:239], a[204:207], 0
buffer_load_dwordx2 a[160:161], v247, s[16:19], s32 offen offset:2048 sc1
v_mfma_f32_16x16x32_bf16 v[36:39], a[232:235], a[188:191], v[36:39]
v_mfma_f32_16x16x32_bf16 v[68:71], a[232:235], a[192:195], 0
ds_read_b64_tr_b16 a[228:229], v216 offset:2560
ds_read_b64_tr_b16 a[230:231], v218 offset:2560
v_mfma_f32_16x16x32_bf16 v[68:71], a[236:239], a[208:211], v[68:71]
v_mfma_f32_16x16x32_bf16 v[100:103], a[236:239], a[212:215], 0
buffer_load_dwordx2 a[162:163], v247, s[16:19], s32 offen offset:2560 sc1
v_mfma_f32_16x16x32_bf16 v[100:103], a[232:235], a[196:199], v[100:103]
s_waitcnt lgkmcnt(4)
v_mfma_f32_16x16x32_bf16 v[116:119], a[216:219], a[196:199], 0
ds_read_b64_tr_b16 a[232:233], v216 offset:1536
ds_read_b64_tr_b16 a[234:235], v218 offset:1536
v_mfma_f32_16x16x32_bf16 v[116:119], a[220:223], a[212:215], v[116:119]
v_mfma_f32_16x16x32_bf16 v[84:87], a[220:223], a[208:211], 0
buffer_load_dwordx2 a[164:165], v247, s[16:19], s32 offen offset:3072 sc1
v_mfma_f32_16x16x32_bf16 v[84:87], a[216:219], a[192:195], v[84:87]
v_mfma_f32_16x16x32_bf16 v[52:55], a[216:219], a[188:191], 0
ds_read_b64_tr_b16 a[236:237], v216 offset:3584
ds_read_b64_tr_b16 a[238:239], v218 offset:3584
v_mfma_f32_16x16x32_bf16 v[52:55], a[220:223], a[204:207], v[52:55]
v_mfma_f32_16x16x32_bf16 v[20:23], a[220:223], a[200:203], 0
buffer_load_dwordx2 a[166:167], v247, s[16:19], s32 offen offset:3584 sc1
v_mfma_f32_16x16x32_bf16 v[20:23], a[216:219], a[184:187], v[20:23]
s_waitcnt lgkmcnt(4)
v_mfma_f32_16x16x32_bf16 v[8:11], a[224:227], a[184:187], 0
ds_read_b64_tr_b16 a[216:217], v217 offset:512
ds_read_b64_tr_b16 a[218:219], v219 offset:512
v_mfma_f32_16x16x32_bf16 v[8:11], a[228:231], a[200:203], v[8:11]
v_mfma_f32_16x16x32_bf16 v[40:43], a[228:231], a[204:207], 0
s_add_u32 s32, s35, 20480
buffer_load_dwordx4 a[168:171], v250, s[16:19], s32 offen offset:0 sc1
v_mfma_f32_16x16x32_bf16 v[40:43], a[224:227], a[188:191], v[40:43]
v_mfma_f32_16x16x32_bf16 v[72:75], a[224:227], a[192:195], 0
ds_read_b64_tr_b16 a[220:221], v217 offset:2560
ds_read_b64_tr_b16 a[222:223], v219 offset:2560
v_mfma_f32_16x16x32_bf16 v[72:75], a[228:231], a[208:211], v[72:75]
v_mfma_f32_16x16x32_bf16 v[104:107], a[228:231], a[212:215], 0
buffer_load_dwordx4 a[172:175], v250, s[16:19], s32 offen offset:1024 sc1
v_mfma_f32_16x16x32_bf16 v[104:107], a[224:227], a[196:199], v[104:107]
s_waitcnt lgkmcnt(4)
v_mfma_f32_16x16x32_bf16 v[120:123], a[232:235], a[196:199], 0
ds_read_b64_tr_b16 a[224:225], v217 offset:1536
ds_read_b64_tr_b16 a[226:227], v219 offset:1536
v_mfma_f32_16x16x32_bf16 v[120:123], a[236:239], a[212:215], v[120:123]
v_mfma_f32_16x16x32_bf16 v[88:91], a[236:239], a[208:211], 0
buffer_load_dwordx4 a[176:179], v250, s[16:19], s32 offen offset:2048 sc1
v_mfma_f32_16x16x32_bf16 v[88:91], a[232:235], a[192:195], v[88:91]
v_mfma_f32_16x16x32_bf16 v[56:59], a[232:235], a[188:191], 0
ds_read_b64_tr_b16 a[228:229], v217 offset:3584
ds_read_b64_tr_b16 a[230:231], v219 offset:3584
v_mfma_f32_16x16x32_bf16 v[56:59], a[236:239], a[204:207], v[56:59]
v_mfma_f32_16x16x32_bf16 v[24:27], a[236:239], a[200:203], 0
buffer_load_dwordx4 a[180:183], v250, s[16:19], s32 offen offset:3072 sc1
v_mfma_f32_16x16x32_bf16 v[24:27], a[232:235], a[184:187], v[24:27]
s_waitcnt lgkmcnt(4)
v_mfma_f32_16x16x32_bf16 v[12:15], a[216:219], a[184:187], 0
ds_read_b64_tr_b16 a[232:233], v216 offset:20480
ds_read_b64_tr_b16 a[234:235], v218 offset:20480
v_mfma_f32_16x16x32_bf16 v[12:15], a[220:223], a[200:203], v[12:15]
v_mfma_f32_16x16x32_bf16 v[44:47], a[220:223], a[204:207], 0
s_add_u32 m0, s90, 131072
s_add_u32 s91, s89, 1769472
buffer_load_dwordx4 v249, s[12:15], s91 offen lds
v_mfma_f32_16x16x32_bf16 v[44:47], a[216:219], a[188:191], v[44:47]
v_mfma_f32_16x16x32_bf16 v[76:79], a[216:219], a[192:195], 0
ds_read_b64_tr_b16 a[236:237], v216 offset:22528
ds_read_b64_tr_b16 a[238:239], v218 offset:22528
v_mfma_f32_16x16x32_bf16 v[76:79], a[220:223], a[208:211], v[76:79]
v_mfma_f32_16x16x32_bf16 v[108:111], a[220:223], a[212:215], 0
s_add_u32 m0, s90, 143360
s_add_u32 s91, s89, 1935360
buffer_load_dwordx4 v249, s[12:15], s91 offen lds
v_mfma_f32_16x16x32_bf16 v[108:111], a[216:219], a[196:199], v[108:111]
s_waitcnt lgkmcnt(4)
v_mfma_f32_16x16x32_bf16 v[124:127], a[224:227], a[196:199], 0
ds_read_b64_tr_b16 a[216:217], v216 offset:21504
ds_read_b64_tr_b16 a[218:219], v218 offset:21504
v_mfma_f32_16x16x32_bf16 v[124:127], a[228:231], a[212:215], v[124:127]
v_mfma_f32_16x16x32_bf16 v[92:95], a[228:231], a[208:211], 0
v_mfma_f32_16x16x32_bf16 v[92:95], a[224:227], a[192:195], v[92:95]
v_mfma_f32_16x16x32_bf16 v[60:63], a[224:227], a[188:191], 0
ds_read_b64_tr_b16 a[220:221], v216 offset:23552
ds_read_b64_tr_b16 a[222:223], v218 offset:23552
v_mfma_f32_16x16x32_bf16 v[60:63], a[228:231], a[204:207], v[60:63]
v_mfma_f32_16x16x32_bf16 v[28:31], a[228:231], a[200:203], 0
v_mfma_f32_16x16x32_bf16 v[28:31], a[224:227], a[184:187], v[28:31]
s_waitcnt lgkmcnt(4)
s_waitcnt vmcnt(14)
v_mfma_f32_16x16x32_bf16 v[0:3], a[232:235], a[120:123], v[0:3]
ds_read_b64_tr_b16 a[224:225], v217 offset:20480
ds_read_b64_tr_b16 a[226:227], v219 offset:20480
v_mfma_f32_16x16x32_bf16 v[0:3], a[236:239], a[136:139], v[0:3]
v_mfma_f32_16x16x32_bf16 v[32:35], a[236:239], a[140:143], v[32:35]
s_add_u32 s32, s35, 24576
buffer_load_dwordx4 a[184:187], v250, s[16:19], s32 offen offset:0 sc1
v_mfma_f32_16x16x32_bf16 v[32:35], a[232:235], a[124:127], v[32:35]
v_mfma_f32_16x16x32_bf16 v[64:67], a[232:235], a[128:131], v[64:67]
ds_read_b64_tr_b16 a[228:229], v217 offset:22528
ds_read_b64_tr_b16 a[230:231], v219 offset:22528
v_mfma_f32_16x16x32_bf16 v[64:67], a[236:239], a[144:147], v[64:67]
v_mfma_f32_16x16x32_bf16 v[96:99], a[236:239], a[148:151], v[96:99]
buffer_load_dwordx4 a[188:191], v250, s[16:19], s32 offen offset:1024 sc1
v_mfma_f32_16x16x32_bf16 v[96:99], a[232:235], a[132:135], v[96:99]
s_waitcnt lgkmcnt(4)
v_mfma_f32_16x16x32_bf16 v[112:115], a[216:219], a[132:135], v[112:115]
ds_read_b64_tr_b16 a[232:233], v217 offset:21504
ds_read_b64_tr_b16 a[234:235], v219 offset:21504
v_mfma_f32_16x16x32_bf16 v[112:115], a[220:223], a[148:151], v[112:115]
v_mfma_f32_16x16x32_bf16 v[80:83], a[220:223], a[144:147], v[80:83]
buffer_load_dwordx4 a[192:195], v250, s[16:19], s32 offen offset:2048 sc1
v_mfma_f32_16x16x32_bf16 v[80:83], a[216:219], a[128:131], v[80:83]
v_mfma_f32_16x16x32_bf16 v[48:51], a[216:219], a[124:127], v[48:51]
ds_read_b64_tr_b16 a[236:237], v217 offset:23552
ds_read_b64_tr_b16 a[238:239], v219 offset:23552
v_mfma_f32_16x16x32_bf16 v[48:51], a[220:223], a[140:143], v[48:51]
v_mfma_f32_16x16x32_bf16 v[16:19], a[220:223], a[136:139], v[16:19]
buffer_load_dwordx4 a[196:199], v250, s[16:19], s32 offen offset:3072 sc1
v_mfma_f32_16x16x32_bf16 v[16:19], a[216:219], a[120:123], v[16:19]
s_waitcnt lgkmcnt(4)
v_mfma_f32_16x16x32_bf16 v[4:7], a[224:227], a[120:123], v[4:7]
ds_read_b64_tr_b16 a[216:217], v216 offset:20992
ds_read_b64_tr_b16 a[218:219], v218 offset:20992
v_mfma_f32_16x16x32_bf16 v[4:7], a[228:231], a[136:139], v[4:7]
v_mfma_f32_16x16x32_bf16 v[36:39], a[228:231], a[140:143], v[36:39]
s_add_u32 m0, s90, 145408
s_add_u32 s91, s89, 1963008
buffer_load_dwordx4 v249, s[12:15], s91 offen lds
v_mfma_f32_16x16x32_bf16 v[36:39], a[224:227], a[124:127], v[36:39]
v_mfma_f32_16x16x32_bf16 v[68:71], a[224:227], a[128:131], v[68:71]
ds_read_b64_tr_b16 a[220:221], v216 offset:23040
ds_read_b64_tr_b16 a[222:223], v218 offset:23040
v_mfma_f32_16x16x32_bf16 v[68:71], a[228:231], a[144:147], v[68:71]
v_mfma_f32_16x16x32_bf16 v[100:103], a[228:231], a[148:151], v[100:103]
s_add_u32 m0, s90, 147456
s_add_u32 s91, s89, 1990656
buffer_load_dwordx4 v249, s[12:15], s91 offen lds
v_mfma_f32_16x16x32_bf16 v[100:103], a[224:227], a[132:135], v[100:103]
s_waitcnt lgkmcnt(4)
v_mfma_f32_16x16x32_bf16 v[116:119], a[232:235], a[132:135], v[116:119]
ds_read_b64_tr_b16 a[224:225], v216 offset:22016
ds_read_b64_tr_b16 a[226:227], v218 offset:22016
v_mfma_f32_16x16x32_bf16 v[116:119], a[236:239], a[148:151], v[116:119]
v_mfma_f32_16x16x32_bf16 v[84:87], a[236:239], a[144:147], v[84:87]
v_mfma_f32_16x16x32_bf16 v[84:87], a[232:235], a[128:131], v[84:87]
v_mfma_f32_16x16x32_bf16 v[52:55], a[232:235], a[124:127], v[52:55]
ds_read_b64_tr_b16 a[228:229], v216 offset:24064
ds_read_b64_tr_b16 a[230:231], v218 offset:24064
v_mfma_f32_16x16x32_bf16 v[52:55], a[236:239], a[140:143], v[52:55]
v_mfma_f32_16x16x32_bf16 v[20:23], a[236:239], a[136:139], v[20:23]
v_mfma_f32_16x16x32_bf16 v[20:23], a[232:235], a[120:123], v[20:23]
s_waitcnt lgkmcnt(4)
v_mfma_f32_16x16x32_bf16 v[8:11], a[216:219], a[120:123], v[8:11]
ds_read_b64_tr_b16 a[232:233], v217 offset:20992
ds_read_b64_tr_b16 a[234:235], v219 offset:20992
v_mfma_f32_16x16x32_bf16 v[8:11], a[220:223], a[136:139], v[8:11]
v_mfma_f32_16x16x32_bf16 v[40:43], a[220:223], a[140:143], v[40:43]
s_add_u32 s32, s35, 28672
buffer_load_dwordx4 a[200:203], v250, s[16:19], s32 offen offset:0 sc1
v_mfma_f32_16x16x32_bf16 v[40:43], a[216:219], a[124:127], v[40:43]
v_mfma_f32_16x16x32_bf16 v[72:75], a[216:219], a[128:131], v[72:75]
ds_read_b64_tr_b16 a[236:237], v217 offset:23040
ds_read_b64_tr_b16 a[238:239], v219 offset:23040
v_mfma_f32_16x16x32_bf16 v[72:75], a[220:223], a[144:147], v[72:75]
v_mfma_f32_16x16x32_bf16 v[104:107], a[220:223], a[148:151], v[104:107]
buffer_load_dwordx4 a[204:207], v250, s[16:19], s32 offen offset:1024 sc1
v_mfma_f32_16x16x32_bf16 v[104:107], a[216:219], a[132:135], v[104:107]
s_waitcnt lgkmcnt(4)
v_mfma_f32_16x16x32_bf16 v[120:123], a[224:227], a[132:135], v[120:123]
ds_read_b64_tr_b16 a[216:217], v217 offset:22016
ds_read_b64_tr_b16 a[218:219], v219 offset:22016
v_mfma_f32_16x16x32_bf16 v[120:123], a[228:231], a[148:151], v[120:123]
v_mfma_f32_16x16x32_bf16 v[88:91], a[228:231], a[144:147], v[88:91]
buffer_load_dwordx4 a[208:211], v250, s[16:19], s32 offen offset:2048 sc1
v_mfma_f32_16x16x32_bf16 v[88:91], a[224:227], a[128:131], v[88:91]
v_mfma_f32_16x16x32_bf16 v[56:59], a[224:227], a[124:127], v[56:59]
ds_read_b64_tr_b16 a[220:221], v217 offset:24064
ds_read_b64_tr_b16 a[222:223], v219 offset:24064
v_mfma_f32_16x16x32_bf16 v[56:59], a[228:231], a[140:143], v[56:59]
v_mfma_f32_16x16x32_bf16 v[24:27], a[228:231], a[136:139], v[24:27]
buffer_load_dwordx4 a[212:215], v250, s[16:19], s32 offen offset:3072 sc1
v_mfma_f32_16x16x32_bf16 v[24:27], a[224:227], a[120:123], v[24:27]
s_waitcnt lgkmcnt(4)
v_mfma_f32_16x16x32_bf16 v[12:15], a[232:235], a[120:123], v[12:15]
ds_read_b64_tr_b16 a[224:225], v216 offset:4096
ds_read_b64_tr_b16 a[226:227], v216 offset:24576
v_mfma_f32_16x16x32_bf16 v[12:15], a[236:239], a[136:139], v[12:15]
v_mfma_f32_16x16x32_bf16 v[44:47], a[236:239], a[140:143], v[44:47]
s_add_u32 m0, s90, 149504
s_add_u32 s91, s89, 2018304
buffer_load_dwordx4 v249, s[12:15], s91 offen lds
v_mfma_f32_16x16x32_bf16 v[44:47], a[232:235], a[124:127], v[44:47]
v_mfma_f32_16x16x32_bf16 v[76:79], a[232:235], a[128:131], v[76:79]
ds_read_b64_tr_b16 a[228:229], v216 offset:40960
ds_read_b64_tr_b16 a[230:231], v218 offset:40960
v_mfma_f32_16x16x32_bf16 v[76:79], a[236:239], a[144:147], v[76:79]
v_mfma_f32_16x16x32_bf16 v[108:111], a[236:239], a[148:151], v[108:111]
s_add_u32 m0, s90, 151552
s_add_u32 s91, s89, 2045952
buffer_load_dwordx4 v249, s[12:15], s91 offen lds
v_mfma_f32_16x16x32_bf16 v[108:111], a[232:235], a[132:135], v[108:111]
s_waitcnt lgkmcnt(4)
v_mfma_f32_16x16x32_bf16 v[124:127], a[216:219], a[132:135], v[124:127]
ds_read_b64_tr_b16 a[232:233], v216 offset:5120
ds_read_b64_tr_b16 a[234:235], v216 offset:25600
v_mfma_f32_16x16x32_bf16 v[124:127], a[220:223], a[148:151], v[124:127]
v_mfma_f32_16x16x32_bf16 v[92:95], a[220:223], a[144:147], v[92:95]
v_mfma_f32_16x16x32_bf16 v[92:95], a[216:219], a[128:131], v[92:95]
v_mfma_f32_16x16x32_bf16 v[60:63], a[216:219], a[124:127], v[60:63]
ds_read_b64_tr_b16 a[236:237], v216 offset:41984
ds_read_b64_tr_b16 a[238:239], v218 offset:41984
v_mfma_f32_16x16x32_bf16 v[60:63], a[220:223], a[140:143], v[60:63]
v_mfma_f32_16x16x32_bf16 v[28:31], a[220:223], a[136:139], v[28:31]
v_mfma_f32_16x16x32_bf16 v[28:31], a[216:219], a[120:123], v[28:31]
s_waitcnt lgkmcnt(4)
s_waitcnt vmcnt(14)
v_mfma_f32_16x16x32_bf16 v[0:3], a[224:227], a[152:155], v[0:3]
ds_read_b64_tr_b16 a[216:217], v217 offset:4096
ds_read_b64_tr_b16 a[218:219], v217 offset:24576
v_mfma_f32_16x16x32_bf16 v[0:3], a[228:231], a[168:171], v[0:3]
v_mfma_f32_16x16x32_bf16 v[32:35], a[228:231], a[172:175], v[32:35]
s_add_u32 s32, s35, 32768
buffer_load_dwordx4 a[120:123], v250, s[16:19], s32 offen offset:0 sc1
v_mfma_f32_16x16x32_bf16 v[32:35], a[224:227], a[156:159], v[32:35]
v_mfma_f32_16x16x32_bf16 v[64:67], a[224:227], a[160:163], v[64:67]
ds_read_b64_tr_b16 a[220:221], v217 offset:40960
ds_read_b64_tr_b16 a[222:223], v219 offset:40960
v_mfma_f32_16x16x32_bf16 v[64:67], a[228:231], a[176:179], v[64:67]
v_mfma_f32_16x16x32_bf16 v[96:99], a[228:231], a[180:183], v[96:99]
buffer_load_dwordx4 a[124:127], v250, s[16:19], s32 offen offset:1024 sc1
v_mfma_f32_16x16x32_bf16 v[96:99], a[224:227], a[164:167], v[96:99]
s_waitcnt lgkmcnt(4)
v_mfma_f32_16x16x32_bf16 v[112:115], a[232:235], a[164:167], v[112:115]
ds_read_b64_tr_b16 a[224:225], v217 offset:5120
ds_read_b64_tr_b16 a[226:227], v217 offset:25600
v_mfma_f32_16x16x32_bf16 v[112:115], a[236:239], a[180:183], v[112:115]
v_mfma_f32_16x16x32_bf16 v[80:83], a[236:239], a[176:179], v[80:83]
buffer_load_dwordx4 a[128:131], v250, s[16:19], s32 offen offset:2048 sc1
v_mfma_f32_16x16x32_bf16 v[80:83], a[232:235], a[160:163], v[80:83]
v_mfma_f32_16x16x32_bf16 v[48:51], a[232:235], a[156:159], v[48:51]
ds_read_b64_tr_b16 a[228:229], v217 offset:41984
ds_read_b64_tr_b16 a[230:231], v219 offset:41984
v_mfma_f32_16x16x32_bf16 v[48:51], a[236:239], a[172:175], v[48:51]
v_mfma_f32_16x16x32_bf16 v[16:19], a[236:239], a[168:171], v[16:19]
buffer_load_dwordx4 a[132:135], v250, s[16:19], s32 offen offset:3072 sc1
v_mfma_f32_16x16x32_bf16 v[16:19], a[232:235], a[152:155], v[16:19]
s_waitcnt lgkmcnt(4)
v_mfma_f32_16x16x32_bf16 v[4:7], a[216:219], a[152:155], v[4:7]
ds_read_b64_tr_b16 a[232:233], v216 offset:4608
ds_read_b64_tr_b16 a[234:235], v216 offset:25088
v_mfma_f32_16x16x32_bf16 v[4:7], a[220:223], a[168:171], v[4:7]
v_mfma_f32_16x16x32_bf16 v[36:39], a[220:223], a[172:175], v[36:39]
v_mfma_f32_16x16x32_bf16 v[36:39], a[216:219], a[156:159], v[36:39]
v_mfma_f32_16x16x32_bf16 v[68:71], a[216:219], a[160:163], v[68:71]
ds_read_b64_tr_b16 a[236:237], v216 offset:41472
ds_read_b64_tr_b16 a[238:239], v218 offset:41472
v_mfma_f32_16x16x32_bf16 v[68:71], a[220:223], a[176:179], v[68:71]
v_mfma_f32_16x16x32_bf16 v[100:103], a[220:223], a[180:183], v[100:103]
v_mfma_f32_16x16x32_bf16 v[100:103], a[216:219], a[164:167], v[100:103]
s_waitcnt lgkmcnt(4)
v_mfma_f32_16x16x32_bf16 v[116:119], a[224:227], a[164:167], v[116:119]
ds_read_b64_tr_b16 a[216:217], v216 offset:5632
ds_read_b64_tr_b16 a[218:219], v216 offset:26112
v_mfma_f32_16x16x32_bf16 v[116:119], a[228:231], a[180:183], v[116:119]
v_mfma_f32_16x16x32_bf16 v[84:87], a[228:231], a[176:179], v[84:87]
v_mfma_f32_16x16x32_bf16 v[84:87], a[224:227], a[160:163], v[84:87]
v_mfma_f32_16x16x32_bf16 v[52:55], a[224:227], a[156:159], v[52:55]
ds_read_b64_tr_b16 a[220:221], v216 offset:42496
ds_read_b64_tr_b16 a[222:223], v218 offset:42496
v_mfma_f32_16x16x32_bf16 v[52:55], a[228:231], a[172:175], v[52:55]
v_mfma_f32_16x16x32_bf16 v[20:23], a[228:231], a[168:171], v[20:23]
v_mfma_f32_16x16x32_bf16 v[20:23], a[224:227], a[152:155], v[20:23]
s_waitcnt lgkmcnt(4)
v_mfma_f32_16x16x32_bf16 v[8:11], a[232:235], a[152:155], v[8:11]
ds_read_b64_tr_b16 a[224:225], v217 offset:4608
ds_read_b64_tr_b16 a[226:227], v217 offset:25088
v_mfma_f32_16x16x32_bf16 v[8:11], a[236:239], a[168:171], v[8:11]
v_mfma_f32_16x16x32_bf16 v[40:43], a[236:239], a[172:175], v[40:43]
s_add_u32 s32, s35, 36864
buffer_load_dwordx2 a[136:137], v247, s[16:19], s32 offen offset:0 sc1
v_mfma_f32_16x16x32_bf16 v[40:43], a[232:235], a[156:159], v[40:43]
v_mfma_f32_16x16x32_bf16 v[72:75], a[232:235], a[160:163], v[72:75]
ds_read_b64_tr_b16 a[228:229], v217 offset:41472
ds_read_b64_tr_b16 a[230:231], v219 offset:41472
v_mfma_f32_16x16x32_bf16 v[72:75], a[236:239], a[176:179], v[72:75]
v_mfma_f32_16x16x32_bf16 v[104:107], a[236:239], a[180:183], v[104:107]
buffer_load_dwordx2 a[138:139], v247, s[16:19], s32 offen offset:512 sc1
v_mfma_f32_16x16x32_bf16 v[104:107], a[232:235], a[164:167], v[104:107]
s_waitcnt lgkmcnt(4)
v_mfma_f32_16x16x32_bf16 v[120:123], a[216:219], a[164:167], v[120:123]
ds_read_b64_tr_b16 a[232:233], v217 offset:5632
ds_read_b64_tr_b16 a[234:235], v217 offset:26112
v_mfma_f32_16x16x32_bf16 v[120:123], a[220:223], a[180:183], v[120:123]
v_mfma_f32_16x16x32_bf16 v[88:91], a[220:223], a[176:179], v[88:91]
buffer_load_dwordx2 a[140:141], v247, s[16:19], s32 offen offset:1024 sc1
v_mfma_f32_16x16x32_bf16 v[88:91], a[216:219], a[160:163], v[88:91]
v_mfma_f32_16x16x32_bf16 v[56:59], a[216:219], a[156:159], v[56:59]
ds_read_b64_tr_b16 a[236:237], v217 offset:42496
ds_read_b64_tr_b16 a[238:239], v219 offset:42496
v_mfma_f32_16x16x32_bf16 v[56:59], a[220:223], a[172:175], v[56:59]
v_add_u32 v216, 40960, v216
v_add_u32 v217, 40960, v217
v_mfma_f32_16x16x32_bf16 v[24:27], a[220:223], a[168:171], v[24:27]
buffer_load_dwordx2 a[142:143], v247, s[16:19], s32 offen offset:1536 sc1
v_mfma_f32_16x16x32_bf16 v[24:27], a[216:219], a[152:155], v[24:27]
s_waitcnt lgkmcnt(4)
v_add_u32 v218, 40960, v218
v_add_u32 v219, 40960, v219
v_mfma_f32_16x16x32_bf16 v[12:15], a[224:227], a[152:155], v[12:15]
ds_read_b64_tr_b16 a[216:217], v216 offset:2048
ds_read_b64_tr_b16 a[218:219], v218 offset:2048
v_mfma_f32_16x16x32_bf16 v[12:15], a[228:231], a[168:171], v[12:15]
v_mfma_f32_16x16x32_bf16 v[44:47], a[228:231], a[172:175], v[44:47]
buffer_load_dwordx2 a[144:145], v247, s[16:19], s32 offen offset:2048 sc1
v_mfma_f32_16x16x32_bf16 v[44:47], a[224:227], a[156:159], v[44:47]
v_mfma_f32_16x16x32_bf16 v[76:79], a[224:227], a[160:163], v[76:79]
ds_read_b64_tr_b16 a[220:221], v216 offset:20480
ds_read_b64_tr_b16 a[222:223], v218 offset:20480
v_mfma_f32_16x16x32_bf16 v[76:79], a[228:231], a[176:179], v[76:79]
v_mfma_f32_16x16x32_bf16 v[108:111], a[228:231], a[180:183], v[108:111]
buffer_load_dwordx2 a[146:147], v247, s[16:19], s32 offen offset:2560 sc1
v_mfma_f32_16x16x32_bf16 v[108:111], a[224:227], a[164:167], v[108:111]
s_waitcnt lgkmcnt(4)
v_mfma_f32_16x16x32_bf16 v[124:127], a[232:235], a[164:167], v[124:127]
ds_read_b64_tr_b16 a[224:225], v216 offset:3072
ds_read_b64_tr_b16 a[226:227], v218 offset:3072
v_mfma_f32_16x16x32_bf16 v[124:127], a[236:239], a[180:183], v[124:127]
v_mfma_f32_16x16x32_bf16 v[92:95], a[236:239], a[176:179], v[92:95]
buffer_load_dwordx2 a[148:149], v247, s[16:19], s32 offen offset:3072 sc1
v_mfma_f32_16x16x32_bf16 v[92:95], a[232:235], a[160:163], v[92:95]
v_mfma_f32_16x16x32_bf16 v[60:63], a[232:235], a[156:159], v[60:63]
ds_read_b64_tr_b16 a[228:229], v216 offset:21504
ds_read_b64_tr_b16 a[230:231], v218 offset:21504
v_mfma_f32_16x16x32_bf16 v[60:63], a[236:239], a[172:175], v[60:63]
v_mfma_f32_16x16x32_bf16 v[28:31], a[236:239], a[168:171], v[28:31]
buffer_load_dwordx2 a[150:151], v247, s[16:19], s32 offen offset:3584 sc1
v_mfma_f32_16x16x32_bf16 v[28:31], a[232:235], a[152:155], v[28:31]
s_waitcnt lgkmcnt(4)
s_waitcnt vmcnt(14)
v_mfma_f32_16x16x32_bf16 v[0:3], a[216:219], a[184:187], v[0:3]
ds_read_b64_tr_b16 a[232:233], v217 offset:2048
ds_read_b64_tr_b16 a[234:235], v219 offset:2048
v_mfma_f32_16x16x32_bf16 v[0:3], a[220:223], a[200:203], v[0:3]
v_mfma_f32_16x16x32_bf16 v[32:35], a[220:223], a[204:207], v[32:35]
s_add_u32 s32, s35, 40960
buffer_load_dwordx4 a[152:155], v250, s[16:19], s32 offen offset:0 sc1
v_mfma_f32_16x16x32_bf16 v[32:35], a[216:219], a[188:191], v[32:35]
v_mfma_f32_16x16x32_bf16 v[64:67], a[216:219], a[192:195], v[64:67]
ds_read_b64_tr_b16 a[236:237], v217 offset:20480
ds_read_b64_tr_b16 a[238:239], v219 offset:20480
v_mfma_f32_16x16x32_bf16 v[64:67], a[220:223], a[208:211], v[64:67]
v_mfma_f32_16x16x32_bf16 v[96:99], a[220:223], a[212:215], v[96:99]
buffer_load_dwordx4 a[156:159], v250, s[16:19], s32 offen offset:1024 sc1
v_mfma_f32_16x16x32_bf16 v[96:99], a[216:219], a[196:199], v[96:99]
s_waitcnt lgkmcnt(4)
v_mfma_f32_16x16x32_bf16 v[112:115], a[224:227], a[196:199], v[112:115]
ds_read_b64_tr_b16 a[216:217], v217 offset:3072
ds_read_b64_tr_b16 a[218:219], v219 offset:3072
v_mfma_f32_16x16x32_bf16 v[112:115], a[228:231], a[212:215], v[112:115]
v_mfma_f32_16x16x32_bf16 v[80:83], a[228:231], a[208:211], v[80:83]
buffer_load_dwordx4 a[160:163], v250, s[16:19], s32 offen offset:2048 sc1
v_mfma_f32_16x16x32_bf16 v[80:83], a[224:227], a[192:195], v[80:83]
v_mfma_f32_16x16x32_bf16 v[48:51], a[224:227], a[188:191], v[48:51]
ds_read_b64_tr_b16 a[220:221], v217 offset:21504
ds_read_b64_tr_b16 a[222:223], v219 offset:21504
v_mfma_f32_16x16x32_bf16 v[48:51], a[228:231], a[204:207], v[48:51]
v_mfma_f32_16x16x32_bf16 v[16:19], a[228:231], a[200:203], v[16:19]
buffer_load_dwordx4 a[164:167], v250, s[16:19], s32 offen offset:3072 sc1
v_mfma_f32_16x16x32_bf16 v[16:19], a[224:227], a[184:187], v[16:19]
s_waitcnt lgkmcnt(4)
v_mfma_f32_16x16x32_bf16 v[4:7], a[232:235], a[184:187], v[4:7]
ds_read_b64_tr_b16 a[224:225], v216 offset:2560
ds_read_b64_tr_b16 a[226:227], v218 offset:2560
v_mfma_f32_16x16x32_bf16 v[4:7], a[236:239], a[200:203], v[4:7]
v_mfma_f32_16x16x32_bf16 v[36:39], a[236:239], a[204:207], v[36:39]
buffer_load_dwordx2 v[228:229], v227, s[16:19], s38 offen offset:0 sc1
v_mfma_f32_16x16x32_bf16 v[36:39], a[232:235], a[188:191], v[36:39]
v_mfma_f32_16x16x32_bf16 v[68:71], a[232:235], a[192:195], v[68:71]
ds_read_b64_tr_b16 a[228:229], v216 offset:20992
ds_read_b64_tr_b16 a[230:231], v218 offset:20992
v_mfma_f32_16x16x32_bf16 v[68:71], a[236:239], a[208:211], v[68:71]
v_mfma_f32_16x16x32_bf16 v[100:103], a[236:239], a[212:215], v[100:103]
buffer_load_dwordx2 v[230:231], v227, s[16:19], s38 offen offset:128 sc1
v_mfma_f32_16x16x32_bf16 v[100:103], a[232:235], a[196:199], v[100:103]
s_waitcnt lgkmcnt(4)
v_mfma_f32_16x16x32_bf16 v[116:119], a[216:219], a[196:199], v[116:119]
ds_read_b64_tr_b16 a[232:233], v216 offset:3584
ds_read_b64_tr_b16 a[234:235], v218 offset:3584
v_mfma_f32_16x16x32_bf16 v[116:119], a[220:223], a[212:215], v[116:119]
v_mfma_f32_16x16x32_bf16 v[84:87], a[220:223], a[208:211], v[84:87]
buffer_load_dwordx2 v[232:233], v227, s[16:19], s38 offen offset:1024 sc1
v_mfma_f32_16x16x32_bf16 v[84:87], a[216:219], a[192:195], v[84:87]
v_mfma_f32_16x16x32_bf16 v[52:55], a[216:219], a[188:191], v[52:55]
ds_read_b64_tr_b16 a[236:237], v216 offset:22016
ds_read_b64_tr_b16 a[238:239], v218 offset:22016
v_mfma_f32_16x16x32_bf16 v[52:55], a[220:223], a[204:207], v[52:55]
v_mfma_f32_16x16x32_bf16 v[20:23], a[220:223], a[200:203], v[20:23]
buffer_load_dwordx2 v[234:235], v227, s[16:19], s38 offen offset:1152 sc1
v_mfma_f32_16x16x32_bf16 v[20:23], a[216:219], a[184:187], v[20:23]
s_waitcnt lgkmcnt(4)
v_mfma_f32_16x16x32_bf16 v[8:11], a[224:227], a[184:187], v[8:11]
ds_read_b64_tr_b16 a[216:217], v217 offset:2560
ds_read_b64_tr_b16 a[218:219], v219 offset:2560
v_mfma_f32_16x16x32_bf16 v[8:11], a[228:231], a[200:203], v[8:11]
v_mfma_f32_16x16x32_bf16 v[40:43], a[228:231], a[204:207], v[40:43]
s_add_u32 s32, s35, 45056
buffer_load_dwordx4 a[168:171], v250, s[16:19], s32 offen offset:0 sc1
buffer_load_dwordx4 a[172:175], v250, s[16:19], s32 offen offset:1024 sc1
v_mfma_f32_16x16x32_bf16 v[40:43], a[224:227], a[188:191], v[40:43]
v_mfma_f32_16x16x32_bf16 v[72:75], a[224:227], a[192:195], v[72:75]
ds_read_b64_tr_b16 a[220:221], v217 offset:20992
ds_read_b64_tr_b16 a[222:223], v219 offset:20992
v_mfma_f32_16x16x32_bf16 v[72:75], a[228:231], a[208:211], v[72:75]
v_mfma_f32_16x16x32_bf16 v[104:107], a[228:231], a[212:215], v[104:107]
buffer_load_dwordx4 a[176:179], v250, s[16:19], s32 offen offset:2048 sc1
buffer_load_dwordx4 a[180:183], v250, s[16:19], s32 offen offset:3072 sc1
v_mfma_f32_16x16x32_bf16 v[104:107], a[224:227], a[196:199], v[104:107]
s_waitcnt lgkmcnt(4)
v_mfma_f32_16x16x32_bf16 v[120:123], a[232:235], a[196:199], v[120:123]
ds_read_b64_tr_b16 a[224:225], v217 offset:3584
ds_read_b64_tr_b16 a[226:227], v219 offset:3584
v_mfma_f32_16x16x32_bf16 v[120:123], a[236:239], a[212:215], v[120:123]
v_mfma_f32_16x16x32_bf16 v[88:91], a[236:239], a[208:211], v[88:91]
buffer_load_dwordx2 v[236:237], v227, s[16:19], s38 offen offset:2048 sc1
buffer_load_dwordx2 v[238:239], v227, s[16:19], s38 offen offset:2176 sc1
v_mfma_f32_16x16x32_bf16 v[88:91], a[232:235], a[192:195], v[88:91]
v_mfma_f32_16x16x32_bf16 v[56:59], a[232:235], a[188:191], v[56:59]
ds_read_b64_tr_b16 a[228:229], v217 offset:22016
ds_read_b64_tr_b16 a[230:231], v219 offset:22016
v_mfma_f32_16x16x32_bf16 v[56:59], a[236:239], a[204:207], v[56:59]
v_mfma_f32_16x16x32_bf16 v[24:27], a[236:239], a[200:203], v[24:27]
buffer_load_dwordx2 v[240:241], v227, s[16:19], s38 offen offset:3072 sc1
v_mfma_f32_16x16x32_bf16 v[24:27], a[232:235], a[184:187], v[24:27]
s_waitcnt lgkmcnt(4)
v_mfma_f32_16x16x32_bf16 v[12:15], a[216:219], a[184:187], v[12:15]
ds_read_b64_tr_b16 a[232:233], v216 offset:22528
ds_read_b64_tr_b16 a[234:235], v218 offset:22528
v_mfma_f32_16x16x32_bf16 v[12:15], a[220:223], a[200:203], v[12:15]
v_mfma_f32_16x16x32_bf16 v[44:47], a[220:223], a[204:207], v[44:47]
buffer_load_dwordx2 v[242:243], v227, s[16:19], s38 offen offset:3200 sc1
v_mfma_f32_16x16x32_bf16 v[44:47], a[216:219], a[188:191], v[44:47]
v_mfma_f32_16x16x32_bf16 v[76:79], a[216:219], a[192:195], v[76:79]
ds_read_b64_tr_b16 a[236:237], v216 offset:4096
ds_read_b64_tr_b16 a[238:239], v216 offset:24576
v_mfma_f32_16x16x32_bf16 v[76:79], a[220:223], a[208:211], v[76:79]
v_mfma_f32_16x16x32_bf16 v[108:111], a[220:223], a[212:215], v[108:111]
s_add_u32 s33, s81, 0
buffer_load_dwordx4 a[0:3], v250, s[16:19], s33 offen offset:0 sc1
v_mfma_f32_16x16x32_bf16 v[108:111], a[216:219], a[196:199], v[108:111]
s_waitcnt lgkmcnt(4)
v_mfma_f32_16x16x32_bf16 v[124:127], a[224:227], a[196:199], v[124:127]
ds_read_b64_tr_b16 a[216:217], v216 offset:23552
ds_read_b64_tr_b16 a[218:219], v218 offset:23552
v_mfma_f32_16x16x32_bf16 v[124:127], a[228:231], a[212:215], v[124:127]
v_mfma_f32_16x16x32_bf16 v[92:95], a[228:231], a[208:211], v[92:95]
buffer_load_dwordx4 a[4:7], v250, s[16:19], s33 offen offset:1024 sc1
v_mfma_f32_16x16x32_bf16 v[92:95], a[224:227], a[192:195], v[92:95]
v_mfma_f32_16x16x32_bf16 v[60:63], a[224:227], a[188:191], v[60:63]
ds_read_b64_tr_b16 a[220:221], v216 offset:5120
ds_read_b64_tr_b16 a[222:223], v216 offset:25600
v_mfma_f32_16x16x32_bf16 v[60:63], a[228:231], a[204:207], v[60:63]
v_mfma_f32_16x16x32_bf16 v[28:31], a[228:231], a[200:203], v[28:31]
buffer_load_dwordx4 a[8:11], v250, s[16:19], s33 offen offset:2048 sc1
v_mfma_f32_16x16x32_bf16 v[28:31], a[224:227], a[184:187], v[28:31]
s_waitcnt lgkmcnt(4)
s_waitcnt vmcnt(19)
v_mfma_f32_16x16x32_bf16 v[0:3], a[232:235], a[120:123], v[0:3]
ds_read_b64_tr_b16 a[224:225], v217 offset:22528
ds_read_b64_tr_b16 a[226:227], v219 offset:22528
v_mfma_f32_16x16x32_bf16 v[0:3], a[236:239], a[136:139], v[0:3]
v_mfma_f32_16x16x32_bf16 v[32:35], a[236:239], a[140:143], v[32:35]
buffer_load_dword v246, v245, s[16:19], s88 offen sc1
v_mfma_f32_16x16x32_bf16 v[32:35], a[232:235], a[124:127], v[32:35]
v_mfma_f32_16x16x32_bf16 v[64:67], a[232:235], a[128:131], v[64:67]
ds_read_b64_tr_b16 a[228:229], v217 offset:4096
ds_read_b64_tr_b16 a[230:231], v217 offset:24576
v_mfma_f32_16x16x32_bf16 v[64:67], a[236:239], a[144:147], v[64:67]
v_mfma_f32_16x16x32_bf16 v[96:99], a[236:239], a[148:151], v[96:99]
s_add_u32 s32, s35, 49152
buffer_load_dwordx4 a[184:187], v250, s[16:19], s32 offen offset:0 sc1
v_mfma_f32_16x16x32_bf16 v[96:99], a[232:235], a[132:135], v[96:99]
s_waitcnt lgkmcnt(4)
v_mfma_f32_16x16x32_bf16 v[112:115], a[216:219], a[132:135], v[112:115]
ds_read_b64_tr_b16 a[232:233], v217 offset:23552
ds_read_b64_tr_b16 a[234:235], v219 offset:23552
v_mfma_f32_16x16x32_bf16 v[112:115], a[220:223], a[148:151], v[112:115]
v_mfma_f32_16x16x32_bf16 v[80:83], a[220:223], a[144:147], v[80:83]
buffer_load_dwordx4 a[188:191], v250, s[16:19], s32 offen offset:1024 sc1
v_mfma_f32_16x16x32_bf16 v[80:83], a[216:219], a[128:131], v[80:83]
v_mfma_f32_16x16x32_bf16 v[48:51], a[216:219], a[124:127], v[48:51]
ds_read_b64_tr_b16 a[236:237], v217 offset:5120
ds_read_b64_tr_b16 a[238:239], v217 offset:25600
v_mfma_f32_16x16x32_bf16 v[48:51], a[220:223], a[140:143], v[48:51]
v_mfma_f32_16x16x32_bf16 v[16:19], a[220:223], a[136:139], v[16:19]
buffer_load_dwordx4 a[192:195], v250, s[16:19], s32 offen offset:2048 sc1
v_mfma_f32_16x16x32_bf16 v[16:19], a[216:219], a[120:123], v[16:19]
s_waitcnt lgkmcnt(4)
v_mfma_f32_16x16x32_bf16 v[4:7], a[224:227], a[120:123], v[4:7]
ds_read_b64_tr_b16 a[216:217], v216 offset:23040
ds_read_b64_tr_b16 a[218:219], v218 offset:23040
v_mfma_f32_16x16x32_bf16 v[4:7], a[228:231], a[136:139], v[4:7]
L_m_c2_4:
s_cbranch_execz L_m_c2_ret
v_mfma_f32_16x16x32_bf16 v[36:39], a[228:231], a[140:143], v[36:39]
buffer_load_dwordx4 a[196:199], v250, s[16:19], s32 offen offset:3072 sc1
v_mfma_f32_16x16x32_bf16 v[36:39], a[224:227], a[124:127], v[36:39]
v_mfma_f32_16x16x32_bf16 v[68:71], a[224:227], a[128:131], v[68:71]
ds_read_b64_tr_b16 a[220:221], v216 offset:4608
ds_read_b64_tr_b16 a[222:223], v216 offset:25088
v_mfma_f32_16x16x32_bf16 v[68:71], a[228:231], a[144:147], v[68:71]
v_mfma_f32_16x16x32_bf16 v[100:103], a[228:231], a[148:151], v[100:103]
buffer_load_dwordx4 a[12:15], v250, s[16:19], s33 offen offset:3072 sc1
v_mfma_f32_16x16x32_bf16 v[100:103], a[224:227], a[132:135], v[100:103]
s_waitcnt lgkmcnt(4)
v_mfma_f32_16x16x32_bf16 v[116:119], a[232:235], a[132:135], v[116:119]
ds_read_b64_tr_b16 a[224:225], v216 offset:24064
ds_read_b64_tr_b16 a[226:227], v218 offset:24064
v_mfma_f32_16x16x32_bf16 v[116:119], a[236:239], a[148:151], v[116:119]
v_mfma_f32_16x16x32_bf16 v[84:87], a[236:239], a[144:147], v[84:87]
s_add_u32 s34, s81, 4096
buffer_load_dwordx4 a[16:19], v250, s[16:19], s34 offen offset:0 sc1
v_mfma_f32_16x16x32_bf16 v[84:87], a[232:235], a[128:131], v[84:87]
v_mfma_f32_16x16x32_bf16 v[52:55], a[232:235], a[124:127], v[52:55]
ds_read_b64_tr_b16 a[228:229], v216 offset:5632
ds_read_b64_tr_b16 a[230:231], v216 offset:26112
v_mfma_f32_16x16x32_bf16 v[52:55], a[236:239], a[140:143], v[52:55]
v_mfma_f32_16x16x32_bf16 v[20:23], a[236:239], a[136:139], v[20:23]
s_add_u32 s33, s81, 5120
buffer_load_dwordx4 a[20:23], v250, s[16:19], s33 offen offset:0 sc1
v_mfma_f32_16x16x32_bf16 v[20:23], a[232:235], a[120:123], v[20:23]
s_waitcnt lgkmcnt(4)
v_mfma_f32_16x16x32_bf16 v[8:11], a[216:219], a[120:123], v[8:11]
s_barrier
ds_read_b64_tr_b16 a[232:233], v217 offset:23040
ds_read_b64_tr_b16 a[234:235], v219 offset:23040
v_mfma_f32_16x16x32_bf16 v[8:11], a[220:223], a[136:139], v[8:11]
v_mfma_f32_16x16x32_bf16 v[40:43], a[220:223], a[140:143], v[40:43]
s_add_u32 s32, s35, 53248
buffer_load_dwordx4 a[200:203], v250, s[16:19], s32 offen offset:0 sc1
v_mfma_f32_16x16x32_bf16 v[40:43], a[216:219], a[124:127], v[40:43]
v_mfma_f32_16x16x32_bf16 v[72:75], a[216:219], a[128:131], v[72:75]
ds_read_b64_tr_b16 a[236:237], v217 offset:4608
ds_read_b64_tr_b16 a[238:239], v217 offset:25088
v_mfma_f32_16x16x32_bf16 v[72:75], a[220:223], a[144:147], v[72:75]
v_mfma_f32_16x16x32_bf16 v[104:107], a[220:223], a[148:151], v[104:107]
buffer_load_dwordx4 a[204:207], v250, s[16:19], s32 offen offset:1024 sc1
v_mfma_f32_16x16x32_bf16 v[104:107], a[216:219], a[132:135], v[104:107]
s_waitcnt lgkmcnt(4)
v_mfma_f32_16x16x32_bf16 v[120:123], a[224:227], a[132:135], v[120:123]
ds_read_b64_tr_b16 a[216:217], v217 offset:24064
ds_read_b64_tr_b16 a[218:219], v219 offset:24064
v_mfma_f32_16x16x32_bf16 v[120:123], a[228:231], a[148:151], v[120:123]
v_mfma_f32_16x16x32_bf16 v[88:91], a[228:231], a[144:147], v[88:91]
buffer_load_dwordx4 a[208:211], v250, s[16:19], s32 offen offset:2048 sc1
v_mfma_f32_16x16x32_bf16 v[88:91], a[224:227], a[128:131], v[88:91]
v_mfma_f32_16x16x32_bf16 v[56:59], a[224:227], a[124:127], v[56:59]
ds_read_b64_tr_b16 a[220:221], v217 offset:5632
ds_read_b64_tr_b16 a[222:223], v217 offset:26112
v_mfma_f32_16x16x32_bf16 v[56:59], a[228:231], a[140:143], v[56:59]
v_add_u32 v216, 40960, v216
v_add_u32 v217, 40960, v217
v_mfma_f32_16x16x32_bf16 v[24:27], a[228:231], a[136:139], v[24:27]
buffer_load_dwordx4 a[212:215], v250, s[16:19], s32 offen offset:3072 sc1
v_mfma_f32_16x16x32_bf16 v[24:27], a[224:227], a[120:123], v[24:27]
s_waitcnt lgkmcnt(4)
v_add_u32 v218, 40960, v218
v_add_u32 v219, 40960, v219
v_mfma_f32_16x16x32_bf16 v[12:15], a[232:235], a[120:123], v[12:15]
ds_read_b64_tr_b16 a[224:225], v216 offset:0
ds_read_b64_tr_b16 a[226:227], v218 offset:0
v_mfma_f32_16x16x32_bf16 v[12:15], a[236:239], a[136:139], v[12:15]
v_mfma_f32_16x16x32_bf16 v[44:47], a[236:239], a[140:143], v[44:47]
buffer_load_dwordx4 a[24:27], v250, s[16:19], s33 offen offset:1024 sc1
v_mfma_f32_16x16x32_bf16 v[44:47], a[232:235], a[124:127], v[44:47]
v_mfma_f32_16x16x32_bf16 v[76:79], a[232:235], a[128:131], v[76:79]
ds_read_b64_tr_b16 a[228:229], v216 offset:2048
ds_read_b64_tr_b16 a[230:231], v218 offset:2048
v_mfma_f32_16x16x32_bf16 v[76:79], a[236:239], a[144:147], v[76:79]
v_mfma_f32_16x16x32_bf16 v[108:111], a[236:239], a[148:151], v[108:111]
buffer_load_dwordx4 a[28:31], v250, s[16:19], s33 offen offset:2048 sc1
v_mfma_f32_16x16x32_bf16 v[108:111], a[232:235], a[132:135], v[108:111]
s_waitcnt lgkmcnt(4)
v_mfma_f32_16x16x32_bf16 v[124:127], a[216:219], a[132:135], v[124:127]
ds_read_b64_tr_b16 a[232:233], v216 offset:1024
ds_read_b64_tr_b16 a[234:235], v218 offset:1024
v_mfma_f32_16x16x32_bf16 v[124:127], a[220:223], a[148:151], v[124:127]
v_mfma_f32_16x16x32_bf16 v[92:95], a[220:223], a[144:147], v[92:95]
buffer_load_dwordx4 a[32:35], v250, s[16:19], s33 offen offset:3072 sc1
v_mfma_f32_16x16x32_bf16 v[92:95], a[216:219], a[128:131], v[92:95]
v_mfma_f32_16x16x32_bf16 v[60:63], a[216:219], a[124:127], v[60:63]
ds_read_b64_tr_b16 a[236:237], v216 offset:3072
ds_read_b64_tr_b16 a[238:239], v218 offset:3072
v_mfma_f32_16x16x32_bf16 v[60:63], a[220:223], a[140:143], v[60:63]
v_mfma_f32_16x16x32_bf16 v[28:31], a[220:223], a[136:139], v[28:31]
v_mfma_f32_16x16x32_bf16 v[28:31], a[216:219], a[120:123], v[28:31]
s_waitcnt lgkmcnt(4)
s_waitcnt vmcnt(22)
v_mfma_f32_16x16x32_bf16 v[0:3], a[224:227], a[152:155], v[0:3]
ds_read_b64_tr_b16 a[216:217], v217 offset:0
ds_read_b64_tr_b16 a[218:219], v219 offset:0
v_mfma_f32_16x16x32_bf16 v[0:3], a[228:231], a[168:171], v[0:3]
s_waitcnt vmcnt(18)
v_add_f32 v200, v228, v230
v_add_f32 v202, v232, v234
v_mfma_f32_16x16x32_bf16 v[32:35], a[228:231], a[172:175], v[32:35]
s_add_u32 s32, s35, 57344
buffer_load_dwordx2 a[120:121], v247, s[16:19], s32 offen offset:0 sc1
buffer_load_dwordx2 a[122:123], v247, s[16:19], s32 offen offset:512 sc1
v_mfma_f32_16x16x32_bf16 v[32:35], a[224:227], a[156:159], v[32:35]
v_add_f32 v204, v236, v238
v_add_f32 v206, v240, v242
v_mfma_f32_16x16x32_bf16 v[64:67], a[224:227], a[160:163], v[64:67]
ds_read_b64_tr_b16 a[220:221], v217 offset:2048
ds_read_b64_tr_b16 a[222:223], v219 offset:2048
v_mfma_f32_16x16x32_bf16 v[64:67], a[228:231], a[176:179], v[64:67]
v_mov_b32 v201, v200
v_mov_b32 v203, v202
v_mfma_f32_16x16x32_bf16 v[96:99], a[228:231], a[180:183], v[96:99]
buffer_load_dwordx2 a[124:125], v247, s[16:19], s32 offen offset:1024 sc1
buffer_load_dwordx2 a[126:127], v247, s[16:19], s32 offen offset:1536 sc1
v_mfma_f32_16x16x32_bf16 v[96:99], a[224:227], a[164:167], v[96:99]
s_waitcnt lgkmcnt(4)
v_mov_b32 v205, v204
v_mov_b32 v207, v206
v_mfma_f32_16x16x32_bf16 v[112:115], a[232:235], a[164:167], v[112:115]
ds_read_b64_tr_b16 a[224:225], v217 offset:1024
ds_read_b64_tr_b16 a[226:227], v219 offset:1024
v_mfma_f32_16x16x32_bf16 v[112:115], a[236:239], a[180:183], v[112:115]
v_permlane16_swap_b32 v200, v201
v_permlane16_swap_b32 v202, v203
v_mfma_f32_16x16x32_bf16 v[80:83], a[236:239], a[176:179], v[80:83]
buffer_load_dwordx2 a[128:129], v247, s[16:19], s32 offen offset:2048 sc1
buffer_load_dwordx2 a[130:131], v247, s[16:19], s32 offen offset:2560 sc1
v_mfma_f32_16x16x32_bf16 v[80:83], a[232:235], a[160:163], v[80:83]
v_permlane16_swap_b32 v204, v205
v_permlane16_swap_b32 v206, v207
v_mfma_f32_16x16x32_bf16 v[48:51], a[232:235], a[156:159], v[48:51]
ds_read_b64_tr_b16 a[228:229], v217 offset:3072
ds_read_b64_tr_b16 a[230:231], v219 offset:3072
v_mfma_f32_16x16x32_bf16 v[48:51], a[236:239], a[172:175], v[48:51]
v_add_f32 v200, v200, v201
v_add_f32 v202, v202, v203
v_mfma_f32_16x16x32_bf16 v[16:19], a[236:239], a[168:171], v[16:19]
buffer_load_dwordx2 a[132:133], v247, s[16:19], s32 offen offset:3072 sc1
v_add_f32 v204, v204, v205
v_mfma_f32_16x16x32_bf16 v[16:19], a[232:235], a[152:155], v[16:19]
s_waitcnt lgkmcnt(4)
v_add_f32 v206, v206, v207
v_mov_b32 v201, v200
v_mfma_f32_16x16x32_bf16 v[4:7], a[216:219], a[152:155], v[4:7]
ds_read_b64_tr_b16 a[232:233], v216 offset:512
ds_read_b64_tr_b16 a[234:235], v218 offset:512
v_mfma_f32_16x16x32_bf16 v[4:7], a[220:223], a[168:171], v[4:7]
v_mov_b32 v203, v202
v_mov_b32 v205, v204
v_mfma_f32_16x16x32_bf16 v[36:39], a[220:223], a[172:175], v[36:39]
buffer_load_dwordx2 a[134:135], v247, s[16:19], s32 offen offset:3584 sc1
v_mov_b32 v207, v206
v_mfma_f32_16x16x32_bf16 v[36:39], a[216:219], a[156:159], v[36:39]
v_permlane32_swap_b32 v200, v201
v_permlane32_swap_b32 v202, v203
v_mfma_f32_16x16x32_bf16 v[68:71], a[216:219], a[160:163], v[68:71]
ds_read_b64_tr_b16 a[236:237], v216 offset:2560
ds_read_b64_tr_b16 a[238:239], v218 offset:2560
v_mfma_f32_16x16x32_bf16 v[68:71], a[220:223], a[176:179], v[68:71]
v_permlane32_swap_b32 v204, v205
v_permlane32_swap_b32 v206, v207
v_mfma_f32_16x16x32_bf16 v[100:103], a[220:223], a[180:183], v[100:103]
s_add_u32 s34, s81, 9216
buffer_load_dwordx4 a[36:39], v250, s[16:19], s34 offen offset:0 sc1
v_add_f32 v200, v200, v201
v_mfma_f32_16x16x32_bf16 v[100:103], a[216:219], a[164:167], v[100:103]
s_waitcnt lgkmcnt(4)
v_add_f32 v202, v202, v203
v_add_f32 v204, v204, v205
v_mfma_f32_16x16x32_bf16 v[116:119], a[224:227], a[164:167], v[116:119]
ds_read_b64_tr_b16 a[216:217], v216 offset:1536
ds_read_b64_tr_b16 a[218:219], v218 offset:1536
v_mfma_f32_16x16x32_bf16 v[116:119], a[228:231], a[180:183], v[116:119]
v_add_f32 v206, v206, v207
v_mul_f32 v200, 0xbacccccd, v200
v_mfma_f32_16x16x32_bf16 v[84:87], a[228:231], a[176:179], v[84:87]
s_add_u32 s33, s81, 10240
buffer_load_dwordx4 a[40:43], v250, s[16:19], s33 offen offset:0 sc1
v_mul_f32 v202, 0xbacccccd, v202
v_mfma_f32_16x16x32_bf16 v[84:87], a[224:227], a[160:163], v[84:87]
v_mul_f32 v204, 0xbacccccd, v204
v_mul_f32 v206, 0xbacccccd, v206
v_mfma_f32_16x16x32_bf16 v[52:55], a[224:227], a[156:159], v[52:55]
ds_read_b64_tr_b16 a[220:221], v216 offset:3584
ds_read_b64_tr_b16 a[222:223], v218 offset:3584
v_mfma_f32_16x16x32_bf16 v[52:55], a[228:231], a[172:175], v[52:55]
v_fma_f32 v228, v228, s39, v200
v_fma_f32 v230, v230, s39, v200
v_mfma_f32_16x16x32_bf16 v[20:23], a[228:231], a[168:171], v[20:23]
buffer_load_dwordx4 a[44:47], v250, s[16:19], s33 offen offset:1024 sc1
v_add_f32 v208, v229, v231
v_mfma_f32_16x16x32_bf16 v[20:23], a[224:227], a[152:155], v[20:23]
s_waitcnt lgkmcnt(4)
v_mul_f32 v228, v228, v228
v_fmac_f32 v228, v230, v230
s_waitcnt vmcnt(25)
v_cmp_eq_u32 vcc, 0, v246
s_cmp_eq_u64 vcc, 0
s_cbranch_scc1 L_m_qu
s_mov_b32 s82, 0
L_m_poll13:
buffer_load_dword v246, v245, s[16:19], s88 offen sc1
s_waitcnt vmcnt(0)
v_cmp_gt_u32 vcc, 1, v246
s_cmp_eq_u64 vcc, 0
s_cbranch_scc1 L_m_poll13d
s_sleep 1
s_add_u32 s82, s82, 1
s_cmp_lt_u32 s82, 0x40000
s_cbranch_scc1 L_m_poll13
L_m_poll13d:
L_m_qu:
v_mfma_f32_16x16x32_bf16 v[8:11], a[232:235], a[152:155], v[8:11]
ds_read_b64_tr_b16 a[224:225], v217 offset:512
ds_read_b64_tr_b16 a[226:227], v219 offset:512
v_mfma_f32_16x16x32_bf16 v[8:11], a[236:239], a[168:171], v[8:11]
v_fmac_f32 v208, 0x42a00000, v228
v_fma_f32 v232, v232, s39, v202
v_mfma_f32_16x16x32_bf16 v[40:43], a[236:239], a[172:175], v[40:43]
s_lshl_b32 m0, s28, 10
s_nop 0
buffer_load_dwordx4 v250, s[16:19], s86 offen sc1 lds
v_fma_f32 v234, v234, s39, v202
v_mfma_f32_16x16x32_bf16 v[40:43], a[232:235], a[156:159], v[40:43]
v_add_f32 v210, v233, v235
v_mul_f32 v232, v232, v232
v_mfma_f32_16x16x32_bf16 v[72:75], a[232:235], a[160:163], v[72:75]
ds_read_b64_tr_b16 a[228:229], v217 offset:2560
ds_read_b64_tr_b16 a[230:231], v219 offset:2560
v_mfma_f32_16x16x32_bf16 v[72:75], a[236:239], a[176:179], v[72:75]
v_fmac_f32 v232, v234, v234
v_fmac_f32 v210, 0x42a00000, v232
v_mfma_f32_16x16x32_bf16 v[104:107], a[236:239], a[180:183], v[104:107]
s_add_u32 s32, s35, 61440
buffer_load_dwordx4 a[136:139], v250, s[16:19], s32 offen offset:0 sc1
v_fma_f32 v236, v236, s39, v204
v_mfma_f32_16x16x32_bf16 v[104:107], a[232:235], a[164:167], v[104:107]
s_waitcnt lgkmcnt(4)
v_fma_f32 v238, v238, s39, v204
v_add_f32 v212, v237, v239
v_mfma_f32_16x16x32_bf16 v[120:123], a[216:219], a[164:167], v[120:123]
ds_read_b64_tr_b16 a[232:233], v217 offset:1536
ds_read_b64_tr_b16 a[234:235], v219 offset:1536
v_mfma_f32_16x16x32_bf16 v[120:123], a[220:223], a[180:183], v[120:123]
v_mul_f32 v236, v236, v236
v_fmac_f32 v236, v238, v238
v_mfma_f32_16x16x32_bf16 v[88:91], a[220:223], a[176:179], v[88:91]
buffer_load_dwordx4 a[140:143], v250, s[16:19], s32 offen offset:1024 sc1
v_fmac_f32 v212, 0x42a00000, v236
v_mfma_f32_16x16x32_bf16 v[88:91], a[216:219], a[160:163], v[88:91]
v_fma_f32 v240, v240, s39, v206
v_fma_f32 v242, v242, s39, v206
v_mfma_f32_16x16x32_bf16 v[56:59], a[216:219], a[156:159], v[56:59]
ds_read_b64_tr_b16 a[236:237], v217 offset:3584
ds_read_b64_tr_b16 a[238:239], v219 offset:3584
v_mfma_f32_16x16x32_bf16 v[56:59], a[220:223], a[172:175], v[56:59]
v_add_f32 v214, v241, v243
v_mul_f32 v240, v240, v240
v_mfma_f32_16x16x32_bf16 v[24:27], a[220:223], a[168:171], v[24:27]
buffer_load_dwordx4 a[144:147], v250, s[16:19], s32 offen offset:2048 sc1
v_fmac_f32 v240, v242, v242
v_mfma_f32_16x16x32_bf16 v[24:27], a[216:219], a[152:155], v[24:27]
s_waitcnt lgkmcnt(4)
v_fmac_f32 v214, 0x42a00000, v240
v_mov_b32 v209, v208
v_mfma_f32_16x16x32_bf16 v[12:15], a[224:227], a[152:155], v[12:15]
ds_read_b64_tr_b16 a[216:217], v216 offset:20480
ds_read_b64_tr_b16 a[218:219], v218 offset:20480
v_mfma_f32_16x16x32_bf16 v[12:15], a[228:231], a[168:171], v[12:15]
v_mov_b32 v211, v210
v_mov_b32 v213, v212
v_mfma_f32_16x16x32_bf16 v[44:47], a[228:231], a[172:175], v[44:47]
buffer_load_dwordx4 a[148:151], v250, s[16:19], s32 offen offset:3072 sc1
v_mov_b32 v215, v214
v_mfma_f32_16x16x32_bf16 v[44:47], a[224:227], a[156:159], v[44:47]
v_permlane16_swap_b32 v208, v209
v_permlane16_swap_b32 v210, v211
v_mfma_f32_16x16x32_bf16 v[76:79], a[224:227], a[160:163], v[76:79]
ds_read_b64_tr_b16 a[220:221], v216 offset:22528
ds_read_b64_tr_b16 a[222:223], v218 offset:22528
v_mfma_f32_16x16x32_bf16 v[76:79], a[228:231], a[176:179], v[76:79]
v_permlane16_swap_b32 v212, v213
v_permlane16_swap_b32 v214, v215
v_mfma_f32_16x16x32_bf16 v[108:111], a[228:231], a[180:183], v[108:111]
buffer_load_dwordx4 a[48:51], v250, s[16:19], s33 offen offset:2048 sc1
v_add_f32 v208, v208, v209
v_mfma_f32_16x16x32_bf16 v[108:111], a[224:227], a[164:167], v[108:111]
s_waitcnt lgkmcnt(4)
v_add_f32 v210, v210, v211
v_add_f32 v212, v212, v213
v_mfma_f32_16x16x32_bf16 v[124:127], a[232:235], a[164:167], v[124:127]
ds_read_b64_tr_b16 a[224:225], v216 offset:21504
ds_read_b64_tr_b16 a[226:227], v218 offset:21504
v_mfma_f32_16x16x32_bf16 v[124:127], a[236:239], a[180:183], v[124:127]
v_add_f32 v214, v214, v215
v_mov_b32 v209, v208
v_mfma_f32_16x16x32_bf16 v[92:95], a[236:239], a[176:179], v[92:95]
buffer_load_dwordx4 a[52:55], v250, s[16:19], s33 offen offset:3072 sc1
v_mov_b32 v211, v210
v_mfma_f32_16x16x32_bf16 v[92:95], a[232:235], a[160:163], v[92:95]
v_mov_b32 v213, v212
v_mov_b32 v215, v214
v_mfma_f32_16x16x32_bf16 v[60:63], a[232:235], a[156:159], v[60:63]
ds_read_b64_tr_b16 a[228:229], v216 offset:23552
ds_read_b64_tr_b16 a[230:231], v218 offset:23552
v_mfma_f32_16x16x32_bf16 v[60:63], a[236:239], a[172:175], v[60:63]
v_permlane32_swap_b32 v208, v209
v_permlane32_swap_b32 v210, v211
v_mfma_f32_16x16x32_bf16 v[28:31], a[236:239], a[168:171], v[28:31]
s_add_u32 s34, s81, 14336
buffer_load_dwordx4 a[56:59], v250, s[16:19], s34 offen offset:0 sc1
v_permlane32_swap_b32 v212, v213
v_mfma_f32_16x16x32_bf16 v[28:31], a[232:235], a[152:155], v[28:31]
s_waitcnt lgkmcnt(4)
s_waitcnt vmcnt(22)
v_permlane32_swap_b32 v214, v215
v_add_f32 v208, v208, v209
v_mfma_f32_16x16x32_bf16 v[0:3], a[216:219], a[184:187], v[0:3]
ds_read_b64_tr_b16 a[232:233], v217 offset:20480
ds_read_b64_tr_b16 a[234:235], v219 offset:20480
v_mfma_f32_16x16x32_bf16 v[0:3], a[220:223], a[200:203], v[0:3]
v_add_f32 v210, v210, v211
v_add_f32 v212, v212, v213
v_mfma_f32_16x16x32_bf16 v[32:35], a[220:223], a[204:207], v[32:35]
s_add_u32 s32, s35, 65536
buffer_load_dwordx4 a[152:155], v250, s[16:19], s32 offen offset:0 sc1
v_add_f32 v214, v214, v215
v_mfma_f32_16x16x32_bf16 v[32:35], a[216:219], a[188:191], v[32:35]
v_fma_f32 v208, v208, s40, v226
v_fma_f32 v210, v210, s40, v226
v_mfma_f32_16x16x32_bf16 v[64:67], a[216:219], a[192:195], v[64:67]
ds_read_b64_tr_b16 a[236:237], v217 offset:22528
ds_read_b64_tr_b16 a[238:239], v219 offset:22528
v_mfma_f32_16x16x32_bf16 v[64:67], a[220:223], a[208:211], v[64:67]
v_fma_f32 v212, v212, s40, v226
v_fma_f32 v214, v214, s40, v226
v_mfma_f32_16x16x32_bf16 v[96:99], a[220:223], a[212:215], v[96:99]
buffer_load_dwordx4 a[156:159], v250, s[16:19], s32 offen offset:1024 sc1
v_rsq_f32 v208, v208
v_mfma_f32_16x16x32_bf16 v[96:99], a[216:219], a[196:199], v[96:99]
s_waitcnt lgkmcnt(4)
v_rsq_f32 v210, v210
v_mfma_f32_16x16x32_bf16 v[112:115], a[224:227], a[196:199], v[112:115]
ds_read_b64_tr_b16 a[216:217], v217 offset:21504
ds_read_b64_tr_b16 a[218:219], v219 offset:21504
v_mfma_f32_16x16x32_bf16 v[112:115], a[228:231], a[212:215], v[112:115]
v_rsq_f32 v212, v212
v_mfma_f32_16x16x32_bf16 v[80:83], a[228:231], a[208:211], v[80:83]
buffer_load_dwordx4 a[160:163], v250, s[16:19], s32 offen offset:2048 sc1
v_rsq_f32 v214, v214
v_mfma_f32_16x16x32_bf16 v[80:83], a[224:227], a[192:195], v[80:83]
v_lshrrev_b32 v227, 8, v250
s_lshl_b32 s3, s28, 10
v_lshl_add_u32 v227, v227, 4, s3
v_mfma_f32_16x16x32_bf16 v[48:51], a[224:227], a[188:191], v[48:51]
ds_read_b64_tr_b16 a[220:221], v217 offset:23552
ds_read_b64_tr_b16 a[222:223], v219 offset:23552
v_mfma_f32_16x16x32_bf16 v[48:51], a[228:231], a[204:207], v[48:51]
s_mul_i32 s41, s30, 54
s_lshl_b32 s3, s74, 1
s_add_u32 s41, s41, s3
s_lshl_b32 s41, s41, 12
s_add_u32 s41, s41, 33554432
s_add_u32 s43, s41, 4096
s_lshl_b32 s42, s30, 5
s_add_u32 s42, s42, s74
s_lshl_b32 s42, s42, 7
s_add_u32 s42, s42, 41156608
v_mfma_f32_16x16x32_bf16 v[16:19], a[228:231], a[200:203], v[16:19]
buffer_load_dwordx4 a[164:167], v250, s[16:19], s32 offen offset:3072 sc1
v_mfma_f32_16x16x32_bf16 v[16:19], a[224:227], a[184:187], v[16:19]
s_waitcnt lgkmcnt(4)
v_mfma_f32_16x16x32_bf16 v[4:7], a[232:235], a[184:187], v[4:7]
ds_read_b64_tr_b16 a[224:225], v216 offset:20992
ds_read_b64_tr_b16 a[226:227], v218 offset:20992
v_mfma_f32_16x16x32_bf16 v[4:7], a[236:239], a[200:203], v[4:7]
v_mfma_f32_16x16x32_bf16 v[36:39], a[236:239], a[204:207], v[36:39]
s_add_u32 s33, s81, 15360
buffer_load_dwordx4 a[60:63], v250, s[16:19], s33 offen offset:0 sc1
v_mfma_f32_16x16x32_bf16 v[36:39], a[232:235], a[188:191], v[36:39]
v_mfma_f32_16x16x32_bf16 v[68:71], a[232:235], a[192:195], v[68:71]
ds_read_b64_tr_b16 a[228:229], v216 offset:23040
ds_read_b64_tr_b16 a[230:231], v218 offset:23040
v_mfma_f32_16x16x32_bf16 v[68:71], a[236:239], a[208:211], v[68:71]
v_mfma_f32_16x16x32_bf16 v[100:103], a[236:239], a[212:215], v[100:103]
buffer_load_dwordx4 a[64:67], v250, s[16:19], s33 offen offset:1024 sc1
v_mfma_f32_16x16x32_bf16 v[100:103], a[232:235], a[196:199], v[100:103]
s_waitcnt lgkmcnt(4)
v_mfma_f32_16x16x32_bf16 v[116:119], a[216:219], a[196:199], v[116:119]
ds_read_b64_tr_b16 a[232:233], v216 offset:22016
ds_read_b64_tr_b16 a[234:235], v218 offset:22016
v_mfma_f32_16x16x32_bf16 v[116:119], a[220:223], a[212:215], v[116:119]
v_mfma_f32_16x16x32_bf16 v[84:87], a[220:223], a[208:211], v[84:87]
buffer_load_dwordx4 a[68:71], v250, s[16:19], s33 offen offset:2048 sc1
v_mfma_f32_16x16x32_bf16 v[84:87], a[216:219], a[192:195], v[84:87]
v_mfma_f32_16x16x32_bf16 v[52:55], a[216:219], a[188:191], v[52:55]
ds_read_b64_tr_b16 a[236:237], v216 offset:24064
ds_read_b64_tr_b16 a[238:239], v218 offset:24064
v_mfma_f32_16x16x32_bf16 v[52:55], a[220:223], a[204:207], v[52:55]
v_mfma_f32_16x16x32_bf16 v[20:23], a[220:223], a[200:203], v[20:23]
v_mfma_f32_16x16x32_bf16 v[20:23], a[216:219], a[184:187], v[20:23]
s_waitcnt lgkmcnt(4)
v_mfma_f32_16x16x32_bf16 v[8:11], a[224:227], a[184:187], v[8:11]
ds_read_b64_tr_b16 a[216:217], v217 offset:20992
ds_read_b64_tr_b16 a[218:219], v219 offset:20992
v_mfma_f32_16x16x32_bf16 v[8:11], a[228:231], a[200:203], v[8:11]
s_waitcnt vmcnt(14)
ds_read_b128 v[136:139], v227 offset:0
ds_read_b128 v[144:147], v227 offset:64
v_mfma_f32_16x16x32_bf16 v[40:43], a[228:231], a[204:207], v[40:43]
s_add_u32 s32, s35, 69632
buffer_load_dwordx4 a[168:171], v250, s[16:19], s32 offen offset:0 sc1
ds_read_b128 v[152:155], v227 offset:128
v_mfma_f32_16x16x32_bf16 v[40:43], a[224:227], a[188:191], v[40:43]
ds_read_b128 v[160:163], v227 offset:192
ds_read_b128 v[168:171], v227 offset:256
v_mfma_f32_16x16x32_bf16 v[72:75], a[224:227], a[192:195], v[72:75]
ds_read_b64_tr_b16 a[220:221], v217 offset:23040
ds_read_b64_tr_b16 a[222:223], v219 offset:23040
v_mfma_f32_16x16x32_bf16 v[72:75], a[228:231], a[208:211], v[72:75]
ds_read_b128 v[176:179], v227 offset:320
ds_read_b128 v[184:187], v227 offset:384
v_mfma_f32_16x16x32_bf16 v[104:107], a[228:231], a[212:215], v[104:107]
buffer_load_dwordx4 a[172:175], v250, s[16:19], s32 offen offset:1024 sc1
ds_read_b128 v[192:195], v227 offset:448
v_mfma_f32_16x16x32_bf16 v[104:107], a[224:227], a[196:199], v[104:107]
s_waitcnt lgkmcnt(12)
ds_read_b128 v[140:143], v227 offset:512
ds_read_b128 v[148:151], v227 offset:576
v_mfma_f32_16x16x32_bf16 v[120:123], a[232:235], a[196:199], v[120:123]
ds_read_b64_tr_b16 a[224:225], v217 offset:22016
ds_read_b64_tr_b16 a[226:227], v219 offset:22016
v_mfma_f32_16x16x32_bf16 v[120:123], a[236:239], a[212:215], v[120:123]
ds_read_b128 v[156:159], v227 offset:640
ds_read_b128 v[164:167], v227 offset:704
v_mfma_f32_16x16x32_bf16 v[88:91], a[236:239], a[208:211], v[88:91]
buffer_load_dwordx4 a[176:179], v250, s[16:19], s32 offen offset:2048 sc1
ds_read_b128 v[172:175], v227 offset:768
v_mfma_f32_16x16x32_bf16 v[88:91], a[232:235], a[192:195], v[88:91]
ds_read_b128 v[180:183], v227 offset:832
ds_read_b128 v[188:191], v227 offset:896
v_mfma_f32_16x16x32_bf16 v[56:59], a[232:235], a[188:191], v[56:59]
ds_read_b64_tr_b16 a[228:229], v217 offset:24064
ds_read_b64_tr_b16 a[230:231], v219 offset:24064
v_mfma_f32_16x16x32_bf16 v[56:59], a[236:239], a[204:207], v[56:59]
ds_read_b128 v[196:199], v227 offset:960
v_mfma_f32_16x16x32_bf16 v[24:27], a[236:239], a[200:203], v[24:27]
buffer_load_dwordx4 a[180:183], v250, s[16:19], s32 offen offset:3072 sc1
v_mfma_f32_16x16x32_bf16 v[24:27], a[232:235], a[184:187], v[24:27]
s_waitcnt lgkmcnt(15)
v_mfma_f32_16x16x32_bf16 v[12:15], a[216:219], a[184:187], v[12:15]
ds_read_b64_tr_b16 a[232:233], v216 offset:4096
ds_read_b64_tr_b16 a[234:235], v216 offset:24576
v_mfma_f32_16x16x32_bf16 v[12:15], a[220:223], a[200:203], v[12:15]
v_mfma_f32_16x16x32_bf16 v[44:47], a[220:223], a[204:207], v[44:47]
buffer_load_dwordx4 a[72:75], v250, s[16:19], s33 offen offset:3072 sc1
s_waitcnt lgkmcnt(2)
v_fmac_f32 v0, v136, v200
v_mfma_f32_16x16x32_bf16 v[44:47], a[216:219], a[188:191], v[44:47]
v_fmac_f32 v16, v168, v200
v_fmac_f32 v4, v144, v200
v_mfma_f32_16x16x32_bf16 v[76:79], a[216:219], a[192:195], v[76:79]
ds_read_b64_tr_b16 a[236:237], v216 offset:40960
ds_read_b64_tr_b16 a[238:239], v218 offset:40960
v_mfma_f32_16x16x32_bf16 v[76:79], a[220:223], a[208:211], v[76:79]
v_fmac_f32 v20, v176, v200
v_fmac_f32 v8, v152, v200
v_mfma_f32_16x16x32_bf16 v[108:111], a[220:223], a[212:215], v[108:111]
s_add_u32 s34, s81, 19456
buffer_load_dwordx4 a[76:79], v250, s[16:19], s34 offen offset:0 sc1
v_fmac_f32 v1, v137, v200
v_mfma_f32_16x16x32_bf16 v[108:111], a[216:219], a[196:199], v[108:111]
v_fmac_f32 v17, v169, v200
v_fmac_f32 v5, v145, v200
v_mfma_f32_16x16x32_bf16 v[124:127], a[224:227], a[196:199], v[124:127]
ds_read_b64_tr_b16 a[216:217], v216 offset:5120
ds_read_b64_tr_b16 a[218:219], v216 offset:25600
v_mfma_f32_16x16x32_bf16 v[124:127], a[228:231], a[212:215], v[124:127]
v_fmac_f32 v24, v184, v200
v_fmac_f32 v21, v177, v200
v_mfma_f32_16x16x32_bf16 v[92:95], a[228:231], a[208:211], v[92:95]
s_add_u32 s33, s81, 20480
buffer_load_dwordx4 a[80:83], v250, s[16:19], s33 offen offset:0 sc1
v_fmac_f32 v9, v153, v200
v_mfma_f32_16x16x32_bf16 v[92:95], a[224:227], a[192:195], v[92:95]
v_fmac_f32 v25, v185, v200
v_fmac_f32 v18, v170, v200
v_mfma_f32_16x16x32_bf16 v[60:63], a[224:227], a[188:191], v[60:63]
ds_read_b64_tr_b16 a[220:221], v216 offset:41984
ds_read_b64_tr_b16 a[222:223], v218 offset:41984
v_mfma_f32_16x16x32_bf16 v[60:63], a[228:231], a[204:207], v[60:63]
v_fmac_f32 v6, v146, v200
v_fmac_f32 v22, v178, v200
v_mfma_f32_16x16x32_bf16 v[28:31], a[228:231], a[200:203], v[28:31]
v_fmac_f32 v10, v154, v200
v_fmac_f32 v26, v186, v200
v_mfma_f32_16x16x32_bf16 v[28:31], a[224:227], a[184:187], v[28:31]
s_waitcnt lgkmcnt(4)
s_waitcnt vmcnt(17)
v_fmac_f32 v19, v171, v200
v_fmac_f32 v7, v147, v200
v_mfma_f32_16x16x32_bf16 v[0:3], a[232:235], a[120:123], v[0:3]
ds_read_b64_tr_b16 a[224:225], v217 offset:4096
ds_read_b64_tr_b16 a[226:227], v217 offset:24576
v_mfma_f32_16x16x32_bf16 v[0:3], a[236:239], a[136:139], v[0:3]
v_fmac_f32 v12, v160, v200
v_fmac_f32 v13, v161, v200
v_mfma_f32_16x16x32_bf16 v[32:35], a[236:239], a[140:143], v[32:35]
s_add_u32 s32, s35, 73728
buffer_load_dwordx4 a[184:187], v250, s[16:19], s32 offen offset:0 sc1
v_fmac_f32 v14, v162, v200
v_mfma_f32_16x16x32_bf16 v[32:35], a[232:235], a[124:127], v[32:35]
v_fmac_f32 v23, v179, v200
v_fmac_f32 v11, v155, v200
v_mfma_f32_16x16x32_bf16 v[64:67], a[232:235], a[128:131], v[64:67]
ds_read_b64_tr_b16 a[228:229], v217 offset:40960
ds_read_b64_tr_b16 a[230:231], v219 offset:40960
v_mfma_f32_16x16x32_bf16 v[64:67], a[236:239], a[144:147], v[64:67]
v_fmac_f32 v27, v187, v200
v_fmac_f32 v15, v163, v200
v_mfma_f32_16x16x32_bf16 v[96:99], a[236:239], a[148:151], v[96:99]
buffer_load_dwordx4 a[188:191], v250, s[16:19], s32 offen offset:1024 sc1
v_fmac_f32 v36, v144, v202
v_mfma_f32_16x16x32_bf16 v[96:99], a[232:235], a[132:135], v[96:99]
s_waitcnt lgkmcnt(4)
v_fmac_f32 v52, v176, v202
v_fmac_f32 v40, v152, v202
v_mfma_f32_16x16x32_bf16 v[112:115], a[216:219], a[132:135], v[112:115]
ds_read_b64_tr_b16 a[232:233], v217 offset:5120
ds_read_b64_tr_b16 a[234:235], v217 offset:25600
v_mfma_f32_16x16x32_bf16 v[112:115], a[220:223], a[148:151], v[112:115]
v_fmac_f32 v28, v192, v200
v_fmac_f32 v29, v193, v200
v_mfma_f32_16x16x32_bf16 v[80:83], a[220:223], a[144:147], v[80:83]
buffer_load_dwordx4 a[192:195], v250, s[16:19], s32 offen offset:2048 sc1
v_fmac_f32 v30, v194, v200
v_mfma_f32_16x16x32_bf16 v[80:83], a[216:219], a[128:131], v[80:83]
v_fmac_f32 v31, v195, v200
v_fmac_f32 v56, v184, v202
v_mfma_f32_16x16x32_bf16 v[48:51], a[216:219], a[124:127], v[48:51]
ds_read_b64_tr_b16 a[236:237], v217 offset:41984
ds_read_b64_tr_b16 a[238:239], v219 offset:41984
v_mfma_f32_16x16x32_bf16 v[48:51], a[220:223], a[140:143], v[48:51]
v_fmac_f32 v44, v160, v202
v_fmac_f32 v60, v192, v202
v_mfma_f32_16x16x32_bf16 v[16:19], a[220:223], a[136:139], v[16:19]
buffer_load_dwordx4 a[196:199], v250, s[16:19], s32 offen offset:3072 sc1
v_fmac_f32 v53, v177, v202
v_mfma_f32_16x16x32_bf16 v[16:19], a[216:219], a[120:123], v[16:19]
s_waitcnt lgkmcnt(4)
v_fmac_f32 v41, v153, v202
v_fmac_f32 v57, v185, v202
v_mfma_f32_16x16x32_bf16 v[4:7], a[224:227], a[120:123], v[4:7]
ds_read_b64_tr_b16 a[216:217], v216 offset:4608
ds_read_b64_tr_b16 a[218:219], v216 offset:25088
v_mfma_f32_16x16x32_bf16 v[4:7], a[228:231], a[136:139], v[4:7]
v_fmac_f32 v2, v138, v200
v_fmac_f32 v3, v139, v200
v_mfma_f32_16x16x32_bf16 v[36:39], a[228:231], a[140:143], v[36:39]
buffer_load_dwordx4 a[84:87], v250, s[16:19], s33 offen offset:1024 sc1
v_fmac_f32 v32, v136, v202
v_mfma_f32_16x16x32_bf16 v[36:39], a[224:227], a[124:127], v[36:39]
v_fmac_f32 v33, v137, v202
v_fmac_f32 v45, v161, v202
v_mfma_f32_16x16x32_bf16 v[68:71], a[224:227], a[128:131], v[68:71]
ds_read_b64_tr_b16 a[220:221], v216 offset:41472
ds_read_b64_tr_b16 a[222:223], v218 offset:41472
v_mfma_f32_16x16x32_bf16 v[68:71], a[228:231], a[144:147], v[68:71]
v_fmac_f32 v61, v193, v202
v_fmac_f32 v34, v138, v202
v_mfma_f32_16x16x32_bf16 v[100:103], a[228:231], a[148:151], v[100:103]
buffer_load_dwordx4 a[88:91], v250, s[16:19], s33 offen offset:2048 sc1
v_fmac_f32 v42, v154, v202
v_mfma_f32_16x16x32_bf16 v[100:103], a[224:227], a[132:135], v[100:103]
s_waitcnt lgkmcnt(4)
v_fmac_f32 v58, v186, v202
v_fmac_f32 v46, v162, v202
v_mfma_f32_16x16x32_bf16 v[116:119], a[232:235], a[132:135], v[116:119]
ds_read_b64_tr_b16 a[224:225], v216 offset:5632
ds_read_b64_tr_b16 a[226:227], v216 offset:26112
v_mfma_f32_16x16x32_bf16 v[116:119], a[236:239], a[148:151], v[116:119]
v_fmac_f32 v48, v168, v202
v_fmac_f32 v49, v169, v202
v_mfma_f32_16x16x32_bf16 v[84:87], a[236:239], a[144:147], v[84:87]
buffer_load_dwordx4 a[92:95], v250, s[16:19], s33 offen offset:3072 sc1
v_fmac_f32 v50, v170, v202
v_mfma_f32_16x16x32_bf16 v[84:87], a[232:235], a[128:131], v[84:87]
v_fmac_f32 v62, v194, v202
v_fmac_f32 v35, v139, v202
v_mfma_f32_16x16x32_bf16 v[52:55], a[232:235], a[124:127], v[52:55]
ds_read_b64_tr_b16 a[228:229], v216 offset:42496
ds_read_b64_tr_b16 a[230:231], v218 offset:42496
v_mfma_f32_16x16x32_bf16 v[52:55], a[236:239], a[140:143], v[52:55]
v_fmac_f32 v51, v171, v202
v_fmac_f32 v59, v187, v202
v_mfma_f32_16x16x32_bf16 v[20:23], a[236:239], a[136:139], v[20:23]
v_fmac_f32 v47, v163, v202
v_fmac_f32 v63, v195, v202
v_mfma_f32_16x16x32_bf16 v[20:23], a[232:235], a[120:123], v[20:23]
s_waitcnt lgkmcnt(4)
v_fmac_f32 v64, v136, v204
v_fmac_f32 v80, v168, v204
v_mfma_f32_16x16x32_bf16 v[8:11], a[216:219], a[120:123], v[8:11]
L_m_c2_5:
s_cbranch_execz L_m_c2_ret
ds_read_b64_tr_b16 a[232:233], v217 offset:4608
ds_read_b64_tr_b16 a[234:235], v217 offset:25088
v_mfma_f32_16x16x32_bf16 v[8:11], a[220:223], a[136:139], v[8:11]
v_fmac_f32 v37, v145, v202
v_fmac_f32 v38, v146, v202
v_mfma_f32_16x16x32_bf16 v[40:43], a[220:223], a[140:143], v[40:43]
s_add_u32 s32, s35, 77824
buffer_load_dwordx2 a[200:201], v247, s[16:19], s32 offen offset:0 sc1
buffer_load_dwordx2 a[202:203], v247, s[16:19], s32 offen offset:512 sc1
v_mfma_f32_16x16x32_bf16 v[40:43], a[216:219], a[124:127], v[40:43]
v_fmac_f32 v39, v147, v202
v_fmac_f32 v68, v144, v204
v_mfma_f32_16x16x32_bf16 v[72:75], a[216:219], a[128:131], v[72:75]
ds_read_b64_tr_b16 a[236:237], v217 offset:41472
ds_read_b64_tr_b16 a[238:239], v219 offset:41472
v_mfma_f32_16x16x32_bf16 v[72:75], a[220:223], a[144:147], v[72:75]
v_fmac_f32 v76, v160, v204
v_fmac_f32 v92, v192, v204
v_mfma_f32_16x16x32_bf16 v[104:107], a[220:223], a[148:151], v[104:107]
buffer_load_dwordx2 a[204:205], v247, s[16:19], s32 offen offset:1024 sc1
buffer_load_dwordx2 a[206:207], v247, s[16:19], s32 offen offset:1536 sc1
v_mfma_f32_16x16x32_bf16 v[104:107], a[216:219], a[132:135], v[104:107]
s_waitcnt lgkmcnt(4)
v_fmac_f32 v65, v137, v204
v_fmac_f32 v81, v169, v204
v_mfma_f32_16x16x32_bf16 v[120:123], a[224:227], a[132:135], v[120:123]
ds_read_b64_tr_b16 a[216:217], v217 offset:5632
ds_read_b64_tr_b16 a[218:219], v217 offset:26112
v_mfma_f32_16x16x32_bf16 v[120:123], a[228:231], a[148:151], v[120:123]
v_fmac_f32 v54, v178, v202
v_fmac_f32 v55, v179, v202
v_mfma_f32_16x16x32_bf16 v[88:91], a[228:231], a[144:147], v[88:91]
buffer_load_dwordx2 a[208:209], v247, s[16:19], s32 offen offset:2048 sc1
buffer_load_dwordx2 a[210:211], v247, s[16:19], s32 offen offset:2560 sc1
v_mfma_f32_16x16x32_bf16 v[88:91], a[224:227], a[128:131], v[88:91]
v_fmac_f32 v84, v176, v204
v_fmac_f32 v69, v145, v204
v_mfma_f32_16x16x32_bf16 v[56:59], a[224:227], a[124:127], v[56:59]
ds_read_b64_tr_b16 a[220:221], v217 offset:42496
ds_read_b64_tr_b16 a[222:223], v219 offset:42496
v_mfma_f32_16x16x32_bf16 v[56:59], a[228:231], a[140:143], v[56:59]
v_add_u32 v216, 40960, v216
v_add_u32 v217, 40960, v217
v_mfma_f32_16x16x32_bf16 v[24:27], a[228:231], a[136:139], v[24:27]
buffer_load_dwordx2 a[212:213], v247, s[16:19], s32 offen offset:3072 sc1
v_fmac_f32 v85, v177, v204
v_mfma_f32_16x16x32_bf16 v[24:27], a[224:227], a[120:123], v[24:27]
s_waitcnt lgkmcnt(4)
v_add_u32 v218, 40960, v218
v_add_u32 v219, 40960, v219
v_mfma_f32_16x16x32_bf16 v[12:15], a[232:235], a[120:123], v[12:15]
ds_read_b64_tr_b16 a[224:225], v216 offset:2048
ds_read_b64_tr_b16 a[226:227], v218 offset:2048
v_mfma_f32_16x16x32_bf16 v[12:15], a[236:239], a[136:139], v[12:15]
v_fmac_f32 v43, v155, v202
v_fmac_f32 v72, v152, v204
v_mfma_f32_16x16x32_bf16 v[44:47], a[236:239], a[140:143], v[44:47]
buffer_load_dwordx2 a[214:215], v247, s[16:19], s32 offen offset:3584 sc1
v_fmac_f32 v73, v153, v204
v_mfma_f32_16x16x32_bf16 v[44:47], a[232:235], a[124:127], v[44:47]
v_fmac_f32 v66, v138, v204
v_fmac_f32 v82, v170, v204
v_mfma_f32_16x16x32_bf16 v[76:79], a[232:235], a[128:131], v[76:79]
ds_read_b64_tr_b16 a[228:229], v216 offset:20480
ds_read_b64_tr_b16 a[230:231], v218 offset:20480
v_mfma_f32_16x16x32_bf16 v[76:79], a[236:239], a[144:147], v[76:79]
v_fmac_f32 v70, v146, v204
v_fmac_f32 v86, v178, v204
v_mfma_f32_16x16x32_bf16 v[108:111], a[236:239], a[148:151], v[108:111]
s_add_u32 s34, s81, 24576
buffer_load_dwordx4 a[96:99], v250, s[16:19], s34 offen offset:0 sc1
v_fmac_f32 v74, v154, v204
v_mfma_f32_16x16x32_bf16 v[108:111], a[232:235], a[132:135], v[108:111]
s_waitcnt lgkmcnt(4)
v_fmac_f32 v67, v139, v204
v_fmac_f32 v83, v171, v204
v_mfma_f32_16x16x32_bf16 v[124:127], a[216:219], a[132:135], v[124:127]
ds_read_b64_tr_b16 a[232:233], v216 offset:3072
ds_read_b64_tr_b16 a[234:235], v218 offset:3072
v_mfma_f32_16x16x32_bf16 v[124:127], a[220:223], a[148:151], v[124:127]
v_fmac_f32 v88, v184, v204
v_fmac_f32 v89, v185, v204
v_mfma_f32_16x16x32_bf16 v[92:95], a[220:223], a[144:147], v[92:95]
s_add_u32 s33, s81, 25600
buffer_load_dwordx4 a[100:103], v250, s[16:19], s33 offen offset:0 sc1
v_fmac_f32 v90, v186, v204
v_mfma_f32_16x16x32_bf16 v[92:95], a[216:219], a[128:131], v[92:95]
v_fmac_f32 v71, v147, v204
v_fmac_f32 v87, v179, v204
v_mfma_f32_16x16x32_bf16 v[60:63], a[216:219], a[124:127], v[60:63]
ds_read_b64_tr_b16 a[236:237], v216 offset:21504
ds_read_b64_tr_b16 a[238:239], v218 offset:21504
v_mfma_f32_16x16x32_bf16 v[60:63], a[220:223], a[140:143], v[60:63]
v_fmac_f32 v75, v155, v204
v_fmac_f32 v91, v187, v204
v_mfma_f32_16x16x32_bf16 v[28:31], a[220:223], a[136:139], v[28:31]
buffer_load_dwordx4 a[104:107], v250, s[16:19], s33 offen offset:1024 sc1
v_fmac_f32 v112, v168, v206
v_mfma_f32_16x16x32_bf16 v[28:31], a[216:219], a[120:123], v[28:31]
s_waitcnt lgkmcnt(4)
s_waitcnt vmcnt(21)
v_fmac_f32 v100, v144, v206
v_fmac_f32 v116, v176, v206
v_mfma_f32_16x16x32_bf16 v[0:3], a[224:227], a[152:155], v[0:3]
ds_read_b64_tr_b16 a[216:217], v217 offset:2048
ds_read_b64_tr_b16 a[218:219], v219 offset:2048
v_mfma_f32_16x16x32_bf16 v[0:3], a[228:231], a[168:171], v[0:3]
v_fmac_f32 v77, v161, v204
v_fmac_f32 v78, v162, v204
v_mfma_f32_16x16x32_bf16 v[32:35], a[228:231], a[172:175], v[32:35]
buffer_load_dwordx4 a[108:111], v250, s[16:19], s33 offen offset:2048 sc1
v_fmac_f32 v79, v163, v204
v_mfma_f32_16x16x32_bf16 v[32:35], a[224:227], a[156:159], v[32:35]
v_fmac_f32 v104, v152, v206
v_fmac_f32 v120, v184, v206
v_mfma_f32_16x16x32_bf16 v[64:67], a[224:227], a[160:163], v[64:67]
ds_read_b64_tr_b16 a[220:221], v217 offset:20480
ds_read_b64_tr_b16 a[222:223], v219 offset:20480
v_mfma_f32_16x16x32_bf16 v[64:67], a[228:231], a[176:179], v[64:67]
v_fmac_f32 v108, v160, v206
v_fmac_f32 v101, v145, v206
v_mfma_f32_16x16x32_bf16 v[96:99], a[228:231], a[180:183], v[96:99]
buffer_load_dwordx4 a[112:115], v250, s[16:19], s33 offen offset:3072 sc1
v_fmac_f32 v117, v177, v206
v_mfma_f32_16x16x32_bf16 v[96:99], a[224:227], a[164:167], v[96:99]
s_waitcnt lgkmcnt(4)
v_fmac_f32 v105, v153, v206
v_fmac_f32 v121, v185, v206
v_mfma_f32_16x16x32_bf16 v[112:115], a[232:235], a[164:167], v[112:115]
ds_read_b64_tr_b16 a[224:225], v217 offset:3072
ds_read_b64_tr_b16 a[226:227], v219 offset:3072
v_mfma_f32_16x16x32_bf16 v[112:115], a[236:239], a[180:183], v[112:115]
v_fmac_f32 v93, v193, v204
v_fmac_f32 v94, v194, v204
v_mfma_f32_16x16x32_bf16 v[80:83], a[236:239], a[176:179], v[80:83]
s_add_u32 s34, s81, 29696
buffer_load_dwordx4 a[116:119], v250, s[16:19], s34 offen offset:0 sc1
v_fmac_f32 v95, v195, v204
v_mfma_f32_16x16x32_bf16 v[80:83], a[232:235], a[160:163], v[80:83]
v_fmac_f32 v124, v192, v206
v_fmac_f32 v109, v161, v206
v_mfma_f32_16x16x32_bf16 v[48:51], a[232:235], a[156:159], v[48:51]
ds_read_b64_tr_b16 a[228:229], v217 offset:21504
ds_read_b64_tr_b16 a[230:231], v219 offset:21504
v_mfma_f32_16x16x32_bf16 v[48:51], a[236:239], a[172:175], v[48:51]
v_fmac_f32 v125, v193, v206
v_fmac_f32 v118, v178, v206
v_mfma_f32_16x16x32_bf16 v[16:19], a[236:239], a[168:171], v[16:19]
s_add_u32 s33, s81, 30720
buffer_load_dwordx4 a[120:123], v250, s[16:19], s33 offen offset:0 sc1
v_fmac_f32 v106, v154, v206
v_mfma_f32_16x16x32_bf16 v[16:19], a[232:235], a[152:155], v[16:19]
s_waitcnt lgkmcnt(4)
v_fmac_f32 v122, v186, v206
v_fmac_f32 v110, v162, v206
v_mfma_f32_16x16x32_bf16 v[4:7], a[216:219], a[152:155], v[4:7]
ds_read_b64_tr_b16 a[232:233], v216 offset:2560
ds_read_b64_tr_b16 a[234:235], v218 offset:2560
v_mfma_f32_16x16x32_bf16 v[4:7], a[220:223], a[168:171], v[4:7]
v_fmac_f32 v96, v136, v206
v_fmac_f32 v97, v137, v206
v_mfma_f32_16x16x32_bf16 v[36:39], a[220:223], a[172:175], v[36:39]
buffer_load_dwordx4 a[124:127], v250, s[16:19], s33 offen offset:1024 sc1
v_fmac_f32 v98, v138, v206
v_mfma_f32_16x16x32_bf16 v[36:39], a[216:219], a[156:159], v[36:39]
v_fmac_f32 v126, v194, v206
v_fmac_f32 v99, v139, v206
v_mfma_f32_16x16x32_bf16 v[68:71], a[216:219], a[160:163], v[68:71]
ds_read_b64_tr_b16 a[236:237], v216 offset:20992
ds_read_b64_tr_b16 a[238:239], v218 offset:20992
v_mfma_f32_16x16x32_bf16 v[68:71], a[220:223], a[176:179], v[68:71]
v_fmac_f32 v107, v155, v206
v_fmac_f32 v123, v187, v206
v_mfma_f32_16x16x32_bf16 v[100:103], a[220:223], a[180:183], v[100:103]
buffer_load_dwordx4 a[128:131], v250, s[16:19], s33 offen offset:2048 sc1
v_fmac_f32 v111, v163, v206
v_mfma_f32_16x16x32_bf16 v[100:103], a[216:219], a[164:167], v[100:103]
s_waitcnt lgkmcnt(4)
v_fmac_f32 v127, v195, v206
v_mfma_f32_16x16x32_bf16 v[116:119], a[224:227], a[164:167], v[116:119]
ds_read_b64_tr_b16 a[216:217], v216 offset:3584
ds_read_b64_tr_b16 a[218:219], v218 offset:3584
v_mfma_f32_16x16x32_bf16 v[116:119], a[228:231], a[180:183], v[116:119]
v_fmac_f32 v113, v169, v206
v_fmac_f32 v114, v170, v206
v_mfma_f32_16x16x32_bf16 v[84:87], a[228:231], a[176:179], v[84:87]
buffer_load_dwordx4 a[132:135], v250, s[16:19], s33 offen offset:3072 sc1
v_fmac_f32 v115, v171, v206
v_mfma_f32_16x16x32_bf16 v[84:87], a[224:227], a[160:163], v[84:87]
v_mfma_f32_16x16x32_bf16 v[52:55], a[224:227], a[156:159], v[52:55]
ds_read_b64_tr_b16 a[220:221], v216 offset:22016
ds_read_b64_tr_b16 a[222:223], v218 offset:22016
v_mfma_f32_16x16x32_bf16 v[52:55], a[228:231], a[172:175], v[52:55]
v_mfma_f32_16x16x32_bf16 v[20:23], a[228:231], a[168:171], v[20:23]
v_mfma_f32_16x16x32_bf16 v[20:23], a[224:227], a[152:155], v[20:23]
s_waitcnt lgkmcnt(4)
v_mfma_f32_16x16x32_bf16 v[8:11], a[232:235], a[152:155], v[8:11]
ds_read_b64_tr_b16 a[224:225], v217 offset:2560
ds_read_b64_tr_b16 a[226:227], v219 offset:2560
v_mfma_f32_16x16x32_bf16 v[8:11], a[236:239], a[168:171], v[8:11]
v_fmac_f32 v102, v146, v206
v_fmac_f32 v103, v147, v206
v_mfma_f32_16x16x32_bf16 v[40:43], a[236:239], a[172:175], v[40:43]
s_add_u32 s34, s81, 34816
buffer_load_dwordx4 a[136:139], v250, s[16:19], s34 offen offset:0 sc1
v_mfma_f32_16x16x32_bf16 v[40:43], a[232:235], a[156:159], v[40:43]
v_mfma_f32_16x16x32_bf16 v[72:75], a[232:235], a[160:163], v[72:75]
ds_read_b64_tr_b16 a[228:229], v217 offset:20992
ds_read_b64_tr_b16 a[230:231], v219 offset:20992
v_mfma_f32_16x16x32_bf16 v[72:75], a[236:239], a[176:179], v[72:75]
v_mfma_f32_16x16x32_bf16 v[104:107], a[236:239], a[180:183], v[104:107]
s_add_u32 s33, s81, 35840
buffer_load_dwordx4 a[140:143], v250, s[16:19], s33 offen offset:0 sc1
v_mfma_f32_16x16x32_bf16 v[104:107], a[232:235], a[164:167], v[104:107]
s_waitcnt lgkmcnt(4)
v_mfma_f32_16x16x32_bf16 v[120:123], a[216:219], a[164:167], v[120:123]
ds_read_b64_tr_b16 a[232:233], v217 offset:3584
ds_read_b64_tr_b16 a[234:235], v219 offset:3584
v_mfma_f32_16x16x32_bf16 v[120:123], a[220:223], a[180:183], v[120:123]
v_fmac_f32 v119, v179, v206
v_mfma_f32_16x16x32_bf16 v[88:91], a[220:223], a[176:179], v[88:91]
buffer_load_dwordx4 a[144:147], v250, s[16:19], s33 offen offset:1024 sc1
v_mfma_f32_16x16x32_bf16 v[88:91], a[216:219], a[160:163], v[88:91]
v_mfma_f32_16x16x32_bf16 v[56:59], a[216:219], a[156:159], v[56:59]
ds_read_b64_tr_b16 a[236:237], v217 offset:22016
ds_read_b64_tr_b16 a[238:239], v219 offset:22016
v_mfma_f32_16x16x32_bf16 v[56:59], a[220:223], a[172:175], v[56:59]
v_mfma_f32_16x16x32_bf16 v[24:27], a[220:223], a[168:171], v[24:27]
buffer_load_dwordx4 a[148:151], v250, s[16:19], s33 offen offset:2048 sc1
v_mfma_f32_16x16x32_bf16 v[24:27], a[216:219], a[152:155], v[24:27]
s_waitcnt lgkmcnt(4)
v_mfma_f32_16x16x32_bf16 v[12:15], a[224:227], a[152:155], v[12:15]
ds_read_b64_tr_b16 a[216:217], v216 offset:22528
ds_read_b64_tr_b16 a[218:219], v218 offset:22528
v_mfma_f32_16x16x32_bf16 v[12:15], a[228:231], a[168:171], v[12:15]
v_mfma_f32_16x16x32_bf16 v[44:47], a[228:231], a[172:175], v[44:47]
v_mfma_f32_16x16x32_bf16 v[44:47], a[224:227], a[156:159], v[44:47]
v_mfma_f32_16x16x32_bf16 v[76:79], a[224:227], a[160:163], v[76:79]
ds_read_b64_tr_b16 a[220:221], v216 offset:4096
ds_read_b64_tr_b16 a[222:223], v216 offset:24576
v_mfma_f32_16x16x32_bf16 v[76:79], a[228:231], a[176:179], v[76:79]
v_mfma_f32_16x16x32_bf16 v[108:111], a[228:231], a[180:183], v[108:111]
v_mfma_f32_16x16x32_bf16 v[108:111], a[224:227], a[164:167], v[108:111]
s_waitcnt lgkmcnt(4)
v_mfma_f32_16x16x32_bf16 v[124:127], a[232:235], a[164:167], v[124:127]
ds_read_b64_tr_b16 a[224:225], v216 offset:23552
ds_read_b64_tr_b16 a[226:227], v218 offset:23552
v_mfma_f32_16x16x32_bf16 v[124:127], a[236:239], a[180:183], v[124:127]
v_mfma_f32_16x16x32_bf16 v[92:95], a[236:239], a[176:179], v[92:95]
v_mfma_f32_16x16x32_bf16 v[92:95], a[232:235], a[160:163], v[92:95]
v_mfma_f32_16x16x32_bf16 v[60:63], a[232:235], a[156:159], v[60:63]
ds_read_b64_tr_b16 a[228:229], v216 offset:5120
ds_read_b64_tr_b16 a[230:231], v216 offset:25600
v_mfma_f32_16x16x32_bf16 v[60:63], a[236:239], a[172:175], v[60:63]
v_mfma_f32_16x16x32_bf16 v[28:31], a[236:239], a[168:171], v[28:31]
v_mfma_f32_16x16x32_bf16 v[28:31], a[232:235], a[152:155], v[28:31]
s_waitcnt lgkmcnt(4)
s_waitcnt vmcnt(14)
v_mfma_f32_16x16x32_bf16 v[0:3], a[216:219], a[184:187], v[0:3]
ds_read_b64_tr_b16 a[232:233], v217 offset:22528
ds_read_b64_tr_b16 a[234:235], v219 offset:22528
v_mfma_f32_16x16x32_bf16 v[0:3], a[220:223], a[200:203], v[0:3]
v_mfma_f32_16x16x32_bf16 v[32:35], a[220:223], a[204:207], v[32:35]
buffer_load_dwordx4 a[152:155], v250, s[16:19], s33 offen offset:3072 sc1
v_mfma_f32_16x16x32_bf16 v[32:35], a[216:219], a[188:191], v[32:35]
v_mfma_f32_16x16x32_bf16 v[64:67], a[216:219], a[192:195], v[64:67]
ds_read_b64_tr_b16 a[236:237], v217 offset:4096
ds_read_b64_tr_b16 a[238:239], v217 offset:24576
v_mfma_f32_16x16x32_bf16 v[64:67], a[220:223], a[208:211], v[64:67]
v_mfma_f32_16x16x32_bf16 v[96:99], a[220:223], a[212:215], v[96:99]
s_add_u32 s34, s81, 39936
buffer_load_dwordx4 a[156:159], v250, s[16:19], s34 offen offset:0 sc1
v_mfma_f32_16x16x32_bf16 v[96:99], a[216:219], a[196:199], v[96:99]
s_waitcnt lgkmcnt(4)
v_mfma_f32_16x16x32_bf16 v[112:115], a[224:227], a[196:199], v[112:115]
ds_read_b64_tr_b16 a[216:217], v217 offset:23552
ds_read_b64_tr_b16 a[218:219], v219 offset:23552
v_mfma_f32_16x16x32_bf16 v[112:115], a[228:231], a[212:215], v[112:115]
v_mfma_f32_16x16x32_bf16 v[80:83], a[228:231], a[208:211], v[80:83]
s_add_u32 s33, s81, 40960
buffer_load_dwordx4 a[160:163], v250, s[16:19], s33 offen offset:0 sc1
v_mfma_f32_16x16x32_bf16 v[80:83], a[224:227], a[192:195], v[80:83]
v_mfma_f32_16x16x32_bf16 v[48:51], a[224:227], a[188:191], v[48:51]
ds_read_b64_tr_b16 a[220:221], v217 offset:5120
ds_read_b64_tr_b16 a[222:223], v217 offset:25600
v_mfma_f32_16x16x32_bf16 v[48:51], a[228:231], a[204:207], v[48:51]
v_mfma_f32_16x16x32_bf16 v[16:19], a[228:231], a[200:203], v[16:19]
buffer_load_dwordx4 a[164:167], v250, s[16:19], s33 offen offset:1024 sc1
v_mfma_f32_16x16x32_bf16 v[16:19], a[224:227], a[184:187], v[16:19]
s_waitcnt lgkmcnt(4)
v_mfma_f32_16x16x32_bf16 v[4:7], a[232:235], a[184:187], v[4:7]
ds_read_b64_tr_b16 a[224:225], v216 offset:23040
ds_read_b64_tr_b16 a[226:227], v218 offset:23040
v_mfma_f32_16x16x32_bf16 v[4:7], a[236:239], a[200:203], v[4:7]
v_mfma_f32_16x16x32_bf16 v[36:39], a[236:239], a[204:207], v[36:39]
buffer_load_dwordx4 a[168:171], v250, s[16:19], s33 offen offset:2048 sc1
v_mfma_f32_16x16x32_bf16 v[36:39], a[232:235], a[188:191], v[36:39]
v_mfma_f32_16x16x32_bf16 v[68:71], a[232:235], a[192:195], v[68:71]
ds_read_b64_tr_b16 a[228:229], v216 offset:4608
ds_read_b64_tr_b16 a[230:231], v216 offset:25088
v_mfma_f32_16x16x32_bf16 v[68:71], a[236:239], a[208:211], v[68:71]
v_fma_f32 v0, v0, v208, v140
v_fma_f32 v1, v1, v208, v141
v_mfma_f32_16x16x32_bf16 v[100:103], a[236:239], a[212:215], v[100:103]
buffer_load_dwordx4 a[172:175], v250, s[16:19], s33 offen offset:3072 sc1
v_fma_f32 v2, v2, v208, v142
v_mfma_f32_16x16x32_bf16 v[100:103], a[232:235], a[196:199], v[100:103]
s_waitcnt lgkmcnt(4)
v_fma_f32 v3, v3, v208, v143
v_fma_f32 v16, v16, v208, v172
v_mfma_f32_16x16x32_bf16 v[116:119], a[216:219], a[196:199], v[116:119]
ds_read_b64_tr_b16 a[232:233], v216 offset:24064
ds_read_b64_tr_b16 a[234:235], v218 offset:24064
v_mfma_f32_16x16x32_bf16 v[116:119], a[220:223], a[212:215], v[116:119]
v_fma_f32 v17, v17, v208, v173
v_fma_f32 v18, v18, v208, v174
v_mfma_f32_16x16x32_bf16 v[84:87], a[220:223], a[208:211], v[84:87]
s_add_u32 s34, s81, 45056
buffer_load_dwordx4 a[176:179], v250, s[16:19], s34 offen offset:0 sc1
v_fma_f32 v19, v19, v208, v175
v_mfma_f32_16x16x32_bf16 v[84:87], a[216:219], a[192:195], v[84:87]
v_max_f32 v0, 0, v0
v_max_f32 v1, 0, v1
v_mfma_f32_16x16x32_bf16 v[52:55], a[216:219], a[188:191], v[52:55]
ds_read_b64_tr_b16 a[236:237], v216 offset:5632
ds_read_b64_tr_b16 a[238:239], v216 offset:26112
v_mfma_f32_16x16x32_bf16 v[52:55], a[220:223], a[204:207], v[52:55]
v_max_f32 v2, 0, v2
v_max_f32 v3, 0, v3
v_mfma_f32_16x16x32_bf16 v[20:23], a[220:223], a[200:203], v[20:23]
v_mul_f32 v0, v0, v16
v_mul_f32 v1, v1, v17
v_mfma_f32_16x16x32_bf16 v[20:23], a[216:219], a[184:187], v[20:23]
s_waitcnt lgkmcnt(4)
v_mul_f32 v2, v2, v18
v_mul_f32 v3, v3, v19
v_mfma_f32_16x16x32_bf16 v[8:11], a[224:227], a[184:187], v[8:11]
ds_read_b64_tr_b16 a[216:217], v217 offset:23040
ds_read_b64_tr_b16 a[218:219], v219 offset:23040
v_mfma_f32_16x16x32_bf16 v[8:11], a[228:231], a[200:203], v[8:11]
v_cvt_pk_bf16_f32 v228, v0, v1
v_cvt_pk_bf16_f32 v229, v2, v3
v_mfma_f32_16x16x32_bf16 v[40:43], a[228:231], a[204:207], v[40:43]
s_add_u32 s33, s81, 46080
buffer_load_dwordx4 a[180:183], v250, s[16:19], s33 offen offset:0 sc1
v_fma_f32 v32, v32, v210, v140
v_mfma_f32_16x16x32_bf16 v[40:43], a[224:227], a[188:191], v[40:43]
v_fma_f32 v33, v33, v210, v141
v_fma_f32 v34, v34, v210, v142
v_mfma_f32_16x16x32_bf16 v[72:75], a[224:227], a[192:195], v[72:75]
ds_read_b64_tr_b16 a[220:221], v217 offset:4608
ds_read_b64_tr_b16 a[222:223], v217 offset:25088
v_mfma_f32_16x16x32_bf16 v[72:75], a[228:231], a[208:211], v[72:75]
v_fma_f32 v35, v35, v210, v143
v_fma_f32 v48, v48, v210, v172
v_mfma_f32_16x16x32_bf16 v[104:107], a[228:231], a[212:215], v[104:107]
v_fma_f32 v49, v49, v210, v173
v_fma_f32 v50, v50, v210, v174
v_mfma_f32_16x16x32_bf16 v[104:107], a[224:227], a[196:199], v[104:107]
s_waitcnt lgkmcnt(4)
v_fma_f32 v51, v51, v210, v175
v_max_f32 v32, 0, v32
v_mfma_f32_16x16x32_bf16 v[120:123], a[232:235], a[196:199], v[120:123]
ds_read_b64_tr_b16 a[224:225], v217 offset:24064
ds_read_b64_tr_b16 a[226:227], v219 offset:24064
v_mfma_f32_16x16x32_bf16 v[120:123], a[236:239], a[212:215], v[120:123]
v_max_f32 v33, 0, v33
v_max_f32 v34, 0, v34
v_mfma_f32_16x16x32_bf16 v[88:91], a[236:239], a[208:211], v[88:91]
v_max_f32 v35, 0, v35
v_mul_f32 v32, v32, v48
v_mfma_f32_16x16x32_bf16 v[88:91], a[232:235], a[192:195], v[88:91]
v_mul_f32 v33, v33, v49
v_mul_f32 v34, v34, v50
v_mfma_f32_16x16x32_bf16 v[56:59], a[232:235], a[188:191], v[56:59]
ds_read_b64_tr_b16 a[228:229], v217 offset:5632
ds_read_b64_tr_b16 a[230:231], v217 offset:26112
v_mfma_f32_16x16x32_bf16 v[56:59], a[236:239], a[204:207], v[56:59]
v_mul_f32 v35, v35, v51
v_cvt_pk_bf16_f32 v232, v32, v33
v_mfma_f32_16x16x32_bf16 v[24:27], a[236:239], a[200:203], v[24:27]
v_cvt_pk_bf16_f32 v233, v34, v35
v_mfma_f32_16x16x32_bf16 v[24:27], a[232:235], a[184:187], v[24:27]
s_waitcnt lgkmcnt(4)
v_mfma_f32_16x16x32_bf16 v[12:15], a[216:219], a[184:187], v[12:15]
v_fma_f32 v4, v4, v208, v148
v_fma_f32 v5, v5, v208, v149
v_mfma_f32_16x16x32_bf16 v[12:15], a[220:223], a[200:203], v[12:15]
v_fma_f32 v6, v6, v208, v150
v_fma_f32 v7, v7, v208, v151
v_mfma_f32_16x16x32_bf16 v[44:47], a[220:223], a[204:207], v[44:47]
v_fma_f32 v20, v20, v208, v180
v_fma_f32 v21, v21, v208, v181
v_mfma_f32_16x16x32_bf16 v[44:47], a[216:219], a[188:191], v[44:47]
v_fma_f32 v22, v22, v208, v182
v_fma_f32 v23, v23, v208, v183
v_mfma_f32_16x16x32_bf16 v[76:79], a[216:219], a[192:195], v[76:79]
v_max_f32 v4, 0, v4
v_max_f32 v5, 0, v5
v_mfma_f32_16x16x32_bf16 v[76:79], a[220:223], a[208:211], v[76:79]
v_max_f32 v6, 0, v6
v_max_f32 v7, 0, v7
v_mfma_f32_16x16x32_bf16 v[108:111], a[220:223], a[212:215], v[108:111]
v_mul_f32 v4, v4, v20
v_mul_f32 v5, v5, v21
v_mfma_f32_16x16x32_bf16 v[108:111], a[216:219], a[196:199], v[108:111]
s_waitcnt lgkmcnt(0)
v_mul_f32 v6, v6, v22
v_mul_f32 v7, v7, v23
v_mfma_f32_16x16x32_bf16 v[124:127], a[224:227], a[196:199], v[124:127]
v_cvt_pk_bf16_f32 v230, v4, v5
v_cvt_pk_bf16_f32 v231, v6, v7
v_mfma_f32_16x16x32_bf16 v[124:127], a[228:231], a[212:215], v[124:127]
buffer_store_dwordx4 v[228:231], v250, s[16:19], s41 offen offset:0 sc1
v_fma_f32 v36, v36, v210, v148
v_mfma_f32_16x16x32_bf16 v[92:95], a[228:231], a[208:211], v[92:95]
v_fma_f32 v37, v37, v210, v149
v_fma_f32 v38, v38, v210, v150
v_mfma_f32_16x16x32_bf16 v[92:95], a[224:227], a[192:195], v[92:95]
v_fma_f32 v39, v39, v210, v151
v_fma_f32 v52, v52, v210, v180
v_mfma_f32_16x16x32_bf16 v[60:63], a[224:227], a[188:191], v[60:63]
v_fma_f32 v53, v53, v210, v181
v_fma_f32 v54, v54, v210, v182
v_mfma_f32_16x16x32_bf16 v[60:63], a[228:231], a[204:207], v[60:63]
v_fma_f32 v55, v55, v210, v183
v_max_f32 v36, 0, v36
v_mfma_f32_16x16x32_bf16 v[28:31], a[228:231], a[200:203], v[28:31]
v_max_f32 v37, 0, v37
v_max_f32 v38, 0, v38
v_mfma_f32_16x16x32_bf16 v[28:31], a[224:227], a[184:187], v[28:31]
v_max_f32 v39, 0, v39
v_mul_f32 v36, v36, v52
v_mul_f32 v37, v37, v53
v_mul_f32 v38, v38, v54
v_mul_f32 v39, v39, v55
v_cvt_pk_bf16_f32 v234, v36, v37
v_cvt_pk_bf16_f32 v235, v38, v39
buffer_store_dwordx4 v[232:235], v250, s[16:19], s41 offen offset:1024 sc1
v_pk_fma_f32 v[64:65], v[64:65], v[212:213], v[140:141] op_sel_hi:[1,0,1]
v_pk_fma_f32 v[66:67], v[66:67], v[212:213], v[142:143] op_sel_hi:[1,0,1]
v_pk_fma_f32 v[80:81], v[80:81], v[212:213], v[172:173] op_sel_hi:[1,0,1]
v_pk_fma_f32 v[82:83], v[82:83], v[212:213], v[174:175] op_sel_hi:[1,0,1]
v_max_f32 v64, 0, v64
v_max_f32 v65, 0, v65
v_max_f32 v66, 0, v66
v_max_f32 v67, 0, v67
v_pk_mul_f32 v[64:65], v[64:65], v[80:81]
v_pk_mul_f32 v[66:67], v[66:67], v[82:83]
v_cvt_pk_bf16_f32 v236, v64, v65
v_cvt_pk_bf16_f32 v237, v66, v67
v_pk_fma_f32 v[68:69], v[68:69], v[212:213], v[148:149] op_sel_hi:[1,0,1]
v_pk_fma_f32 v[70:71], v[70:71], v[212:213], v[150:151] op_sel_hi:[1,0,1]
v_pk_fma_f32 v[84:85], v[84:85], v[212:213], v[180:181] op_sel_hi:[1,0,1]
v_pk_fma_f32 v[86:87], v[86:87], v[212:213], v[182:183] op_sel_hi:[1,0,1]
v_max_f32 v68, 0, v68
v_max_f32 v69, 0, v69
v_max_f32 v70, 0, v70
v_max_f32 v71, 0, v71
v_pk_mul_f32 v[68:69], v[68:69], v[84:85]
v_pk_mul_f32 v[70:71], v[70:71], v[86:87]
v_cvt_pk_bf16_f32 v238, v68, v69
v_cvt_pk_bf16_f32 v239, v70, v71
buffer_store_dwordx4 v[236:239], v250, s[16:19], s41 offen offset:2048 sc1
v_pk_fma_f32 v[96:97], v[96:97], v[214:215], v[140:141] op_sel_hi:[1,0,1]
v_pk_fma_f32 v[98:99], v[98:99], v[214:215], v[142:143] op_sel_hi:[1,0,1]
v_pk_fma_f32 v[112:113], v[112:113], v[214:215], v[172:173] op_sel_hi:[1,0,1]
v_pk_fma_f32 v[114:115], v[114:115], v[214:215], v[174:175] op_sel_hi:[1,0,1]
v_max_f32 v96, 0, v96
v_max_f32 v97, 0, v97
v_max_f32 v98, 0, v98
v_max_f32 v99, 0, v99
v_pk_mul_f32 v[96:97], v[96:97], v[112:113]
v_pk_mul_f32 v[98:99], v[98:99], v[114:115]
v_cvt_pk_bf16_f32 v240, v96, v97
v_cvt_pk_bf16_f32 v241, v98, v99
v_pk_fma_f32 v[100:101], v[100:101], v[214:215], v[148:149] op_sel_hi:[1,0,1]
v_pk_fma_f32 v[102:103], v[102:103], v[214:215], v[150:151] op_sel_hi:[1,0,1]
v_pk_fma_f32 v[116:117], v[116:117], v[214:215], v[180:181] op_sel_hi:[1,0,1]
v_pk_fma_f32 v[118:119], v[118:119], v[214:215], v[182:183] op_sel_hi:[1,0,1]
v_max_f32 v100, 0, v100
v_max_f32 v101, 0, v101
v_max_f32 v102, 0, v102
v_max_f32 v103, 0, v103
v_pk_mul_f32 v[100:101], v[100:101], v[116:117]
v_pk_mul_f32 v[102:103], v[102:103], v[118:119]
v_cvt_pk_bf16_f32 v242, v100, v101
v_cvt_pk_bf16_f32 v243, v102, v103
buffer_store_dwordx4 v[240:243], v250, s[16:19], s41 offen offset:3072 sc1
v_pk_fma_f32 v[8:9], v[8:9], v[208:209], v[156:157] op_sel_hi:[1,0,1]
v_pk_fma_f32 v[10:11], v[10:11], v[208:209], v[158:159] op_sel_hi:[1,0,1]
v_pk_fma_f32 v[24:25], v[24:25], v[208:209], v[188:189] op_sel_hi:[1,0,1]
v_pk_fma_f32 v[26:27], v[26:27], v[208:209], v[190:191] op_sel_hi:[1,0,1]
v_max_f32 v8, 0, v8
v_max_f32 v9, 0, v9
v_max_f32 v10, 0, v10
v_max_f32 v11, 0, v11
v_pk_mul_f32 v[8:9], v[8:9], v[24:25]
v_pk_mul_f32 v[10:11], v[10:11], v[26:27]
v_cvt_pk_bf16_f32 v228, v8, v9
v_cvt_pk_bf16_f32 v229, v10, v11
v_pk_fma_f32 v[12:13], v[12:13], v[208:209], v[164:165] op_sel_hi:[1,0,1]
v_pk_fma_f32 v[14:15], v[14:15], v[208:209], v[166:167] op_sel_hi:[1,0,1]
v_pk_fma_f32 v[28:29], v[28:29], v[208:209], v[196:197] op_sel_hi:[1,0,1]
v_pk_fma_f32 v[30:31], v[30:31], v[208:209], v[198:199] op_sel_hi:[1,0,1]
v_max_f32 v12, 0, v12
v_max_f32 v13, 0, v13
v_max_f32 v14, 0, v14
v_max_f32 v15, 0, v15
v_pk_mul_f32 v[12:13], v[12:13], v[28:29]
v_pk_mul_f32 v[14:15], v[14:15], v[30:31]
v_cvt_pk_bf16_f32 v230, v12, v13
v_cvt_pk_bf16_f32 v231, v14, v15
buffer_store_dwordx4 v[228:231], v250, s[16:19], s43 offen offset:0 sc1
v_pk_fma_f32 v[40:41], v[40:41], v[210:211], v[156:157] op_sel_hi:[1,0,1]
v_pk_fma_f32 v[42:43], v[42:43], v[210:211], v[158:159] op_sel_hi:[1,0,1]
v_pk_fma_f32 v[56:57], v[56:57], v[210:211], v[188:189] op_sel_hi:[1,0,1]
v_pk_fma_f32 v[58:59], v[58:59], v[210:211], v[190:191] op_sel_hi:[1,0,1]
v_max_f32 v40, 0, v40
v_max_f32 v41, 0, v41
v_max_f32 v42, 0, v42
v_max_f32 v43, 0, v43
v_pk_mul_f32 v[40:41], v[40:41], v[56:57]
v_pk_mul_f32 v[42:43], v[42:43], v[58:59]
v_cvt_pk_bf16_f32 v232, v40, v41
v_cvt_pk_bf16_f32 v233, v42, v43
v_pk_fma_f32 v[44:45], v[44:45], v[210:211], v[164:165] op_sel_hi:[1,0,1]
v_pk_fma_f32 v[46:47], v[46:47], v[210:211], v[166:167] op_sel_hi:[1,0,1]
v_pk_fma_f32 v[60:61], v[60:61], v[210:211], v[196:197] op_sel_hi:[1,0,1]
v_pk_fma_f32 v[62:63], v[62:63], v[210:211], v[198:199] op_sel_hi:[1,0,1]
v_max_f32 v44, 0, v44
v_max_f32 v45, 0, v45
v_max_f32 v46, 0, v46
v_max_f32 v47, 0, v47
v_pk_mul_f32 v[44:45], v[44:45], v[60:61]
v_pk_mul_f32 v[46:47], v[46:47], v[62:63]
v_cvt_pk_bf16_f32 v234, v44, v45
v_cvt_pk_bf16_f32 v235, v46, v47
buffer_store_dwordx4 v[232:235], v250, s[16:19], s43 offen offset:1024 sc1
v_pk_fma_f32 v[72:73], v[72:73], v[212:213], v[156:157] op_sel_hi:[1,0,1]
v_pk_fma_f32 v[74:75], v[74:75], v[212:213], v[158:159] op_sel_hi:[1,0,1]
v_pk_fma_f32 v[88:89], v[88:89], v[212:213], v[188:189] op_sel_hi:[1,0,1]
v_pk_fma_f32 v[90:91], v[90:91], v[212:213], v[190:191] op_sel_hi:[1,0,1]
v_max_f32 v72, 0, v72
v_max_f32 v73, 0, v73
v_max_f32 v74, 0, v74
v_max_f32 v75, 0, v75
v_pk_mul_f32 v[72:73], v[72:73], v[88:89]
v_pk_mul_f32 v[74:75], v[74:75], v[90:91]
v_cvt_pk_bf16_f32 v236, v72, v73
v_cvt_pk_bf16_f32 v237, v74, v75
v_pk_fma_f32 v[76:77], v[76:77], v[212:213], v[164:165] op_sel_hi:[1,0,1]
v_pk_fma_f32 v[78:79], v[78:79], v[212:213], v[166:167] op_sel_hi:[1,0,1]
v_pk_fma_f32 v[92:93], v[92:93], v[212:213], v[196:197] op_sel_hi:[1,0,1]
v_pk_fma_f32 v[94:95], v[94:95], v[212:213], v[198:199] op_sel_hi:[1,0,1]
v_max_f32 v76, 0, v76
v_max_f32 v77, 0, v77
v_max_f32 v78, 0, v78
v_max_f32 v79, 0, v79
v_pk_mul_f32 v[76:77], v[76:77], v[92:93]
v_pk_mul_f32 v[78:79], v[78:79], v[94:95]
v_cvt_pk_bf16_f32 v238, v76, v77
v_cvt_pk_bf16_f32 v239, v78, v79
buffer_store_dwordx4 v[236:239], v250, s[16:19], s43 offen offset:2048 sc1
v_pk_fma_f32 v[104:105], v[104:105], v[214:215], v[156:157] op_sel_hi:[1,0,1]
v_pk_fma_f32 v[106:107], v[106:107], v[214:215], v[158:159] op_sel_hi:[1,0,1]
v_pk_fma_f32 v[120:121], v[120:121], v[214:215], v[188:189] op_sel_hi:[1,0,1]
v_pk_fma_f32 v[122:123], v[122:123], v[214:215], v[190:191] op_sel_hi:[1,0,1]
v_max_f32 v104, 0, v104
v_max_f32 v105, 0, v105
v_max_f32 v106, 0, v106
v_max_f32 v107, 0, v107
v_pk_mul_f32 v[104:105], v[104:105], v[120:121]
v_pk_mul_f32 v[106:107], v[106:107], v[122:123]
v_cvt_pk_bf16_f32 v240, v104, v105
v_cvt_pk_bf16_f32 v241, v106, v107
v_pk_fma_f32 v[108:109], v[108:109], v[214:215], v[164:165] op_sel_hi:[1,0,1]
v_pk_fma_f32 v[110:111], v[110:111], v[214:215], v[166:167] op_sel_hi:[1,0,1]
v_pk_fma_f32 v[124:125], v[124:125], v[214:215], v[196:197] op_sel_hi:[1,0,1]
v_pk_fma_f32 v[126:127], v[126:127], v[214:215], v[198:199] op_sel_hi:[1,0,1]
v_max_f32 v108, 0, v108
v_max_f32 v109, 0, v109
v_max_f32 v110, 0, v110
v_max_f32 v111, 0, v111
v_pk_mul_f32 v[108:109], v[108:109], v[124:125]
v_pk_mul_f32 v[110:111], v[110:111], v[126:127]
v_cvt_pk_bf16_f32 v242, v108, v109
v_cvt_pk_bf16_f32 v243, v110, v111
buffer_store_dwordx4 v[240:243], v250, s[16:19], s43 offen offset:3072 sc1
s_mov_b32 s3, s87
s_mul_i32 s35, s72, 54
s_add_u32 s35, s35, s3
s_lshl_b32 s35, s35, 12
s_add_u32 s35, s35, 33554432
v_bfe_u32 v2, v250, 4, 4
v_lshrrev_b32 v3, 8, v250
v_mul_u32_u24 v85, 1280, v2
v_mad_u32_u24 v85, v3, 40, v85
v_mul_u32_u24 v86, 40, v3
s_lshl_b32 s40, s72, 2
s_add_u32 s40, s40, s28
s_mul_i32 s41, s40, 20480
s_mul_i32 s3, s73, 160
s_add_u32 s41, s41, s3
s_add_u32 s37, s3, 2652416
L_m_c2_6:
s_cbranch_execz L_m_c2_ret
s_add_u32 s39, s37, 2560
s_mul_i32 s3, s28, 15360
s_add_u32 s3, s3, 102400
v_lshrrev_b32 v91, 1, v250
v_add_u32 v90, s3, v250
s_add_u32 s3, s28, 0
s_and_b32 s36, s3, 3
s_lshl_b32 s3, s36, 10
v_add_u32 v80, s3, v250
s_add_u32 s3, s28, 1
s_and_b32 s36, s3, 3
s_lshl_b32 s3, s36, 10
v_add_u32 v81, s3, v250
s_mul_i32 s3, s36, 15360
s_add_u32 s3, s3, 102400
v_add_u32 v87, s3, v250
s_add_u32 s3, s28, 2
s_and_b32 s36, s3, 3
s_lshl_b32 s3, s36, 10
v_add_u32 v82, s3, v250
s_mul_i32 s3, s36, 15360
s_add_u32 s3, s3, 107520
v_add_u32 v88, s3, v250
s_add_u32 s3, s28, 3
s_and_b32 s36, s3, 3
s_lshl_b32 s3, s36, 10
v_add_u32 v83, s3, v250
s_mul_i32 s3, s36, 15360
s_add_u32 s3, s3, 112640
v_add_u32 v89, s3, v250
s_mov_b32 s4, s66
s_mov_b32 s5, s67
s_mov_b32 s6, 2621440
s_mov_b32 s7, 0x20000
s_lshr_b32 s3, s87, 1
v_min_u32 v4, 6, v2
v_add_u32 v4, s3, v4
v_lshlrev_b32 v4, 7, v4
s_lshl_b32 s36, s72, 12
s_add_u32 s36, s36, 41156608
s_waitcnt vmcnt(0)
v_mov_b32 v10, 1
s_mov_b64 exec, 1
buffer_store_dword v10, off, s[16:19], s42 sc1
s_mov_b64 exec, -1
buffer_load_dwordx4 a[184:187], v250, s[16:19], s33 offen offset:1024 sc1
buffer_load_dwordx4 a[188:191], v250, s[16:19], s33 offen offset:2048 sc1
buffer_load_dwordx4 a[192:195], v250, s[16:19], s33 offen offset:3072 sc1
s_add_u32 s34, s81, 50176
buffer_load_dwordx4 a[196:199], v250, s[16:19], s34 offen offset:0 sc1
s_add_u32 s33, s81, 51200
buffer_load_dwordx4 a[200:203], v250, s[16:19], s33 offen offset:0 sc1
buffer_load_dwordx4 a[204:207], v250, s[16:19], s33 offen offset:1024 sc1
buffer_load_dwordx4 a[208:211], v250, s[16:19], s33 offen offset:2048 sc1
buffer_load_dwordx4 a[212:215], v250, s[16:19], s33 offen offset:3072 sc1
s_add_u32 s34, s81, 55296
buffer_load_dwordx4 a[216:219], v250, s[16:19], s34 offen offset:0 sc1
s_add_u32 s33, s81, 56320
buffer_load_dwordx4 a[220:223], v250, s[16:19], s33 offen offset:0 sc1
buffer_load_dwordx4 a[224:227], v250, s[16:19], s33 offen offset:1024 sc1
buffer_load_dwordx4 a[228:231], v250, s[16:19], s33 offen offset:2048 sc1
buffer_load_dwordx4 a[232:235], v250, s[16:19], s33 offen offset:3072 sc1
s_add_u32 s34, s81, 60416
buffer_load_dwordx4 a[236:239], v250, s[16:19], s34 offen offset:0 sc1
s_branch L_m_p5
L_m_idle4:
s_cmp_ge_u32 s74, 27
s_cbranch_scc1 L_m_idle5
buffer_load_dwordx4 v[152:155], v224, s[16:19], s37 offen offset:0 sc1
buffer_load_dwordx4 v[156:159], v224, s[16:19], s37 offen offset:640 sc1
buffer_load_dwordx2 v[160:161], v225, s[16:19], s37 offen offset:32 sc1
buffer_load_dwordx2 v[162:163], v225, s[16:19], s37 offen offset:192 sc1
s_add_u32 m0, s90, 81920
s_add_u32 s91, s89, 1105920
buffer_load_dwordx4 v249, s[12:15], s91 offen lds
s_add_u32 m0, s90, 83968
s_add_u32 s91, s89, 1133568
buffer_load_dwordx4 v249, s[12:15], s91 offen lds
s_add_u32 m0, s90, 86016
s_add_u32 s91, s89, 1161216
buffer_load_dwordx4 v249, s[12:15], s91 offen lds
s_add_u32 m0, s90, 88064
s_add_u32 s91, s89, 1188864
buffer_load_dwordx4 v249, s[12:15], s91 offen lds
s_add_u32 m0, s90, 90112
s_add_u32 s91, s89, 1216512
buffer_load_dwordx4 v249, s[12:15], s91 offen lds
s_add_u32 m0, s90, 102400
s_add_u32 s91, s89, 1382400
buffer_load_dwordx4 v249, s[12:15], s91 offen lds
s_add_u32 m0, s90, 104448
s_add_u32 s91, s89, 1410048
buffer_load_dwordx4 v249, s[12:15], s91 offen lds
s_add_u32 m0, s90, 106496
s_add_u32 s91, s89, 1437696
buffer_load_dwordx4 v249, s[12:15], s91 offen lds
s_add_u32 m0, s90, 108544
s_add_u32 s91, s89, 1465344
buffer_load_dwordx4 v249, s[12:15], s91 offen lds
s_add_u32 m0, s90, 110592
s_add_u32 s91, s89, 1492992
buffer_load_dwordx4 v249, s[12:15], s91 offen lds
s_add_u32 m0, s90, 122880
s_add_u32 s91, s89, 1658880
buffer_load_dwordx4 v249, s[12:15], s91 offen lds
s_add_u32 m0, s90, 124928
s_add_u32 s91, s89, 1686528
buffer_load_dwordx4 v249, s[12:15], s91 offen lds
s_add_u32 m0, s90, 126976
s_add_u32 s91, s89, 1714176
buffer_load_dwordx4 v249, s[12:15], s91 offen lds
s_add_u32 m0, s90, 129024
s_add_u32 s91, s89, 1741824
buffer_load_dwordx4 v249, s[12:15], s91 offen lds
s_add_u32 m0, s90, 131072
s_add_u32 s91, s89, 1769472
buffer_load_dwordx4 v249, s[12:15], s91 offen lds
s_add_u32 m0, s90, 143360
s_add_u32 s91, s89, 1935360
buffer_load_dwordx4 v249, s[12:15], s91 offen lds
s_add_u32 m0, s90, 145408
s_add_u32 s91, s89, 1963008
buffer_load_dwordx4 v249, s[12:15], s91 offen lds
s_add_u32 m0, s90, 147456
s_add_u32 s91, s89, 1990656
buffer_load_dwordx4 v249, s[12:15], s91 offen lds
s_add_u32 m0, s90, 149504
s_add_u32 s91, s89, 2018304
buffer_load_dwordx4 v249, s[12:15], s91 offen lds
s_add_u32 m0, s90, 151552
s_add_u32 s91, s89, 2045952
buffer_load_dwordx4 v249, s[12:15], s91 offen lds
v_bfe_u32 v226, v250, 4, 1
v_lshrrev_b32 v227, 8, v250
v_lshlrev_b32 v227, 4, v227
v_lshl_add_u32 v226, v226, 9, v227
s_lshl_b32 s3, s28, 7
s_add_u32 s86, s86, s3
s_add_u32 s88, s88, s3
s_waitcnt vmcnt(0)
s_barrier
ds_read_b64_tr_b16 a[204:205], v220 offset:0
ds_read_b64_tr_b16 a[206:207], v222 offset:0
ds_read_b64_tr_b16 a[208:209], v221 offset:0
ds_read_b64_tr_b16 a[210:211], v223 offset:0
ds_read_b64_tr_b16 a[212:213], v220 offset:2048
ds_read_b64_tr_b16 a[214:215], v222 offset:2048
ds_read_b64_tr_b16 a[216:217], v221 offset:2048
ds_read_b64_tr_b16 a[218:219], v223 offset:2048
ds_read_b64_tr_b16 a[220:221], v220 offset:20480
ds_read_b64_tr_b16 a[222:223], v222 offset:20480
ds_read_b64_tr_b16 a[224:225], v221 offset:20480
ds_read_b64_tr_b16 a[226:227], v223 offset:20480
s_waitcnt lgkmcnt(8)
s_nop 0
v_mfma_f32_16x16x32_bf16 v[128:131], a[204:207], v[152:155], 0
v_mfma_f32_16x16x32_bf16 v[132:135], a[208:211], v[152:155], 0
ds_read_b64_tr_b16 a[228:229], v220 offset:22528
ds_read_b64_tr_b16 a[230:231], v222 offset:22528
ds_read_b64_tr_b16 a[232:233], v221 offset:22528
ds_read_b64_tr_b16 a[234:235], v223 offset:22528
v_mov_b32 v164, v152 row_shl:2
v_mov_b32 v165, v153 row_shl:2
v_mov_b32 v166, v154 row_shl:2
v_mov_b32 v167, v155 row_shl:2
s_waitcnt lgkmcnt(8)
s_nop 0
v_mfma_f32_16x16x32_bf16 v[128:131], a[212:215], v[164:167], v[128:131]
v_mfma_f32_16x16x32_bf16 v[132:135], a[216:219], v[164:167], v[132:135]
ds_read_b64_tr_b16 a[204:205], v220 offset:4096
ds_read_b64_tr_b16 a[206:207], v220 offset:24576
ds_read_b64_tr_b16 a[208:209], v221 offset:4096
ds_read_b64_tr_b16 a[210:211], v221 offset:24576
v_mov_b32 v164, v152 row_shl:4
v_mov_b32 v165, v153 row_shl:4
v_mov_b32 v166, v154 row_shl:4
v_mov_b32 v167, v155 row_shl:4
s_waitcnt lgkmcnt(8)
s_nop 0
v_mfma_f32_16x16x32_bf16 v[128:131], a[220:223], v[164:167], v[128:131]
v_mfma_f32_16x16x32_bf16 v[132:135], a[224:227], v[164:167], v[132:135]
v_add_u32 v220, 40960, v220
v_add_u32 v221, 40960, v221
v_add_u32 v222, 40960, v222
v_add_u32 v223, 40960, v223
ds_read_b64_tr_b16 a[212:213], v220 offset:0
ds_read_b64_tr_b16 a[214:215], v222 offset:0
ds_read_b64_tr_b16 a[216:217], v221 offset:0
ds_read_b64_tr_b16 a[218:219], v223 offset:0
v_mov_b32 v164, v152 row_shl:6
v_mov_b32 v165, v153 row_shl:6
v_mov_b32 v166, v154 row_shl:6
v_mov_b32 v167, v155 row_shl:6
s_waitcnt lgkmcnt(8)
s_nop 0
v_mfma_f32_16x16x32_bf16 v[128:131], a[228:231], v[164:167], v[128:131]
v_mfma_f32_16x16x32_bf16 v[132:135], a[232:235], v[164:167], v[132:135]
ds_read_b64_tr_b16 a[220:221], v220 offset:2048
ds_read_b64_tr_b16 a[222:223], v222 offset:2048
ds_read_b64_tr_b16 a[224:225], v221 offset:2048
ds_read_b64_tr_b16 a[226:227], v223 offset:2048
s_waitcnt lgkmcnt(8)
s_nop 0
v_mfma_f32_16x16x32_bf16 v[128:131], a[204:207], v[160:163], v[128:131]
v_mfma_f32_16x16x32_bf16 v[132:135], a[208:211], v[160:163], v[132:135]
ds_read_b64_tr_b16 a[228:229], v220 offset:20480
ds_read_b64_tr_b16 a[230:231], v222 offset:20480
ds_read_b64_tr_b16 a[232:233], v221 offset:20480
ds_read_b64_tr_b16 a[234:235], v223 offset:20480
v_mov_b32 v164, v152 row_shl:8
v_mov_b32 v165, v153 row_shl:8
v_mov_b32 v166, v154 row_shl:8
v_mov_b32 v167, v155 row_shl:8
s_waitcnt lgkmcnt(8)
s_nop 0
v_mfma_f32_16x16x32_bf16 v[128:131], a[212:215], v[164:167], v[128:131]
v_mfma_f32_16x16x32_bf16 v[132:135], a[216:219], v[164:167], v[132:135]
ds_read_b64_tr_b16 a[204:205], v220 offset:22528
ds_read_b64_tr_b16 a[206:207], v222 offset:22528
ds_read_b64_tr_b16 a[208:209], v221 offset:22528
ds_read_b64_tr_b16 a[210:211], v223 offset:22528
v_mov_b32 v164, v152 row_shl:10
v_mov_b32 v165, v153 row_shl:10
v_mov_b32 v166, v154 row_shl:10
v_mov_b32 v167, v155 row_shl:10
s_waitcnt lgkmcnt(8)
s_nop 0
v_mfma_f32_16x16x32_bf16 v[128:131], a[220:223], v[164:167], v[128:131]
v_mfma_f32_16x16x32_bf16 v[132:135], a[224:227], v[164:167], v[132:135]
ds_read_b64_tr_b16 a[212:213], v220 offset:4096
ds_read_b64_tr_b16 a[214:215], v220 offset:24576
ds_read_b64_tr_b16 a[216:217], v221 offset:4096
ds_read_b64_tr_b16 a[218:219], v221 offset:24576
v_mov_b32 v164, v152 row_shl:12
v_mov_b32 v165, v153 row_shl:12
v_mov_b32 v166, v154 row_shl:12
v_mov_b32 v167, v155 row_shl:12
s_waitcnt lgkmcnt(8)
s_nop 0
v_mfma_f32_16x16x32_bf16 v[128:131], a[228:231], v[164:167], v[128:131]
v_mfma_f32_16x16x32_bf16 v[132:135], a[232:235], v[164:167], v[132:135]
v_add_u32 v220, 40960, v220
v_add_u32 v221, 40960, v221
v_add_u32 v222, 40960, v222
v_add_u32 v223, 40960, v223
ds_read_b64_tr_b16 a[220:221], v220 offset:0
ds_read_b64_tr_b16 a[222:223], v222 offset:0
ds_read_b64_tr_b16 a[224:225], v221 offset:0
ds_read_b64_tr_b16 a[226:227], v223 offset:0
v_mov_b32 v164, v152 row_shl:14
v_mov_b32 v165, v153 row_shl:14
v_mov_b32 v166, v154 row_shl:14
v_mov_b32 v167, v155 row_shl:14
s_waitcnt lgkmcnt(8)
s_nop 0
v_mfma_f32_16x16x32_bf16 v[128:131], a[204:207], v[164:167], v[128:131]
v_mfma_f32_16x16x32_bf16 v[132:135], a[208:211], v[164:167], v[132:135]
ds_read_b64_tr_b16 a[228:229], v220 offset:2048
ds_read_b64_tr_b16 a[230:231], v222 offset:2048
ds_read_b64_tr_b16 a[232:233], v221 offset:2048
ds_read_b64_tr_b16 a[234:235], v223 offset:2048
v_mov_b32 v164, v160 row_shl:2
v_mov_b32 v165, v161 row_shl:2
v_mov_b32 v166, v162 row_shl:2
v_mov_b32 v167, v163 row_shl:2
s_waitcnt lgkmcnt(8)
s_nop 0
v_mfma_f32_16x16x32_bf16 v[128:131], a[212:215], v[164:167], v[128:131]
v_mfma_f32_16x16x32_bf16 v[132:135], a[216:219], v[164:167], v[132:135]
ds_read_b64_tr_b16 a[204:205], v220 offset:20480
ds_read_b64_tr_b16 a[206:207], v222 offset:20480
ds_read_b64_tr_b16 a[208:209], v221 offset:20480
ds_read_b64_tr_b16 a[210:211], v223 offset:20480
s_waitcnt lgkmcnt(8)
s_nop 0
v_mfma_f32_16x16x32_bf16 v[128:131], a[220:223], v[156:159], v[128:131]
v_mfma_f32_16x16x32_bf16 v[132:135], a[224:227], v[156:159], v[132:135]
ds_read_b64_tr_b16 a[212:213], v220 offset:22528
ds_read_b64_tr_b16 a[214:215], v222 offset:22528
ds_read_b64_tr_b16 a[216:217], v221 offset:22528
ds_read_b64_tr_b16 a[218:219], v223 offset:22528
v_mov_b32 v164, v156 row_shl:2
v_mov_b32 v165, v157 row_shl:2
v_mov_b32 v166, v158 row_shl:2
v_mov_b32 v167, v159 row_shl:2
s_waitcnt lgkmcnt(8)
s_nop 0
v_mfma_f32_16x16x32_bf16 v[128:131], a[228:231], v[164:167], v[128:131]
v_mfma_f32_16x16x32_bf16 v[132:135], a[232:235], v[164:167], v[132:135]
ds_read_b64_tr_b16 a[220:221], v220 offset:4096
ds_read_b64_tr_b16 a[222:223], v220 offset:24576
ds_read_b64_tr_b16 a[224:225], v221 offset:4096
ds_read_b64_tr_b16 a[226:227], v221 offset:24576
v_mov_b32 v164, v156 row_shl:4
v_mov_b32 v165, v157 row_shl:4
v_mov_b32 v166, v158 row_shl:4
v_mov_b32 v167, v159 row_shl:4
s_waitcnt lgkmcnt(8)
s_nop 0
v_mfma_f32_16x16x32_bf16 v[128:131], a[204:207], v[164:167], v[128:131]
v_mfma_f32_16x16x32_bf16 v[132:135], a[208:211], v[164:167], v[132:135]
v_add_u32 v220, 40960, v220
v_add_u32 v221, 40960, v221
v_add_u32 v222, 40960, v222
v_add_u32 v223, 40960, v223
ds_read_b64_tr_b16 a[228:229], v220 offset:0
ds_read_b64_tr_b16 a[230:231], v222 offset:0
ds_read_b64_tr_b16 a[232:233], v221 offset:0
ds_read_b64_tr_b16 a[234:235], v223 offset:0
v_mov_b32 v164, v156 row_shl:6
v_mov_b32 v165, v157 row_shl:6
v_mov_b32 v166, v158 row_shl:6
v_mov_b32 v167, v159 row_shl:6
s_waitcnt lgkmcnt(8)
s_nop 0
v_mfma_f32_16x16x32_bf16 v[128:131], a[212:215], v[164:167], v[128:131]
v_mfma_f32_16x16x32_bf16 v[132:135], a[216:219], v[164:167], v[132:135]
ds_read_b64_tr_b16 a[204:205], v220 offset:2048
ds_read_b64_tr_b16 a[206:207], v222 offset:2048
ds_read_b64_tr_b16 a[208:209], v221 offset:2048
ds_read_b64_tr_b16 a[210:211], v223 offset:2048
v_mov_b32 v164, v160 row_shl:4
v_mov_b32 v165, v161 row_shl:4
v_mov_b32 v166, v162 row_shl:4
v_mov_b32 v167, v163 row_shl:4
s_waitcnt lgkmcnt(8)
s_nop 0
v_mfma_f32_16x16x32_bf16 v[128:131], a[220:223], v[164:167], v[128:131]
v_mfma_f32_16x16x32_bf16 v[132:135], a[224:227], v[164:167], v[132:135]
ds_read_b64_tr_b16 a[212:213], v220 offset:20480
ds_read_b64_tr_b16 a[214:215], v222 offset:20480
ds_read_b64_tr_b16 a[216:217], v221 offset:20480
ds_read_b64_tr_b16 a[218:219], v223 offset:20480
v_mov_b32 v164, v156 row_shl:8
v_mov_b32 v165, v157 row_shl:8
v_mov_b32 v166, v158 row_shl:8
v_mov_b32 v167, v159 row_shl:8
s_waitcnt lgkmcnt(8)
s_nop 0
v_mfma_f32_16x16x32_bf16 v[128:131], a[228:231], v[164:167], v[128:131]
v_mfma_f32_16x16x32_bf16 v[132:135], a[232:235], v[164:167], v[132:135]
ds_read_b64_tr_b16 a[220:221], v220 offset:22528
ds_read_b64_tr_b16 a[222:223], v222 offset:22528
ds_read_b64_tr_b16 a[224:225], v221 offset:22528
ds_read_b64_tr_b16 a[226:227], v223 offset:22528
v_mov_b32 v164, v156 row_shl:10
v_mov_b32 v165, v157 row_shl:10
v_mov_b32 v166, v158 row_shl:10
v_mov_b32 v167, v159 row_shl:10
s_waitcnt lgkmcnt(8)
s_nop 0
v_mfma_f32_16x16x32_bf16 v[128:131], a[204:207], v[164:167], v[128:131]
v_mfma_f32_16x16x32_bf16 v[132:135], a[208:211], v[164:167], v[132:135]
ds_read_b64_tr_b16 a[228:229], v220 offset:4096
ds_read_b64_tr_b16 a[230:231], v220 offset:24576
ds_read_b64_tr_b16 a[232:233], v221 offset:4096
ds_read_b64_tr_b16 a[234:235], v221 offset:24576
v_mov_b32 v164, v156 row_shl:12
v_mov_b32 v165, v157 row_shl:12
v_mov_b32 v166, v158 row_shl:12
v_mov_b32 v167, v159 row_shl:12
s_waitcnt lgkmcnt(8)
s_nop 0
v_mfma_f32_16x16x32_bf16 v[128:131], a[212:215], v[164:167], v[128:131]
v_mfma_f32_16x16x32_bf16 v[132:135], a[216:219], v[164:167], v[132:135]
v_mov_b32 v164, v156 row_shl:14
v_mov_b32 v165, v157 row_shl:14
v_mov_b32 v166, v158 row_shl:14
v_mov_b32 v167, v159 row_shl:14
s_waitcnt lgkmcnt(4)
s_nop 0
v_mfma_f32_16x16x32_bf16 v[128:131], a[220:223], v[164:167], v[128:131]
v_mfma_f32_16x16x32_bf16 v[132:135], a[224:227], v[164:167], v[132:135]
v_mov_b32 v164, v160 row_shl:6
v_mov_b32 v165, v161 row_shl:6
v_mov_b32 v166, v162 row_shl:6
v_mov_b32 v167, v163 row_shl:6
s_waitcnt lgkmcnt(0)
s_nop 0
v_mfma_f32_16x16x32_bf16 v[128:131], a[228:231], v[164:167], v[128:131]
v_mfma_f32_16x16x32_bf16 v[132:135], a[232:235], v[164:167], v[132:135]
s_nop 7
s_mov_b32 exec_lo, 0x30003
s_mov_b32 exec_hi, 0x30003
buffer_store_dwordx4 v[128:131], v226, s[16:19], s86 offen sc1
buffer_store_dwordx4 v[132:135], v226, s[16:19], s86 offen offset:64 sc1
s_mov_b64 exec, -1
s_waitcnt vmcnt(0)
v_mov_b32 v10, 1
s_mov_b64 exec, 1
buffer_store_dword v10, off, s[16:19], s88 sc1
s_mov_b64 exec, -1
L_m_idle5:
s_mov_b32 s3, s87
s_mul_i32 s35, s72, 54
s_add_u32 s35, s35, s3
s_lshl_b32 s35, s35, 12
s_add_u32 s35, s35, 33554432
v_bfe_u32 v2, v250, 4, 4
v_lshrrev_b32 v3, 8, v250
v_mul_u32_u24 v85, 1280, v2
v_mad_u32_u24 v85, v3, 40, v85
v_mul_u32_u24 v86, 40, v3
s_lshl_b32 s40, s72, 2
s_add_u32 s40, s40, s28
s_mul_i32 s41, s40, 20480
s_mul_i32 s3, s73, 160
s_add_u32 s41, s41, s3
s_add_u32 s37, s3, 2652416
s_add_u32 s39, s37, 2560
s_mul_i32 s3, s28, 15360
s_add_u32 s3, s3, 102400
v_lshrrev_b32 v91, 1, v250
v_add_u32 v90, s3, v250
s_add_u32 s3, s28, 0
s_and_b32 s36, s3, 3
s_lshl_b32 s3, s36, 10
v_add_u32 v80, s3, v250
s_add_u32 s3, s28, 1
s_and_b32 s36, s3, 3
s_lshl_b32 s3, s36, 10
v_add_u32 v81, s3, v250
s_mul_i32 s3, s36, 15360
s_add_u32 s3, s3, 102400
v_add_u32 v87, s3, v250
s_add_u32 s3, s28, 2
s_and_b32 s36, s3, 3
s_lshl_b32 s3, s36, 10
v_add_u32 v82, s3, v250
s_mul_i32 s3, s36, 15360
s_add_u32 s3, s3, 107520
v_add_u32 v88, s3, v250
s_add_u32 s3, s28, 3
s_and_b32 s36, s3, 3
s_lshl_b32 s3, s36, 10
v_add_u32 v83, s3, v250
s_mul_i32 s3, s36, 15360
s_add_u32 s3, s3, 112640
v_add_u32 v89, s3, v250
s_mov_b32 s4, s66
s_mov_b32 s5, s67
s_mov_b32 s6, 2621440
s_mov_b32 s7, 0x20000
s_lshr_b32 s3, s87, 1
v_min_u32 v4, 6, v2
v_add_u32 v4, s3, v4
v_lshlrev_b32 v4, 7, v4
s_lshl_b32 s36, s72, 12
s_add_u32 s36, s36, 41156608
s_add_u32 s33, s81, 0
buffer_load_dwordx4 a[0:3], v250, s[16:19], s33 offen offset:0 sc1
buffer_load_dwordx4 a[4:7], v250, s[16:19], s33 offen offset:1024 sc1
buffer_load_dwordx4 a[8:11], v250, s[16:19], s33 offen offset:2048 sc1
buffer_load_dwordx4 a[12:15], v250, s[16:19], s33 offen offset:3072 sc1
s_add_u32 s34, s81, 4096
buffer_load_dwordx4 a[16:19], v250, s[16:19], s34 offen offset:0 sc1
s_waitcnt vmcnt(0)
s_add_u32 s33, s81, 5120
buffer_load_dwordx4 a[20:23], v250, s[16:19], s33 offen offset:0 sc1
buffer_load_dwordx4 a[24:27], v250, s[16:19], s33 offen offset:1024 sc1
buffer_load_dwordx4 a[28:31], v250, s[16:19], s33 offen offset:2048 sc1
buffer_load_dwordx4 a[32:35], v250, s[16:19], s33 offen offset:3072 sc1
s_add_u32 s34, s81, 9216
buffer_load_dwordx4 a[36:39], v250, s[16:19], s34 offen offset:0 sc1
s_waitcnt vmcnt(0)
s_add_u32 s33, s81, 10240
buffer_load_dwordx4 a[40:43], v250, s[16:19], s33 offen offset:0 sc1
buffer_load_dwordx4 a[44:47], v250, s[16:19], s33 offen offset:1024 sc1
buffer_load_dwordx4 a[48:51], v250, s[16:19], s33 offen offset:2048 sc1
buffer_load_dwordx4 a[52:55], v250, s[16:19], s33 offen offset:3072 sc1
s_add_u32 s34, s81, 14336
buffer_load_dwordx4 a[56:59], v250, s[16:19], s34 offen offset:0 sc1
s_waitcnt vmcnt(0)
s_add_u32 s33, s81, 15360
buffer_load_dwordx4 a[60:63], v250, s[16:19], s33 offen offset:0 sc1
buffer_load_dwordx4 a[64:67], v250, s[16:19], s33 offen offset:1024 sc1
buffer_load_dwordx4 a[68:71], v250, s[16:19], s33 offen offset:2048 sc1
buffer_load_dwordx4 a[72:75], v250, s[16:19], s33 offen offset:3072 sc1
s_add_u32 s34, s81, 19456
buffer_load_dwordx4 a[76:79], v250, s[16:19], s34 offen offset:0 sc1
s_waitcnt vmcnt(0)
s_add_u32 s33, s81, 20480
buffer_load_dwordx4 a[80:83], v250, s[16:19], s33 offen offset:0 sc1
buffer_load_dwordx4 a[84:87], v250, s[16:19], s33 offen offset:1024 sc1
buffer_load_dwordx4 a[88:91], v250, s[16:19], s33 offen offset:2048 sc1
buffer_load_dwordx4 a[92:95], v250, s[16:19], s33 offen offset:3072 sc1
s_add_u32 s34, s81, 24576
buffer_load_dwordx4 a[96:99], v250, s[16:19], s34 offen offset:0 sc1
s_waitcnt vmcnt(0)
s_add_u32 s33, s81, 25600
buffer_load_dwordx4 a[100:103], v250, s[16:19], s33 offen offset:0 sc1
buffer_load_dwordx4 a[104:107], v250, s[16:19], s33 offen offset:1024 sc1
buffer_load_dwordx4 a[108:111], v250, s[16:19], s33 offen offset:2048 sc1
buffer_load_dwordx4 a[112:115], v250, s[16:19], s33 offen offset:3072 sc1
s_add_u32 s34, s81, 29696
buffer_load_dwordx4 a[116:119], v250, s[16:19], s34 offen offset:0 sc1
s_waitcnt vmcnt(0)
s_add_u32 s33, s81, 30720
buffer_load_dwordx4 a[120:123], v250, s[16:19], s33 offen offset:0 sc1
buffer_load_dwordx4 a[124:127], v250, s[16:19], s33 offen offset:1024 sc1
buffer_load_dwordx4 a[128:131], v250, s[16:19], s33 offen offset:2048 sc1
buffer_load_dwordx4 a[132:135], v250, s[16:19], s33 offen offset:3072 sc1
s_add_u32 s34, s81, 34816
buffer_load_dwordx4 a[136:139], v250, s[16:19], s34 offen offset:0 sc1
s_waitcnt vmcnt(0)
s_add_u32 s33, s81, 35840
buffer_load_dwordx4 a[140:143], v250, s[16:19], s33 offen offset:0 sc1
buffer_load_dwordx4 a[144:147], v250, s[16:19], s33 offen offset:1024 sc1
buffer_load_dwordx4 a[148:151], v250, s[16:19], s33 offen offset:2048 sc1
buffer_load_dwordx4 a[152:155], v250, s[16:19], s33 offen offset:3072 sc1
s_add_u32 s34, s81, 39936
buffer_load_dwordx4 a[156:159], v250, s[16:19], s34 offen offset:0 sc1
s_waitcnt vmcnt(0)
s_add_u32 s33, s81, 40960
buffer_load_dwordx4 a[160:163], v250, s[16:19], s33 offen offset:0 sc1
buffer_load_dwordx4 a[164:167], v250, s[16:19], s33 offen offset:1024 sc1
buffer_load_dwordx4 a[168:171], v250, s[16:19], s33 offen offset:2048 sc1
buffer_load_dwordx4 a[172:175], v250, s[16:19], s33 offen offset:3072 sc1
s_add_u32 s34, s81, 45056
buffer_load_dwordx4 a[176:179], v250, s[16:19], s34 offen offset:0 sc1
s_waitcnt vmcnt(0)
s_add_u32 s33, s81, 46080
buffer_load_dwordx4 a[180:183], v250, s[16:19], s33 offen offset:0 sc1
buffer_load_dwordx4 a[184:187], v250, s[16:19], s33 offen offset:1024 sc1
buffer_load_dwordx4 a[188:191], v250, s[16:19], s33 offen offset:2048 sc1
buffer_load_dwordx4 a[192:195], v250, s[16:19], s33 offen offset:3072 sc1
s_add_u32 s34, s81, 50176
buffer_load_dwordx4 a[196:199], v250, s[16:19], s34 offen offset:0 sc1
s_waitcnt vmcnt(0)
s_add_u32 s33, s81, 51200
buffer_load_dwordx4 a[200:203], v250, s[16:19], s33 offen offset:0 sc1
buffer_load_dwordx4 a[204:207], v250, s[16:19], s33 offen offset:1024 sc1
buffer_load_dwordx4 a[208:211], v250, s[16:19], s33 offen offset:2048 sc1
buffer_load_dwordx4 a[212:215], v250, s[16:19], s33 offen offset:3072 sc1
s_add_u32 s34, s81, 55296
buffer_load_dwordx4 a[216:219], v250, s[16:19], s34 offen offset:0 sc1
s_waitcnt vmcnt(0)
s_add_u32 s33, s81, 56320
buffer_load_dwordx4 a[220:223], v250, s[16:19], s33 offen offset:0 sc1
buffer_load_dwordx4 a[224:227], v250, s[16:19], s33 offen offset:1024 sc1
buffer_load_dwordx4 a[228:231], v250, s[16:19], s33 offen offset:2048 sc1
buffer_load_dwordx4 a[232:235], v250, s[16:19], s33 offen offset:3072 sc1
s_add_u32 s34, s81, 60416
buffer_load_dwordx4 a[236:239], v250, s[16:19], s34 offen offset:0 sc1
s_waitcnt vmcnt(0)
s_waitcnt vmcnt(30)
L_m_p5:
buffer_load_dwordx4 v[92:95], v86, s[16:19], s37 offen sc1
buffer_load_dwordx4 v[96:99], v86, s[16:19], s37 offen offset:16 sc1
buffer_load_dwordx2 v[100:101], v86, s[16:19], s37 offen offset:32 sc1
s_add_u32 s33, s81, 61440
buffer_load_dwordx4 v[124:127], v250, s[16:19], s33 offen offset:0 sc1
buffer_load_dwordx4 v[128:131], v250, s[16:19], s33 offen offset:1024 sc1
buffer_load_dword v5, v4, s[16:19], s36 offen sc1
buffer_load_dwordx4 v[132:135], v250, s[16:19], s33 offen offset:2048 sc1
buffer_load_dwordx4 v[136:139], v250, s[16:19], s33 offen offset:3072 sc1
s_add_u32 s34, s81, 65536
buffer_load_dwordx4 v[140:143], v250, s[16:19], s34 offen offset:0 sc1
s_add_u32 s33, s81, 66560
buffer_load_dwordx4 v[144:147], v250, s[20:23], s33 offen offset:0 sc1
buffer_load_dwordx4 v[148:151], v250, s[20:23], s33 offen offset:1024 sc1
buffer_load_dwordx4 v[152:155], v250, s[20:23], s33 offen offset:2048 sc1
buffer_load_dwordx4 v[156:159], v250, s[20:23], s33 offen offset:3072 sc1
s_add_u32 s34, s81, 70656
buffer_load_dwordx4 v[160:163], v250, s[20:23], s34 offen offset:0 sc1
s_waitcnt vmcnt(8)
v_cmp_eq_u32 vcc, 0, v5
s_cmp_eq_u64 vcc, 0
s_cbranch_scc1 L_m_q5
s_mov_b32 s82, 0
L_m_poll14:
buffer_load_dword v5, v4, s[16:19], s36 offen sc1
s_waitcnt vmcnt(0)
v_cmp_gt_u32 vcc, 1, v5
s_cmp_eq_u64 vcc, 0
s_cbranch_scc1 L_m_poll14d
s_sleep 3
s_add_u32 s82, s82, 1
s_cmp_lt_u32 s82, 0x40000
s_cbranch_scc1 L_m_poll14
L_m_poll14d:
L_m_q5:
s_add_u32 s32, s35, 0
buffer_load_dwordx4 v[164:167], v80, s[16:19], s32 offen sc1
buffer_load_dwordx4 v[168:171], v81, s[16:19], s32 offen sc1
buffer_load_dwordx4 v[172:175], v82, s[16:19], s32 offen sc1
buffer_load_dwordx4 v[176:179], v83, s[16:19], s32 offen sc1
s_add_u32 s32, s35, 4096
buffer_load_dwordx4 v[180:183], v80, s[16:19], s32 offen sc1
buffer_load_dwordx4 v[184:187], v81, s[16:19], s32 offen sc1
buffer_load_dwordx4 v[188:191], v82, s[16:19], s32 offen sc1
buffer_load_dwordx4 v[192:195], v83, s[16:19], s32 offen sc1
s_add_u32 s32, s35, 8192
L_m_c2_7:
s_cbranch_execz L_m_c2_ret
buffer_load_dwordx4 v[196:199], v80, s[16:19], s32 offen sc1
buffer_load_dwordx4 v[200:203], v81, s[16:19], s32 offen sc1
buffer_load_dwordx4 v[204:207], v82, s[16:19], s32 offen sc1
buffer_load_dwordx4 v[208:211], v83, s[16:19], s32 offen sc1
s_mov_b32 s38, 0xffff0000
s_waitcnt vmcnt(8)
v_mfma_f32_16x16x32_bf16 v[0:3], a[0:3], v[164:167], 0
s_add_u32 s32, s35, 12288
buffer_load_dwordx4 v[212:215], v80, s[16:19], s32 offen sc1
v_mfma_f32_16x16x32_bf16 v[20:23], a[0:3], v[168:171], 0
v_mfma_f32_16x16x32_bf16 v[40:43], a[0:3], v[172:175], 0
buffer_load_dwordx4 v[216:219], v81, s[16:19], s32 offen sc1
v_mfma_f32_16x16x32_bf16 v[60:63], a[0:3], v[176:179], 0
v_mfma_f32_16x16x32_bf16 v[64:67], a[4:7], v[176:179], 0
buffer_load_dwordx4 v[220:223], v82, s[16:19], s32 offen sc1
v_mfma_f32_16x16x32_bf16 v[44:47], a[4:7], v[172:175], 0
v_mfma_f32_16x16x32_bf16 v[24:27], a[4:7], v[168:171], 0
buffer_load_dwordx4 v[224:227], v83, s[16:19], s32 offen sc1
v_mfma_f32_16x16x32_bf16 v[4:7], a[4:7], v[164:167], 0
v_mfma_f32_16x16x32_bf16 v[8:11], a[8:11], v[164:167], 0
v_mfma_f32_16x16x32_bf16 v[28:31], a[8:11], v[168:171], 0
v_mfma_f32_16x16x32_bf16 v[48:51], a[8:11], v[172:175], 0
v_mfma_f32_16x16x32_bf16 v[68:71], a[8:11], v[176:179], 0
v_mfma_f32_16x16x32_bf16 v[72:75], a[12:15], v[176:179], 0
v_mfma_f32_16x16x32_bf16 v[52:55], a[12:15], v[172:175], 0
v_mfma_f32_16x16x32_bf16 v[32:35], a[12:15], v[168:171], 0
v_mfma_f32_16x16x32_bf16 v[12:15], a[12:15], v[164:167], 0
v_mfma_f32_16x16x32_bf16 v[16:19], a[16:19], v[164:167], 0
v_mfma_f32_16x16x32_bf16 v[36:39], a[16:19], v[168:171], 0
v_mfma_f32_16x16x32_bf16 v[56:59], a[16:19], v[172:175], 0
v_mfma_f32_16x16x32_bf16 v[76:79], a[16:19], v[176:179], 0
s_waitcnt vmcnt(8)
v_mfma_f32_16x16x32_bf16 v[76:79], a[36:39], v[192:195], v[76:79]
s_add_u32 s32, s35, 16384
buffer_load_dwordx4 v[164:167], v80, s[16:19], s32 offen sc1
v_mfma_f32_16x16x32_bf16 v[56:59], a[36:39], v[188:191], v[56:59]
v_mfma_f32_16x16x32_bf16 v[36:39], a[36:39], v[184:187], v[36:39]
buffer_load_dwordx4 v[168:171], v81, s[16:19], s32 offen sc1
v_mfma_f32_16x16x32_bf16 v[16:19], a[36:39], v[180:183], v[16:19]
v_mfma_f32_16x16x32_bf16 v[12:15], a[32:35], v[180:183], v[12:15]
buffer_load_dwordx4 v[172:175], v82, s[16:19], s32 offen sc1
v_mfma_f32_16x16x32_bf16 v[32:35], a[32:35], v[184:187], v[32:35]
v_mfma_f32_16x16x32_bf16 v[52:55], a[32:35], v[188:191], v[52:55]
buffer_load_dwordx4 v[176:179], v83, s[16:19], s32 offen sc1
v_mfma_f32_16x16x32_bf16 v[72:75], a[32:35], v[192:195], v[72:75]
v_mfma_f32_16x16x32_bf16 v[68:71], a[28:31], v[192:195], v[68:71]
v_mfma_f32_16x16x32_bf16 v[48:51], a[28:31], v[188:191], v[48:51]
v_mfma_f32_16x16x32_bf16 v[28:31], a[28:31], v[184:187], v[28:31]
v_mfma_f32_16x16x32_bf16 v[8:11], a[28:31], v[180:183], v[8:11]
v_mfma_f32_16x16x32_bf16 v[4:7], a[24:27], v[180:183], v[4:7]
v_mfma_f32_16x16x32_bf16 v[24:27], a[24:27], v[184:187], v[24:27]
v_mfma_f32_16x16x32_bf16 v[44:47], a[24:27], v[188:191], v[44:47]
v_mfma_f32_16x16x32_bf16 v[64:67], a[24:27], v[192:195], v[64:67]
v_mfma_f32_16x16x32_bf16 v[60:63], a[20:23], v[192:195], v[60:63]
v_mfma_f32_16x16x32_bf16 v[40:43], a[20:23], v[188:191], v[40:43]
v_mfma_f32_16x16x32_bf16 v[20:23], a[20:23], v[184:187], v[20:23]
v_mfma_f32_16x16x32_bf16 v[0:3], a[20:23], v[180:183], v[0:3]
s_waitcnt vmcnt(8)
v_mfma_f32_16x16x32_bf16 v[0:3], a[40:43], v[196:199], v[0:3]
s_add_u32 s32, s35, 20480
buffer_load_dwordx4 v[180:183], v80, s[16:19], s32 offen sc1
v_mfma_f32_16x16x32_bf16 v[20:23], a[40:43], v[200:203], v[20:23]
v_mfma_f32_16x16x32_bf16 v[40:43], a[40:43], v[204:207], v[40:43]
buffer_load_dwordx4 v[184:187], v81, s[16:19], s32 offen sc1
v_mfma_f32_16x16x32_bf16 v[60:63], a[40:43], v[208:211], v[60:63]
v_mfma_f32_16x16x32_bf16 v[64:67], a[44:47], v[208:211], v[64:67]
buffer_load_dwordx4 v[188:191], v82, s[16:19], s32 offen sc1
v_mfma_f32_16x16x32_bf16 v[44:47], a[44:47], v[204:207], v[44:47]
v_mfma_f32_16x16x32_bf16 v[24:27], a[44:47], v[200:203], v[24:27]
buffer_load_dwordx4 v[192:195], v83, s[16:19], s32 offen sc1
v_mfma_f32_16x16x32_bf16 v[4:7], a[44:47], v[196:199], v[4:7]
v_mfma_f32_16x16x32_bf16 v[8:11], a[48:51], v[196:199], v[8:11]
v_mfma_f32_16x16x32_bf16 v[28:31], a[48:51], v[200:203], v[28:31]
v_mfma_f32_16x16x32_bf16 v[48:51], a[48:51], v[204:207], v[48:51]
v_mfma_f32_16x16x32_bf16 v[68:71], a[48:51], v[208:211], v[68:71]
v_mfma_f32_16x16x32_bf16 v[72:75], a[52:55], v[208:211], v[72:75]
v_mfma_f32_16x16x32_bf16 v[52:55], a[52:55], v[204:207], v[52:55]
v_mfma_f32_16x16x32_bf16 v[32:35], a[52:55], v[200:203], v[32:35]
v_mfma_f32_16x16x32_bf16 v[12:15], a[52:55], v[196:199], v[12:15]
v_mfma_f32_16x16x32_bf16 v[16:19], a[56:59], v[196:199], v[16:19]
v_mfma_f32_16x16x32_bf16 v[36:39], a[56:59], v[200:203], v[36:39]
v_mfma_f32_16x16x32_bf16 v[56:59], a[56:59], v[204:207], v[56:59]
v_mfma_f32_16x16x32_bf16 v[76:79], a[56:59], v[208:211], v[76:79]
s_waitcnt vmcnt(8)
v_mfma_f32_16x16x32_bf16 v[76:79], a[76:79], v[224:227], v[76:79]
s_add_u32 s32, s35, 24576
buffer_load_dwordx4 v[196:199], v81, s[16:19], s32 offen sc1
v_lshlrev_b32 v104, 16, v92
v_mfma_f32_16x16x32_bf16 v[56:59], a[76:79], v[220:223], v[56:59]
v_and_b32 v105, s38, v92
v_lshlrev_b32 v106, 16, v93
v_mfma_f32_16x16x32_bf16 v[36:39], a[76:79], v[216:219], v[36:39]
s_add_u32 s32, s35, 28672
buffer_load_dwordx4 v[200:203], v81, s[16:19], s32 offen sc1
v_and_b32 v107, s38, v93
v_mfma_f32_16x16x32_bf16 v[16:19], a[76:79], v[212:215], v[16:19]
v_lshlrev_b32 v108, 16, v94
v_and_b32 v109, s38, v94
v_mfma_f32_16x16x32_bf16 v[12:15], a[72:75], v[212:215], v[12:15]
s_add_u32 s32, s35, 32768
buffer_load_dwordx4 v[204:207], v81, s[16:19], s32 offen sc1
v_lshlrev_b32 v110, 16, v95
v_mfma_f32_16x16x32_bf16 v[32:35], a[72:75], v[216:219], v[32:35]
v_and_b32 v111, s38, v95
v_lshlrev_b32 v112, 16, v96
v_mfma_f32_16x16x32_bf16 v[52:55], a[72:75], v[220:223], v[52:55]
s_add_u32 s32, s35, 36864
buffer_load_dwordx4 v[208:211], v81, s[16:19], s32 offen sc1
v_and_b32 v113, s38, v96
v_mfma_f32_16x16x32_bf16 v[72:75], a[72:75], v[224:227], v[72:75]
v_lshlrev_b32 v114, 16, v97
v_and_b32 v115, s38, v97
v_mfma_f32_16x16x32_bf16 v[68:71], a[68:71], v[224:227], v[68:71]
v_lshlrev_b32 v116, 16, v98
v_and_b32 v117, s38, v98
v_mfma_f32_16x16x32_bf16 v[48:51], a[68:71], v[220:223], v[48:51]
v_lshlrev_b32 v118, 16, v99
v_and_b32 v119, s38, v99
v_mfma_f32_16x16x32_bf16 v[28:31], a[68:71], v[216:219], v[28:31]
v_lshlrev_b32 v120, 16, v100
v_and_b32 v121, s38, v100
v_mfma_f32_16x16x32_bf16 v[8:11], a[68:71], v[212:215], v[8:11]
v_lshlrev_b32 v122, 16, v101
v_and_b32 v123, s38, v101
v_mfma_f32_16x16x32_bf16 v[4:7], a[64:67], v[212:215], v[4:7]
v_accvgpr_read_b32 v92, a244
v_accvgpr_read_b32 v93, a245
v_mfma_f32_16x16x32_bf16 v[24:27], a[64:67], v[216:219], v[24:27]
v_accvgpr_read_b32 v94, a246
v_accvgpr_read_b32 v95, a247
v_mfma_f32_16x16x32_bf16 v[44:47], a[64:67], v[220:223], v[44:47]
v_accvgpr_read_b32 v96, a248
v_accvgpr_read_b32 v97, a249
v_mfma_f32_16x16x32_bf16 v[64:67], a[64:67], v[224:227], v[64:67]
v_accvgpr_read_b32 v98, a250
v_accvgpr_read_b32 v99, a251
v_mfma_f32_16x16x32_bf16 v[60:63], a[60:63], v[224:227], v[60:63]
v_accvgpr_read_b32 v100, a252
v_accvgpr_read_b32 v101, a253
v_mfma_f32_16x16x32_bf16 v[40:43], a[60:63], v[220:223], v[40:43]
v_lshlrev_b32 v228, 16, v92
v_and_b32 v229, s38, v92
v_mfma_f32_16x16x32_bf16 v[20:23], a[60:63], v[216:219], v[20:23]
v_lshlrev_b32 v230, 16, v93
v_and_b32 v231, s38, v93
v_mfma_f32_16x16x32_bf16 v[0:3], a[60:63], v[212:215], v[0:3]
v_lshlrev_b32 v232, 16, v94
v_and_b32 v233, s38, v94
s_waitcnt vmcnt(8)
v_mfma_f32_16x16x32_bf16 v[0:3], a[80:83], v[164:167], v[0:3]
s_add_u32 s32, s35, 24576
buffer_load_dwordx4 v[212:215], v82, s[16:19], s32 offen sc1
v_lshlrev_b32 v234, 16, v95
v_mfma_f32_16x16x32_bf16 v[20:23], a[80:83], v[168:171], v[20:23]
v_and_b32 v235, s38, v95
v_lshlrev_b32 v236, 16, v96
v_mfma_f32_16x16x32_bf16 v[40:43], a[80:83], v[172:175], v[40:43]
s_add_u32 s32, s35, 28672
buffer_load_dwordx4 v[216:219], v82, s[16:19], s32 offen sc1
v_and_b32 v237, s38, v96
v_mfma_f32_16x16x32_bf16 v[60:63], a[80:83], v[176:179], v[60:63]
v_lshlrev_b32 v238, 16, v97
v_and_b32 v239, s38, v97
v_mfma_f32_16x16x32_bf16 v[64:67], a[84:87], v[176:179], v[64:67]
s_add_u32 s32, s35, 32768
buffer_load_dwordx4 v[220:223], v82, s[16:19], s32 offen sc1
v_lshlrev_b32 v240, 16, v98
v_mfma_f32_16x16x32_bf16 v[44:47], a[84:87], v[172:175], v[44:47]
v_and_b32 v241, s38, v98
v_lshlrev_b32 v242, 16, v99
v_mfma_f32_16x16x32_bf16 v[24:27], a[84:87], v[168:171], v[24:27]
s_add_u32 s32, s35, 36864
buffer_load_dwordx4 v[224:227], v82, s[16:19], s32 offen sc1
v_and_b32 v243, s38, v99
v_mfma_f32_16x16x32_bf16 v[4:7], a[84:87], v[164:167], v[4:7]
v_lshlrev_b32 v244, 16, v100
v_and_b32 v245, s38, v100
v_mfma_f32_16x16x32_bf16 v[8:11], a[88:91], v[164:167], v[8:11]
v_lshlrev_b32 v246, 16, v101
v_and_b32 v247, s38, v101
v_mfma_f32_16x16x32_bf16 v[28:31], a[88:91], v[168:171], v[28:31]
v_mfma_f32_16x16x32_bf16 v[48:51], a[88:91], v[172:175], v[48:51]
v_mfma_f32_16x16x32_bf16 v[68:71], a[88:91], v[176:179], v[68:71]
v_mfma_f32_16x16x32_bf16 v[72:75], a[92:95], v[176:179], v[72:75]
v_mfma_f32_16x16x32_bf16 v[52:55], a[92:95], v[172:175], v[52:55]
v_mfma_f32_16x16x32_bf16 v[32:35], a[92:95], v[168:171], v[32:35]
v_mfma_f32_16x16x32_bf16 v[12:15], a[92:95], v[164:167], v[12:15]
v_mfma_f32_16x16x32_bf16 v[16:19], a[96:99], v[164:167], v[16:19]
v_mfma_f32_16x16x32_bf16 v[36:39], a[96:99], v[168:171], v[36:39]
v_mfma_f32_16x16x32_bf16 v[56:59], a[96:99], v[172:175], v[56:59]
v_mfma_f32_16x16x32_bf16 v[76:79], a[96:99], v[176:179], v[76:79]
s_waitcnt vmcnt(8)
v_mfma_f32_16x16x32_bf16 v[76:79], a[116:119], v[192:195], v[76:79]
s_add_u32 s32, s35, 24576
buffer_load_dwordx4 v[164:167], v83, s[16:19], s32 offen sc1
v_mfma_f32_16x16x32_bf16 v[56:59], a[116:119], v[188:191], v[56:59]
v_mfma_f32_16x16x32_bf16 v[36:39], a[116:119], v[184:187], v[36:39]
s_add_u32 s32, s35, 28672
buffer_load_dwordx4 v[168:171], v83, s[16:19], s32 offen sc1
v_mfma_f32_16x16x32_bf16 v[16:19], a[116:119], v[180:183], v[16:19]
v_mfma_f32_16x16x32_bf16 v[12:15], a[112:115], v[180:183], v[12:15]
s_add_u32 s32, s35, 32768
buffer_load_dwordx4 v[172:175], v83, s[16:19], s32 offen sc1
v_mfma_f32_16x16x32_bf16 v[32:35], a[112:115], v[184:187], v[32:35]
v_mfma_f32_16x16x32_bf16 v[52:55], a[112:115], v[188:191], v[52:55]
s_add_u32 s32, s35, 36864
buffer_load_dwordx4 v[176:179], v83, s[16:19], s32 offen sc1
v_mfma_f32_16x16x32_bf16 v[72:75], a[112:115], v[192:195], v[72:75]
v_mfma_f32_16x16x32_bf16 v[68:71], a[108:111], v[192:195], v[68:71]
v_mfma_f32_16x16x32_bf16 v[48:51], a[108:111], v[188:191], v[48:51]
v_mfma_f32_16x16x32_bf16 v[28:31], a[108:111], v[184:187], v[28:31]
v_mfma_f32_16x16x32_bf16 v[8:11], a[108:111], v[180:183], v[8:11]
v_mfma_f32_16x16x32_bf16 v[4:7], a[104:107], v[180:183], v[4:7]
v_mfma_f32_16x16x32_bf16 v[24:27], a[104:107], v[184:187], v[24:27]
v_mfma_f32_16x16x32_bf16 v[44:47], a[104:107], v[188:191], v[44:47]
v_mfma_f32_16x16x32_bf16 v[64:67], a[104:107], v[192:195], v[64:67]
v_mfma_f32_16x16x32_bf16 v[60:63], a[100:103], v[192:195], v[60:63]
v_mfma_f32_16x16x32_bf16 v[40:43], a[100:103], v[188:191], v[40:43]
v_mfma_f32_16x16x32_bf16 v[20:23], a[100:103], v[184:187], v[20:23]
v_mfma_f32_16x16x32_bf16 v[0:3], a[100:103], v[180:183], v[0:3]
s_waitcnt vmcnt(8)
v_mfma_f32_16x16x32_bf16 v[20:23], a[120:123], v[196:199], v[20:23]
s_add_u32 s32, s35, 40960
buffer_load_dwordx4 v[180:183], v81, s[16:19], s32 offen sc1
v_mfma_f32_16x16x32_bf16 v[20:23], a[140:143], v[200:203], v[20:23]
v_mfma_f32_16x16x32_bf16 v[20:23], a[160:163], v[204:207], v[20:23]
s_add_u32 s32, s35, 45056
buffer_load_dwordx4 v[184:187], v81, s[16:19], s32 offen sc1
v_mfma_f32_16x16x32_bf16 v[20:23], a[180:183], v[208:211], v[20:23]
v_mfma_f32_16x16x32_bf16 v[24:27], a[184:187], v[208:211], v[24:27]
s_add_u32 s32, s35, 49152
buffer_load_dwordx4 v[188:191], v81, s[16:19], s32 offen sc1
v_mfma_f32_16x16x32_bf16 v[24:27], a[164:167], v[204:207], v[24:27]
v_mfma_f32_16x16x32_bf16 v[24:27], a[144:147], v[200:203], v[24:27]
s_add_u32 s32, s35, 53248
buffer_load_dwordx4 v[192:195], v81, s[20:23], s32 offen sc1
v_mfma_f32_16x16x32_bf16 v[24:27], a[124:127], v[196:199], v[24:27]
v_mfma_f32_16x16x32_bf16 v[28:31], a[128:131], v[196:199], v[28:31]
v_mfma_f32_16x16x32_bf16 v[28:31], a[148:151], v[200:203], v[28:31]
v_mfma_f32_16x16x32_bf16 v[28:31], a[168:171], v[204:207], v[28:31]
v_mfma_f32_16x16x32_bf16 v[28:31], a[188:191], v[208:211], v[28:31]
v_mfma_f32_16x16x32_bf16 v[32:35], a[192:195], v[208:211], v[32:35]
v_mfma_f32_16x16x32_bf16 v[32:35], a[172:175], v[204:207], v[32:35]
v_mfma_f32_16x16x32_bf16 v[32:35], a[152:155], v[200:203], v[32:35]
v_mfma_f32_16x16x32_bf16 v[32:35], a[132:135], v[196:199], v[32:35]
v_mfma_f32_16x16x32_bf16 v[36:39], a[136:139], v[196:199], v[36:39]
v_mfma_f32_16x16x32_bf16 v[36:39], a[156:159], v[200:203], v[36:39]
v_mfma_f32_16x16x32_bf16 v[36:39], a[176:179], v[204:207], v[36:39]
v_mfma_f32_16x16x32_bf16 v[36:39], a[196:199], v[208:211], v[36:39]
s_waitcnt vmcnt(8)
v_mfma_f32_16x16x32_bf16 v[56:59], a[196:199], v[224:227], v[56:59]
s_add_u32 s32, s35, 40960
buffer_load_dwordx4 v[196:199], v82, s[16:19], s32 offen sc1
v_mfma_f32_16x16x32_bf16 v[56:59], a[176:179], v[220:223], v[56:59]
v_mfma_f32_16x16x32_bf16 v[56:59], a[156:159], v[216:219], v[56:59]
s_add_u32 s32, s35, 45056
buffer_load_dwordx4 v[200:203], v82, s[16:19], s32 offen sc1
v_mfma_f32_16x16x32_bf16 v[56:59], a[136:139], v[212:215], v[56:59]
v_mfma_f32_16x16x32_bf16 v[52:55], a[132:135], v[212:215], v[52:55]
s_add_u32 s32, s35, 49152
buffer_load_dwordx4 v[204:207], v82, s[16:19], s32 offen sc1
v_mfma_f32_16x16x32_bf16 v[52:55], a[152:155], v[216:219], v[52:55]
v_mfma_f32_16x16x32_bf16 v[52:55], a[172:175], v[220:223], v[52:55]
s_add_u32 s32, s35, 53248
buffer_load_dwordx4 v[208:211], v82, s[20:23], s32 offen sc1
v_mfma_f32_16x16x32_bf16 v[52:55], a[192:195], v[224:227], v[52:55]
v_mfma_f32_16x16x32_bf16 v[48:51], a[188:191], v[224:227], v[48:51]
v_mfma_f32_16x16x32_bf16 v[48:51], a[168:171], v[220:223], v[48:51]
v_mfma_f32_16x16x32_bf16 v[48:51], a[148:151], v[216:219], v[48:51]
v_mfma_f32_16x16x32_bf16 v[48:51], a[128:131], v[212:215], v[48:51]
v_mfma_f32_16x16x32_bf16 v[44:47], a[124:127], v[212:215], v[44:47]
v_mfma_f32_16x16x32_bf16 v[44:47], a[144:147], v[216:219], v[44:47]
v_mfma_f32_16x16x32_bf16 v[44:47], a[164:167], v[220:223], v[44:47]
v_mfma_f32_16x16x32_bf16 v[44:47], a[184:187], v[224:227], v[44:47]
v_mfma_f32_16x16x32_bf16 v[40:43], a[180:183], v[224:227], v[40:43]
v_mfma_f32_16x16x32_bf16 v[40:43], a[160:163], v[220:223], v[40:43]
v_mfma_f32_16x16x32_bf16 v[40:43], a[140:143], v[216:219], v[40:43]
v_mfma_f32_16x16x32_bf16 v[40:43], a[120:123], v[212:215], v[40:43]
s_waitcnt vmcnt(8)
v_mfma_f32_16x16x32_bf16 v[60:63], a[120:123], v[164:167], v[60:63]
s_add_u32 s32, s35, 40960
buffer_load_dwordx4 v[212:215], v83, s[16:19], s32 offen sc1
v_mfma_f32_16x16x32_bf16 v[60:63], a[140:143], v[168:171], v[60:63]
v_mfma_f32_16x16x32_bf16 v[60:63], a[160:163], v[172:175], v[60:63]
s_add_u32 s32, s35, 45056
buffer_load_dwordx4 v[216:219], v83, s[16:19], s32 offen sc1
v_mfma_f32_16x16x32_bf16 v[60:63], a[180:183], v[176:179], v[60:63]
v_mfma_f32_16x16x32_bf16 v[64:67], a[184:187], v[176:179], v[64:67]
s_add_u32 s32, s35, 49152
buffer_load_dwordx4 v[220:223], v83, s[16:19], s32 offen sc1
v_mfma_f32_16x16x32_bf16 v[64:67], a[164:167], v[172:175], v[64:67]
v_mfma_f32_16x16x32_bf16 v[64:67], a[144:147], v[168:171], v[64:67]
s_add_u32 s32, s35, 53248
buffer_load_dwordx4 v[224:227], v83, s[20:23], s32 offen sc1
v_mfma_f32_16x16x32_bf16 v[64:67], a[124:127], v[164:167], v[64:67]
v_mfma_f32_16x16x32_bf16 v[68:71], a[128:131], v[164:167], v[68:71]
v_mfma_f32_16x16x32_bf16 v[68:71], a[148:151], v[168:171], v[68:71]
v_mfma_f32_16x16x32_bf16 v[68:71], a[168:171], v[172:175], v[68:71]
v_mfma_f32_16x16x32_bf16 v[68:71], a[188:191], v[176:179], v[68:71]
v_mfma_f32_16x16x32_bf16 v[72:75], a[192:195], v[176:179], v[72:75]
v_mfma_f32_16x16x32_bf16 v[72:75], a[172:175], v[172:175], v[72:75]
v_mfma_f32_16x16x32_bf16 v[72:75], a[152:155], v[168:171], v[72:75]
v_mfma_f32_16x16x32_bf16 v[72:75], a[132:135], v[164:167], v[72:75]
v_mfma_f32_16x16x32_bf16 v[76:79], a[136:139], v[164:167], v[76:79]
v_mfma_f32_16x16x32_bf16 v[76:79], a[156:159], v[168:171], v[76:79]
v_mfma_f32_16x16x32_bf16 v[76:79], a[176:179], v[172:175], v[76:79]
v_mfma_f32_16x16x32_bf16 v[76:79], a[196:199], v[176:179], v[76:79]
s_waitcnt vmcnt(8)
v_mfma_f32_16x16x32_bf16 v[36:39], v[160:163], v[192:195], v[36:39]
s_add_u32 s32, s35, 24576
buffer_load_dwordx4 v[164:167], v80, s[16:19], s32 offen sc1
v_mfma_f32_16x16x32_bf16 v[36:39], v[140:143], v[188:191], v[36:39]
v_mfma_f32_16x16x32_bf16 v[36:39], a[236:239], v[184:187], v[36:39]
s_add_u32 s32, s35, 28672
buffer_load_dwordx4 v[168:171], v80, s[16:19], s32 offen sc1
v_mfma_f32_16x16x32_bf16 v[36:39], a[216:219], v[180:183], v[36:39]
v_mfma_f32_16x16x32_bf16 v[32:35], a[212:215], v[180:183], v[32:35]
s_add_u32 s32, s35, 32768
buffer_load_dwordx4 v[172:175], v80, s[16:19], s32 offen sc1
v_mfma_f32_16x16x32_bf16 v[32:35], a[232:235], v[184:187], v[32:35]
v_mfma_f32_16x16x32_bf16 v[32:35], v[136:139], v[188:191], v[32:35]
s_add_u32 s32, s35, 36864
buffer_load_dwordx4 v[176:179], v80, s[16:19], s32 offen sc1
v_mfma_f32_16x16x32_bf16 v[32:35], v[156:159], v[192:195], v[32:35]
v_mfma_f32_16x16x32_bf16 v[28:31], v[152:155], v[192:195], v[28:31]
v_mfma_f32_16x16x32_bf16 v[28:31], v[132:135], v[188:191], v[28:31]
v_mfma_f32_16x16x32_bf16 v[28:31], a[228:231], v[184:187], v[28:31]
v_mfma_f32_16x16x32_bf16 v[28:31], a[208:211], v[180:183], v[28:31]
v_mfma_f32_16x16x32_bf16 v[24:27], a[204:207], v[180:183], v[24:27]
v_mfma_f32_16x16x32_bf16 v[24:27], a[224:227], v[184:187], v[24:27]
v_mfma_f32_16x16x32_bf16 v[24:27], v[128:131], v[188:191], v[24:27]
v_mfma_f32_16x16x32_bf16 v[24:27], v[148:151], v[192:195], v[24:27]
v_mfma_f32_16x16x32_bf16 v[20:23], v[144:147], v[192:195], v[20:23]
v_mfma_f32_16x16x32_bf16 v[20:23], v[124:127], v[188:191], v[20:23]
v_mfma_f32_16x16x32_bf16 v[20:23], a[220:223], v[184:187], v[20:23]
v_mfma_f32_16x16x32_bf16 v[20:23], a[200:203], v[180:183], v[20:23]
s_barrier
s_waitcnt vmcnt(8)
v_mfma_f32_16x16x32_bf16 v[40:43], a[200:203], v[196:199], v[40:43]
s_add_u32 s32, s35, 40960
buffer_load_dwordx4 v[180:183], v80, s[16:19], s32 offen sc1
v_mfma_f32_16x16x32_bf16 v[40:43], a[220:223], v[200:203], v[40:43]
v_mfma_f32_16x16x32_bf16 v[40:43], v[124:127], v[204:207], v[40:43]
s_add_u32 s32, s35, 45056
buffer_load_dwordx4 v[184:187], v80, s[16:19], s32 offen sc1
v_mfma_f32_16x16x32_bf16 v[40:43], v[144:147], v[208:211], v[40:43]
ds_write_b128 v87, v[36:39] offset:4096
v_mfma_f32_16x16x32_bf16 v[44:47], v[148:151], v[208:211], v[44:47]
s_add_u32 s32, s35, 49152
buffer_load_dwordx4 v[188:191], v80, s[16:19], s32 offen sc1
v_mfma_f32_16x16x32_bf16 v[44:47], v[128:131], v[204:207], v[44:47]
v_mfma_f32_16x16x32_bf16 v[44:47], a[224:227], v[200:203], v[44:47]
s_add_u32 s32, s35, 53248
buffer_load_dwordx4 v[192:195], v80, s[20:23], s32 offen sc1
v_mfma_f32_16x16x32_bf16 v[44:47], a[204:207], v[196:199], v[44:47]
ds_write_b128 v87, v[32:35] offset:3072
v_mfma_f32_16x16x32_bf16 v[48:51], a[208:211], v[196:199], v[48:51]
v_mfma_f32_16x16x32_bf16 v[48:51], a[228:231], v[200:203], v[48:51]
v_mfma_f32_16x16x32_bf16 v[48:51], v[132:135], v[204:207], v[48:51]
v_mfma_f32_16x16x32_bf16 v[48:51], v[152:155], v[208:211], v[48:51]
ds_write_b128 v87, v[28:31] offset:2048
v_mfma_f32_16x16x32_bf16 v[52:55], v[156:159], v[208:211], v[52:55]
v_mfma_f32_16x16x32_bf16 v[52:55], v[136:139], v[204:207], v[52:55]
v_mfma_f32_16x16x32_bf16 v[52:55], a[232:235], v[200:203], v[52:55]
v_mfma_f32_16x16x32_bf16 v[52:55], a[212:215], v[196:199], v[52:55]
ds_write_b128 v87, v[24:27] offset:1024
v_mfma_f32_16x16x32_bf16 v[56:59], a[216:219], v[196:199], v[56:59]
v_mfma_f32_16x16x32_bf16 v[56:59], a[236:239], v[200:203], v[56:59]
v_mfma_f32_16x16x32_bf16 v[56:59], v[140:143], v[204:207], v[56:59]
v_mfma_f32_16x16x32_bf16 v[56:59], v[160:163], v[208:211], v[56:59]
ds_write_b128 v87, v[20:23] offset:0
s_waitcnt vmcnt(8)
v_mfma_f32_16x16x32_bf16 v[76:79], v[160:163], v[224:227], v[76:79]
v_mfma_f32_16x16x32_bf16 v[76:79], v[140:143], v[220:223], v[76:79]
v_mfma_f32_16x16x32_bf16 v[76:79], a[236:239], v[216:219], v[76:79]
v_mfma_f32_16x16x32_bf16 v[76:79], a[216:219], v[212:215], v[76:79]
ds_write_b128 v88, v[40:43] offset:0
v_mfma_f32_16x16x32_bf16 v[72:75], a[212:215], v[212:215], v[72:75]
v_mfma_f32_16x16x32_bf16 v[72:75], a[232:235], v[216:219], v[72:75]
v_mfma_f32_16x16x32_bf16 v[72:75], v[136:139], v[220:223], v[72:75]
v_mfma_f32_16x16x32_bf16 v[72:75], v[156:159], v[224:227], v[72:75]
ds_write_b128 v88, v[44:47] offset:1024
v_mfma_f32_16x16x32_bf16 v[68:71], v[152:155], v[224:227], v[68:71]
v_mfma_f32_16x16x32_bf16 v[68:71], v[132:135], v[220:223], v[68:71]
v_mfma_f32_16x16x32_bf16 v[68:71], a[228:231], v[216:219], v[68:71]
v_mfma_f32_16x16x32_bf16 v[68:71], a[208:211], v[212:215], v[68:71]
ds_write_b128 v88, v[48:51] offset:2048
v_mfma_f32_16x16x32_bf16 v[64:67], a[204:207], v[212:215], v[64:67]
v_mfma_f32_16x16x32_bf16 v[64:67], a[224:227], v[216:219], v[64:67]
v_mfma_f32_16x16x32_bf16 v[64:67], v[128:131], v[220:223], v[64:67]
v_mfma_f32_16x16x32_bf16 v[64:67], v[148:151], v[224:227], v[64:67]
ds_write_b128 v88, v[52:55] offset:3072
v_mfma_f32_16x16x32_bf16 v[60:63], v[144:147], v[224:227], v[60:63]
v_mfma_f32_16x16x32_bf16 v[60:63], v[124:127], v[220:223], v[60:63]
v_mfma_f32_16x16x32_bf16 v[60:63], a[220:223], v[216:219], v[60:63]
v_mfma_f32_16x16x32_bf16 v[60:63], a[200:203], v[212:215], v[60:63]
ds_write_b128 v88, v[56:59] offset:4096
s_waitcnt vmcnt(4)
v_mfma_f32_16x16x32_bf16 v[0:3], a[120:123], v[164:167], v[0:3]
v_mfma_f32_16x16x32_bf16 v[0:3], a[140:143], v[168:171], v[0:3]
v_mfma_f32_16x16x32_bf16 v[0:3], a[160:163], v[172:175], v[0:3]
v_mfma_f32_16x16x32_bf16 v[0:3], a[180:183], v[176:179], v[0:3]
ds_write_b128 v89, v[76:79] offset:4096
v_mfma_f32_16x16x32_bf16 v[4:7], a[184:187], v[176:179], v[4:7]
v_mfma_f32_16x16x32_bf16 v[4:7], a[164:167], v[172:175], v[4:7]
v_mfma_f32_16x16x32_bf16 v[4:7], a[144:147], v[168:171], v[4:7]
v_mfma_f32_16x16x32_bf16 v[4:7], a[124:127], v[164:167], v[4:7]
ds_write_b128 v89, v[72:75] offset:3072
v_mfma_f32_16x16x32_bf16 v[8:11], a[128:131], v[164:167], v[8:11]
v_mfma_f32_16x16x32_bf16 v[8:11], a[148:151], v[168:171], v[8:11]
v_mfma_f32_16x16x32_bf16 v[8:11], a[168:171], v[172:175], v[8:11]
v_mfma_f32_16x16x32_bf16 v[8:11], a[188:191], v[176:179], v[8:11]
ds_write_b128 v89, v[68:71] offset:2048
v_mfma_f32_16x16x32_bf16 v[12:15], a[192:195], v[176:179], v[12:15]
v_mfma_f32_16x16x32_bf16 v[12:15], a[172:175], v[172:175], v[12:15]
v_mfma_f32_16x16x32_bf16 v[12:15], a[152:155], v[168:171], v[12:15]
v_mfma_f32_16x16x32_bf16 v[12:15], a[132:135], v[164:167], v[12:15]
ds_write_b128 v89, v[64:67] offset:1024
v_mfma_f32_16x16x32_bf16 v[16:19], a[136:139], v[164:167], v[16:19]
v_mfma_f32_16x16x32_bf16 v[16:19], a[156:159], v[168:171], v[16:19]
v_mfma_f32_16x16x32_bf16 v[16:19], a[176:179], v[172:175], v[16:19]
v_mfma_f32_16x16x32_bf16 v[16:19], a[196:199], v[176:179], v[16:19]
ds_write_b128 v89, v[60:63] offset:0
s_waitcnt vmcnt(0)
v_mfma_f32_16x16x32_bf16 v[16:19], v[160:163], v[192:195], v[16:19]
v_mfma_f32_16x16x32_bf16 v[16:19], v[140:143], v[188:191], v[16:19]
s_waitcnt lgkmcnt(0)
s_barrier
ds_read_b128 v[20:23], v90 offset:0
ds_read_b128 v[24:27], v90 offset:1024
v_mfma_f32_16x16x32_bf16 v[16:19], a[236:239], v[184:187], v[16:19]
ds_read_b128 v[28:31], v90 offset:2048
ds_read_b128 v[32:35], v90 offset:3072
v_mfma_f32_16x16x32_bf16 v[16:19], a[216:219], v[180:183], v[16:19]
ds_read_b128 v[36:39], v90 offset:4096
ds_read_b128 v[40:43], v90 offset:5120
v_mfma_f32_16x16x32_bf16 v[12:15], a[212:215], v[180:183], v[12:15]
ds_read_b128 v[44:47], v90 offset:6144
ds_read_b128 v[48:51], v90 offset:7168
v_mfma_f32_16x16x32_bf16 v[12:15], a[232:235], v[184:187], v[12:15]
ds_read_b128 v[52:55], v90 offset:8192
ds_read_b128 v[56:59], v90 offset:9216
v_mfma_f32_16x16x32_bf16 v[12:15], v[136:139], v[188:191], v[12:15]
ds_read_b128 v[60:63], v90 offset:10240
ds_read_b128 v[64:67], v90 offset:11264
v_mfma_f32_16x16x32_bf16 v[12:15], v[156:159], v[192:195], v[12:15]
ds_read_b128 v[68:71], v90 offset:12288
ds_read_b128 v[72:75], v90 offset:13312
v_mfma_f32_16x16x32_bf16 v[8:11], v[152:155], v[192:195], v[8:11]
ds_read_b128 v[76:79], v90 offset:14336
v_mfma_f32_16x16x32_bf16 v[8:11], v[132:135], v[188:191], v[8:11]
v_mfma_f32_16x16x32_bf16 v[8:11], a[228:231], v[184:187], v[8:11]
s_waitcnt lgkmcnt(5)
v_add_f32 v20, v20, v40
v_mfma_f32_16x16x32_bf16 v[8:11], a[208:211], v[180:183], v[8:11]
v_add_f32 v21, v21, v41
v_add_f32 v22, v22, v42
v_mfma_f32_16x16x32_bf16 v[4:7], a[204:207], v[180:183], v[4:7]
v_add_f32 v23, v23, v43
v_add_f32 v24, v24, v44
v_mfma_f32_16x16x32_bf16 v[4:7], a[224:227], v[184:187], v[4:7]
v_add_f32 v25, v25, v45
v_add_f32 v26, v26, v46
v_mfma_f32_16x16x32_bf16 v[4:7], v[128:131], v[188:191], v[4:7]
v_add_f32 v27, v27, v47
v_add_f32 v28, v28, v48
v_mfma_f32_16x16x32_bf16 v[4:7], v[148:151], v[192:195], v[4:7]
v_add_f32 v29, v29, v49
v_add_f32 v30, v30, v50
v_mfma_f32_16x16x32_bf16 v[0:3], v[144:147], v[192:195], v[0:3]
v_add_f32 v31, v31, v51
v_add_f32 v32, v32, v52
v_mfma_f32_16x16x32_bf16 v[0:3], v[124:127], v[188:191], v[0:3]
v_add_f32 v33, v33, v53
v_add_f32 v34, v34, v54
v_mfma_f32_16x16x32_bf16 v[0:3], a[220:223], v[184:187], v[0:3]
v_add_f32 v35, v35, v55
v_add_f32 v36, v36, v56
v_mfma_f32_16x16x32_bf16 v[0:3], a[200:203], v[180:183], v[0:3]
v_add_f32 v37, v37, v57
v_add_f32 v38, v38, v58
v_add_f32 v39, v39, v59
v_pk_add_f32 v[16:17], v[16:17], v[36:37]
v_pk_add_f32 v[18:19], v[18:19], v[38:39]
v_pk_add_f32 v[12:13], v[12:13], v[32:33]
v_pk_add_f32 v[14:15], v[14:15], v[34:35]
v_pk_add_f32 v[8:9], v[8:9], v[28:29]
v_pk_add_f32 v[10:11], v[10:11], v[30:31]
v_pk_add_f32 v[4:5], v[4:5], v[24:25]
v_pk_add_f32 v[6:7], v[6:7], v[26:27]
v_pk_add_f32 v[0:1], v[0:1], v[20:21]
v_pk_add_f32 v[2:3], v[2:3], v[22:23]
s_waitcnt lgkmcnt(0)
v_pk_add_f32 v[16:17], v[16:17], v[76:77]
v_pk_add_f32 v[18:19], v[18:19], v[78:79]
v_pk_add_f32 v[12:13], v[12:13], v[72:73]
v_pk_add_f32 v[14:15], v[14:15], v[74:75]
v_pk_add_f32 v[8:9], v[8:9], v[68:69]
v_pk_add_f32 v[10:11], v[10:11], v[70:71]
v_pk_add_f32 v[4:5], v[4:5], v[64:65]
v_pk_add_f32 v[6:7], v[6:7], v[66:67]
v_pk_add_f32 v[0:1], v[0:1], v[60:61]
v_pk_add_f32 v[2:3], v[2:3], v[62:63]
v_pk_fma_f32 v[16:17], v[16:17], v[120:121], v[244:245]
v_pk_fma_f32 v[18:19], v[18:19], v[122:123], v[246:247]
v_pk_fma_f32 v[12:13], v[12:13], v[116:117], v[240:241]
v_pk_fma_f32 v[14:15], v[14:15], v[118:119], v[242:243]
v_pk_fma_f32 v[8:9], v[8:9], v[112:113], v[236:237]
v_pk_fma_f32 v[10:11], v[10:11], v[114:115], v[238:239]
v_pk_fma_f32 v[4:5], v[4:5], v[108:109], v[232:233]
v_pk_fma_f32 v[6:7], v[6:7], v[110:111], v[234:235]
v_pk_fma_f32 v[0:1], v[0:1], v[104:105], v[228:229]
v_pk_fma_f32 v[2:3], v[2:3], v[106:107], v[230:231]
v_cvt_pk_bf16_f32 v92, v0, v1
v_cvt_pk_bf16_f32 v93, v2, v3
v_cvt_pk_bf16_f32 v94, v4, v5
v_cvt_pk_bf16_f32 v95, v6, v7
v_cvt_pk_bf16_f32 v96, v8, v9
v_cvt_pk_bf16_f32 v97, v10, v11
v_cvt_pk_bf16_f32 v98, v12, v13
v_cvt_pk_bf16_f32 v99, v14, v15
v_cvt_pk_bf16_f32 v100, v16, v17
v_cvt_pk_bf16_f32 v101, v18, v19
buffer_store_dwordx4 v[92:95], v85, s[4:7], s41 offen
buffer_store_dwordx4 v[96:99], v85, s[4:7], s41 offen offset:16
buffer_store_dwordx2 v[100:101], v85, s[4:7], s41 offen offset:32
s_endpgm
L_m_fallback:
s_mov_b32 s38, 1
s_mov_b32 s80, 256
s_mov_b32 s76, 30408704
s_mov_b32 s20, s52
s_mov_b32 s21, s53
s_mov_b32 s22, 5242880
s_mov_b32 s88, s64
s_mov_b32 s89, s65
s_cmp_lt_u32 s2, 160
s_cselect_b32 s90, 4915200, 0
s_mov_b32 s34, 0
s_mov_b32 m0, s31
v_mov_b32 v244, v245
s_waitcnt vmcnt(0)
s_add_u32 s4, s46, 896
s_addc_u32 s5, s47, 0
s_add_u32 s6, s46, 0
s_addc_u32 s7, s47, 0
v_mov_b32 v224, 0xff800000
v_mov_b32 v228, 0xff800000
v_mov_b32 v232, 0xff800000
v_mov_b32 v236, 0xff800000
L_m_fbloop:
s_barrier
global_load_lds_dwordx4 v248, s[4:5] offset:0
global_load_lds_dwordx4 v248, s[6:7] offset:1024
global_load_lds_dwordx4 v248, s[4:5] offset:2048
global_load_lds_dwordx4 v248, s[6:7] offset:3072
s_waitcnt vmcnt(0)
s_barrier
ds_read_b128 a[64:67], v244 offset:0
ds_read_b128 a[68:71], v244 offset:512
ds_read_b128 a[72:75], v244 offset:1024
ds_read_b128 a[76:79], v244 offset:1536
ds_read_b128 a[80:83], v244 offset:4096
ds_read_b128 a[84:87], v244 offset:4608
ds_read_b128 a[88:91], v244 offset:5120
ds_read_b128 a[92:95], v244 offset:5632
s_waitcnt lgkmcnt(0)
v_mfma_f32_16x16x32_bf16 v[128:131], a[64:67], a[0:3], 0
v_mfma_f32_16x16x32_bf16 v[136:139], a[64:67], a[16:19], 0
v_mfma_f32_16x16x32_bf16 v[144:147], a[64:67], a[32:35], 0
v_mfma_f32_16x16x32_bf16 v[152:155], a[64:67], a[48:51], 0
v_mfma_f32_16x16x32_bf16 v[128:131], a[68:71], a[4:7], v[128:131]
v_mfma_f32_16x16x32_bf16 v[136:139], a[68:71], a[20:23], v[136:139]
v_mfma_f32_16x16x32_bf16 v[144:147], a[68:71], a[36:39], v[144:147]
v_mfma_f32_16x16x32_bf16 v[152:155], a[68:71], a[52:55], v[152:155]
v_mfma_f32_16x16x32_bf16 v[128:131], a[72:75], a[8:11], v[128:131]
v_mfma_f32_16x16x32_bf16 v[136:139], a[72:75], a[24:27], v[136:139]
v_mfma_f32_16x16x32_bf16 v[144:147], a[72:75], a[40:43], v[144:147]
v_mfma_f32_16x16x32_bf16 v[152:155], a[72:75], a[56:59], v[152:155]
v_mfma_f32_16x16x32_bf16 v[128:131], a[76:79], a[12:15], v[128:131]
v_mfma_f32_16x16x32_bf16 v[136:139], a[76:79], a[28:31], v[136:139]
v_mfma_f32_16x16x32_bf16 v[144:147], a[76:79], a[44:47], v[144:147]
v_mfma_f32_16x16x32_bf16 v[152:155], a[76:79], a[60:63], v[152:155]
v_mfma_f32_16x16x32_bf16 v[132:135], a[80:83], a[0:3], 0
v_mfma_f32_16x16x32_bf16 v[140:143], a[80:83], a[16:19], 0
v_mfma_f32_16x16x32_bf16 v[148:151], a[80:83], a[32:35], 0
v_mfma_f32_16x16x32_bf16 v[156:159], a[80:83], a[48:51], 0
v_mfma_f32_16x16x32_bf16 v[132:135], a[84:87], a[4:7], v[132:135]
v_mfma_f32_16x16x32_bf16 v[140:143], a[84:87], a[20:23], v[140:143]
v_mfma_f32_16x16x32_bf16 v[148:151], a[84:87], a[36:39], v[148:151]
v_mfma_f32_16x16x32_bf16 v[156:159], a[84:87], a[52:55], v[156:159]
v_mfma_f32_16x16x32_bf16 v[132:135], a[88:91], a[8:11], v[132:135]
v_mfma_f32_16x16x32_bf16 v[140:143], a[88:91], a[24:27], v[140:143]
v_mfma_f32_16x16x32_bf16 v[148:151], a[88:91], a[40:43], v[148:151]
v_mfma_f32_16x16x32_bf16 v[156:159], a[88:91], a[56:59], v[156:159]
v_mfma_f32_16x16x32_bf16 v[132:135], a[92:95], a[12:15], v[132:135]
v_mfma_f32_16x16x32_bf16 v[140:143], a[92:95], a[28:31], v[140:143]
v_mfma_f32_16x16x32_bf16 v[148:151], a[92:95], a[44:47], v[148:151]
v_mfma_f32_16x16x32_bf16 v[156:159], a[92:95], a[60:63], v[156:159]
s_nop 7
v_max3_f32 v224, v224, v128, v129
v_max3_f32 v224, v224, v130, v131
v_max3_f32 v224, v224, v132, v133
v_max3_f32 v224, v224, v134, v135
v_max3_f32 v228, v228, v136, v137
v_max3_f32 v228, v228, v138, v139
v_max3_f32 v228, v228, v140, v141
v_max3_f32 v228, v228, v142, v143
v_max3_f32 v232, v232, v144, v145
v_max3_f32 v232, v232, v146, v147
v_max3_f32 v232, v232, v148, v149
v_max3_f32 v232, v232, v150, v151
v_max3_f32 v236, v236, v152, v153
v_max3_f32 v236, v236, v154, v155
v_max3_f32 v236, v236, v156, v157
v_max3_f32 v236, v236, v158, v159
ds_read_b128 a[64:67], v244 offset:8192
ds_read_b128 a[68:71], v244 offset:8704
ds_read_b128 a[72:75], v244 offset:9216
ds_read_b128 a[76:79], v244 offset:9728
ds_read_b128 a[80:83], v244 offset:12288
ds_read_b128 a[84:87], v244 offset:12800
ds_read_b128 a[88:91], v244 offset:13312
ds_read_b128 a[92:95], v244 offset:13824
s_waitcnt lgkmcnt(0)
v_mfma_f32_16x16x32_bf16 v[128:131], a[64:67], a[0:3], 0
v_mfma_f32_16x16x32_bf16 v[136:139], a[64:67], a[16:19], 0
v_mfma_f32_16x16x32_bf16 v[144:147], a[64:67], a[32:35], 0
v_mfma_f32_16x16x32_bf16 v[152:155], a[64:67], a[48:51], 0
v_mfma_f32_16x16x32_bf16 v[128:131], a[68:71], a[4:7], v[128:131]
v_mfma_f32_16x16x32_bf16 v[136:139], a[68:71], a[20:23], v[136:139]
v_mfma_f32_16x16x32_bf16 v[144:147], a[68:71], a[36:39], v[144:147]
v_mfma_f32_16x16x32_bf16 v[152:155], a[68:71], a[52:55], v[152:155]
v_mfma_f32_16x16x32_bf16 v[128:131], a[72:75], a[8:11], v[128:131]
v_mfma_f32_16x16x32_bf16 v[136:139], a[72:75], a[24:27], v[136:139]
v_mfma_f32_16x16x32_bf16 v[144:147], a[72:75], a[40:43], v[144:147]
v_mfma_f32_16x16x32_bf16 v[152:155], a[72:75], a[56:59], v[152:155]
v_mfma_f32_16x16x32_bf16 v[128:131], a[76:79], a[12:15], v[128:131]
v_mfma_f32_16x16x32_bf16 v[136:139], a[76:79], a[28:31], v[136:139]
v_mfma_f32_16x16x32_bf16 v[144:147], a[76:79], a[44:47], v[144:147]
v_mfma_f32_16x16x32_bf16 v[152:155], a[76:79], a[60:63], v[152:155]
v_mfma_f32_16x16x32_bf16 v[132:135], a[80:83], a[0:3], 0
v_mfma_f32_16x16x32_bf16 v[140:143], a[80:83], a[16:19], 0
v_mfma_f32_16x16x32_bf16 v[148:151], a[80:83], a[32:35], 0
v_mfma_f32_16x16x32_bf16 v[156:159], a[80:83], a[48:51], 0
v_mfma_f32_16x16x32_bf16 v[132:135], a[84:87], a[4:7], v[132:135]
v_mfma_f32_16x16x32_bf16 v[140:143], a[84:87], a[20:23], v[140:143]
v_mfma_f32_16x16x32_bf16 v[148:151], a[84:87], a[36:39], v[148:151]
v_mfma_f32_16x16x32_bf16 v[156:159], a[84:87], a[52:55], v[156:159]
v_mfma_f32_16x16x32_bf16 v[132:135], a[88:91], a[8:11], v[132:135]
v_mfma_f32_16x16x32_bf16 v[140:143], a[88:91], a[24:27], v[140:143]
v_mfma_f32_16x16x32_bf16 v[148:151], a[88:91], a[40:43], v[148:151]
v_mfma_f32_16x16x32_bf16 v[156:159], a[88:91], a[56:59], v[156:159]
v_mfma_f32_16x16x32_bf16 v[132:135], a[92:95], a[12:15], v[132:135]
v_mfma_f32_16x16x32_bf16 v[140:143], a[92:95], a[28:31], v[140:143]
v_mfma_f32_16x16x32_bf16 v[148:151], a[92:95], a[44:47], v[148:151]
v_mfma_f32_16x16x32_bf16 v[156:159], a[92:95], a[60:63], v[156:159]
s_nop 7
v_max3_f32 v224, v224, v128, v129
v_max3_f32 v224, v224, v130, v131
v_max3_f32 v224, v224, v132, v133
v_max3_f32 v224, v224, v134, v135
v_max3_f32 v228, v228, v136, v137
v_max3_f32 v228, v228, v138, v139
v_max3_f32 v228, v228, v140, v141
v_max3_f32 v228, v228, v142, v143
v_max3_f32 v232, v232, v144, v145
v_max3_f32 v232, v232, v146, v147
v_max3_f32 v232, v232, v148, v149
v_max3_f32 v232, v232, v150, v151
v_max3_f32 v236, v236, v152, v153
v_max3_f32 v236, v236, v154, v155
v_max3_f32 v236, v236, v156, v157
v_max3_f32 v236, v236, v158, v159
s_add_u32 s4, s4, 16384
s_addc_u32 s5, s5, 0
s_add_u32 s6, s6, 16384
s_addc_u32 s7, s7, 0
s_add_u32 s34, s34, 1
s_cmp_lt_u32 s34, 32
s_cbranch_scc1 L_m_fbloop
v_mov_b32 v225, v224
s_nop 1
v_permlane16_swap_b32 v224, v225
s_nop 1
v_max_f32 v224, v224, v225
v_mov_b32 v225, v224
s_nop 1
v_permlane32_swap_b32 v224, v225
s_nop 1
v_max_f32 v224, v224, v225
v_mov_b32 v229, v228
s_nop 1
v_permlane16_swap_b32 v228, v229
s_nop 1
v_max_f32 v228, v228, v229
v_mov_b32 v229, v228
s_nop 1
v_permlane32_swap_b32 v228, v229
s_nop 1
v_max_f32 v228, v228, v229
v_mov_b32 v233, v232
s_nop 1
v_permlane16_swap_b32 v232, v233
s_nop 1
v_max_f32 v232, v232, v233
v_mov_b32 v233, v232
s_nop 1
v_permlane32_swap_b32 v232, v233
s_nop 1
v_max_f32 v232, v232, v233
v_mov_b32 v237, v236
s_nop 1
v_permlane16_swap_b32 v236, v237
s_nop 1
v_max_f32 v236, v236, v237
v_mov_b32 v237, v236
s_nop 1
v_permlane32_swap_b32 v236, v237
s_nop 1
v_max_f32 v236, v236, v237
v_sub_f32 v224, 0, v224
v_mov_b32 v225, v224
v_mov_b32 v226, v224
v_mov_b32 v227, v224
v_sub_f32 v228, 0, v228
v_mov_b32 v229, v228
v_mov_b32 v230, v228
v_mov_b32 v231, v228
v_sub_f32 v232, 0, v232
v_mov_b32 v233, v232
v_mov_b32 v234, v232
v_mov_b32 v235, v232
v_sub_f32 v236, 0, v236
v_mov_b32 v237, v236
v_mov_b32 v238, v236
v_mov_b32 v239, v236
s_barrier
s_add_u32 m0, s31, 0
s_add_u32 s4, s46, 896
s_addc_u32 s5, s47, 0
s_add_u32 s6, s46, 0
s_addc_u32 s7, s47, 0
global_load_lds_dwordx4 v248, s[4:5] offset:0
global_load_lds_dwordx4 v248, s[6:7] offset:1024
global_load_lds_dwordx4 v248, s[4:5] offset:2048
global_load_lds_dwordx4 v248, s[6:7] offset:3072
s_add_u32 m0, s31, 16384
s_add_u32 s4, s46, 17280
s_addc_u32 s5, s47, 0
s_add_u32 s6, s46, 16384
s_addc_u32 s7, s47, 0
global_load_lds_dwordx4 v248, s[4:5] offset:0
global_load_lds_dwordx4 v248, s[6:7] offset:1024
global_load_lds_dwordx4 v248, s[4:5] offset:2048
global_load_lds_dwordx4 v248, s[6:7] offset:3072
s_add_u32 m0, s31, 32768
s_add_u32 s4, s46, 33664
s_addc_u32 s5, s47, 0
s_add_u32 s6, s46, 32768
s_addc_u32 s7, s47, 0
global_load_lds_dwordx4 v248, s[4:5] offset:0
global_load_lds_dwordx4 v248, s[6:7] offset:1024
global_load_lds_dwordx4 v248, s[4:5] offset:2048
global_load_lds_dwordx4 v248, s[6:7] offset:3072
s_add_u32 m0, s31, 65536
s_add_u32 s8, s48, 896
s_addc_u32 s9, s49, 0
s_add_u32 s10, s48, 0
s_addc_u32 s11, s49, 0
global_load_lds_dwordx4 v248, s[8:9] offset:0
global_load_lds_dwordx4 v248, s[10:11] offset:1024
global_load_lds_dwordx4 v248, s[8:9] offset:2048
global_load_lds_dwordx4 v248, s[10:11] offset:3072
s_add_u32 m0, s31, 81920
s_add_u32 s8, s48, 17280
s_addc_u32 s9, s49, 0
s_add_u32 s10, s48, 16384
s_addc_u32 s11, s49, 0
global_load_lds_dwordx4 v248, s[8:9] offset:0
global_load_lds_dwordx4 v248, s[10:11] offset:1024
global_load_lds_dwordx4 v248, s[8:9] offset:2048
global_load_lds_dwordx4 v248, s[10:11] offset:3072
s_waitcnt vmcnt(0)
s_barrier
v_mov_b32 v244, v245
v_mov_b32 v246, v247
v_xor_b32 v249, 32, v247
s_mov_b32 s34, 12
s_mov_b32 s35, 0
s_mov_b32 s37, 49152
s_mov_b32 s39, 98304
s_add_u32 s4, s46, 50048
s_addc_u32 s5, s47, 0
s_add_u32 s6, s46, 49152
s_addc_u32 s7, s47, 0
s_add_u32 s8, s48, 33664
s_addc_u32 s9, s49, 0
s_add_u32 s10, s48, 32768
s_addc_u32 s11, s49, 0
ds_read_b128 a[64:67], v244 offset:0
ds_read_b128 a[68:71], v244 offset:512
ds_read_b128 a[72:75], v244 offset:1024
ds_read_b128 a[76:79], v244 offset:1536
ds_read_b128 a[80:83], v244 offset:4096
ds_read_b128 a[84:87], v244 offset:4608
ds_read_b128 a[88:91], v244 offset:5120
ds_read_b128 a[92:95], v244 offset:5632
v_mov_b32 v240, 0
v_mov_b32 v241, 0
v_mov_b32 v242, 0
v_mov_b32 v243, 0
s_waitcnt lgkmcnt(0)
v_mfma_f32_16x16x32_bf16 v[128:131], a[64:67], a[0:3], 0
v_mfma_f32_16x16x32_bf16 v[136:139], a[64:67], a[16:19], 0
v_mfma_f32_16x16x32_bf16 v[144:147], a[64:67], a[32:35], 0
v_mfma_f32_16x16x32_bf16 v[152:155], a[64:67], a[48:51], 0
ds_read_b128 a[64:67], v244 offset:8192
v_mfma_f32_16x16x32_bf16 v[128:131], a[68:71], a[4:7], v[128:131]
v_mfma_f32_16x16x32_bf16 v[136:139], a[68:71], a[20:23], v[136:139]
v_mfma_f32_16x16x32_bf16 v[144:147], a[68:71], a[36:39], v[144:147]
v_mfma_f32_16x16x32_bf16 v[152:155], a[68:71], a[52:55], v[152:155]
ds_read_b128 a[68:71], v244 offset:8704
v_mfma_f32_16x16x32_bf16 v[128:131], a[72:75], a[8:11], v[128:131]
v_mfma_f32_16x16x32_bf16 v[136:139], a[72:75], a[24:27], v[136:139]
v_mfma_f32_16x16x32_bf16 v[144:147], a[72:75], a[40:43], v[144:147]
v_mfma_f32_16x16x32_bf16 v[152:155], a[72:75], a[56:59], v[152:155]
ds_read_b128 a[72:75], v244 offset:9216
v_mfma_f32_16x16x32_bf16 v[128:131], a[76:79], a[12:15], v[128:131]
v_mfma_f32_16x16x32_bf16 v[136:139], a[76:79], a[28:31], v[136:139]
v_mfma_f32_16x16x32_bf16 v[144:147], a[76:79], a[44:47], v[144:147]
v_mfma_f32_16x16x32_bf16 v[152:155], a[76:79], a[60:63], v[152:155]
ds_read_b128 a[76:79], v244 offset:9728
v_mfma_f32_16x16x32_bf16 v[132:135], a[80:83], a[0:3], 0
v_mfma_f32_16x16x32_bf16 v[140:143], a[80:83], a[16:19], 0
v_mfma_f32_16x16x32_bf16 v[148:151], a[80:83], a[32:35], 0
v_mfma_f32_16x16x32_bf16 v[156:159], a[80:83], a[48:51], 0
ds_read_b128 a[80:83], v244 offset:12288
v_mfma_f32_16x16x32_bf16 v[132:135], a[84:87], a[4:7], v[132:135]
v_mfma_f32_16x16x32_bf16 v[140:143], a[84:87], a[20:23], v[140:143]
v_mfma_f32_16x16x32_bf16 v[148:151], a[84:87], a[36:39], v[148:151]
v_mfma_f32_16x16x32_bf16 v[156:159], a[84:87], a[52:55], v[156:159]
ds_read_b128 a[84:87], v244 offset:12800
v_mfma_f32_16x16x32_bf16 v[132:135], a[88:91], a[8:11], v[132:135]
v_mfma_f32_16x16x32_bf16 v[140:143], a[88:91], a[24:27], v[140:143]
v_mfma_f32_16x16x32_bf16 v[148:151], a[88:91], a[40:43], v[148:151]
v_mfma_f32_16x16x32_bf16 v[156:159], a[88:91], a[56:59], v[156:159]
v_mfma_f32_16x16x32_bf16 v[132:135], a[92:95], a[12:15], v[132:135]
v_mfma_f32_16x16x32_bf16 v[140:143], a[92:95], a[28:31], v[140:143]
v_mfma_f32_16x16x32_bf16 v[148:151], a[92:95], a[44:47], v[148:151]
v_mfma_f32_16x16x32_bf16 v[156:159], a[92:95], a[60:63], v[156:159]
s_nop 7
s_branch L_m_havemax
L_m_end:
s_endpgm
.section .rodata,"a"
.p2align 6
.amdhsa_kernel adaLN_cond__mha_block_cached__glu_gated_reglu__prompt_kernel
  .amdhsa_next_free_vgpr 512
  .amdhsa_next_free_sgpr 102
  .amdhsa_accum_offset 256
  .amdhsa_group_segment_fixed_size 0
  .amdhsa_kernarg_size 112
  .amdhsa_user_sgpr_count 2
  .amdhsa_user_sgpr_kernarg_segment_ptr 1
  .amdhsa_system_sgpr_workgroup_id_x 1
  .amdhsa_float_denorm_mode_32 3
  .amdhsa_float_denorm_mode_16_64 3
  .amdhsa_ieee_mode 0
  .amdhsa_dx10_clamp 0
.end_amdhsa_kernel
```
